```python
import torch

def _softmax(x, axis=-1):
    return torch.softmax(x, dim=axis)
def _gelu(x):
    return torch.nn.functional.gelu(x, approximate="tanh")
def _silu(x):
    return torch.nn.functional.silu(x)
def _sigmoid(x):
    return torch.sigmoid(x)
def _layernorm(x, axis=-1, eps=1e-5):
    m = x.mean(dim=axis, keepdim=True)
    v = x.var(dim=axis, keepdim=True, unbiased=False)
    return (x - m) / torch.sqrt(v + eps)
def _scatter_add(tgt, idx, src, axis=0):
    return tgt.clone().index_add_(axis, idx, src)
def _segment_sum(src, seg, n):
    out = torch.zeros((n,) + src.shape[1:], dtype=src.dtype)
    return out.index_add_(0, seg, src)
def _pad(x, pw):
    flat = tuple(v for pair in reversed(pw) for v in pair)
    return torch.nn.functional.pad(x, flat)

kernel_name = 'recurrent_scan__linear_attn_block__swiglu_ffn__prompt'

def setup_inputs():

    _w = (lambda a: (lambda t: t.to(torch.bfloat16) if t.is_floating_point() else t)(torch.as_tensor(a)))
    def _A_setup():
        B, S, D = 1, 2048, 640
        return {
            "x": _w((lambda *s: torch.randn(*s, dtype=torch.bfloat16) * 0.05)(B, S, D)),
            "wqkv": _w((lambda *s: torch.randn(*s, dtype=torch.bfloat16) * 0.05)(D, 3 * D)),
            "wo": _w((lambda *s: torch.randn(*s, dtype=torch.bfloat16) * 0.05)(D, D)),
        }
    _A_in = _A_setup()

    def _B_setup():
        B, S, D, F = 1, 2048, 640, 1728
        return {
            "x": _w((lambda *s: torch.randn(*s, dtype=torch.bfloat16) * 0.05)(B, S, D)),
            "w_gate": _w((lambda *s: torch.randn(*s, dtype=torch.bfloat16) * 0.05)(D, F)),
            "w_up": _w((lambda *s: torch.randn(*s, dtype=torch.bfloat16) * 0.05)(D, F)),
            "w_down": _w((lambda *s: torch.randn(*s, dtype=torch.bfloat16) * 0.05)(F, D)),
        }
    _B_in = _B_setup()

    return {
        "A_x": _A_in["x"],
        "A_wqkv": _A_in["wqkv"],
        "A_wo": _A_in["wo"],
        "B_x": _B_in["x"],
        "B_w_gate": _B_in["w_gate"],
        "B_w_up": _B_in["w_up"],
        "B_w_down": _B_in["w_down"],
    }

def reference(A_x, A_wqkv, A_wo, B_x, B_w_gate, B_w_up, B_w_down):
    def _A_ref(x, wqkv, wo):
        B, S, D = x.shape
        H = 32; Dh = D // H
        qkv = (lambda x, *d: x.permute(*d))((x @ wqkv).reshape(B, S, 3, H, Dh), 2, 0, 3, 1, 4)
        q, k, v = qkv[0], qkv[1], qkv[2]
        phi = lambda t: torch.where(t > 0, t + 1, torch.exp(t)) + 1e-6
        pq, pk = phi(q), phi(k)
        kv = torch.einsum("bhsd,bhse->bhde", pk, v)
        z = torch.einsum("bhsd->bhd", pk)
        num = torch.einsum("bhqd,bhde->bhqe", pq, kv)
        den = torch.einsum("bhqd,bhd->bhq", pq, z)[..., None] + 1e-6
        o = num / den
        return (lambda x, *d: x.permute(*d))(o, 0, 2, 1, 3).reshape(B, S, D) @ wo

    def _B_ref(x, w_gate, w_up, w_down):
        g = _silu(x @ w_gate)
        u = x @ w_up
        return (g * u) @ w_down

    x = A_x
    xn = _layernorm(x, axis=-1)
    s = _A_ref(xn, A_wqkv, A_wo)
    g = _silu(_B_ref(xn, B_w_gate, B_w_up, B_w_down))
    return x + s * g
```

```asm
; @launch grid=(256,1,1) block=(256,1,1) lds=163840
.amdgcn_target "amdgcn-amd-amdhsa--gfx950"
.text
  .globl recurrent_scan__linear_attn_block__swiglu_ffn__prompt_kernel
  .p2align 8
  .type recurrent_scan__linear_attn_block__swiglu_ffn__prompt_kernel,@function
recurrent_scan__linear_attn_block__swiglu_ffn__prompt_kernel:
  s_load_dwordx16 s[24:39], s[0:1], 0
  s_load_dwordx4 s[40:43], s[0:1], 64
  s_cmp_ge_u32 s2, 256
  s_cbranch_scc1 L_end
  v_lshrrev_b32 v1, 6, v0
  v_and_b32 v0, 63, v0
  s_and_b32 s64, s2, 1
  v_readfirstlane_b32 s3, v1
  s_bfe_u32 s65, s2, 0x20003
  s_lshl2_add_u32 s4, s64, s65
  s_bfe_u32 s66, s2, 0x20001
  s_lshr_b32 s67, s2, 5
  s_lshl1_add_u32 s71, s65, s64
  s_add_u32 s71, s71, s66
  s_and_b32 s71, s71, 3
  s_lshl_b32 s72, s71, 2
  s_lshr_b32 s50, 0x7520, s72
  s_and_b32 s50, s50, 15
  s_lshr_b32 s65, s65, 1
  s_getpc_b64 s[74:75]
L_pc_1:
  s_lshr_b32 s76, s2, 3
  s_lshl2_add_u32 s76, s76, s3
  v_lshrrev_b32 v61, 3, v0
  v_lshl_add_u32 v61, v61, 7, s76
  v_min_u32 v61, (L_end-L_pc_1)/128, v61
  v_lshlrev_b32 v61, 7, v61
  global_load_dword a255, v61, s[74:75]
  s_and_b32 s69, s66, 2
  s_lshl2_add_u32 s68, s66, s69
  s_add_u32 s5, s68, s67
  s_lshl1_add_u32 s68, s66, s67
  s_sub_u32 s68, s68, 4
  s_cmp_ge_u32 s67, 4
  s_cselect_b32 s5, s68, s5
  s_cselect_b32 s6, 1, 0
  s_cmp_ge_u32 s67, 6
  s_cselect_b32 s5, s66, s5
  s_cselect_b32 s6, 2, s6
  s_lshr_b32 s68, s66, 1
  s_xor_b32 s69, s66, s65
  s_add_u32 s68, s68, 8
  s_bitcmp0_b32 s69, 0
  s_cselect_b32 s69, 3, 0
  s_cmp_eq_u32 s67, 7
  s_cselect_b32 s5, s68, s5
  s_cselect_b32 s6, s69, s6
  s_cmp_eq_u32 s6, 3
  s_cbranch_scc1 L_helper
  s_and_b32 s68, s67, 1
  s_mul_i32 s69, s68, 10240
  s_lshl_b32 s70, s50, 7
  s_add_u32 s70, s70, s69
  v_lshrrev_b32 v20, 3, v0
  v_mul_u32_u24 v20, 1280, v20
  v_lshrrev_b32 v22, 4, v0
  v_lshl_add_u32 v22, s68, 2, v22
  v_and_b32 v21, 7, v0
  v_xor_b32 v21, v21, v22
  v_lshlrev_b32 v21, 4, v21
  v_add3_u32 v2, v21, v20, s70
  s_mul_i32 s69, s69, -2
  s_add_u32 s69, s69, 10240
  v_xor_b32 v21, 64, v2
  v_add_u32 v3, s69, v21
  s_lshl2_add_u32 s64, s4, s3
  s_lshr_b32 s69, s67, 1
  s_lshl2_add_u32 s64, s64, s69
  s_mul_i32 s44, s64, 20480
  s_lshl3_add_u32 s49, s3, s67
  s_lshl_b32 s49, s49, 10
  s_mov_b32 s10, 2621440
  s_mov_b32 s11, 0x00020000
  s_mul_i32 s68, s5, 192
  s_mul_i32 s69, s5, 160
  s_and_b32 s69, s69, 0xffffffc0
  s_add_u32 s69, s69, 1280
  s_mul_i32 s70, s5, 320
  s_cmp_eq_u32 s6, 1
  s_cselect_b32 s69, s69, s70
  s_cselect_b32 s70, 40, 4
  s_cmp_eq_u32 s6, 0
  s_cselect_b32 s69, s68, s69
  s_cselect_b32 s70, 0, s70
  s_cselect_b32 s58, 27, 30
  s_lshl_b32 s58, s58, 7
  s_lshl2_add_u32 s68, s50, s3
  s_lshl1_add_u32 s68, s68, s65
  v_bfe_u32 v24, v0, 2, 3
  v_lshl_add_u32 v24, s68, 3, v24
  v_mul_lo_u32 v24, v24, s58
  v_and_b32 v25, 32, v0
  v_mad_u32_u24 v24, v25, s70, v24
  v_and_b32 v25, 3, v0
  s_lshl_b32 s68, s65, 1
  v_xor_b32 v25, s68, v25
  v_lshlrev_b32 v25, 4, v25
  v_add3_u32 v26, v25, v24, s69
  s_sub_u32 s68, 1, s68
  s_mul_i32 s68, s68, s58
  v_xor_b32 v28, 32, v26
  v_lshl_add_u32 v28, s68, 3, v28
  v_mov_b32 v27, 0
  v_mov_b32 v29, 0
  s_lshl1_add_u32 s98, s3, s65
  s_lshl_b32 s98, s98, 10
  s_xor_b32 s99, s98, 1024
  s_mov_b32 m0, s49
  s_cmp_eq_u32 s6, 0
  s_waitcnt lgkmcnt(0)
  s_mov_b64 s[8:9], s[24:25]
  buffer_load_dwordx4 v2, s[8:11], s44 offen lds
  s_cselect_b64 s[68:69], s[32:33], s[26:27]
  s_cselect_b64 s[72:73], s[34:35], s[26:27]
  v_lshl_add_u64 v[4:5], v[26:27], 0, s[68:69]
  v_lshl_add_u64 v[6:7], v[28:29], 0, s[68:69]
  s_mov_b32 exec_lo, 0
  v_lshl_add_u64 v[4:5], v[26:27], 0, s[72:73]
  v_lshl_add_u64 v[6:7], v[28:29], 0, s[72:73]
  s_mov_b64 exec, -1
  s_add_u32 m0, s98, 65536
  s_nop 0
  global_load_lds_dwordx4 v[4:5], off offset:0
  s_add_u32 m0, s98, 73664
  s_nop 0
  global_load_lds_dwordx4 v[4:5], off offset:64
  s_add_u32 m0, s98, 81792
  s_nop 0
  global_load_lds_dwordx4 v[4:5], off offset:128
  s_xor_b32 s68, s64, 1
  s_mul_i32 s45, s68, 20480
  s_xor_b32 s68, s64, 2
  s_mul_i32 s46, s68, 20480
  s_xor_b32 s68, s64, 3
  s_mul_i32 s47, s68, 20480
  s_lshl_b32 s52, s58, 6
  s_mov_b32 s53, 0
  s_mul_i32 s54, s52, -9
  s_mov_b32 s55, -1
  s_cmp_eq_u32 s50, 9
  s_cselect_b64 s[56:57], s[54:55], s[52:53]
  s_cselect_b32 s51, -18, 2
  v_lshl_add_u64 v[4:5], v[4:5], 0, s[56:57]
  s_xor_b32 m0, s49, 2048
  s_nop 0
  buffer_load_dwordx4 v2, s[8:11], s45 offen lds
  s_xor_b32 m0, s49, 4096
  s_nop 0
  buffer_load_dwordx4 v2, s[8:11], s46 offen lds
  s_xor_b32 m0, s49, 6144
  s_nop 0
  buffer_load_dwordx4 v2, s[8:11], s47 offen lds
  s_load_dword s62, s[42:43], 32768
  s_mov_b32 s12, s42
  s_mov_b32 s13, s43
  s_mov_b32 s14, 50331648
  s_mov_b32 s15, 0x00020000
  s_mov_b32 s16, s38
  s_mov_b32 s17, s39
  s_mov_b32 s18, 2621440
  s_mov_b32 s19, 0x00020000
  s_cmp_eq_u32 s65, 1
  s_cselect_b32 s20, 0, 0x3f803f80
  s_cselect_b32 s21, 0x3f803f80, 0
  s_bitcmp1_b32 s71, 0
  s_cselect_b32 s22, s20, 0
  s_lshl_b32 s68, s6, 3
  s_lshr_b32 s68, 0x161a1200, s68
  s_and_b32 s68, s68, 0xff
  s_add_u32 s7, s68, s5
  s_mul_i32 s68, s4, 32
  s_add_u32 s68, s68, s7
  s_lshl_b32 s69, s3, 9
  s_add_u32 s68, s68, s69
  s_lshl_b32 s68, s68, 7
  s_cmp_eq_u32 s6, 9
  s_cselect_b32 s69, 0, s3
  s_cmp_eq_u32 s69, 0
  s_cselect_b32 s68, s68, 1073741824
  v_lshrrev_b32 v1, 5, v0
  v_lshlrev_b32 v59, 4, v0
  v_lshl_add_u32 v1, v1, 28, v0
  v_lshl_add_u32 v1, v1, 2, s68
  v_add_u32 v60, 4096, v59
  s_bfe_u32 s68, s2, 0x20001
  s_bfe_u32 s69, s2, 0x30003
  s_lshl3_add_u32 s80, s68, s69
  s_and_b32 s68, s2, 1
  s_lshr_b32 s69, s2, 6
  s_lshl2_add_u32 s81, s68, s69
  s_lshl4_add_u32 s82, s80, s3
  s_mul_i32 s82, s82, 19456
  s_add_u32 s82, s82, 5242880
  s_lshl3_add_u32 s83, s3, s81
  s_mul_i32 s83, s83, 5120
  s_add_u32 s83, s83, 1048576
  s_lshl_b32 s48, s3, 13
  v_and_b32 v20, 15, v0
  v_lshrrev_b32 v21, 1, v20
  v_lshrrev_b32 v22, 4, v0
  v_xor_b32 v21, v21, v22
  v_lshlrev_b32 v20, 7, v20
  v_add_u32 v20, s48, v20
  v_lshl_add_u32 v8, v21, 4, v20
  v_xor_b32 v21, 4, v21
  v_lshl_add_u32 v9, v21, 4, v20
  v_lshrrev_b32 v21, 4, v0
  v_bfe_u32 v22, v0, 2, 2
  v_lshlrev_b32 v20, 10, v21
  v_lshl_add_u32 v20, v22, 6, v20
  v_add_u32 v20, 65536, v20
  v_and_b32 v21, 1, v21
  v_lshlrev_b32 v21, 5, v21
  v_and_b32 v22, 3, v0
  s_and_b32 s64, s3, 1
  s_mul_i32 s64, s64, 96
  s_lshr_b32 s65, s3, 1
  s_lshl_b32 s65, s65, 9
  v_lshl_add_u32 v23, v22, 3, s64
  v_add_u32 v23, 0, v23
  v_lshrrev_b32 v24, 6, v23
  v_and_b32 v25, 63, v23
  v_xor_b32 v25, v25, v21
  v_lshl_add_u32 v24, v24, 13, v20
  v_add_u32 v56, v24, v25
  v_add_u32 v56, s65, v56
  v_lshl_add_u32 v23, v22, 3, s64
  v_add_u32 v23, 32, v23
  v_lshrrev_b32 v24, 6, v23
  v_and_b32 v25, 63, v23
  v_xor_b32 v25, v25, v21
  v_lshl_add_u32 v24, v24, 13, v20
  v_add_u32 v57, v24, v25
  v_add_u32 v57, s65, v57
  v_lshl_add_u32 v23, v22, 3, s64
  v_add_u32 v23, 64, v23
  v_lshrrev_b32 v24, 6, v23
  v_and_b32 v25, 63, v23
  v_xor_b32 v25, v25, v21
  v_lshl_add_u32 v24, v24, 13, v20
  v_add_u32 v58, v24, v25
  v_add_u32 v58, s65, v58
  v_mov_b32 v52, s20
  v_mov_b32 v53, s20
  v_mov_b32 v54, s20
  v_mov_b32 v55, s20
  v_lshl_add_u32 v2, s51, 6, v2
  s_add_u32 m0, s99, 65536
  s_nop 0
  global_load_lds_dwordx4 v[6:7], off offset:0
  s_add_u32 m0, s99, 73664
  s_nop 0
  global_load_lds_dwordx4 v[6:7], off offset:64
  s_add_u32 m0, s99, 81792
  s_nop 0
  global_load_lds_dwordx4 v[6:7], off offset:128
  v_lshl_add_u64 v[6:7], v[6:7], 0, s[56:57]
  s_xor_b32 m0, s49, 1024
  s_nop 0
  buffer_load_dwordx4 v3, s[8:11], s44 offen lds
  s_xor_b32 m0, s49, 3072
  s_nop 0
  buffer_load_dwordx4 v3, s[8:11], s45 offen lds
  s_xor_b32 m0, s49, 5120
  s_nop 0
  buffer_load_dwordx4 v3, s[8:11], s46 offen lds
  s_xor_b32 m0, s49, 7168
  s_nop 0
  buffer_load_dwordx4 v3, s[8:11], s47 offen lds
  v_lshl_add_u32 v3, s51, 6, v3
  s_cmp_eq_u32 s6, 1
  s_cbranch_scc1 L_kv
  s_cmp_eq_u32 s6, 2
  s_cbranch_scc1 L_q
  s_branch L_ffn
L_helper:
  s_waitcnt lgkmcnt(0)
  s_load_dword s62, s[42:43], 32768
  s_mov_b32 s8, s24
  s_mov_b32 s9, s25
  s_mov_b32 s10, 2621440
  s_mov_b32 s11, 0x00020000
  v_mov_b32 v237, 0
  v_mov_b32 v236, 0x3f803f80
  v_lshrrev_b32 v239, 2, v0
  v_lshlrev_b32 v238, 3, v239
  v_mul_u32_u24 v239, 1280, v239
  v_and_b32 v240, 3, v0
  v_lshl_add_u32 v239, v240, 4, v239
  v_lshl_add_u32 v238, v240, 27, v238
  s_lshl_b32 s64, s4, 2
  s_and_b32 s65, s5, 1
  s_add_u32 s64, s64, s65
  s_lshl_b32 s64, s64, 2
  s_add_u32 s64, s64, s3
  s_lshl_b32 s64, s64, 4
  s_add_u32 s65, s64, 128
  s_mul_i32 s66, s64, 1280
  s_mul_i32 s67, s65, 1280
  buffer_load_dwordx4 v[88:91], v239, s[8:11], s66 offen offset:384
  buffer_load_dwordx4 v[92:95], v239, s[8:11], s66 offen offset:448
  buffer_load_dwordx4 v[128:131], v239, s[8:11], s66 offen offset:1024
  buffer_load_dwordx4 v[132:135], v239, s[8:11], s66 offen offset:1088
  buffer_load_dwordx4 v[168:171], v239, s[8:11], s67 offen offset:384
  buffer_load_dwordx4 v[172:175], v239, s[8:11], s67 offen offset:448
  buffer_load_dwordx4 v[208:211], v239, s[8:11], s67 offen offset:1024
  buffer_load_dwordx4 v[212:215], v239, s[8:11], s67 offen offset:1088
  buffer_load_dwordx4 v[64:67], v239, s[8:11], s66 offen offset:0
  buffer_load_dwordx4 v[68:71], v239, s[8:11], s66 offen offset:64
  buffer_load_dwordx4 v[72:75], v239, s[8:11], s66 offen offset:128
  buffer_load_dwordx4 v[76:79], v239, s[8:11], s66 offen offset:192
  buffer_load_dwordx4 v[80:83], v239, s[8:11], s66 offen offset:256
  buffer_load_dwordx4 v[84:87], v239, s[8:11], s66 offen offset:320
  buffer_load_dwordx4 v[96:99], v239, s[8:11], s66 offen offset:512
  buffer_load_dwordx4 v[100:103], v239, s[8:11], s66 offen offset:576
  buffer_load_dwordx4 v[104:107], v239, s[8:11], s66 offen offset:640
  buffer_load_dwordx4 v[108:111], v239, s[8:11], s66 offen offset:704
  buffer_load_dwordx4 v[112:115], v239, s[8:11], s66 offen offset:768
  buffer_load_dwordx4 v[116:119], v239, s[8:11], s66 offen offset:832
  buffer_load_dwordx4 v[120:123], v239, s[8:11], s66 offen offset:896
  buffer_load_dwordx4 v[124:127], v239, s[8:11], s66 offen offset:960
  buffer_load_dwordx4 v[136:139], v239, s[8:11], s66 offen offset:1152
  buffer_load_dwordx4 v[140:143], v239, s[8:11], s66 offen offset:1216
  buffer_load_dwordx4 v[144:147], v239, s[8:11], s67 offen offset:0
  buffer_load_dwordx4 v[148:151], v239, s[8:11], s67 offen offset:64
  buffer_load_dwordx4 v[152:155], v239, s[8:11], s67 offen offset:128
  buffer_load_dwordx4 v[156:159], v239, s[8:11], s67 offen offset:192
  buffer_load_dwordx4 v[160:163], v239, s[8:11], s67 offen offset:256
  buffer_load_dwordx4 v[164:167], v239, s[8:11], s67 offen offset:320
  buffer_load_dwordx4 v[176:179], v239, s[8:11], s67 offen offset:512
  buffer_load_dwordx4 v[180:183], v239, s[8:11], s67 offen offset:576
  buffer_load_dwordx4 v[184:187], v239, s[8:11], s67 offen offset:640
  buffer_load_dwordx4 v[188:191], v239, s[8:11], s67 offen offset:704
  buffer_load_dwordx4 v[192:195], v239, s[8:11], s67 offen offset:768
  buffer_load_dwordx4 v[196:199], v239, s[8:11], s67 offen offset:832
  buffer_load_dwordx4 v[200:203], v239, s[8:11], s67 offen offset:896
  buffer_load_dwordx4 v[204:207], v239, s[8:11], s67 offen offset:960
  buffer_load_dwordx4 v[216:219], v239, s[8:11], s67 offen offset:1152
  buffer_load_dwordx4 v[220:223], v239, s[8:11], s67 offen offset:1216
  s_mov_b32 s12, s42
  s_mov_b32 s13, s43
  s_mov_b32 s14, 50331648
  s_mov_b32 s15, 0x00020000
  s_mov_b32 s16, s38
  s_mov_b32 s17, s39
  s_mov_b32 s18, 2621440
  s_mov_b32 s19, 0x00020000
  s_lshl_b32 s68, s6, 3
  s_lshr_b32 s68, 0x161a1200, s68
  s_and_b32 s68, s68, 0xff
  s_add_u32 s7, s68, s5
  s_mul_i32 s68, s4, 32
  s_add_u32 s68, s68, s7
  s_lshl_b32 s69, s3, 9
  s_add_u32 s68, s68, s69
  s_lshl_b32 s68, s68, 7
  s_cmp_eq_u32 s6, 9
  s_cselect_b32 s69, 0, s3
  s_cmp_eq_u32 s69, 0
  s_cselect_b32 s68, s68, 1073741824
  v_lshrrev_b32 v1, 5, v0
  v_lshlrev_b32 v59, 4, v0
  v_lshl_add_u32 v1, v1, 28, v0
  v_lshl_add_u32 v1, v1, 2, s68
  v_add_u32 v60, 4096, v59
  s_bfe_u32 s68, s2, 0x20001
  s_bfe_u32 s69, s2, 0x30003
  s_lshl3_add_u32 s80, s68, s69
  s_and_b32 s68, s2, 1
  s_lshr_b32 s69, s2, 6
  s_lshl2_add_u32 s81, s68, s69
  s_lshl4_add_u32 s82, s80, s3
  s_mul_i32 s82, s82, 19456
  s_add_u32 s82, s82, 5242880
  s_lshl3_add_u32 s83, s3, s81
  s_mul_i32 s83, s83, 5120
  s_add_u32 s83, s83, 1048576
  s_lshl_b32 s48, s3, 13
  s_lshl1_add_u32 s5, s4, s5
  s_sub_u32 s5, s5, 8
  v_lshrrev_b32 v8, 5, v0
  v_bfe_u32 v9, v0, 3, 2
  v_mov_b32 v10, 1280
  v_lshrrev_b32 v11, 1, v9
  s_and_b32 s68, s3, 1
  s_lshl_b32 s68, s68, 1
  v_add_u32 v11, s68, v11
  v_lshlrev_b32 v11, 1, v11
  v_and_b32 v12, 7, v0
  v_xor_b32 v11, v11, v12
  v_lshlrev_b32 v11, 4, v11
  v_bfe_u32 v12, v0, 3, 2
  v_xor_b32 v12, s3, v12
  v_lshlrev_b32 v12, 5, v12
  v_and_b32 v13, 3, v0
  v_lshl_add_u32 v12, v13, 3, v12
  v_bfe_u32 v13, v0, 2, 2
  v_lshl_add_u32 v12, v13, 7, v12
  v_lshrrev_b32 v13, 4, v0
  v_lshl_add_u32 v12, v13, 10, v12
  s_waitcnt lgkmcnt(0)
  s_and_b32 s61, s62, -8
  s_add_u32 s61, s61, 8
  v_mov_b32 v240, 0
  v_mov_b32 v241, 0
  v_mov_b32 v242, 0
  v_mov_b32 v243, 0
  v_mov_b32 v244, 0
  v_mov_b32 v245, 0
  v_mov_b32 v246, 0
  v_mov_b32 v247, 0
  s_waitcnt vmcnt(31)
  v_dot2c_f32_bf16 v240, v64, v236
  v_dot2c_f32_bf16 v244, v64, v64
  v_dot2c_f32_bf16 v241, v65, v236
  v_dot2c_f32_bf16 v245, v65, v65
  v_dot2c_f32_bf16 v242, v66, v236
  v_dot2c_f32_bf16 v246, v66, v66
  v_dot2c_f32_bf16 v243, v67, v236
  v_dot2c_f32_bf16 v247, v67, v67
  s_waitcnt vmcnt(30)
  v_dot2c_f32_bf16 v240, v68, v236
  v_dot2c_f32_bf16 v244, v68, v68
  v_dot2c_f32_bf16 v241, v69, v236
  v_dot2c_f32_bf16 v245, v69, v69
  v_dot2c_f32_bf16 v242, v70, v236
  v_dot2c_f32_bf16 v246, v70, v70
  v_dot2c_f32_bf16 v243, v71, v236
  v_dot2c_f32_bf16 v247, v71, v71
  s_waitcnt vmcnt(29)
  v_dot2c_f32_bf16 v240, v72, v236
  v_dot2c_f32_bf16 v244, v72, v72
  v_dot2c_f32_bf16 v241, v73, v236
  v_dot2c_f32_bf16 v245, v73, v73
  v_dot2c_f32_bf16 v242, v74, v236
  v_dot2c_f32_bf16 v246, v74, v74
  v_dot2c_f32_bf16 v243, v75, v236
  v_dot2c_f32_bf16 v247, v75, v75
  s_waitcnt vmcnt(28)
  v_dot2c_f32_bf16 v240, v76, v236
  v_dot2c_f32_bf16 v244, v76, v76
  v_dot2c_f32_bf16 v241, v77, v236
  v_dot2c_f32_bf16 v245, v77, v77
  v_dot2c_f32_bf16 v242, v78, v236
  v_dot2c_f32_bf16 v246, v78, v78
  v_dot2c_f32_bf16 v243, v79, v236
  v_dot2c_f32_bf16 v247, v79, v79
  s_waitcnt vmcnt(27)
  v_dot2c_f32_bf16 v240, v80, v236
  v_dot2c_f32_bf16 v244, v80, v80
  v_dot2c_f32_bf16 v241, v81, v236
  v_dot2c_f32_bf16 v245, v81, v81
  v_dot2c_f32_bf16 v242, v82, v236
  v_dot2c_f32_bf16 v246, v82, v82
  v_dot2c_f32_bf16 v243, v83, v236
  v_dot2c_f32_bf16 v247, v83, v83
  s_waitcnt vmcnt(26)
  v_dot2c_f32_bf16 v240, v84, v236
  v_dot2c_f32_bf16 v244, v84, v84
  v_dot2c_f32_bf16 v241, v85, v236
  v_dot2c_f32_bf16 v245, v85, v85
  v_dot2c_f32_bf16 v242, v86, v236
  v_dot2c_f32_bf16 v246, v86, v86
  v_dot2c_f32_bf16 v243, v87, v236
  v_dot2c_f32_bf16 v247, v87, v87
  v_dot2c_f32_bf16 v240, v88, v236
  v_dot2c_f32_bf16 v244, v88, v88
  v_dot2c_f32_bf16 v241, v89, v236
  v_dot2c_f32_bf16 v245, v89, v89
  v_dot2c_f32_bf16 v242, v90, v236
  v_dot2c_f32_bf16 v246, v90, v90
  v_dot2c_f32_bf16 v243, v91, v236
  v_dot2c_f32_bf16 v247, v91, v91
  v_dot2c_f32_bf16 v240, v92, v236
  v_dot2c_f32_bf16 v244, v92, v92
  v_dot2c_f32_bf16 v241, v93, v236
  v_dot2c_f32_bf16 v245, v93, v93
  v_dot2c_f32_bf16 v242, v94, v236
  v_dot2c_f32_bf16 v246, v94, v94
  v_dot2c_f32_bf16 v243, v95, v236
  v_dot2c_f32_bf16 v247, v95, v95
  s_waitcnt vmcnt(25)
  v_dot2c_f32_bf16 v240, v96, v236
  v_dot2c_f32_bf16 v244, v96, v96
  v_dot2c_f32_bf16 v241, v97, v236
  v_dot2c_f32_bf16 v245, v97, v97
  v_dot2c_f32_bf16 v242, v98, v236
  v_dot2c_f32_bf16 v246, v98, v98
  v_dot2c_f32_bf16 v243, v99, v236
  v_dot2c_f32_bf16 v247, v99, v99
  s_waitcnt vmcnt(24)
  v_dot2c_f32_bf16 v240, v100, v236
  v_dot2c_f32_bf16 v244, v100, v100
  v_dot2c_f32_bf16 v241, v101, v236
  v_dot2c_f32_bf16 v245, v101, v101
  v_dot2c_f32_bf16 v242, v102, v236
  v_dot2c_f32_bf16 v246, v102, v102
  v_dot2c_f32_bf16 v243, v103, v236
  v_dot2c_f32_bf16 v247, v103, v103
  s_waitcnt vmcnt(23)
  v_dot2c_f32_bf16 v240, v104, v236
  v_dot2c_f32_bf16 v244, v104, v104
  v_dot2c_f32_bf16 v241, v105, v236
  v_dot2c_f32_bf16 v245, v105, v105
  v_dot2c_f32_bf16 v242, v106, v236
  v_dot2c_f32_bf16 v246, v106, v106
  v_dot2c_f32_bf16 v243, v107, v236
  v_dot2c_f32_bf16 v247, v107, v107
  s_waitcnt vmcnt(22)
  v_dot2c_f32_bf16 v240, v108, v236
  v_dot2c_f32_bf16 v244, v108, v108
  v_dot2c_f32_bf16 v241, v109, v236
  v_dot2c_f32_bf16 v245, v109, v109
  v_dot2c_f32_bf16 v242, v110, v236
  v_dot2c_f32_bf16 v246, v110, v110
  v_dot2c_f32_bf16 v243, v111, v236
  v_dot2c_f32_bf16 v247, v111, v111
  s_waitcnt vmcnt(21)
  v_dot2c_f32_bf16 v240, v112, v236
  v_dot2c_f32_bf16 v244, v112, v112
  v_dot2c_f32_bf16 v241, v113, v236
  v_dot2c_f32_bf16 v245, v113, v113
  v_dot2c_f32_bf16 v242, v114, v236
  v_dot2c_f32_bf16 v246, v114, v114
  v_dot2c_f32_bf16 v243, v115, v236
  v_dot2c_f32_bf16 v247, v115, v115
  s_waitcnt vmcnt(20)
  v_dot2c_f32_bf16 v240, v116, v236
  v_dot2c_f32_bf16 v244, v116, v116
  v_dot2c_f32_bf16 v241, v117, v236
  v_dot2c_f32_bf16 v245, v117, v117
  v_dot2c_f32_bf16 v242, v118, v236
  v_dot2c_f32_bf16 v246, v118, v118
  v_dot2c_f32_bf16 v243, v119, v236
  v_dot2c_f32_bf16 v247, v119, v119
  s_waitcnt vmcnt(19)
  v_dot2c_f32_bf16 v240, v120, v236
  v_dot2c_f32_bf16 v244, v120, v120
  v_dot2c_f32_bf16 v241, v121, v236
  v_dot2c_f32_bf16 v245, v121, v121
  v_dot2c_f32_bf16 v242, v122, v236
  v_dot2c_f32_bf16 v246, v122, v122
  v_dot2c_f32_bf16 v243, v123, v236
  v_dot2c_f32_bf16 v247, v123, v123
  s_waitcnt vmcnt(18)
  v_dot2c_f32_bf16 v240, v124, v236
  v_dot2c_f32_bf16 v244, v124, v124
  v_dot2c_f32_bf16 v241, v125, v236
  v_dot2c_f32_bf16 v245, v125, v125
  v_dot2c_f32_bf16 v242, v126, v236
  v_dot2c_f32_bf16 v246, v126, v126
  v_dot2c_f32_bf16 v243, v127, v236
  v_dot2c_f32_bf16 v247, v127, v127
  v_dot2c_f32_bf16 v240, v128, v236
  v_dot2c_f32_bf16 v244, v128, v128
  v_dot2c_f32_bf16 v241, v129, v236
  v_dot2c_f32_bf16 v245, v129, v129
  v_dot2c_f32_bf16 v242, v130, v236
  v_dot2c_f32_bf16 v246, v130, v130
  v_dot2c_f32_bf16 v243, v131, v236
  v_dot2c_f32_bf16 v247, v131, v131
  v_dot2c_f32_bf16 v240, v132, v236
  v_dot2c_f32_bf16 v244, v132, v132
  v_dot2c_f32_bf16 v241, v133, v236
  v_dot2c_f32_bf16 v245, v133, v133
  v_dot2c_f32_bf16 v242, v134, v236
  v_dot2c_f32_bf16 v246, v134, v134
  v_dot2c_f32_bf16 v243, v135, v236
  v_dot2c_f32_bf16 v247, v135, v135
  s_waitcnt vmcnt(17)
  v_dot2c_f32_bf16 v240, v136, v236
  v_dot2c_f32_bf16 v244, v136, v136
  v_dot2c_f32_bf16 v241, v137, v236
  v_dot2c_f32_bf16 v245, v137, v137
  v_dot2c_f32_bf16 v242, v138, v236
  v_dot2c_f32_bf16 v246, v138, v138
  v_dot2c_f32_bf16 v243, v139, v236
  v_dot2c_f32_bf16 v247, v139, v139
  s_waitcnt vmcnt(16)
  v_dot2c_f32_bf16 v240, v140, v236
  v_dot2c_f32_bf16 v244, v140, v140
  v_dot2c_f32_bf16 v241, v141, v236
  v_dot2c_f32_bf16 v245, v141, v141
  v_dot2c_f32_bf16 v242, v142, v236
  v_dot2c_f32_bf16 v246, v142, v142
  v_dot2c_f32_bf16 v243, v143, v236
  v_dot2c_f32_bf16 v247, v143, v143
  s_nop 2
  v_add_f32 v240, v240, v241
  v_add_f32 v244, v244, v245
  v_add_f32 v242, v242, v243
  v_add_f32 v246, v246, v247
  v_add_f32 v240, v240, v242
  v_add_f32 v244, v244, v246
  s_nop 0
  v_add_f32_dpp v240, v240, v240 quad_perm:[1,0,3,2] row_mask:0xf bank_mask:0xf
  v_add_f32_dpp v244, v244, v244 quad_perm:[1,0,3,2] row_mask:0xf bank_mask:0xf
  s_nop 0
  v_add_f32_dpp v240, v240, v240 quad_perm:[2,3,0,1] row_mask:0xf bank_mask:0xf
  v_add_f32_dpp v244, v244, v244 quad_perm:[2,3,0,1] row_mask:0xf bank_mask:0xf
  v_mul_f32 v241, 0xbacccccd, v240
  v_mul_f32 v240, 0x3acccccd, v244
  v_fma_f32 v240, -v241, v241, v240
  v_cmp_gt_f32 vcc, 0, v240
  s_lshl_b32 s78, s64, 3
  s_add_u32 s78, s78, 65536
  v_cndmask_b32 v240, v240, v237, vcc
  v_cvt_pk_bf16_f32 v240, v240, v240
  v_lshlrev_b32 v240, 16, v240
  v_add_f32 v240, 0x3727c5ac, v240
  v_cvt_pk_bf16_f32 v240, v240, v240
  v_lshlrev_b32 v240, 16, v240
  v_sqrt_f32 v240, v240
  v_mov_b32 v245, s61
  v_cvt_pk_bf16_f32 v244, v240, v241
  buffer_store_dwordx2 v[244:245], v238, s[12:15], s78 offen sc1
  s_add_u32 s73, s5, 0
  s_lshl_b32 s73, s73, 3
  s_add_u32 s73, s73, s3
  s_mul_i32 s73, s73, 5120
  s_mov_b32 s16, s36
  s_mov_b32 s17, s37
  s_mov_b32 s18, 2211840
  s_mov_b32 s19, 0x00020000
  v_lshl_add_u32 v14, v8, 4, v9
  v_mad_u32_u24 v14, v14, v10, v11
  s_lshl_b32 s79, s3, 10
  s_add_u32 m0, s79, 0
  s_nop 0
  buffer_load_dwordx4 v14, s[16:19], s73 offen offset:0 lds
  s_add_u32 m0, s79, 3968
  s_nop 0
  buffer_load_dwordx4 v14, s[16:19], s73 offen offset:128 lds
  s_add_u32 m0, s79, 7936
  s_nop 0
  buffer_load_dwordx4 v14, s[16:19], s73 offen offset:256 lds
  s_add_u32 m0, s79, 11904
  s_nop 0
  buffer_load_dwordx4 v14, s[16:19], s73 offen offset:384 lds
  s_add_u32 m0, s79, 15872
  s_nop 0
  buffer_load_dwordx4 v14, s[16:19], s73 offen offset:512 lds
  s_add_u32 m0, s79, 19840
  s_nop 0
  buffer_load_dwordx4 v14, s[16:19], s73 offen offset:640 lds
  v_mov_b32 v240, 0
  v_mov_b32 v241, 0
  v_mov_b32 v242, 0
  v_mov_b32 v243, 0
  v_mov_b32 v244, 0
  v_mov_b32 v245, 0
  v_mov_b32 v246, 0
  v_mov_b32 v247, 0
  s_waitcnt vmcnt(22)
  v_dot2c_f32_bf16 v240, v144, v236
  v_dot2c_f32_bf16 v244, v144, v144
  v_dot2c_f32_bf16 v241, v145, v236
  v_dot2c_f32_bf16 v245, v145, v145
  v_dot2c_f32_bf16 v242, v146, v236
  v_dot2c_f32_bf16 v246, v146, v146
  v_dot2c_f32_bf16 v243, v147, v236
  v_dot2c_f32_bf16 v247, v147, v147
  s_waitcnt vmcnt(21)
  v_dot2c_f32_bf16 v240, v148, v236
  v_dot2c_f32_bf16 v244, v148, v148
  v_dot2c_f32_bf16 v241, v149, v236
  v_dot2c_f32_bf16 v245, v149, v149
  v_dot2c_f32_bf16 v242, v150, v236
  v_dot2c_f32_bf16 v246, v150, v150
  v_dot2c_f32_bf16 v243, v151, v236
  v_dot2c_f32_bf16 v247, v151, v151
  s_waitcnt vmcnt(20)
  v_dot2c_f32_bf16 v240, v152, v236
  v_dot2c_f32_bf16 v244, v152, v152
  v_dot2c_f32_bf16 v241, v153, v236
  v_dot2c_f32_bf16 v245, v153, v153
  v_dot2c_f32_bf16 v242, v154, v236
  v_dot2c_f32_bf16 v246, v154, v154
  v_dot2c_f32_bf16 v243, v155, v236
  v_dot2c_f32_bf16 v247, v155, v155
  s_waitcnt vmcnt(19)
  v_dot2c_f32_bf16 v240, v156, v236
  v_dot2c_f32_bf16 v244, v156, v156
  v_dot2c_f32_bf16 v241, v157, v236
  v_dot2c_f32_bf16 v245, v157, v157
  v_dot2c_f32_bf16 v242, v158, v236
  v_dot2c_f32_bf16 v246, v158, v158
  v_dot2c_f32_bf16 v243, v159, v236
  v_dot2c_f32_bf16 v247, v159, v159
  s_waitcnt vmcnt(18)
  v_dot2c_f32_bf16 v240, v160, v236
  v_dot2c_f32_bf16 v244, v160, v160
  v_dot2c_f32_bf16 v241, v161, v236
  v_dot2c_f32_bf16 v245, v161, v161
  v_dot2c_f32_bf16 v242, v162, v236
  v_dot2c_f32_bf16 v246, v162, v162
  v_dot2c_f32_bf16 v243, v163, v236
  v_dot2c_f32_bf16 v247, v163, v163
  s_waitcnt vmcnt(17)
  v_dot2c_f32_bf16 v240, v164, v236
  v_dot2c_f32_bf16 v244, v164, v164
  v_dot2c_f32_bf16 v241, v165, v236
  v_dot2c_f32_bf16 v245, v165, v165
  v_dot2c_f32_bf16 v242, v166, v236
  v_dot2c_f32_bf16 v246, v166, v166
  v_dot2c_f32_bf16 v243, v167, v236
  v_dot2c_f32_bf16 v247, v167, v167
  v_dot2c_f32_bf16 v240, v168, v236
  v_dot2c_f32_bf16 v244, v168, v168
  v_dot2c_f32_bf16 v241, v169, v236
  v_dot2c_f32_bf16 v245, v169, v169
  v_dot2c_f32_bf16 v242, v170, v236
  v_dot2c_f32_bf16 v246, v170, v170
  v_dot2c_f32_bf16 v243, v171, v236
  v_dot2c_f32_bf16 v247, v171, v171
  v_dot2c_f32_bf16 v240, v172, v236
  v_dot2c_f32_bf16 v244, v172, v172
  v_dot2c_f32_bf16 v241, v173, v236
  v_dot2c_f32_bf16 v245, v173, v173
  v_dot2c_f32_bf16 v242, v174, v236
  v_dot2c_f32_bf16 v246, v174, v174
  v_dot2c_f32_bf16 v243, v175, v236
  v_dot2c_f32_bf16 v247, v175, v175
  s_waitcnt vmcnt(16)
  v_dot2c_f32_bf16 v240, v176, v236
  v_dot2c_f32_bf16 v244, v176, v176
  v_dot2c_f32_bf16 v241, v177, v236
  v_dot2c_f32_bf16 v245, v177, v177
  v_dot2c_f32_bf16 v242, v178, v236
  v_dot2c_f32_bf16 v246, v178, v178
  v_dot2c_f32_bf16 v243, v179, v236
  v_dot2c_f32_bf16 v247, v179, v179
  s_waitcnt vmcnt(15)
  v_dot2c_f32_bf16 v240, v180, v236
  v_dot2c_f32_bf16 v244, v180, v180
  v_dot2c_f32_bf16 v241, v181, v236
  v_dot2c_f32_bf16 v245, v181, v181
  v_dot2c_f32_bf16 v242, v182, v236
  v_dot2c_f32_bf16 v246, v182, v182
  v_dot2c_f32_bf16 v243, v183, v236
  v_dot2c_f32_bf16 v247, v183, v183
  s_waitcnt vmcnt(14)
  v_dot2c_f32_bf16 v240, v184, v236
  v_dot2c_f32_bf16 v244, v184, v184
  v_dot2c_f32_bf16 v241, v185, v236
  v_dot2c_f32_bf16 v245, v185, v185
  v_dot2c_f32_bf16 v242, v186, v236
  v_dot2c_f32_bf16 v246, v186, v186
  v_dot2c_f32_bf16 v243, v187, v236
  v_dot2c_f32_bf16 v247, v187, v187
  s_waitcnt vmcnt(13)
  v_dot2c_f32_bf16 v240, v188, v236
  v_dot2c_f32_bf16 v244, v188, v188
  v_dot2c_f32_bf16 v241, v189, v236
  v_dot2c_f32_bf16 v245, v189, v189
  v_dot2c_f32_bf16 v242, v190, v236
  v_dot2c_f32_bf16 v246, v190, v190
  v_dot2c_f32_bf16 v243, v191, v236
  v_dot2c_f32_bf16 v247, v191, v191
  s_waitcnt vmcnt(12)
  v_dot2c_f32_bf16 v240, v192, v236
  v_dot2c_f32_bf16 v244, v192, v192
  v_dot2c_f32_bf16 v241, v193, v236
  v_dot2c_f32_bf16 v245, v193, v193
  v_dot2c_f32_bf16 v242, v194, v236
  v_dot2c_f32_bf16 v246, v194, v194
  v_dot2c_f32_bf16 v243, v195, v236
  v_dot2c_f32_bf16 v247, v195, v195
  s_waitcnt vmcnt(11)
  v_dot2c_f32_bf16 v240, v196, v236
  v_dot2c_f32_bf16 v244, v196, v196
  v_dot2c_f32_bf16 v241, v197, v236
  v_dot2c_f32_bf16 v245, v197, v197
  v_dot2c_f32_bf16 v242, v198, v236
  v_dot2c_f32_bf16 v246, v198, v198
  v_dot2c_f32_bf16 v243, v199, v236
  v_dot2c_f32_bf16 v247, v199, v199
  s_waitcnt vmcnt(10)
  v_dot2c_f32_bf16 v240, v200, v236
  v_dot2c_f32_bf16 v244, v200, v200
  v_dot2c_f32_bf16 v241, v201, v236
  v_dot2c_f32_bf16 v245, v201, v201
  v_dot2c_f32_bf16 v242, v202, v236
  v_dot2c_f32_bf16 v246, v202, v202
  v_dot2c_f32_bf16 v243, v203, v236
  v_dot2c_f32_bf16 v247, v203, v203
  s_waitcnt vmcnt(9)
  v_dot2c_f32_bf16 v240, v204, v236
  v_dot2c_f32_bf16 v244, v204, v204
  v_dot2c_f32_bf16 v241, v205, v236
  v_dot2c_f32_bf16 v245, v205, v205
  v_dot2c_f32_bf16 v242, v206, v236
  v_dot2c_f32_bf16 v246, v206, v206
  v_dot2c_f32_bf16 v243, v207, v236
  v_dot2c_f32_bf16 v247, v207, v207
  v_dot2c_f32_bf16 v240, v208, v236
  v_dot2c_f32_bf16 v244, v208, v208
  v_dot2c_f32_bf16 v241, v209, v236
  v_dot2c_f32_bf16 v245, v209, v209
  v_dot2c_f32_bf16 v242, v210, v236
  v_dot2c_f32_bf16 v246, v210, v210
  v_dot2c_f32_bf16 v243, v211, v236
  v_dot2c_f32_bf16 v247, v211, v211
  v_dot2c_f32_bf16 v240, v212, v236
  v_dot2c_f32_bf16 v244, v212, v212
  v_dot2c_f32_bf16 v241, v213, v236
  v_dot2c_f32_bf16 v245, v213, v213
  v_dot2c_f32_bf16 v242, v214, v236
  v_dot2c_f32_bf16 v246, v214, v214
  v_dot2c_f32_bf16 v243, v215, v236
  v_dot2c_f32_bf16 v247, v215, v215
  s_waitcnt vmcnt(8)
  v_dot2c_f32_bf16 v240, v216, v236
  v_dot2c_f32_bf16 v244, v216, v216
  v_dot2c_f32_bf16 v241, v217, v236
  v_dot2c_f32_bf16 v245, v217, v217
  v_dot2c_f32_bf16 v242, v218, v236
  v_dot2c_f32_bf16 v246, v218, v218
  v_dot2c_f32_bf16 v243, v219, v236
  v_dot2c_f32_bf16 v247, v219, v219
  s_waitcnt vmcnt(7)
  v_dot2c_f32_bf16 v240, v220, v236
  v_dot2c_f32_bf16 v244, v220, v220
  v_dot2c_f32_bf16 v241, v221, v236
  v_dot2c_f32_bf16 v245, v221, v221
  v_dot2c_f32_bf16 v242, v222, v236
  v_dot2c_f32_bf16 v246, v222, v222
  v_dot2c_f32_bf16 v243, v223, v236
  v_dot2c_f32_bf16 v247, v223, v223
  s_nop 2
  v_add_f32 v240, v240, v241
  v_add_f32 v244, v244, v245
  v_add_f32 v242, v242, v243
  v_add_f32 v246, v246, v247
  v_add_f32 v240, v240, v242
  v_add_f32 v244, v244, v246
  s_nop 0
  v_add_f32_dpp v240, v240, v240 quad_perm:[1,0,3,2] row_mask:0xf bank_mask:0xf
  v_add_f32_dpp v244, v244, v244 quad_perm:[1,0,3,2] row_mask:0xf bank_mask:0xf
  s_nop 0
  v_add_f32_dpp v240, v240, v240 quad_perm:[2,3,0,1] row_mask:0xf bank_mask:0xf
  v_add_f32_dpp v244, v244, v244 quad_perm:[2,3,0,1] row_mask:0xf bank_mask:0xf
  v_mul_f32 v241, 0xbacccccd, v240
  v_mul_f32 v240, 0x3acccccd, v244
  v_fma_f32 v240, -v241, v241, v240
  v_cmp_gt_f32 vcc, 0, v240
  s_lshl_b32 s78, s65, 3
  s_add_u32 s78, s78, 65536
  v_cndmask_b32 v240, v240, v237, vcc
  v_cvt_pk_bf16_f32 v240, v240, v240
  v_lshlrev_b32 v240, 16, v240
  v_add_f32 v240, 0x3727c5ac, v240
  v_cvt_pk_bf16_f32 v240, v240, v240
  v_lshlrev_b32 v240, 16, v240
  v_sqrt_f32 v240, v240
  v_mov_b32 v245, s61
  v_cvt_pk_bf16_f32 v244, v240, v241
  buffer_store_dwordx2 v[244:245], v238, s[12:15], s78 offen sc1
  s_add_u32 m0, s79, 23808
  s_nop 0
  buffer_load_dwordx4 v14, s[16:19], s73 offen offset:768 lds
  s_add_u32 m0, s79, 27776
  s_nop 0
  buffer_load_dwordx4 v14, s[16:19], s73 offen offset:896 lds
  s_add_u32 m0, s79, 31744
  s_nop 0
  buffer_load_dwordx4 v14, s[16:19], s73 offen offset:1024 lds
  s_add_u32 m0, s79, 35712
  s_nop 0
  buffer_load_dwordx4 v14, s[16:19], s73 offen offset:1152 lds
  s_add_u32 s73, s5, 16
  s_lshl_b32 s73, s73, 3
  s_add_u32 s73, s73, s3
  s_mul_i32 s73, s73, 5120
  s_add_u32 m0, s79, 40960
  s_nop 0
  buffer_load_dwordx4 v14, s[16:19], s73 offen offset:0 lds
  s_add_u32 m0, s79, 44928
  s_nop 0
  buffer_load_dwordx4 v14, s[16:19], s73 offen offset:128 lds
  s_add_u32 m0, s79, 48896
  s_nop 0
  buffer_load_dwordx4 v14, s[16:19], s73 offen offset:256 lds
  s_add_u32 m0, s79, 52864
  s_nop 0
  buffer_load_dwordx4 v14, s[16:19], s73 offen offset:384 lds
  s_add_u32 m0, s79, 56832
  s_nop 0
  buffer_load_dwordx4 v14, s[16:19], s73 offen offset:512 lds
  s_add_u32 m0, s79, 60800
  s_nop 0
  buffer_load_dwordx4 v14, s[16:19], s73 offen offset:640 lds
  s_add_u32 m0, s79, 64768
  s_nop 0
  buffer_load_dwordx4 v14, s[16:19], s73 offen offset:768 lds
  s_add_u32 m0, s79, 68736
  s_nop 0
  buffer_load_dwordx4 v14, s[16:19], s73 offen offset:896 lds
  s_add_u32 m0, s79, 72704
  s_nop 0
  buffer_load_dwordx4 v14, s[16:19], s73 offen offset:1024 lds
  s_add_u32 m0, s79, 76672
  s_nop 0
  buffer_load_dwordx4 v14, s[16:19], s73 offen offset:1152 lds
  s_add_u32 s71, s5, 0
  s_mul_i32 s69, s71, 40960
  s_add_u32 s69, s69, s79
  s_add_u32 s69, s69, 1048576
  v_add_u32 v16, 0, v12
  s_waitcnt vmcnt(10)
  s_barrier
  ds_read_b64_tr_b16 v[64:65], v16 offset:0
  ds_read_b64_tr_b16 v[66:67], v16 offset:512
  ds_read_b64_tr_b16 v[68:69], v16 offset:4096
  ds_read_b64_tr_b16 v[70:71], v16 offset:4608
  ds_read_b64_tr_b16 v[72:73], v16 offset:8192
  ds_read_b64_tr_b16 v[74:75], v16 offset:8704
  ds_read_b64_tr_b16 v[76:77], v16 offset:12288
  ds_read_b64_tr_b16 v[78:79], v16 offset:12800
  s_waitcnt lgkmcnt(6)
  buffer_store_dwordx4 v[64:67], v59, s[12:15], s69 offen sc1
  s_add_u32 s69, s69, 4096
  ds_read_b64_tr_b16 v[80:81], v16 offset:16384
  ds_read_b64_tr_b16 v[82:83], v16 offset:16896
  s_waitcnt lgkmcnt(6)
  buffer_store_dwordx4 v[68:71], v59, s[12:15], s69 offen sc1
  s_add_u32 s69, s69, 4096
  ds_read_b64_tr_b16 v[84:85], v16 offset:20480
  ds_read_b64_tr_b16 v[86:87], v16 offset:20992
  s_waitcnt lgkmcnt(6)
  buffer_store_dwordx4 v[72:75], v59, s[12:15], s69 offen sc1
  s_add_u32 s69, s69, 4096
  ds_read_b64_tr_b16 v[88:89], v16 offset:24576
  ds_read_b64_tr_b16 v[90:91], v16 offset:25088
  s_waitcnt lgkmcnt(6)
  buffer_store_dwordx4 v[76:79], v59, s[12:15], s69 offen sc1
  s_add_u32 s69, s69, 4096
  ds_read_b64_tr_b16 v[92:93], v16 offset:28672
  ds_read_b64_tr_b16 v[94:95], v16 offset:29184
  s_waitcnt lgkmcnt(6)
  buffer_store_dwordx4 v[80:83], v59, s[12:15], s69 offen sc1
  s_add_u32 s69, s69, 4096
  ds_read_b64_tr_b16 v[96:97], v16 offset:32768
  ds_read_b64_tr_b16 v[98:99], v16 offset:33280
  s_waitcnt lgkmcnt(6)
  buffer_store_dwordx4 v[84:87], v59, s[12:15], s69 offen sc1
  s_add_u32 s69, s69, 4096
  ds_read_b64_tr_b16 v[100:101], v16 offset:36864
  ds_read_b64_tr_b16 v[102:103], v16 offset:37376
  s_waitcnt lgkmcnt(6)
  buffer_store_dwordx4 v[88:91], v59, s[12:15], s69 offen sc1
  s_add_u32 s69, s69, 4096
  s_waitcnt lgkmcnt(4)
  buffer_store_dwordx4 v[92:95], v59, s[12:15], s69 offen sc1
  s_add_u32 s69, s69, 4096
  s_waitcnt lgkmcnt(2)
  buffer_store_dwordx4 v[96:99], v59, s[12:15], s69 offen sc1
  s_add_u32 s69, s69, 4096
  s_waitcnt lgkmcnt(0)
  buffer_store_dwordx4 v[100:103], v59, s[12:15], s69 offen sc1
  s_add_u32 s69, s69, 4096
  s_add_u32 s71, s5, 16
  s_mul_i32 s69, s71, 40960
  s_add_u32 s69, s69, s79
  s_add_u32 s69, s69, 1048576
  v_add_u32 v16, 40960, v12
  s_waitcnt vmcnt(10)
  s_barrier
  ds_read_b64_tr_b16 v[104:105], v16 offset:0
  ds_read_b64_tr_b16 v[106:107], v16 offset:512
  ds_read_b64_tr_b16 v[108:109], v16 offset:4096
  ds_read_b64_tr_b16 v[110:111], v16 offset:4608
  ds_read_b64_tr_b16 v[112:113], v16 offset:8192
  ds_read_b64_tr_b16 v[114:115], v16 offset:8704
  ds_read_b64_tr_b16 v[116:117], v16 offset:12288
  ds_read_b64_tr_b16 v[118:119], v16 offset:12800
  s_waitcnt lgkmcnt(6)
  buffer_store_dwordx4 v[104:107], v59, s[12:15], s69 offen sc1
  s_add_u32 s69, s69, 4096
  ds_read_b64_tr_b16 v[120:121], v16 offset:16384
  ds_read_b64_tr_b16 v[122:123], v16 offset:16896
  s_waitcnt lgkmcnt(6)
  buffer_store_dwordx4 v[108:111], v59, s[12:15], s69 offen sc1
  s_add_u32 s69, s69, 4096
  ds_read_b64_tr_b16 v[124:125], v16 offset:20480
  ds_read_b64_tr_b16 v[126:127], v16 offset:20992
  s_waitcnt lgkmcnt(6)
  buffer_store_dwordx4 v[112:115], v59, s[12:15], s69 offen sc1
  s_add_u32 s69, s69, 4096
  ds_read_b64_tr_b16 v[128:129], v16 offset:24576
  ds_read_b64_tr_b16 v[130:131], v16 offset:25088
  s_waitcnt lgkmcnt(6)
  buffer_store_dwordx4 v[116:119], v59, s[12:15], s69 offen sc1
  s_add_u32 s69, s69, 4096
  ds_read_b64_tr_b16 v[132:133], v16 offset:28672
  ds_read_b64_tr_b16 v[134:135], v16 offset:29184
  s_waitcnt lgkmcnt(6)
  buffer_store_dwordx4 v[120:123], v59, s[12:15], s69 offen sc1
  s_add_u32 s69, s69, 4096
  ds_read_b64_tr_b16 v[136:137], v16 offset:32768
  ds_read_b64_tr_b16 v[138:139], v16 offset:33280
  s_waitcnt lgkmcnt(6)
  buffer_store_dwordx4 v[124:127], v59, s[12:15], s69 offen sc1
  s_add_u32 s69, s69, 4096
  ds_read_b64_tr_b16 v[140:141], v16 offset:36864
  ds_read_b64_tr_b16 v[142:143], v16 offset:37376
  s_waitcnt lgkmcnt(6)
  buffer_store_dwordx4 v[128:131], v59, s[12:15], s69 offen sc1
  s_add_u32 s69, s69, 4096
  s_waitcnt lgkmcnt(4)
  buffer_store_dwordx4 v[132:135], v59, s[12:15], s69 offen sc1
  s_add_u32 s69, s69, 4096
  s_waitcnt lgkmcnt(2)
  buffer_store_dwordx4 v[136:139], v59, s[12:15], s69 offen sc1
  s_add_u32 s69, s69, 4096
  s_waitcnt lgkmcnt(0)
  buffer_store_dwordx4 v[140:143], v59, s[12:15], s69 offen sc1
  s_add_u32 s69, s69, 4096
  s_add_u32 s73, s5, 32
  s_lshl_b32 s73, s73, 3
  s_add_u32 s73, s73, s3
  s_mul_i32 s73, s73, 5120
  s_add_u32 m0, s79, 81920
  s_nop 0
  buffer_load_dwordx4 v14, s[16:19], s73 offen offset:0 lds
  s_add_u32 m0, s79, 85888
  s_nop 0
  buffer_load_dwordx4 v14, s[16:19], s73 offen offset:128 lds
  s_add_u32 m0, s79, 89856
  s_nop 0
  buffer_load_dwordx4 v14, s[16:19], s73 offen offset:256 lds
  s_add_u32 m0, s79, 93824
  s_nop 0
  buffer_load_dwordx4 v14, s[16:19], s73 offen offset:384 lds
  s_add_u32 m0, s79, 97792
  s_nop 0
  buffer_load_dwordx4 v14, s[16:19], s73 offen offset:512 lds
  s_waitcnt vmcnt(5)
  s_barrier
  s_mov_b32 s62, 22020096
  v_mov_b32 v39, s61
  buffer_store_dword v39, v1, s[12:15], s62 offen sc1
  s_add_u32 m0, s79, 101760
  s_nop 0
  buffer_load_dwordx4 v14, s[16:19], s73 offen offset:640 lds
  s_add_u32 m0, s79, 105728
  s_nop 0
  buffer_load_dwordx4 v14, s[16:19], s73 offen offset:768 lds
  s_add_u32 m0, s79, 109696
  s_nop 0
  buffer_load_dwordx4 v14, s[16:19], s73 offen offset:896 lds
  s_add_u32 m0, s79, 113664
  s_nop 0
  buffer_load_dwordx4 v14, s[16:19], s73 offen offset:1024 lds
  s_add_u32 m0, s79, 117632
  s_nop 0
  buffer_load_dwordx4 v14, s[16:19], s73 offen offset:1152 lds
  s_add_u32 s71, s5, 48
  s_sub_u32 s72, s71, 54
  s_and_b32 s73, s72, 3
  s_lshr_b32 s74, s72, 2
  s_mul_i32 s73, s73, 160
  s_mul_i32 s75, s74, 40
  s_cmp_eq_u32 s74, 4
  s_cselect_b32 s75, 16, s75
  s_cselect_b32 s76, 80, 20
  s_cselect_b32 s77, 20, 1
  s_cselect_b32 s78, 1, 4
  s_add_u32 s73, s73, s75
  s_lshl_b32 s75, s71, 5
  s_cmp_lt_u32 s71, 54
  s_cselect_b32 s73, s75, s73
  s_cselect_b32 s76, 16, s76
  s_cselect_b32 s77, 1, s77
  s_cselect_b32 s78, 4, s78
  s_cselect_b32 s16, s36, s28
  s_cselect_b32 s17, s37, s29
  s_mov_b32 s75, 819200
  s_cselect_b32 s18, 2211840, s75
  s_cmp_lt_u32 s71, 74
  s_cselect_b32 s18, s18, 0
  s_mul_i32 s78, s78, s3
  s_add_u32 s73, s73, s78
  s_mul_i32 s73, s73, 1280
  v_mul_lo_u32 v14, v8, s76
  v_mul_lo_u32 v15, v9, s77
  v_add_u32 v14, v14, v15
  v_mad_u32_u24 v14, v14, v10, v11
  s_add_u32 m0, s79, 122880
  s_nop 0
  buffer_load_dwordx4 v14, s[16:19], s73 offen offset:0 lds
  s_add_u32 m0, s79, 126848
  s_nop 0
  buffer_load_dwordx4 v14, s[16:19], s73 offen offset:128 lds
  s_add_u32 m0, s79, 130816
  s_nop 0
  buffer_load_dwordx4 v14, s[16:19], s73 offen offset:256 lds
  s_add_u32 m0, s79, 134784
  s_nop 0
  buffer_load_dwordx4 v14, s[16:19], s73 offen offset:384 lds
  s_add_u32 m0, s79, 138752
  s_nop 0
  buffer_load_dwordx4 v14, s[16:19], s73 offen offset:512 lds
  s_add_u32 m0, s79, 142720
  s_nop 0
  buffer_load_dwordx4 v14, s[16:19], s73 offen offset:640 lds
  s_add_u32 m0, s79, 146688
  s_nop 0
  buffer_load_dwordx4 v14, s[16:19], s73 offen offset:768 lds
  s_add_u32 m0, s79, 150656
  s_nop 0
  buffer_load_dwordx4 v14, s[16:19], s73 offen offset:896 lds
  s_add_u32 m0, s79, 154624
  s_nop 0
  buffer_load_dwordx4 v14, s[16:19], s73 offen offset:1024 lds
  s_add_u32 m0, s79, 158592
  s_nop 0
  buffer_load_dwordx4 v14, s[16:19], s73 offen offset:1152 lds
  s_add_u32 s71, s5, 32
  s_mul_i32 s69, s71, 40960
  s_add_u32 s69, s69, s79
  s_add_u32 s69, s69, 1048576
  v_add_u32 v16, 81920, v12
  s_waitcnt vmcnt(10)
  s_barrier
  ds_read_b64_tr_b16 v[64:65], v16 offset:0
  ds_read_b64_tr_b16 v[66:67], v16 offset:512
  ds_read_b64_tr_b16 v[68:69], v16 offset:4096
  ds_read_b64_tr_b16 v[70:71], v16 offset:4608
  ds_read_b64_tr_b16 v[72:73], v16 offset:8192
  ds_read_b64_tr_b16 v[74:75], v16 offset:8704
  ds_read_b64_tr_b16 v[76:77], v16 offset:12288
  ds_read_b64_tr_b16 v[78:79], v16 offset:12800
  s_waitcnt lgkmcnt(6)
  buffer_store_dwordx4 v[64:67], v59, s[12:15], s69 offen sc1
  s_add_u32 s69, s69, 4096
  ds_read_b64_tr_b16 v[80:81], v16 offset:16384
  ds_read_b64_tr_b16 v[82:83], v16 offset:16896
  s_waitcnt lgkmcnt(6)
  buffer_store_dwordx4 v[68:71], v59, s[12:15], s69 offen sc1
  s_add_u32 s69, s69, 4096
  ds_read_b64_tr_b16 v[84:85], v16 offset:20480
  ds_read_b64_tr_b16 v[86:87], v16 offset:20992
  s_waitcnt lgkmcnt(6)
  buffer_store_dwordx4 v[72:75], v59, s[12:15], s69 offen sc1
  s_add_u32 s69, s69, 4096
  ds_read_b64_tr_b16 v[88:89], v16 offset:24576
  ds_read_b64_tr_b16 v[90:91], v16 offset:25088
  s_waitcnt lgkmcnt(6)
  buffer_store_dwordx4 v[76:79], v59, s[12:15], s69 offen sc1
  s_add_u32 s69, s69, 4096
  ds_read_b64_tr_b16 v[92:93], v16 offset:28672
  ds_read_b64_tr_b16 v[94:95], v16 offset:29184
  s_waitcnt lgkmcnt(6)
  buffer_store_dwordx4 v[80:83], v59, s[12:15], s69 offen sc1
  s_add_u32 s69, s69, 4096
  ds_read_b64_tr_b16 v[96:97], v16 offset:32768
  ds_read_b64_tr_b16 v[98:99], v16 offset:33280
  s_waitcnt lgkmcnt(6)
  buffer_store_dwordx4 v[84:87], v59, s[12:15], s69 offen sc1
  s_add_u32 s69, s69, 4096
  ds_read_b64_tr_b16 v[100:101], v16 offset:36864
  ds_read_b64_tr_b16 v[102:103], v16 offset:37376
  s_waitcnt lgkmcnt(6)
  buffer_store_dwordx4 v[88:91], v59, s[12:15], s69 offen sc1
  s_add_u32 s69, s69, 4096
  s_waitcnt lgkmcnt(4)
  buffer_store_dwordx4 v[92:95], v59, s[12:15], s69 offen sc1
  s_add_u32 s69, s69, 4096
  s_waitcnt lgkmcnt(2)
  buffer_store_dwordx4 v[96:99], v59, s[12:15], s69 offen sc1
  s_add_u32 s69, s69, 4096
  s_waitcnt lgkmcnt(0)
  buffer_store_dwordx4 v[100:103], v59, s[12:15], s69 offen sc1
  s_add_u32 s69, s69, 4096
  s_add_u32 s71, s5, 64
  s_sub_u32 s72, s71, 54
  s_and_b32 s73, s72, 3
  s_lshr_b32 s74, s72, 2
  s_mul_i32 s73, s73, 160
  s_mul_i32 s75, s74, 40
  s_cmp_eq_u32 s74, 4
  s_cselect_b32 s75, 16, s75
  s_cselect_b32 s76, 80, 20
  s_cselect_b32 s77, 20, 1
  s_cselect_b32 s78, 1, 4
  s_add_u32 s73, s73, s75
  s_lshl_b32 s75, s71, 5
  s_cmp_lt_u32 s71, 54
  s_cselect_b32 s73, s75, s73
  s_cselect_b32 s76, 16, s76
  s_cselect_b32 s77, 1, s77
  s_cselect_b32 s78, 4, s78
  s_cselect_b32 s16, s36, s28
  s_cselect_b32 s17, s37, s29
  s_mov_b32 s75, 819200
  s_cselect_b32 s18, 2211840, s75
  s_cmp_lt_u32 s71, 74
  s_cselect_b32 s18, s18, 0
  s_mul_i32 s78, s78, s3
  s_add_u32 s73, s73, s78
  s_mul_i32 s73, s73, 1280
  v_mul_lo_u32 v14, v8, s76
  v_mul_lo_u32 v15, v9, s77
  v_add_u32 v14, v14, v15
  v_mad_u32_u24 v14, v14, v10, v11
  s_add_u32 m0, s79, 0
  s_nop 0
  buffer_load_dwordx4 v14, s[16:19], s73 offen offset:0 lds
  s_add_u32 m0, s79, 3968
  s_nop 0
  buffer_load_dwordx4 v14, s[16:19], s73 offen offset:128 lds
  s_add_u32 m0, s79, 7936
  s_nop 0
  buffer_load_dwordx4 v14, s[16:19], s73 offen offset:256 lds
  s_add_u32 m0, s79, 11904
  s_nop 0
  buffer_load_dwordx4 v14, s[16:19], s73 offen offset:384 lds
  s_add_u32 m0, s79, 15872
  s_nop 0
  buffer_load_dwordx4 v14, s[16:19], s73 offen offset:512 lds
  s_waitcnt vmcnt(5)
  s_barrier
  s_mov_b32 s62, 24117248
  v_mov_b32 v39, s61
  buffer_store_dword v39, v1, s[12:15], s62 offen sc1
  s_add_u32 s71, s5, 48
  s_mul_i32 s69, s71, 40960
  s_add_u32 s69, s69, s79
  s_add_u32 s69, s69, 1048576
  v_add_u32 v16, 122880, v12
  s_barrier
  ds_read_b64_tr_b16 v[104:105], v16 offset:0
  ds_read_b64_tr_b16 v[106:107], v16 offset:512
  ds_read_b64_tr_b16 v[108:109], v16 offset:4096
  ds_read_b64_tr_b16 v[110:111], v16 offset:4608
  ds_read_b64_tr_b16 v[112:113], v16 offset:8192
  ds_read_b64_tr_b16 v[114:115], v16 offset:8704
  ds_read_b64_tr_b16 v[116:117], v16 offset:12288
  ds_read_b64_tr_b16 v[118:119], v16 offset:12800
  s_waitcnt lgkmcnt(6)
  buffer_store_dwordx4 v[104:107], v59, s[12:15], s69 offen sc1
  s_add_u32 s69, s69, 4096
  ds_read_b64_tr_b16 v[120:121], v16 offset:16384
  ds_read_b64_tr_b16 v[122:123], v16 offset:16896
  s_waitcnt lgkmcnt(6)
  buffer_store_dwordx4 v[108:111], v59, s[12:15], s69 offen sc1
  s_add_u32 s69, s69, 4096
  ds_read_b64_tr_b16 v[124:125], v16 offset:20480
  ds_read_b64_tr_b16 v[126:127], v16 offset:20992
  s_waitcnt lgkmcnt(6)
  buffer_store_dwordx4 v[112:115], v59, s[12:15], s69 offen sc1
  s_add_u32 s69, s69, 4096
  ds_read_b64_tr_b16 v[128:129], v16 offset:24576
  ds_read_b64_tr_b16 v[130:131], v16 offset:25088
  s_waitcnt lgkmcnt(6)
  buffer_store_dwordx4 v[116:119], v59, s[12:15], s69 offen sc1
  s_add_u32 s69, s69, 4096
  ds_read_b64_tr_b16 v[132:133], v16 offset:28672
  ds_read_b64_tr_b16 v[134:135], v16 offset:29184
  s_waitcnt lgkmcnt(6)
  buffer_store_dwordx4 v[120:123], v59, s[12:15], s69 offen sc1
  s_add_u32 s69, s69, 4096
  ds_read_b64_tr_b16 v[136:137], v16 offset:32768
  ds_read_b64_tr_b16 v[138:139], v16 offset:33280
  s_waitcnt lgkmcnt(6)
  buffer_store_dwordx4 v[124:127], v59, s[12:15], s69 offen sc1
  s_add_u32 s69, s69, 4096
  ds_read_b64_tr_b16 v[140:141], v16 offset:36864
  ds_read_b64_tr_b16 v[142:143], v16 offset:37376
  s_waitcnt lgkmcnt(6)
  buffer_store_dwordx4 v[128:131], v59, s[12:15], s69 offen sc1
  s_add_u32 s69, s69, 4096
  s_waitcnt lgkmcnt(4)
  buffer_store_dwordx4 v[132:135], v59, s[12:15], s69 offen sc1
  s_add_u32 s69, s69, 4096
  s_waitcnt lgkmcnt(2)
  buffer_store_dwordx4 v[136:139], v59, s[12:15], s69 offen sc1
  s_add_u32 s69, s69, 4096
  s_waitcnt lgkmcnt(0)
  buffer_store_dwordx4 v[140:143], v59, s[12:15], s69 offen sc1
  s_add_u32 s69, s69, 4096
  s_cmp_ge_u32 s5, 10
  s_cbranch_scc1 L_no5_2
  s_add_u32 m0, s79, 19840
  s_nop 0
  buffer_load_dwordx4 v14, s[16:19], s73 offen offset:640 lds
  s_add_u32 m0, s79, 23808
  s_nop 0
  buffer_load_dwordx4 v14, s[16:19], s73 offen offset:768 lds
  s_add_u32 m0, s79, 27776
  s_nop 0
  buffer_load_dwordx4 v14, s[16:19], s73 offen offset:896 lds
  s_add_u32 m0, s79, 31744
  s_nop 0
  buffer_load_dwordx4 v14, s[16:19], s73 offen offset:1024 lds
  s_add_u32 m0, s79, 35712
  s_nop 0
  buffer_load_dwordx4 v14, s[16:19], s73 offen offset:1152 lds
  s_waitcnt vmcnt(5)
  s_barrier
  s_mov_b32 s62, 26214400
  v_mov_b32 v39, s61
  buffer_store_dword v39, v1, s[12:15], s62 offen sc1
  s_add_u32 s71, s5, 64
  s_mul_i32 s69, s71, 40960
  s_add_u32 s69, s69, s79
  s_add_u32 s69, s69, 1048576
  v_add_u32 v16, 0, v12
  s_waitcnt vmcnt(1)
  s_barrier
  ds_read_b64_tr_b16 v[64:65], v16 offset:0
  ds_read_b64_tr_b16 v[66:67], v16 offset:512
  ds_read_b64_tr_b16 v[68:69], v16 offset:4096
  ds_read_b64_tr_b16 v[70:71], v16 offset:4608
  ds_read_b64_tr_b16 v[72:73], v16 offset:8192
  ds_read_b64_tr_b16 v[74:75], v16 offset:8704
  ds_read_b64_tr_b16 v[76:77], v16 offset:12288
  ds_read_b64_tr_b16 v[78:79], v16 offset:12800
  s_waitcnt lgkmcnt(6)
  buffer_store_dwordx4 v[64:67], v59, s[12:15], s69 offen sc1
  s_add_u32 s69, s69, 4096
  ds_read_b64_tr_b16 v[80:81], v16 offset:16384
  ds_read_b64_tr_b16 v[82:83], v16 offset:16896
  s_waitcnt lgkmcnt(6)
  buffer_store_dwordx4 v[68:71], v59, s[12:15], s69 offen sc1
  s_add_u32 s69, s69, 4096
  ds_read_b64_tr_b16 v[84:85], v16 offset:20480
  ds_read_b64_tr_b16 v[86:87], v16 offset:20992
  s_waitcnt lgkmcnt(6)
  buffer_store_dwordx4 v[72:75], v59, s[12:15], s69 offen sc1
  s_add_u32 s69, s69, 4096
  ds_read_b64_tr_b16 v[88:89], v16 offset:24576
  ds_read_b64_tr_b16 v[90:91], v16 offset:25088
  s_waitcnt lgkmcnt(6)
  buffer_store_dwordx4 v[76:79], v59, s[12:15], s69 offen sc1
  s_add_u32 s69, s69, 4096
  ds_read_b64_tr_b16 v[92:93], v16 offset:28672
  ds_read_b64_tr_b16 v[94:95], v16 offset:29184
  s_waitcnt lgkmcnt(6)
  buffer_store_dwordx4 v[80:83], v59, s[12:15], s69 offen sc1
  s_add_u32 s69, s69, 4096
  ds_read_b64_tr_b16 v[96:97], v16 offset:32768
  ds_read_b64_tr_b16 v[98:99], v16 offset:33280
  s_waitcnt lgkmcnt(6)
  buffer_store_dwordx4 v[84:87], v59, s[12:15], s69 offen sc1
  s_add_u32 s69, s69, 4096
  ds_read_b64_tr_b16 v[100:101], v16 offset:36864
  ds_read_b64_tr_b16 v[102:103], v16 offset:37376
  s_waitcnt lgkmcnt(6)
  buffer_store_dwordx4 v[88:91], v59, s[12:15], s69 offen sc1
  s_add_u32 s69, s69, 4096
  s_waitcnt lgkmcnt(4)
  buffer_store_dwordx4 v[92:95], v59, s[12:15], s69 offen sc1
  s_add_u32 s69, s69, 4096
  s_waitcnt lgkmcnt(2)
  buffer_store_dwordx4 v[96:99], v59, s[12:15], s69 offen sc1
  s_add_u32 s69, s69, 4096
  s_waitcnt lgkmcnt(0)
  buffer_store_dwordx4 v[100:103], v59, s[12:15], s69 offen sc1
  s_add_u32 s69, s69, 4096
L_no5_2:
  v_lshrrev_b32 v38, 3, v0
  v_bfe_u32 v39, v0, 2, 1
  v_mad_u32_u24 v38, v38, 32, v39
  v_add_lshl_u32 v38, v38, 30, 7
  s_mov_b32 s59, 131072
L_spin_3:
  s_mov_b32 s62, 24117248
  buffer_load_dword v39, v38, s[12:15], s62 offen sc1
  s_waitcnt vmcnt(0)
  v_cmp_ne_u32 vcc, s61, v39
  s_sub_u32 s59, s59, 1
  s_cbranch_scc1 L_spun_4
  s_cbranch_vccnz L_spin_3
L_spun_4:
  s_barrier
  s_cmp_lt_u32 s5, 10
  s_cbranch_scc1 L_has4_5
  s_mov_b32 s62, 26214400
  v_mov_b32 v39, s61
  buffer_store_dword v39, v1, s[12:15], s62 offen sc1
L_has4_5:
  s_mov_b32 s62, 28311552
  v_mov_b32 v39, s61
  buffer_store_dword v39, v1, s[12:15], s62 offen sc1
  s_add_u32 s23, s83, 0
  buffer_load_dwordx4 a[96:99], v59, s[12:15], s23 offen offset:0 sc1
  buffer_load_dwordx4 a[100:103], v59, s[12:15], s23 offen offset:1024 sc1
  buffer_load_dwordx4 a[104:107], v59, s[12:15], s23 offen offset:2048 sc1
  buffer_load_dwordx4 a[108:111], v59, s[12:15], s23 offen offset:3072 sc1
  buffer_load_dwordx4 a[112:115], v60, s[12:15], s23 offen offset:0 sc1
  s_add_u32 s23, s83, 163840
  buffer_load_dwordx4 a[116:119], v59, s[12:15], s23 offen offset:0 sc1
  buffer_load_dwordx4 a[120:123], v59, s[12:15], s23 offen offset:1024 sc1
  buffer_load_dwordx4 a[124:127], v59, s[12:15], s23 offen offset:2048 sc1
  buffer_load_dwordx4 a[128:131], v59, s[12:15], s23 offen offset:3072 sc1
  buffer_load_dwordx4 a[132:135], v60, s[12:15], s23 offen offset:0 sc1
  s_add_u32 s23, s83, 327680
  buffer_load_dwordx4 a[136:139], v59, s[12:15], s23 offen offset:0 sc1
  buffer_load_dwordx4 a[140:143], v59, s[12:15], s23 offen offset:1024 sc1
  buffer_load_dwordx4 a[144:147], v59, s[12:15], s23 offen offset:2048 sc1
  buffer_load_dwordx4 a[148:151], v59, s[12:15], s23 offen offset:3072 sc1
  buffer_load_dwordx4 a[152:155], v60, s[12:15], s23 offen offset:0 sc1
  s_add_u32 s23, s83, 491520
  buffer_load_dwordx4 a[156:159], v59, s[12:15], s23 offen offset:0 sc1
  buffer_load_dwordx4 a[160:163], v59, s[12:15], s23 offen offset:1024 sc1
  buffer_load_dwordx4 a[164:167], v59, s[12:15], s23 offen offset:2048 sc1
  buffer_load_dwordx4 a[168:171], v59, s[12:15], s23 offen offset:3072 sc1
  buffer_load_dwordx4 a[172:175], v60, s[12:15], s23 offen offset:0 sc1
  s_add_u32 s23, s83, 655360
  buffer_load_dwordx4 a[176:179], v59, s[12:15], s23 offen offset:0 sc1
  buffer_load_dwordx4 a[180:183], v59, s[12:15], s23 offen offset:1024 sc1
  buffer_load_dwordx4 a[184:187], v59, s[12:15], s23 offen offset:2048 sc1
  buffer_load_dwordx4 a[188:191], v59, s[12:15], s23 offen offset:3072 sc1
  buffer_load_dwordx4 a[192:195], v60, s[12:15], s23 offen offset:0 sc1
  s_add_u32 s23, s83, 819200
  buffer_load_dwordx4 a[196:199], v59, s[12:15], s23 offen offset:0 sc1
  buffer_load_dwordx4 a[200:203], v59, s[12:15], s23 offen offset:1024 sc1
  buffer_load_dwordx4 a[204:207], v59, s[12:15], s23 offen offset:2048 sc1
  buffer_load_dwordx4 a[208:211], v59, s[12:15], s23 offen offset:3072 sc1
  buffer_load_dwordx4 a[212:215], v60, s[12:15], s23 offen offset:0 sc1
  s_add_u32 s23, s83, 983040
  buffer_load_dwordx4 a[216:219], v59, s[12:15], s23 offen offset:0 sc1
  buffer_load_dwordx4 a[220:223], v59, s[12:15], s23 offen offset:1024 sc1
  buffer_load_dwordx4 a[224:227], v59, s[12:15], s23 offen offset:2048 sc1
  buffer_load_dwordx4 a[228:231], v59, s[12:15], s23 offen offset:3072 sc1
  buffer_load_dwordx4 a[232:235], v60, s[12:15], s23 offen offset:0 sc1
  s_add_u32 s23, s83, 1146880
  buffer_load_dwordx4 a[236:239], v59, s[12:15], s23 offen offset:0 sc1
  buffer_load_dwordx4 a[240:243], v59, s[12:15], s23 offen offset:1024 sc1
  buffer_load_dwordx4 a[244:247], v59, s[12:15], s23 offen offset:2048 sc1
  buffer_load_dwordx4 a[248:251], v59, s[12:15], s23 offen offset:3072 sc1
  buffer_load_dwordx4 a[252:255], v60, s[12:15], s23 offen offset:0 sc1
  s_add_u32 s23, s83, 1310720
  s_add_u32 m0, s48, 0
  s_nop 0
  buffer_load_dwordx4 v59, s[12:15], s23 offen offset:0 sc1 lds
  s_add_u32 m0, s48, 0
  s_nop 0
  buffer_load_dwordx4 v59, s[12:15], s23 offen offset:1024 sc1 lds
  s_add_u32 m0, s48, 0
  s_nop 0
  buffer_load_dwordx4 v59, s[12:15], s23 offen offset:2048 sc1 lds
  s_add_u32 m0, s48, 0
  s_nop 0
  buffer_load_dwordx4 v59, s[12:15], s23 offen offset:3072 sc1 lds
  s_add_u32 m0, s48, 4096
  s_nop 0
  buffer_load_dwordx4 v60, s[12:15], s23 offen offset:0 sc1 lds
  s_add_u32 s23, s83, 1474560
  s_add_u32 m0, s48, 5120
  s_nop 0
  buffer_load_dwordx4 v59, s[12:15], s23 offen offset:0 sc1 lds
  s_add_u32 m0, s48, 5120
  s_nop 0
  buffer_load_dwordx4 v59, s[12:15], s23 offen offset:1024 sc1 lds
  s_add_u32 m0, s48, 5120
  s_nop 0
  buffer_load_dwordx4 v59, s[12:15], s23 offen offset:2048 sc1 lds
  s_add_u32 m0, s48, 29696
  s_nop 0
  buffer_load_dwordx4 v59, s[12:15], s23 offen offset:3072 sc1 lds
  s_add_u32 m0, s48, 33792
  s_nop 0
  buffer_load_dwordx4 v60, s[12:15], s23 offen offset:0 sc1 lds
  s_add_u32 s23, s83, 1638400
  s_add_u32 m0, s48, 34816
  s_nop 0
  buffer_load_dwordx4 v59, s[12:15], s23 offen offset:0 sc1 lds
  s_add_u32 m0, s48, 34816
  s_nop 0
  buffer_load_dwordx4 v59, s[12:15], s23 offen offset:1024 sc1 lds
  s_add_u32 m0, s48, 34816
  s_nop 0
  buffer_load_dwordx4 v59, s[12:15], s23 offen offset:2048 sc1 lds
  s_add_u32 m0, s48, 34816
  s_nop 0
  buffer_load_dwordx4 v59, s[12:15], s23 offen offset:3072 sc1 lds
  s_add_u32 m0, s48, 38912
  s_nop 0
  buffer_load_dwordx4 v60, s[12:15], s23 offen offset:0 sc1 lds
  s_add_u32 s23, s83, 1802240
  buffer_load_dwordx4 a[0:3], v59, s[12:15], s23 offen offset:0 sc1
  buffer_load_dwordx4 a[4:7], v59, s[12:15], s23 offen offset:1024 sc1
  buffer_load_dwordx4 a[8:11], v59, s[12:15], s23 offen offset:2048 sc1
  buffer_load_dwordx4 a[12:15], v59, s[12:15], s23 offen offset:3072 sc1
  buffer_load_dwordx4 a[16:19], v60, s[12:15], s23 offen offset:0 sc1
  s_mov_b32 s59, 131072
L_spin_6:
  s_mov_b32 s62, 28311552
  buffer_load_dword v39, v38, s[12:15], s62 offen sc1
  s_waitcnt vmcnt(0)
  v_cmp_ne_u32 vcc, s61, v39
  s_sub_u32 s59, s59, 1
  s_cbranch_scc1 L_spun_7
  s_cbranch_vccnz L_spin_6
L_spun_7:
  s_add_u32 s23, s83, 1966080
  buffer_load_dwordx4 a[20:23], v59, s[12:15], s23 offen offset:0 sc1
  buffer_load_dwordx4 a[24:27], v59, s[12:15], s23 offen offset:1024 sc1
  buffer_load_dwordx4 a[28:31], v59, s[12:15], s23 offen offset:2048 sc1
  buffer_load_dwordx4 a[32:35], v59, s[12:15], s23 offen offset:3072 sc1
  buffer_load_dwordx4 a[36:39], v60, s[12:15], s23 offen offset:0 sc1
  s_and_b32 s23, s3, 2
  s_mul_i32 s23, s23, 40960
  s_sub_u32 s23, s83, s23
  s_add_u32 s23, s23, 2129920
  buffer_load_dwordx4 a[40:43], v59, s[12:15], s23 offen offset:0 sc1
  buffer_load_dwordx4 a[44:47], v59, s[12:15], s23 offen offset:1024 sc1
  buffer_load_dwordx4 a[48:51], v59, s[12:15], s23 offen offset:2048 sc1
  buffer_load_dwordx4 a[52:55], v59, s[12:15], s23 offen offset:3072 sc1
  buffer_load_dwordx4 a[56:59], v60, s[12:15], s23 offen offset:0 sc1
  s_add_u32 s23, s83, 2211840
  buffer_load_dwordx4 a[60:63], v59, s[12:15], s23 offen offset:0 sc1
  buffer_load_dwordx4 a[64:67], v59, s[12:15], s23 offen offset:1024 sc1
  buffer_load_dwordx4 a[68:71], v59, s[12:15], s23 offen offset:2048 sc1
  buffer_load_dwordx4 a[72:75], v59, s[12:15], s23 offen offset:3072 sc1
  buffer_load_dwordx4 a[76:79], v60, s[12:15], s23 offen offset:0 sc1
  s_add_u32 s23, s83, 2375680
  buffer_load_dwordx4 v[176:179], v59, s[12:15], s23 offen offset:0 sc1
  buffer_load_dwordx4 v[180:183], v59, s[12:15], s23 offen offset:1024 sc1
  buffer_load_dwordx4 v[184:187], v59, s[12:15], s23 offen offset:2048 sc1
  buffer_load_dwordx4 v[188:191], v59, s[12:15], s23 offen offset:3072 sc1
  buffer_load_dwordx4 v[192:195], v60, s[12:15], s23 offen offset:0 sc1
  s_mov_b32 s16, s38
  s_mov_b32 s17, s39
  s_mov_b32 s18, 2621440
  s_mov_b32 s19, 0x00020000
  s_branch L_p2
  .p2align 12
L_ffn:
  v_lshlrev_b32 v23, 3, v22
  v_add_u32 v23, 0, v23
  v_lshrrev_b32 v24, 6, v23
  v_and_b32 v25, 63, v23
  v_xor_b32 v25, v25, v21
  v_lshl_add_u32 v24, v24, 13, v20
  v_add_u32 v10, v24, v25
  v_add_u32 v12, 24576, v10
  v_lshlrev_b32 v23, 3, v22
  v_add_u32 v23, 32, v23
  v_lshrrev_b32 v24, 6, v23
  v_and_b32 v25, 63, v23
  v_xor_b32 v25, v25, v21
  v_lshl_add_u32 v24, v24, 13, v20
  v_add_u32 v11, v24, v25
  v_add_u32 v13, 24576, v11
  v_lshrrev_b32 v23, 4, v0
  v_mul_u32_u24 v24, 80, v23
  v_lshlrev_b32 v23, 4, v23
  v_add_u32 v36, 0x20000, v23
  v_add_u32 v37, 0x20000, v24
  s_cmp_eq_u32 s50, 8
  s_cselect_b64 s[56:57], s[54:55], s[52:53]
  s_cselect_b32 s51, -18, 2
  s_add_u32 m0, s98, 90112
  s_nop 0
  global_load_lds_dwordx4 v[4:5], off offset:0
  s_add_u32 m0, s98, 98240
  s_nop 0
  global_load_lds_dwordx4 v[4:5], off offset:64
  s_add_u32 m0, s98, 106368
  s_nop 0
  global_load_lds_dwordx4 v[4:5], off offset:128
  v_lshl_add_u64 v[4:5], v[4:5], 0, s[56:57]
  s_xor_b32 m0, s49, 32768
  s_nop 0
  buffer_load_dwordx4 v2, s[8:11], s44 offen lds
  s_xor_b32 m0, s49, 34816
  s_nop 0
  buffer_load_dwordx4 v2, s[8:11], s45 offen lds
  s_waitcnt vmcnt(5)
  s_barrier
  ds_read_b64_tr_b16 a[64:65], v10 offset:0
  ds_read_b64_tr_b16 a[66:67], v10 offset:256
  ds_read_b64_tr_b16 a[68:69], v10 offset:4096
  ds_read_b64_tr_b16 a[70:71], v10 offset:4352
  ds_read_b128 a[0:3], v8 offset:0
  ds_read_b128 a[4:7], v9 offset:0
  ds_read_b128 a[8:11], v8 offset:2048
  ds_read_b128 a[12:15], v9 offset:2048
  ds_read_b128 a[16:19], v8 offset:4096
  ds_read_b128 a[20:23], v9 offset:4096
  ds_read_b128 a[24:27], v8 offset:6144
  ds_read_b128 a[28:31], v9 offset:6144
  ds_read_b64_tr_b16 a[72:73], v10 offset:512
  ds_read_b64_tr_b16 a[74:75], v10 offset:768
  ds_read_b64_tr_b16 a[76:77], v10 offset:4608
  ds_read_b64_tr_b16 a[78:79], v10 offset:4864
  s_waitcnt lgkmcnt(4)
  v_mfma_f32_16x16x32_bf16 v[64:67], a[64:67], a[0:3], 0
  ds_read_b64_tr_b16 a[80:81], v11 offset:0
  ds_read_b64_tr_b16 a[82:83], v11 offset:256
  v_mfma_f32_16x16x32_bf16 v[64:67], a[68:71], a[4:7], v[64:67]
  s_waitcnt lgkmcnt(6)
  ds_read_b64_tr_b16 a[84:85], v11 offset:4096
  ds_read_b64_tr_b16 a[86:87], v11 offset:4352
  v_mfma_f32_16x16x32_bf16 v[68:71], a[68:71], a[12:15], 0
  ds_read_b64_tr_b16 a[96:97], v56 offset:0
  ds_read_b64_tr_b16 a[98:99], v56 offset:256
  ds_read_b64_tr_b16 a[100:101], v56 offset:4096
  ds_read_b64_tr_b16 a[102:103], v56 offset:4352
  v_mfma_f32_16x16x32_bf16 v[68:71], a[64:67], a[8:11], v[68:71]
  s_xor_b32 m0, s49, 36864
  v_mfma_f32_16x16x32_bf16 v[72:75], a[64:67], a[16:19], 0
  v_mfma_f32_16x16x32_bf16 v[72:75], a[68:71], a[20:23], v[72:75]
  buffer_load_dwordx4 v2, s[8:11], s46 offen lds
  v_mfma_f32_16x16x32_bf16 v[76:79], a[68:71], a[28:31], 0
  v_mfma_f32_16x16x32_bf16 v[76:79], a[64:67], a[24:27], v[76:79]
  s_waitcnt lgkmcnt(8)
  ds_read_b64_tr_b16 a[88:89], v11 offset:512
  ds_read_b64_tr_b16 a[90:91], v11 offset:768
  ds_read_b64_tr_b16 a[92:93], v11 offset:4608
  ds_read_b64_tr_b16 a[94:95], v11 offset:4864
  v_mfma_f32_16x16x32_bf16 v[80:83], a[72:75], a[0:3], 0
  s_xor_b32 m0, s49, 38912
  v_mfma_f32_16x16x32_bf16 v[80:83], a[76:79], a[4:7], v[80:83]
  v_mfma_f32_16x16x32_bf16 v[84:87], a[76:79], a[12:15], 0
  ds_read_b64_tr_b16 a[104:105], v57 offset:0
  ds_read_b64_tr_b16 a[106:107], v57 offset:256
  ds_read_b64_tr_b16 a[108:109], v57 offset:4096
  ds_read_b64_tr_b16 a[110:111], v57 offset:4352
  v_mfma_f32_16x16x32_bf16 v[84:87], a[72:75], a[8:11], v[84:87]
  buffer_load_dwordx4 v2, s[8:11], s47 offen lds
  v_mfma_f32_16x16x32_bf16 v[88:91], a[72:75], a[16:19], 0
  v_mfma_f32_16x16x32_bf16 v[88:91], a[76:79], a[20:23], v[88:91]
  v_lshl_add_u32 v2, s51, 6, v2
  s_add_u32 m0, s99, 90112
  v_mfma_f32_16x16x32_bf16 v[92:95], a[76:79], a[28:31], 0
  v_mfma_f32_16x16x32_bf16 v[92:95], a[72:75], a[24:27], v[92:95]
  s_waitcnt lgkmcnt(12)
  ds_read_b64_tr_b16 a[64:65], v10 offset:8192
  ds_read_b64_tr_b16 a[66:67], v10 offset:8448
  ds_read_b64_tr_b16 a[68:69], v10 offset:12288
  ds_read_b64_tr_b16 a[70:71], v10 offset:12544
  v_mfma_f32_16x16x32_bf16 v[96:99], a[80:83], a[0:3], 0
  global_load_lds_dwordx4 v[6:7], off offset:0
  v_mfma_f32_16x16x32_bf16 v[96:99], a[84:87], a[4:7], v[96:99]
  v_mfma_f32_16x16x32_bf16 v[100:103], a[84:87], a[12:15], 0
  ds_read_b64_tr_b16 a[112:113], v58 offset:0
  ds_read_b64_tr_b16 a[114:115], v58 offset:256
  ds_read_b64_tr_b16 a[116:117], v58 offset:4096
  ds_read_b64_tr_b16 a[118:119], v58 offset:4352
  v_mfma_f32_16x16x32_bf16 v[100:103], a[80:83], a[8:11], v[100:103]
  s_add_u32 m0, s99, 98240
  v_mfma_f32_16x16x32_bf16 v[104:107], a[80:83], a[16:19], 0
  v_mfma_f32_16x16x32_bf16 v[104:107], a[84:87], a[20:23], v[104:107]
  global_load_lds_dwordx4 v[6:7], off offset:64
  v_mfma_f32_16x16x32_bf16 v[108:111], a[84:87], a[28:31], 0
  v_mfma_f32_16x16x32_bf16 v[108:111], a[80:83], a[24:27], v[108:111]
  s_waitcnt lgkmcnt(12)
  ds_read_b64_tr_b16 a[72:73], v10 offset:8704
  ds_read_b64_tr_b16 a[74:75], v10 offset:8960
  ds_read_b64_tr_b16 a[76:77], v10 offset:12800
  ds_read_b64_tr_b16 a[78:79], v10 offset:13056
  v_mfma_f32_16x16x32_bf16 v[112:115], a[88:91], a[0:3], 0
  s_add_u32 m0, s99, 106368
  v_mfma_f32_16x16x32_bf16 v[112:115], a[92:95], a[4:7], v[112:115]
  v_mfma_f32_16x16x32_bf16 v[116:119], a[92:95], a[12:15], 0
  global_load_lds_dwordx4 v[6:7], off offset:128
  v_mfma_f32_16x16x32_bf16 v[116:119], a[88:91], a[8:11], v[116:119]
  v_mfma_f32_16x16x32_bf16 v[120:123], a[88:91], a[16:19], 0
  v_mfma_f32_16x16x32_bf16 v[120:123], a[92:95], a[20:23], v[120:123]
  v_lshl_add_u64 v[6:7], v[6:7], 0, s[56:57]
  s_xor_b32 m0, s49, 33792
  v_mfma_f32_16x16x32_bf16 v[124:127], a[92:95], a[28:31], 0
  v_mfma_f32_16x16x32_bf16 v[124:127], a[88:91], a[24:27], v[124:127]
  s_waitcnt lgkmcnt(4)
  buffer_load_dwordx4 v3, s[8:11], s44 offen lds
  v_mfma_f32_16x16x32_bf16 v[40:43], v[52:55], a[96:99], 0
  v_mfma_f32_16x16x32_bf16 v[40:43], v[52:55], a[100:103], v[40:43]
  v_mfma_f32_16x16x32_bf16 v[44:47], v[52:55], a[104:107], 0
  v_mfma_f32_16x16x32_bf16 v[44:47], v[52:55], a[108:111], v[44:47]
  s_xor_b32 m0, s49, 35840
  v_mfma_f32_16x16x32_bf16 v[48:51], v[52:55], a[112:115], 0
  v_mfma_f32_16x16x32_bf16 v[48:51], v[52:55], a[116:119], v[48:51]
  ds_read_b64_tr_b16 a[80:81], v11 offset:8192
  ds_read_b64_tr_b16 a[82:83], v11 offset:8448
  ds_read_b64_tr_b16 a[84:85], v11 offset:12288
  ds_read_b64_tr_b16 a[86:87], v11 offset:12544
  v_mfma_f32_16x16x32_bf16 v[128:131], a[64:67], a[0:3], 0
  buffer_load_dwordx4 v3, s[8:11], s45 offen lds
  v_mfma_f32_16x16x32_bf16 v[128:131], a[68:71], a[4:7], v[128:131]
  v_mov_b32 v52, s21
  v_mov_b32 v53, s21
  v_mfma_f32_16x16x32_bf16 v[132:135], a[68:71], a[12:15], 0
  s_xor_b32 m0, s49, 37888
  v_mov_b32 v54, s21
  v_mov_b32 v55, s21
  v_mfma_f32_16x16x32_bf16 v[132:135], a[64:67], a[8:11], v[132:135]
  v_lshrrev_b32 v61, 4, v0
  v_and_b32 v62, 15, v0
  v_mfma_f32_16x16x32_bf16 v[136:139], a[64:67], a[16:19], 0
  buffer_load_dwordx4 v3, s[8:11], s46 offen lds
  v_mfma_f32_16x16x32_bf16 v[136:139], a[68:71], a[20:23], v[136:139]
  v_lshlrev_b32 v62, 4, v62
  v_lshl_add_u32 v38, v61, 10, v62
  v_mfma_f32_16x16x32_bf16 v[140:143], a[68:71], a[28:31], 0
  v_lshl_add_u32 v61, v61, 28, v62
  s_lshl_b32 s64, s7, 13
  v_mfma_f32_16x16x32_bf16 v[140:143], a[64:67], a[24:27], v[140:143]
  s_waitcnt lgkmcnt(4)
  ds_read_b64_tr_b16 a[88:89], v11 offset:8704
  ds_read_b64_tr_b16 a[90:91], v11 offset:8960
  ds_read_b64_tr_b16 a[92:93], v11 offset:12800
  ds_read_b64_tr_b16 a[94:95], v11 offset:13056
  v_mfma_f32_16x16x32_bf16 v[144:147], a[72:75], a[0:3], 0
  s_xor_b32 m0, s49, 39936
  s_lshl_b32 s66, s3, 8
  s_add_u32 s64, s64, s66
  v_mfma_f32_16x16x32_bf16 v[144:147], a[76:79], a[4:7], v[144:147]
  s_add_u32 s64, s64, 98304
  buffer_load_dwordx4 v3, s[8:11], s47 offen lds
  v_mfma_f32_16x16x32_bf16 v[148:151], a[76:79], a[12:15], 0
  s_lshl_b32 s65, s4, 10
  s_add_u32 s65, s65, s64
  v_mfma_f32_16x16x32_bf16 v[148:151], a[72:75], a[8:11], v[148:151]
  v_mfma_f32_16x16x32_bf16 v[152:155], a[72:75], a[16:19], 0
  v_lshl_add_u32 v3, s51, 6, v3
  v_mfma_f32_16x16x32_bf16 v[152:155], a[76:79], a[20:23], v[152:155]
  s_cmp_eq_u32 s50, 7
  s_cselect_b64 s[56:57], s[54:55], s[52:53]
  s_cselect_b32 s51, -18, 2
  v_mfma_f32_16x16x32_bf16 v[156:159], a[76:79], a[28:31], 0
  s_add_u32 m0, s98, 114688
  v_mfma_f32_16x16x32_bf16 v[156:159], a[72:75], a[24:27], v[156:159]
  s_waitcnt lgkmcnt(4)
  ds_read_b64_tr_b16 a[64:65], v10 offset:16384
  ds_read_b64_tr_b16 a[66:67], v10 offset:16640
  ds_read_b64_tr_b16 a[68:69], v10 offset:20480
  ds_read_b64_tr_b16 a[70:71], v10 offset:20736
  v_mfma_f32_16x16x32_bf16 v[160:163], a[80:83], a[0:3], 0
  global_load_lds_dwordx4 v[4:5], off offset:0
  v_mfma_f32_16x16x32_bf16 v[160:163], a[84:87], a[4:7], v[160:163]
  v_mfma_f32_16x16x32_bf16 v[164:167], a[84:87], a[12:15], 0
  s_add_u32 m0, s98, 122816
  v_mfma_f32_16x16x32_bf16 v[164:167], a[80:83], a[8:11], v[164:167]
  v_mfma_f32_16x16x32_bf16 v[168:171], a[80:83], a[16:19], 0
  global_load_lds_dwordx4 v[4:5], off offset:64
  v_mfma_f32_16x16x32_bf16 v[168:171], a[84:87], a[20:23], v[168:171]
  v_mfma_f32_16x16x32_bf16 v[172:175], a[84:87], a[28:31], 0
  v_mfma_f32_16x16x32_bf16 v[172:175], a[80:83], a[24:27], v[172:175]
  s_waitcnt lgkmcnt(4)
  ds_read_b64_tr_b16 a[72:73], v10 offset:16896
  ds_read_b64_tr_b16 a[74:75], v10 offset:17152
  ds_read_b64_tr_b16 a[76:77], v10 offset:20992
  ds_read_b64_tr_b16 a[78:79], v10 offset:21248
  v_mfma_f32_16x16x32_bf16 v[176:179], a[88:91], a[0:3], 0
  s_add_u32 m0, s98, 130944
  v_mfma_f32_16x16x32_bf16 v[176:179], a[92:95], a[4:7], v[176:179]
  global_load_lds_dwordx4 v[4:5], off offset:128
  v_mfma_f32_16x16x32_bf16 v[180:183], a[92:95], a[12:15], 0
  v_mfma_f32_16x16x32_bf16 v[180:183], a[88:91], a[8:11], v[180:183]
  v_mfma_f32_16x16x32_bf16 v[184:187], a[88:91], a[16:19], 0
  v_lshl_add_u64 v[4:5], v[4:5], 0, s[56:57]
  s_xor_b32 m0, s49, 0
  v_mfma_f32_16x16x32_bf16 v[184:187], a[92:95], a[20:23], v[184:187]
  v_mfma_f32_16x16x32_bf16 v[188:191], a[92:95], a[28:31], 0
  buffer_load_dwordx4 v2, s[8:11], s44 offen lds
  v_mfma_f32_16x16x32_bf16 v[188:191], a[88:91], a[24:27], v[188:191]
  s_waitcnt lgkmcnt(4)
  ds_read_b64_tr_b16 a[80:81], v11 offset:16384
  ds_read_b64_tr_b16 a[82:83], v11 offset:16640
  ds_read_b64_tr_b16 a[84:85], v11 offset:20480
  ds_read_b64_tr_b16 a[86:87], v11 offset:20736
  v_mfma_f32_16x16x32_bf16 v[192:195], a[64:67], a[0:3], 0
  v_mfma_f32_16x16x32_bf16 v[192:195], a[68:71], a[4:7], v[192:195]
  v_mfma_f32_16x16x32_bf16 v[196:199], a[68:71], a[12:15], 0
  s_waitcnt lgkmcnt(0)
  s_and_b32 s61, s62, -8
  s_add_u32 s61, s61, 8
  s_mov_b64 exec, 0
  s_cmp_eq_u32 s3, 0
  s_cbranch_scc1 L_hop_ffn0
  s_cmp_eq_u32 s3, 1
  s_cbranch_scc1 L_hop_ffn1
  s_cmp_eq_u32 s3, 2
  s_cbranch_scc1 L_hop_ffn2
  s_cmp_eq_u32 s3, 3
  s_cbranch_scc1 L_hop_ffn3
L_retffn1:
  s_mov_b64 exec, -1
  s_mov_b64 exec, 0
  s_cmp_eq_u32 s3, 0
  s_cbranch_scc1 L_hop_ffn4
  s_cmp_eq_u32 s3, 1
  s_cbranch_scc1 L_retffn2
  s_cmp_eq_u32 s3, 2
  s_cbranch_scc1 L_retffn2
  s_cmp_eq_u32 s3, 3
  s_cbranch_scc1 L_retffn2
L_retffn2:
  s_mov_b64 exec, -1
  s_waitcnt vmcnt(4)
  ds_read_b128 a[32:35], v8 offset:32768
  ds_read_b128 a[36:39], v9 offset:32768
  ds_read_b128 a[40:43], v8 offset:34816
  ds_read_b128 a[44:47], v9 offset:34816
  v_mfma_f32_16x16x32_bf16 v[196:199], a[64:67], a[8:11], v[196:199]
  s_xor_b32 m0, s49, 2048
  v_mfma_f32_16x16x32_bf16 v[200:203], a[64:67], a[16:19], 0
  buffer_load_dwordx4 v2, s[8:11], s45 offen lds
  v_mfma_f32_16x16x32_bf16 v[200:203], a[68:71], a[20:23], v[200:203]
  v_mfma_f32_16x16x32_bf16 v[204:207], a[68:71], a[28:31], 0
  v_mfma_f32_16x16x32_bf16 v[204:207], a[64:67], a[24:27], v[204:207]
  s_xor_b32 m0, s49, 4096
  ds_read_b64_tr_b16 a[88:89], v11 offset:16896
  ds_read_b64_tr_b16 a[90:91], v11 offset:17152
  ds_read_b64_tr_b16 a[92:93], v11 offset:20992
  ds_read_b64_tr_b16 a[94:95], v11 offset:21248
  v_mfma_f32_16x16x32_bf16 v[208:211], a[72:75], a[0:3], 0
  v_mfma_f32_16x16x32_bf16 v[208:211], a[76:79], a[4:7], v[208:211]
  buffer_load_dwordx4 v2, s[8:11], s46 offen lds
  v_mfma_f32_16x16x32_bf16 v[212:215], a[76:79], a[12:15], 0
  ds_read_b128 a[48:51], v8 offset:36864
  ds_read_b128 a[52:55], v9 offset:36864
  ds_read_b128 a[56:59], v8 offset:38912
  ds_read_b128 a[60:63], v9 offset:38912
  v_mfma_f32_16x16x32_bf16 v[212:215], a[72:75], a[8:11], v[212:215]
  v_mfma_f32_16x16x32_bf16 v[216:219], a[72:75], a[16:19], 0
  s_xor_b32 m0, s49, 6144
  v_mfma_f32_16x16x32_bf16 v[216:219], a[76:79], a[20:23], v[216:219]
  v_mfma_f32_16x16x32_bf16 v[220:223], a[76:79], a[28:31], 0
  buffer_load_dwordx4 v2, s[8:11], s47 offen lds
  v_mfma_f32_16x16x32_bf16 v[220:223], a[72:75], a[24:27], v[220:223]
  v_mfma_f32_16x16x32_bf16 v[224:227], a[80:83], a[0:3], 0
  v_mfma_f32_16x16x32_bf16 v[224:227], a[84:87], a[4:7], v[224:227]
  s_waitcnt lgkmcnt(0)
  s_barrier
  ds_read_b64_tr_b16 a[64:65], v10 offset:24576
  v_mfma_f32_16x16x32_bf16 v[228:231], a[84:87], a[12:15], 0
  ds_read_b64_tr_b16 a[66:67], v10 offset:24832
  v_lshl_add_u32 v2, s51, 6, v2
  v_mfma_f32_16x16x32_bf16 v[228:231], a[80:83], a[8:11], v[228:231]
  s_add_u32 m0, s99, 114688
  ds_read_b64_tr_b16 a[68:69], v10 offset:28672
  v_mfma_f32_16x16x32_bf16 v[232:235], a[80:83], a[16:19], 0
  ds_read_b64_tr_b16 a[70:71], v10 offset:28928
  v_mfma_f32_16x16x32_bf16 v[232:235], a[84:87], a[20:23], v[232:235]
  global_load_lds_dwordx4 v[6:7], off offset:0
  v_mfma_f32_16x16x32_bf16 v[236:239], a[84:87], a[28:31], 0
  v_mfma_f32_16x16x32_bf16 v[236:239], a[80:83], a[24:27], v[236:239]
  s_add_u32 m0, s99, 122816
  ds_read_b64_tr_b16 a[72:73], v10 offset:25088
  ds_read_b64_tr_b16 a[74:75], v10 offset:25344
  ds_read_b64_tr_b16 a[76:77], v10 offset:29184
  ds_read_b64_tr_b16 a[78:79], v10 offset:29440
  v_mfma_f32_16x16x32_bf16 v[240:243], a[88:91], a[0:3], 0
  v_mfma_f32_16x16x32_bf16 v[240:243], a[92:95], a[4:7], v[240:243]
  global_load_lds_dwordx4 v[6:7], off offset:64
  v_mfma_f32_16x16x32_bf16 v[244:247], a[92:95], a[12:15], 0
  v_mfma_f32_16x16x32_bf16 v[244:247], a[88:91], a[8:11], v[244:247]
  v_mfma_f32_16x16x32_bf16 v[248:251], a[88:91], a[16:19], 0
  s_add_u32 m0, s99, 130944
  v_mfma_f32_16x16x32_bf16 v[248:251], a[92:95], a[20:23], v[248:251]
  v_mfma_f32_16x16x32_bf16 v[252:255], a[92:95], a[28:31], 0
  global_load_lds_dwordx4 v[6:7], off offset:128
  v_mfma_f32_16x16x32_bf16 v[252:255], a[88:91], a[24:27], v[252:255]
  s_waitcnt lgkmcnt(4)
  ds_read_b64_tr_b16 a[80:81], v11 offset:24576
  ds_read_b64_tr_b16 a[82:83], v11 offset:24832
  ds_read_b64_tr_b16 a[84:85], v11 offset:28672
  ds_read_b64_tr_b16 a[86:87], v11 offset:28928
  v_mfma_f32_16x16x32_bf16 v[64:67], a[64:67], a[32:35], v[64:67]
  v_mfma_f32_16x16x32_bf16 v[64:67], a[68:71], a[36:39], v[64:67]
  v_lshl_add_u64 v[6:7], v[6:7], 0, s[56:57]
  s_xor_b32 m0, s49, 1024
  v_mfma_f32_16x16x32_bf16 v[68:71], a[68:71], a[44:47], v[68:71]
  ds_read_b64_tr_b16 a[96:97], v56 offset:24576
  ds_read_b64_tr_b16 a[98:99], v56 offset:24832
  ds_read_b64_tr_b16 a[100:101], v56 offset:28672
  ds_read_b64_tr_b16 a[102:103], v56 offset:28928
  v_mfma_f32_16x16x32_bf16 v[68:71], a[64:67], a[40:43], v[68:71]
  buffer_load_dwordx4 v3, s[8:11], s44 offen lds
  v_mfma_f32_16x16x32_bf16 v[72:75], a[64:67], a[48:51], v[72:75]
  v_mfma_f32_16x16x32_bf16 v[72:75], a[68:71], a[52:55], v[72:75]
  v_mfma_f32_16x16x32_bf16 v[76:79], a[68:71], a[60:63], v[76:79]
  v_mfma_f32_16x16x32_bf16 v[76:79], a[64:67], a[56:59], v[76:79]
  s_waitcnt lgkmcnt(8)
  ds_read_b64_tr_b16 a[88:89], v11 offset:25088
  ds_read_b64_tr_b16 a[90:91], v11 offset:25344
  ds_read_b64_tr_b16 a[92:93], v11 offset:29184
  ds_read_b64_tr_b16 a[94:95], v11 offset:29440
  v_mfma_f32_16x16x32_bf16 v[80:83], a[72:75], a[32:35], v[80:83]
  s_xor_b32 m0, s49, 3072
  v_mfma_f32_16x16x32_bf16 v[80:83], a[76:79], a[36:39], v[80:83]
  buffer_load_dwordx4 v3, s[8:11], s45 offen lds
  v_mfma_f32_16x16x32_bf16 v[84:87], a[76:79], a[44:47], v[84:87]
  ds_read_b64_tr_b16 a[104:105], v57 offset:24576
  ds_read_b64_tr_b16 a[106:107], v57 offset:24832
  ds_read_b64_tr_b16 a[108:109], v57 offset:28672
  ds_read_b64_tr_b16 a[110:111], v57 offset:28928
  v_mfma_f32_16x16x32_bf16 v[84:87], a[72:75], a[40:43], v[84:87]
  v_mfma_f32_16x16x32_bf16 v[88:91], a[72:75], a[48:51], v[88:91]
  s_xor_b32 m0, s49, 5120
  v_mfma_f32_16x16x32_bf16 v[88:91], a[76:79], a[52:55], v[88:91]
  v_mfma_f32_16x16x32_bf16 v[92:95], a[76:79], a[60:63], v[92:95]
  buffer_load_dwordx4 v3, s[8:11], s46 offen lds
  v_mfma_f32_16x16x32_bf16 v[92:95], a[72:75], a[56:59], v[92:95]
  s_waitcnt lgkmcnt(12)
  ds_read_b64_tr_b16 a[64:65], v10 offset:32768
  ds_read_b64_tr_b16 a[66:67], v10 offset:33024
  ds_read_b64_tr_b16 a[68:69], v10 offset:36864
  ds_read_b64_tr_b16 a[70:71], v10 offset:37120
  v_mfma_f32_16x16x32_bf16 v[96:99], a[80:83], a[32:35], v[96:99]
  v_mfma_f32_16x16x32_bf16 v[96:99], a[84:87], a[36:39], v[96:99]
  s_xor_b32 m0, s49, 7168
  v_mfma_f32_16x16x32_bf16 v[100:103], a[84:87], a[44:47], v[100:103]
  ds_read_b64_tr_b16 a[112:113], v58 offset:24576
  ds_read_b64_tr_b16 a[114:115], v58 offset:24832
  ds_read_b64_tr_b16 a[116:117], v58 offset:28672
  ds_read_b64_tr_b16 a[118:119], v58 offset:28928
  v_mfma_f32_16x16x32_bf16 v[100:103], a[80:83], a[40:43], v[100:103]
  buffer_load_dwordx4 v3, s[8:11], s47 offen lds
  v_mfma_f32_16x16x32_bf16 v[104:107], a[80:83], a[48:51], v[104:107]
  v_mfma_f32_16x16x32_bf16 v[104:107], a[84:87], a[52:55], v[104:107]
  v_mfma_f32_16x16x32_bf16 v[108:111], a[84:87], a[60:63], v[108:111]
  v_mfma_f32_16x16x32_bf16 v[108:111], a[80:83], a[56:59], v[108:111]
  s_waitcnt lgkmcnt(12)
  ds_read_b64_tr_b16 a[72:73], v10 offset:33280
  ds_read_b64_tr_b16 a[74:75], v10 offset:33536
  ds_read_b64_tr_b16 a[76:77], v10 offset:37376
  ds_read_b64_tr_b16 a[78:79], v10 offset:37632
  v_mfma_f32_16x16x32_bf16 v[112:115], a[88:91], a[32:35], v[112:115]
  v_lshl_add_u32 v3, s51, 6, v3
  v_mfma_f32_16x16x32_bf16 v[112:115], a[92:95], a[36:39], v[112:115]
  s_cmp_eq_u32 s50, 6
  s_cselect_b64 s[56:57], s[54:55], s[52:53]
  s_cselect_b32 s51, -18, 2
  v_mfma_f32_16x16x32_bf16 v[116:119], a[92:95], a[44:47], v[116:119]
  s_add_u32 m0, s98, 65536
  v_mfma_f32_16x16x32_bf16 v[116:119], a[88:91], a[40:43], v[116:119]
  global_load_lds_dwordx4 v[4:5], off offset:0
  v_mfma_f32_16x16x32_bf16 v[120:123], a[88:91], a[48:51], v[120:123]
  s_add_u32 m0, s98, 73664
  v_mfma_f32_16x16x32_bf16 v[120:123], a[92:95], a[52:55], v[120:123]
  v_mfma_f32_16x16x32_bf16 v[124:127], a[92:95], a[60:63], v[124:127]
  global_load_lds_dwordx4 v[4:5], off offset:64
  v_mfma_f32_16x16x32_bf16 v[124:127], a[88:91], a[56:59], v[124:127]
  s_waitcnt lgkmcnt(4)
  v_mfma_f32_16x16x32_bf16 v[40:43], v[52:55], a[96:99], v[40:43]
  v_mfma_f32_16x16x32_bf16 v[40:43], v[52:55], a[100:103], v[40:43]
  s_add_u32 m0, s98, 81792
  v_mfma_f32_16x16x32_bf16 v[44:47], v[52:55], a[104:107], v[44:47]
  v_mfma_f32_16x16x32_bf16 v[44:47], v[52:55], a[108:111], v[44:47]
  global_load_lds_dwordx4 v[4:5], off offset:128
  v_mfma_f32_16x16x32_bf16 v[48:51], v[52:55], a[112:115], v[48:51]
  v_mfma_f32_16x16x32_bf16 v[48:51], v[52:55], a[116:119], v[48:51]
  ds_read_b64_tr_b16 a[80:81], v11 offset:32768
  ds_read_b64_tr_b16 a[82:83], v11 offset:33024
  ds_read_b64_tr_b16 a[84:85], v11 offset:36864
  ds_read_b64_tr_b16 a[86:87], v11 offset:37120
  v_mfma_f32_16x16x32_bf16 v[128:131], a[64:67], a[32:35], v[128:131]
  v_mov_b32 v52, s22
  v_mov_b32 v53, s22
  v_mfma_f32_16x16x32_bf16 v[128:131], a[68:71], a[36:39], v[128:131]
  v_lshl_add_u64 v[4:5], v[4:5], 0, s[56:57]
  s_xor_b32 m0, s49, 32768
  v_mfma_f32_16x16x32_bf16 v[132:135], a[68:71], a[44:47], v[132:135]
  v_mov_b32 v54, s22
  v_mov_b32 v55, s22
  v_mfma_f32_16x16x32_bf16 v[132:135], a[64:67], a[40:43], v[132:135]
  buffer_load_dwordx4 v2, s[8:11], s44 offen lds
  v_mfma_f32_16x16x32_bf16 v[136:139], a[64:67], a[48:51], v[136:139]
  v_mfma_f32_16x16x32_bf16 v[136:139], a[68:71], a[52:55], v[136:139]
  v_mfma_f32_16x16x32_bf16 v[140:143], a[68:71], a[60:63], v[140:143]
  s_xor_b32 m0, s49, 34816
  v_mfma_f32_16x16x32_bf16 v[140:143], a[64:67], a[56:59], v[140:143]
  s_waitcnt lgkmcnt(4)
  ds_read_b64_tr_b16 a[88:89], v11 offset:33280
  ds_read_b64_tr_b16 a[90:91], v11 offset:33536
  ds_read_b64_tr_b16 a[92:93], v11 offset:37376
  ds_read_b64_tr_b16 a[94:95], v11 offset:37632
  v_mfma_f32_16x16x32_bf16 v[144:147], a[72:75], a[32:35], v[144:147]
  buffer_load_dwordx4 v2, s[8:11], s45 offen lds
  v_mfma_f32_16x16x32_bf16 v[144:147], a[76:79], a[36:39], v[144:147]
  v_mfma_f32_16x16x32_bf16 v[148:151], a[76:79], a[44:47], v[148:151]
  v_mfma_f32_16x16x32_bf16 v[148:151], a[72:75], a[40:43], v[148:151]
  s_xor_b32 m0, s49, 36864
  v_mfma_f32_16x16x32_bf16 v[152:155], a[72:75], a[48:51], v[152:155]
  v_mfma_f32_16x16x32_bf16 v[152:155], a[76:79], a[52:55], v[152:155]
  buffer_load_dwordx4 v2, s[8:11], s46 offen lds
  v_mfma_f32_16x16x32_bf16 v[156:159], a[76:79], a[60:63], v[156:159]
  v_mfma_f32_16x16x32_bf16 v[156:159], a[72:75], a[56:59], v[156:159]
  s_waitcnt lgkmcnt(4)
  ds_read_b64_tr_b16 a[64:65], v10 offset:40960
  ds_read_b64_tr_b16 a[66:67], v10 offset:41216
  ds_read_b64_tr_b16 a[68:69], v10 offset:45056
  ds_read_b64_tr_b16 a[70:71], v10 offset:45312
  v_mfma_f32_16x16x32_bf16 v[160:163], a[80:83], a[32:35], v[160:163]
  v_mfma_f32_16x16x32_bf16 v[160:163], a[84:87], a[36:39], v[160:163]
  s_xor_b32 m0, s49, 38912
  v_mfma_f32_16x16x32_bf16 v[164:167], a[84:87], a[44:47], v[164:167]
  v_mfma_f32_16x16x32_bf16 v[164:167], a[80:83], a[40:43], v[164:167]
  buffer_load_dwordx4 v2, s[8:11], s47 offen lds
  v_mfma_f32_16x16x32_bf16 v[168:171], a[80:83], a[48:51], v[168:171]
  v_mfma_f32_16x16x32_bf16 v[168:171], a[84:87], a[52:55], v[168:171]
  v_mfma_f32_16x16x32_bf16 v[172:175], a[84:87], a[60:63], v[172:175]
  v_lshl_add_u32 v2, s51, 6, v2
  s_add_u32 m0, s99, 65536
  v_mfma_f32_16x16x32_bf16 v[172:175], a[80:83], a[56:59], v[172:175]
  s_waitcnt lgkmcnt(4)
  ds_read_b64_tr_b16 a[72:73], v10 offset:41472
  ds_read_b64_tr_b16 a[74:75], v10 offset:41728
  ds_read_b64_tr_b16 a[76:77], v10 offset:45568
  ds_read_b64_tr_b16 a[78:79], v10 offset:45824
  v_mfma_f32_16x16x32_bf16 v[176:179], a[88:91], a[32:35], v[176:179]
  global_load_lds_dwordx4 v[6:7], off offset:0
  v_mfma_f32_16x16x32_bf16 v[176:179], a[92:95], a[36:39], v[176:179]
  v_mfma_f32_16x16x32_bf16 v[180:183], a[92:95], a[44:47], v[180:183]
  v_mfma_f32_16x16x32_bf16 v[180:183], a[88:91], a[40:43], v[180:183]
  s_add_u32 m0, s99, 73664
  v_mfma_f32_16x16x32_bf16 v[184:187], a[88:91], a[48:51], v[184:187]
  v_mfma_f32_16x16x32_bf16 v[184:187], a[92:95], a[52:55], v[184:187]
  global_load_lds_dwordx4 v[6:7], off offset:64
  v_mfma_f32_16x16x32_bf16 v[188:191], a[92:95], a[60:63], v[188:191]
  v_mfma_f32_16x16x32_bf16 v[188:191], a[88:91], a[56:59], v[188:191]
  s_waitcnt lgkmcnt(4)
  ds_read_b64_tr_b16 a[80:81], v11 offset:40960
  ds_read_b64_tr_b16 a[82:83], v11 offset:41216
  ds_read_b64_tr_b16 a[84:85], v11 offset:45056
  ds_read_b64_tr_b16 a[86:87], v11 offset:45312
  v_mfma_f32_16x16x32_bf16 v[192:195], a[64:67], a[32:35], v[192:195]
  s_add_u32 m0, s99, 81792
  v_mfma_f32_16x16x32_bf16 v[192:195], a[68:71], a[36:39], v[192:195]
  v_mfma_f32_16x16x32_bf16 v[196:199], a[68:71], a[44:47], v[196:199]
  s_waitcnt vmcnt(9)
  ds_read_b128 a[0:3], v8 offset:0
  ds_read_b128 a[4:7], v9 offset:0
  ds_read_b128 a[8:11], v8 offset:2048
  ds_read_b128 a[12:15], v9 offset:2048
  v_mfma_f32_16x16x32_bf16 v[196:199], a[64:67], a[40:43], v[196:199]
  global_load_lds_dwordx4 v[6:7], off offset:128
  v_mfma_f32_16x16x32_bf16 v[200:203], a[64:67], a[48:51], v[200:203]
  v_mfma_f32_16x16x32_bf16 v[200:203], a[68:71], a[52:55], v[200:203]
  v_mfma_f32_16x16x32_bf16 v[204:207], a[68:71], a[60:63], v[204:207]
  v_lshl_add_u64 v[6:7], v[6:7], 0, s[56:57]
  s_xor_b32 m0, s49, 33792
  v_mfma_f32_16x16x32_bf16 v[204:207], a[64:67], a[56:59], v[204:207]
  s_waitcnt lgkmcnt(8)
  ds_read_b64_tr_b16 a[88:89], v11 offset:41472
  ds_read_b64_tr_b16 a[90:91], v11 offset:41728
  ds_read_b64_tr_b16 a[92:93], v11 offset:45568
  ds_read_b64_tr_b16 a[94:95], v11 offset:45824
  v_mfma_f32_16x16x32_bf16 v[208:211], a[72:75], a[32:35], v[208:211]
  buffer_load_dwordx4 v3, s[8:11], s44 offen lds
  v_mfma_f32_16x16x32_bf16 v[208:211], a[76:79], a[36:39], v[208:211]
  v_mfma_f32_16x16x32_bf16 v[212:215], a[76:79], a[44:47], v[212:215]
  ds_read_b128 a[16:19], v8 offset:4096
  ds_read_b128 a[20:23], v9 offset:4096
  ds_read_b128 a[24:27], v8 offset:6144
  ds_read_b128 a[28:31], v9 offset:6144
  v_mfma_f32_16x16x32_bf16 v[212:215], a[72:75], a[40:43], v[212:215]
  s_xor_b32 m0, s49, 35840
  v_mfma_f32_16x16x32_bf16 v[216:219], a[72:75], a[48:51], v[216:219]
  v_mfma_f32_16x16x32_bf16 v[216:219], a[76:79], a[52:55], v[216:219]
  buffer_load_dwordx4 v3, s[8:11], s45 offen lds
  v_mfma_f32_16x16x32_bf16 v[220:223], a[76:79], a[60:63], v[220:223]
  v_mfma_f32_16x16x32_bf16 v[220:223], a[72:75], a[56:59], v[220:223]
  s_waitcnt lgkmcnt(14)
  v_mfma_f32_16x16x32_bf16 v[224:227], a[80:83], a[32:35], v[224:227]
  s_waitcnt lgkmcnt(12)
  s_xor_b32 m0, s49, 37888
  v_mfma_f32_16x16x32_bf16 v[224:227], a[84:87], a[36:39], v[224:227]
  s_waitcnt lgkmcnt(0)
  s_barrier
  ds_read_b64_tr_b16 a[64:65], v12 offset:24576
  v_mfma_f32_16x16x32_bf16 v[228:231], a[84:87], a[44:47], v[228:231]
  ds_read_b64_tr_b16 a[66:67], v12 offset:24832
  v_mfma_f32_16x16x32_bf16 v[228:231], a[80:83], a[40:43], v[228:231]
  ds_read_b64_tr_b16 a[68:69], v12 offset:28672
  v_mfma_f32_16x16x32_bf16 v[232:235], a[80:83], a[48:51], v[232:235]
  ds_read_b64_tr_b16 a[70:71], v12 offset:28928
  v_mfma_f32_16x16x32_bf16 v[232:235], a[84:87], a[52:55], v[232:235]
  buffer_load_dwordx4 v3, s[8:11], s46 offen lds
  v_mfma_f32_16x16x32_bf16 v[236:239], a[84:87], a[60:63], v[236:239]
  s_xor_b32 m0, s49, 39936
  v_mfma_f32_16x16x32_bf16 v[236:239], a[80:83], a[56:59], v[236:239]
  ds_read_b64_tr_b16 a[72:73], v12 offset:25088
  ds_read_b64_tr_b16 a[74:75], v12 offset:25344
  ds_read_b64_tr_b16 a[76:77], v12 offset:29184
  ds_read_b64_tr_b16 a[78:79], v12 offset:29440
  v_mfma_f32_16x16x32_bf16 v[240:243], a[88:91], a[32:35], v[240:243]
  buffer_load_dwordx4 v3, s[8:11], s47 offen lds
  v_mfma_f32_16x16x32_bf16 v[240:243], a[92:95], a[36:39], v[240:243]
  v_mfma_f32_16x16x32_bf16 v[244:247], a[92:95], a[44:47], v[244:247]
  v_mfma_f32_16x16x32_bf16 v[244:247], a[88:91], a[40:43], v[244:247]
  v_lshl_add_u32 v3, s51, 6, v3
  v_mfma_f32_16x16x32_bf16 v[248:251], a[88:91], a[48:51], v[248:251]
  s_cmp_eq_u32 s50, 5
  s_cselect_b64 s[56:57], s[54:55], s[52:53]
  s_cselect_b32 s51, -18, 2
  v_mfma_f32_16x16x32_bf16 v[248:251], a[92:95], a[52:55], v[248:251]
  s_add_u32 m0, s98, 90112
  v_mfma_f32_16x16x32_bf16 v[252:255], a[92:95], a[60:63], v[252:255]
L_hop_ffn0:
  s_cbranch_execz L_retffn1
  global_load_lds_dwordx4 v[4:5], off offset:0
  v_mfma_f32_16x16x32_bf16 v[252:255], a[88:91], a[56:59], v[252:255]
  s_waitcnt lgkmcnt(6)
  ds_read_b64_tr_b16 a[80:81], v13 offset:24576
  ds_read_b64_tr_b16 a[82:83], v13 offset:24832
  v_mfma_f32_16x16x32_bf16 v[64:67], a[64:67], a[0:3], v[64:67]
  s_waitcnt lgkmcnt(6)
  ds_read_b64_tr_b16 a[84:85], v13 offset:28672
  ds_read_b64_tr_b16 a[86:87], v13 offset:28928
  v_mfma_f32_16x16x32_bf16 v[64:67], a[68:71], a[4:7], v[64:67]
  s_add_u32 m0, s98, 98240
  v_mfma_f32_16x16x32_bf16 v[68:71], a[68:71], a[12:15], v[68:71]
  ds_read_b64_tr_b16 a[96:97], v56 offset:49152
  v_mfma_f32_16x16x32_bf16 v[68:71], a[64:67], a[8:11], v[68:71]
  ds_read_b64_tr_b16 a[98:99], v56 offset:49408
  v_mfma_f32_16x16x32_bf16 v[72:75], a[64:67], a[16:19], v[72:75]
  ds_read_b64_tr_b16 a[100:101], v56 offset:53248
  v_mfma_f32_16x16x32_bf16 v[72:75], a[68:71], a[20:23], v[72:75]
  ds_read_b64_tr_b16 a[102:103], v56 offset:53504
  v_mfma_f32_16x16x32_bf16 v[76:79], a[68:71], a[28:31], v[76:79]
  global_load_lds_dwordx4 v[4:5], off offset:64
  v_mfma_f32_16x16x32_bf16 v[76:79], a[64:67], a[24:27], v[76:79]
  s_waitcnt lgkmcnt(10)
  ds_read_b64_tr_b16 a[88:89], v13 offset:25088
  ds_read_b64_tr_b16 a[90:91], v13 offset:25344
  v_mfma_f32_16x16x32_bf16 v[80:83], a[72:75], a[0:3], v[80:83]
  s_waitcnt lgkmcnt(10)
  ds_read_b64_tr_b16 a[92:93], v13 offset:29184
  ds_read_b64_tr_b16 a[94:95], v13 offset:29440
  v_mfma_f32_16x16x32_bf16 v[80:83], a[76:79], a[4:7], v[80:83]
  s_add_u32 m0, s98, 106368
  v_mfma_f32_16x16x32_bf16 v[84:87], a[76:79], a[12:15], v[84:87]
  ds_read_b64_tr_b16 a[104:105], v57 offset:49152
  v_mfma_f32_16x16x32_bf16 v[84:87], a[72:75], a[8:11], v[84:87]
  ds_read_b64_tr_b16 a[106:107], v57 offset:49408
  v_mfma_f32_16x16x32_bf16 v[88:91], a[72:75], a[16:19], v[88:91]
  ds_read_b64_tr_b16 a[108:109], v57 offset:53248
  v_mfma_f32_16x16x32_bf16 v[88:91], a[76:79], a[20:23], v[88:91]
  ds_read_b64_tr_b16 a[110:111], v57 offset:53504
  v_mfma_f32_16x16x32_bf16 v[92:95], a[76:79], a[28:31], v[92:95]
  global_load_lds_dwordx4 v[4:5], off offset:128
  v_mfma_f32_16x16x32_bf16 v[92:95], a[72:75], a[24:27], v[92:95]
  s_waitcnt lgkmcnt(14)
  ds_read_b64_tr_b16 a[64:65], v12 offset:32768
  ds_read_b64_tr_b16 a[66:67], v12 offset:33024
  v_mfma_f32_16x16x32_bf16 v[96:99], a[80:83], a[0:3], v[96:99]
  s_waitcnt lgkmcnt(14)
  ds_read_b64_tr_b16 a[68:69], v12 offset:36864
  ds_read_b64_tr_b16 a[70:71], v12 offset:37120
  v_mfma_f32_16x16x32_bf16 v[96:99], a[84:87], a[4:7], v[96:99]
  v_lshl_add_u64 v[4:5], v[4:5], 0, s[56:57]
  s_xor_b32 m0, s49, 0
  v_mfma_f32_16x16x32_bf16 v[100:103], a[84:87], a[12:15], v[100:103]
  ds_read_b64_tr_b16 a[112:113], v58 offset:49152
  v_mfma_f32_16x16x32_bf16 v[100:103], a[80:83], a[8:11], v[100:103]
  ds_read_b64_tr_b16 a[114:115], v58 offset:49408
  v_mfma_f32_16x16x32_bf16 v[104:107], a[80:83], a[16:19], v[104:107]
  ds_read_b64_tr_b16 a[116:117], v58 offset:53248
  v_mfma_f32_16x16x32_bf16 v[104:107], a[84:87], a[20:23], v[104:107]
  ds_read_b64_tr_b16 a[118:119], v58 offset:53504
  v_mfma_f32_16x16x32_bf16 v[108:111], a[84:87], a[28:31], v[108:111]
  buffer_load_dwordx4 v2, s[8:11], s44 offen lds
  v_mfma_f32_16x16x32_bf16 v[108:111], a[80:83], a[24:27], v[108:111]
  s_waitcnt lgkmcnt(14)
  ds_read_b64_tr_b16 a[72:73], v12 offset:33280
  ds_read_b64_tr_b16 a[74:75], v12 offset:33536
  v_mfma_f32_16x16x32_bf16 v[112:115], a[88:91], a[0:3], v[112:115]
  s_waitcnt lgkmcnt(14)
  ds_read_b64_tr_b16 a[76:77], v12 offset:37376
  ds_read_b64_tr_b16 a[78:79], v12 offset:37632
  v_mfma_f32_16x16x32_bf16 v[112:115], a[92:95], a[4:7], v[112:115]
  s_xor_b32 m0, s49, 2048
  v_mfma_f32_16x16x32_bf16 v[116:119], a[92:95], a[12:15], v[116:119]
  buffer_load_dwordx4 v2, s[8:11], s45 offen lds
  v_mfma_f32_16x16x32_bf16 v[116:119], a[88:91], a[8:11], v[116:119]
  s_xor_b32 m0, s49, 4096
  v_mfma_f32_16x16x32_bf16 v[120:123], a[88:91], a[16:19], v[120:123]
  buffer_load_dwordx4 v2, s[8:11], s46 offen lds
  v_mfma_f32_16x16x32_bf16 v[120:123], a[92:95], a[20:23], v[120:123]
  s_xor_b32 m0, s49, 6144
  v_mfma_f32_16x16x32_bf16 v[124:127], a[92:95], a[28:31], v[124:127]
  buffer_load_dwordx4 v2, s[8:11], s47 offen lds
  v_mfma_f32_16x16x32_bf16 v[124:127], a[88:91], a[24:27], v[124:127]
  s_waitcnt lgkmcnt(4)
  v_mfma_f32_16x16x32_bf16 v[40:43], v[52:55], a[96:99], v[40:43]
  v_lshl_add_u32 v2, s51, 6, v2
  s_add_u32 m0, s99, 90112
  v_mfma_f32_16x16x32_bf16 v[40:43], v[52:55], a[100:103], v[40:43]
  v_mfma_f32_16x16x32_bf16 v[44:47], v[52:55], a[104:107], v[44:47]
  global_load_lds_dwordx4 v[6:7], off offset:0
  v_mfma_f32_16x16x32_bf16 v[44:47], v[52:55], a[108:111], v[44:47]
  v_mfma_f32_16x16x32_bf16 v[48:51], v[52:55], a[112:115], v[48:51]
  v_mfma_f32_16x16x32_bf16 v[48:51], v[52:55], a[116:119], v[48:51]
  s_waitcnt lgkmcnt(4)
  ds_read_b64_tr_b16 a[80:81], v13 offset:32768
  ds_read_b64_tr_b16 a[82:83], v13 offset:33024
  v_mfma_f32_16x16x32_bf16 v[128:131], a[64:67], a[0:3], v[128:131]
  s_waitcnt lgkmcnt(6)
  ds_read_b64_tr_b16 a[84:85], v13 offset:36864
  ds_read_b64_tr_b16 a[86:87], v13 offset:37120
  v_mfma_f32_16x16x32_bf16 v[128:131], a[68:71], a[4:7], v[128:131]
  s_add_u32 m0, s99, 98240
  v_mfma_f32_16x16x32_bf16 v[132:135], a[68:71], a[12:15], v[132:135]
  global_load_lds_dwordx4 v[6:7], off offset:64
  v_mfma_f32_16x16x32_bf16 v[132:135], a[64:67], a[8:11], v[132:135]
  v_mfma_f32_16x16x32_bf16 v[136:139], a[64:67], a[16:19], v[136:139]
  v_mfma_f32_16x16x32_bf16 v[136:139], a[68:71], a[20:23], v[136:139]
  s_add_u32 m0, s99, 106368
  v_mfma_f32_16x16x32_bf16 v[140:143], a[68:71], a[28:31], v[140:143]
  v_mfma_f32_16x16x32_bf16 v[140:143], a[64:67], a[24:27], v[140:143]
  s_waitcnt lgkmcnt(6)
  ds_read_b64_tr_b16 a[88:89], v13 offset:33280
  ds_read_b64_tr_b16 a[90:91], v13 offset:33536
  v_mfma_f32_16x16x32_bf16 v[144:147], a[72:75], a[0:3], v[144:147]
  s_waitcnt lgkmcnt(6)
  ds_read_b64_tr_b16 a[92:93], v13 offset:37376
  ds_read_b64_tr_b16 a[94:95], v13 offset:37632
  v_mfma_f32_16x16x32_bf16 v[144:147], a[76:79], a[4:7], v[144:147]
  global_load_lds_dwordx4 v[6:7], off offset:128
  v_mfma_f32_16x16x32_bf16 v[148:151], a[76:79], a[12:15], v[148:151]
  v_mov_b32 v41, v44
  v_mov_b32 v42, v48
  v_mfma_f32_16x16x32_bf16 v[148:151], a[72:75], a[8:11], v[148:151]
  v_lshl_add_u64 v[6:7], v[6:7], 0, s[56:57]
  s_xor_b32 m0, s49, 1024
  v_mfma_f32_16x16x32_bf16 v[152:155], a[72:75], a[16:19], v[152:155]
  v_mov_b32 v43, s61
  v_mfma_f32_16x16x32_bf16 v[152:155], a[76:79], a[20:23], v[152:155]
  buffer_load_dwordx4 v3, s[8:11], s44 offen lds
  v_mfma_f32_16x16x32_bf16 v[156:159], a[76:79], a[28:31], v[156:159]
  buffer_store_dwordx4 v[40:43], v61, s[12:15], s65 offen sc1
  v_mfma_f32_16x16x32_bf16 v[156:159], a[72:75], a[24:27], v[156:159]
  s_waitcnt lgkmcnt(6)
  ds_read_b64_tr_b16 a[64:65], v12 offset:40960
  ds_read_b64_tr_b16 a[66:67], v12 offset:41216
  v_mfma_f32_16x16x32_bf16 v[160:163], a[80:83], a[0:3], v[160:163]
  s_waitcnt lgkmcnt(6)
  ds_read_b64_tr_b16 a[68:69], v12 offset:45056
  ds_read_b64_tr_b16 a[70:71], v12 offset:45312
  v_mfma_f32_16x16x32_bf16 v[160:163], a[84:87], a[4:7], v[160:163]
  v_not_b32 v39, v43
  s_mov_b32 s62, 26214400
  v_mfma_f32_16x16x32_bf16 v[164:167], a[84:87], a[12:15], v[164:167]
  s_xor_b32 m0, s49, 3072
  buffer_store_dword v39, v1, s[12:15], s62 offen sc1
  v_mfma_f32_16x16x32_bf16 v[164:167], a[80:83], a[8:11], v[164:167]
  s_add_u32 s65, s64, 4096
  s_lshl_b32 s66, s4, 2
  s_add_u32 s66, s66, s3
  v_mfma_f32_16x16x32_bf16 v[168:171], a[80:83], a[16:19], v[168:171]
  s_lshl_b32 s66, s66, 9
  buffer_load_dwordx4 v3, s[8:11], s45 offen lds
  v_mfma_f32_16x16x32_bf16 v[168:171], a[84:87], a[20:23], v[168:171]
  s_add_u32 s66, s66, 65536
  v_lshlrev_b32 v62, 3, v0
  s_mul_i32 s67, s3, 192
  v_mfma_f32_16x16x32_bf16 v[172:175], a[84:87], a[28:31], v[172:175]
  s_add_u32 s67, s67, 139264
  v_min_u32 v61, 48, v0
  v_cmp_lt_u32 vcc, 47, v0
  v_mfma_f32_16x16x32_bf16 v[172:175], a[80:83], a[24:27], v[172:175]
  s_waitcnt lgkmcnt(6)
  ds_read_b64_tr_b16 a[72:73], v12 offset:41472
  ds_read_b64_tr_b16 a[74:75], v12 offset:41728
  v_mfma_f32_16x16x32_bf16 v[176:179], a[88:91], a[0:3], v[176:179]
  s_waitcnt lgkmcnt(6)
  ds_read_b64_tr_b16 a[76:77], v12 offset:45568
  ds_read_b64_tr_b16 a[78:79], v12 offset:45824
  v_mfma_f32_16x16x32_bf16 v[176:179], a[92:95], a[4:7], v[176:179]
  s_xor_b32 m0, s49, 5120
  v_lshl_add_u32 v61, v61, 2, s67
  v_mov_b32 v56, 140032
  v_mfma_f32_16x16x32_bf16 v[180:183], a[92:95], a[12:15], v[180:183]
  s_lshl_b32 s67, s3, 10
  buffer_load_dwordx4 v3, s[8:11], s46 offen lds
  v_mfma_f32_16x16x32_bf16 v[180:183], a[88:91], a[8:11], v[180:183]
  s_add_u32 s67, s67, 140288
  v_cndmask_b32 v61, v61, v56, vcc
  v_lshl_add_u32 v56, v0, 2, s67
  v_mfma_f32_16x16x32_bf16 v[184:187], a[88:91], a[16:19], v[184:187]
  v_and_b32 v57, 15, v0
  v_lshl_add_u32 v57, v57, 2, s67
  v_mfma_f32_16x16x32_bf16 v[184:187], a[92:95], a[20:23], v[184:187]
  v_mfma_f32_16x16x32_bf16 v[188:191], a[92:95], a[28:31], v[188:191]
  v_mfma_f32_16x16x32_bf16 v[188:191], a[88:91], a[24:27], v[188:191]
  s_waitcnt lgkmcnt(6)
  ds_read_b64_tr_b16 a[80:81], v13 offset:40960
  ds_read_b64_tr_b16 a[82:83], v13 offset:41216
  v_mfma_f32_16x16x32_bf16 v[192:195], a[64:67], a[0:3], v[192:195]
  s_waitcnt lgkmcnt(6)
  ds_read_b64_tr_b16 a[84:85], v13 offset:45056
  ds_read_b64_tr_b16 a[86:87], v13 offset:45312
  v_mfma_f32_16x16x32_bf16 v[192:195], a[68:71], a[4:7], v[192:195]
  s_xor_b32 m0, s49, 7168
  v_mfma_f32_16x16x32_bf16 v[196:199], a[68:71], a[12:15], v[196:199]
  s_waitcnt vmcnt(15)
  ds_read_b128 a[32:35], v8 offset:32768
  v_mfma_f32_16x16x32_bf16 v[196:199], a[64:67], a[8:11], v[196:199]
  ds_read_b128 a[36:39], v9 offset:32768
  v_mfma_f32_16x16x32_bf16 v[200:203], a[64:67], a[16:19], v[200:203]
  ds_read_b128 a[40:43], v8 offset:34816
  v_mfma_f32_16x16x32_bf16 v[200:203], a[68:71], a[20:23], v[200:203]
  ds_read_b128 a[44:47], v9 offset:34816
  v_mfma_f32_16x16x32_bf16 v[204:207], a[68:71], a[28:31], v[204:207]
  buffer_load_dwordx4 v3, s[8:11], s47 offen lds
  v_mfma_f32_16x16x32_bf16 v[204:207], a[64:67], a[24:27], v[204:207]
  s_waitcnt lgkmcnt(10)
  ds_read_b64_tr_b16 a[88:89], v13 offset:41472
  ds_read_b64_tr_b16 a[90:91], v13 offset:41728
  v_mfma_f32_16x16x32_bf16 v[208:211], a[72:75], a[0:3], v[208:211]
  s_waitcnt lgkmcnt(10)
  ds_read_b64_tr_b16 a[92:93], v13 offset:45568
  ds_read_b64_tr_b16 a[94:95], v13 offset:45824
  v_mfma_f32_16x16x32_bf16 v[208:211], a[76:79], a[4:7], v[208:211]
  v_lshl_add_u32 v3, s51, 6, v3
  v_mfma_f32_16x16x32_bf16 v[212:215], a[76:79], a[12:15], v[212:215]
  ds_read_b128 a[48:51], v8 offset:36864
  v_mfma_f32_16x16x32_bf16 v[212:215], a[72:75], a[8:11], v[212:215]
  ds_read_b128 a[52:55], v9 offset:36864
  v_mfma_f32_16x16x32_bf16 v[216:219], a[72:75], a[16:19], v[216:219]
  ds_read_b128 a[56:59], v8 offset:38912
  v_mfma_f32_16x16x32_bf16 v[216:219], a[76:79], a[20:23], v[216:219]
  ds_read_b128 a[60:63], v9 offset:38912
  v_mfma_f32_16x16x32_bf16 v[220:223], a[76:79], a[28:31], v[220:223]
  v_mfma_f32_16x16x32_bf16 v[220:223], a[72:75], a[24:27], v[220:223]
  s_waitcnt lgkmcnt(14)
  v_mfma_f32_16x16x32_bf16 v[224:227], a[80:83], a[0:3], v[224:227]
  s_waitcnt lgkmcnt(12)
  v_mfma_f32_16x16x32_bf16 v[224:227], a[84:87], a[4:7], v[224:227]
  s_waitcnt lgkmcnt(0)
  s_barrier
  ds_read_b64_tr_b16 a[64:65], v10 offset:0
  v_mfma_f32_16x16x32_bf16 v[228:231], a[84:87], a[12:15], v[228:231]
  s_cmp_eq_u32 s50, 4
  s_cselect_b64 s[56:57], s[54:55], s[52:53]
  s_cselect_b32 s51, -18, 2
  ds_read_b64_tr_b16 a[66:67], v10 offset:256
  v_mfma_f32_16x16x32_bf16 v[228:231], a[80:83], a[8:11], v[228:231]
  s_add_u32 m0, s98, 114688
  ds_read_b64_tr_b16 a[68:69], v10 offset:4096
  v_mfma_f32_16x16x32_bf16 v[232:235], a[80:83], a[16:19], v[232:235]
  ds_read_b64_tr_b16 a[70:71], v10 offset:4352
  v_mfma_f32_16x16x32_bf16 v[232:235], a[84:87], a[20:23], v[232:235]
  global_load_lds_dwordx4 v[4:5], off offset:0
  v_mfma_f32_16x16x32_bf16 v[236:239], a[84:87], a[28:31], v[236:239]
  s_add_u32 m0, s98, 122816
  v_mfma_f32_16x16x32_bf16 v[236:239], a[80:83], a[24:27], v[236:239]
  s_waitcnt lgkmcnt(4)
  ds_read_b64_tr_b16 a[72:73], v10 offset:512
  ds_read_b64_tr_b16 a[74:75], v10 offset:768
  v_mfma_f32_16x16x32_bf16 v[240:243], a[88:91], a[0:3], v[240:243]
  s_waitcnt lgkmcnt(6)
  ds_read_b64_tr_b16 a[76:77], v10 offset:4608
  ds_read_b64_tr_b16 a[78:79], v10 offset:4864
  v_mfma_f32_16x16x32_bf16 v[240:243], a[92:95], a[4:7], v[240:243]
  global_load_lds_dwordx4 v[4:5], off offset:64
  v_mfma_f32_16x16x32_bf16 v[244:247], a[92:95], a[12:15], v[244:247]
  v_mfma_f32_16x16x32_bf16 v[244:247], a[88:91], a[8:11], v[244:247]
  v_mfma_f32_16x16x32_bf16 v[248:251], a[88:91], a[16:19], v[248:251]
  v_mfma_f32_16x16x32_bf16 v[248:251], a[92:95], a[20:23], v[248:251]
  s_add_u32 m0, s98, 130944
  v_mfma_f32_16x16x32_bf16 v[252:255], a[92:95], a[28:31], v[252:255]
  v_mfma_f32_16x16x32_bf16 v[252:255], a[88:91], a[24:27], v[252:255]
  s_waitcnt lgkmcnt(6)
  ds_read_b64_tr_b16 a[80:81], v11 offset:0
  ds_read_b64_tr_b16 a[82:83], v11 offset:256
  v_mfma_f32_16x16x32_bf16 v[64:67], a[64:67], a[32:35], v[64:67]
  s_waitcnt lgkmcnt(6)
  ds_read_b64_tr_b16 a[84:85], v11 offset:4096
  ds_read_b64_tr_b16 a[86:87], v11 offset:4352
  v_mfma_f32_16x16x32_bf16 v[64:67], a[68:71], a[36:39], v[64:67]
  global_load_lds_dwordx4 v[4:5], off offset:128
  v_mfma_f32_16x16x32_bf16 v[68:71], a[68:71], a[44:47], v[68:71]
  v_mfma_f32_16x16x32_bf16 v[68:71], a[64:67], a[40:43], v[68:71]
  v_lshl_add_u64 v[4:5], v[4:5], 0, s[56:57]
  s_xor_b32 m0, s49, 32768
  v_mfma_f32_16x16x32_bf16 v[72:75], a[64:67], a[48:51], v[72:75]
  v_mfma_f32_16x16x32_bf16 v[72:75], a[68:71], a[52:55], v[72:75]
  buffer_load_dwordx4 v2, s[8:11], s44 offen lds
  v_mfma_f32_16x16x32_bf16 v[76:79], a[68:71], a[60:63], v[76:79]
  v_mfma_f32_16x16x32_bf16 v[76:79], a[64:67], a[56:59], v[76:79]
  s_waitcnt lgkmcnt(6)
  ds_read_b64_tr_b16 a[88:89], v11 offset:512
  ds_read_b64_tr_b16 a[90:91], v11 offset:768
  v_mfma_f32_16x16x32_bf16 v[80:83], a[72:75], a[32:35], v[80:83]
  s_waitcnt lgkmcnt(6)
  ds_read_b64_tr_b16 a[92:93], v11 offset:4608
  ds_read_b64_tr_b16 a[94:95], v11 offset:4864
  v_mfma_f32_16x16x32_bf16 v[80:83], a[76:79], a[36:39], v[80:83]
  v_mfma_f32_16x16x32_bf16 v[84:87], a[76:79], a[44:47], v[84:87]
  s_xor_b32 m0, s49, 34816
  v_mfma_f32_16x16x32_bf16 v[84:87], a[72:75], a[40:43], v[84:87]
  v_mfma_f32_16x16x32_bf16 v[88:91], a[72:75], a[48:51], v[88:91]
  buffer_load_dwordx4 v2, s[8:11], s45 offen lds
  v_mfma_f32_16x16x32_bf16 v[88:91], a[76:79], a[52:55], v[88:91]
  v_mfma_f32_16x16x32_bf16 v[92:95], a[76:79], a[60:63], v[92:95]
  v_mfma_f32_16x16x32_bf16 v[92:95], a[72:75], a[56:59], v[92:95]
  s_waitcnt lgkmcnt(6)
  ds_read_b64_tr_b16 a[64:65], v10 offset:8192
  ds_read_b64_tr_b16 a[66:67], v10 offset:8448
  v_mfma_f32_16x16x32_bf16 v[96:99], a[80:83], a[32:35], v[96:99]
  s_waitcnt lgkmcnt(6)
  ds_read_b64_tr_b16 a[68:69], v10 offset:12288
  ds_read_b64_tr_b16 a[70:71], v10 offset:12544
  v_mfma_f32_16x16x32_bf16 v[96:99], a[84:87], a[36:39], v[96:99]
  s_xor_b32 m0, s49, 36864
  v_mfma_f32_16x16x32_bf16 v[100:103], a[84:87], a[44:47], v[100:103]
  buffer_load_dwordx4 v2, s[8:11], s46 offen lds
  v_mfma_f32_16x16x32_bf16 v[100:103], a[80:83], a[40:43], v[100:103]
  v_mfma_f32_16x16x32_bf16 v[104:107], a[80:83], a[48:51], v[104:107]
  v_mfma_f32_16x16x32_bf16 v[104:107], a[84:87], a[52:55], v[104:107]
  v_mfma_f32_16x16x32_bf16 v[108:111], a[84:87], a[60:63], v[108:111]
  v_mfma_f32_16x16x32_bf16 v[108:111], a[80:83], a[56:59], v[108:111]
  s_waitcnt lgkmcnt(6)
  ds_read_b64_tr_b16 a[72:73], v10 offset:8704
  ds_read_b64_tr_b16 a[74:75], v10 offset:8960
  v_mfma_f32_16x16x32_bf16 v[112:115], a[88:91], a[32:35], v[112:115]
  s_waitcnt lgkmcnt(6)
  ds_read_b64_tr_b16 a[76:77], v10 offset:12800
  ds_read_b64_tr_b16 a[78:79], v10 offset:13056
  v_mfma_f32_16x16x32_bf16 v[112:115], a[92:95], a[36:39], v[112:115]
  s_xor_b32 m0, s49, 38912
  v_mfma_f32_16x16x32_bf16 v[116:119], a[92:95], a[44:47], v[116:119]
  buffer_load_dwordx4 v2, s[8:11], s47 offen lds
  v_mfma_f32_16x16x32_bf16 v[116:119], a[88:91], a[40:43], v[116:119]
  v_mfma_f32_16x16x32_bf16 v[120:123], a[88:91], a[48:51], v[120:123]
  v_mfma_f32_16x16x32_bf16 v[120:123], a[92:95], a[52:55], v[120:123]
  v_mfma_f32_16x16x32_bf16 v[124:127], a[92:95], a[60:63], v[124:127]
  v_lshl_add_u32 v2, s51, 6, v2
  s_add_u32 m0, s99, 114688
  v_mfma_f32_16x16x32_bf16 v[124:127], a[88:91], a[56:59], v[124:127]
  s_waitcnt lgkmcnt(6)
  ds_read_b64_tr_b16 a[80:81], v11 offset:8192
  ds_read_b64_tr_b16 a[82:83], v11 offset:8448
  v_mfma_f32_16x16x32_bf16 v[128:131], a[64:67], a[32:35], v[128:131]
  s_waitcnt lgkmcnt(6)
  ds_read_b64_tr_b16 a[84:85], v11 offset:12288
  ds_read_b64_tr_b16 a[86:87], v11 offset:12544
  v_mfma_f32_16x16x32_bf16 v[128:131], a[68:71], a[36:39], v[128:131]
  global_load_lds_dwordx4 v[6:7], off offset:0
  v_mfma_f32_16x16x32_bf16 v[132:135], a[68:71], a[44:47], v[132:135]
  v_mfma_f32_16x16x32_bf16 v[132:135], a[64:67], a[40:43], v[132:135]
  v_mfma_f32_16x16x32_bf16 v[136:139], a[64:67], a[48:51], v[136:139]
  s_add_u32 m0, s99, 122816
  v_mfma_f32_16x16x32_bf16 v[136:139], a[68:71], a[52:55], v[136:139]
  v_mfma_f32_16x16x32_bf16 v[140:143], a[68:71], a[60:63], v[140:143]
  global_load_lds_dwordx4 v[6:7], off offset:64
  v_mfma_f32_16x16x32_bf16 v[140:143], a[64:67], a[56:59], v[140:143]
  s_waitcnt lgkmcnt(6)
  ds_read_b64_tr_b16 a[88:89], v11 offset:8704
  ds_read_b64_tr_b16 a[90:91], v11 offset:8960
  v_mfma_f32_16x16x32_bf16 v[144:147], a[72:75], a[32:35], v[144:147]
  s_waitcnt lgkmcnt(6)
  ds_read_b64_tr_b16 a[92:93], v11 offset:12800
  ds_read_b64_tr_b16 a[94:95], v11 offset:13056
  v_mfma_f32_16x16x32_bf16 v[144:147], a[76:79], a[36:39], v[144:147]
  v_mfma_f32_16x16x32_bf16 v[148:151], a[76:79], a[44:47], v[148:151]
  v_mfma_f32_16x16x32_bf16 v[148:151], a[72:75], a[40:43], v[148:151]
  s_add_u32 m0, s99, 130944
  v_mfma_f32_16x16x32_bf16 v[152:155], a[72:75], a[48:51], v[152:155]
  v_mfma_f32_16x16x32_bf16 v[152:155], a[76:79], a[52:55], v[152:155]
  global_load_lds_dwordx4 v[6:7], off offset:128
  v_mfma_f32_16x16x32_bf16 v[156:159], a[76:79], a[60:63], v[156:159]
  v_mfma_f32_16x16x32_bf16 v[156:159], a[72:75], a[56:59], v[156:159]
  s_waitcnt lgkmcnt(6)
  ds_read_b64_tr_b16 a[64:65], v10 offset:16384
  ds_read_b64_tr_b16 a[66:67], v10 offset:16640
  v_mfma_f32_16x16x32_bf16 v[160:163], a[80:83], a[32:35], v[160:163]
  s_waitcnt lgkmcnt(6)
  ds_read_b64_tr_b16 a[68:69], v10 offset:20480
  ds_read_b64_tr_b16 a[70:71], v10 offset:20736
  v_mfma_f32_16x16x32_bf16 v[160:163], a[84:87], a[36:39], v[160:163]
  v_lshl_add_u64 v[6:7], v[6:7], 0, s[56:57]
  s_xor_b32 m0, s49, 33792
  v_mfma_f32_16x16x32_bf16 v[164:167], a[84:87], a[44:47], v[164:167]
  v_mfma_f32_16x16x32_bf16 v[164:167], a[80:83], a[40:43], v[164:167]
  buffer_load_dwordx4 v3, s[8:11], s44 offen lds
  v_mfma_f32_16x16x32_bf16 v[168:171], a[80:83], a[48:51], v[168:171]
  v_mfma_f32_16x16x32_bf16 v[168:171], a[84:87], a[52:55], v[168:171]
  v_mfma_f32_16x16x32_bf16 v[172:175], a[84:87], a[60:63], v[172:175]
  v_mfma_f32_16x16x32_bf16 v[172:175], a[80:83], a[56:59], v[172:175]
  s_waitcnt lgkmcnt(6)
  ds_read_b64_tr_b16 a[72:73], v10 offset:16896
  ds_read_b64_tr_b16 a[74:75], v10 offset:17152
  v_mfma_f32_16x16x32_bf16 v[176:179], a[88:91], a[32:35], v[176:179]
  s_waitcnt lgkmcnt(6)
  ds_read_b64_tr_b16 a[76:77], v10 offset:20992
  ds_read_b64_tr_b16 a[78:79], v10 offset:21248
  v_mfma_f32_16x16x32_bf16 v[176:179], a[92:95], a[36:39], v[176:179]
  s_xor_b32 m0, s49, 35840
  v_mfma_f32_16x16x32_bf16 v[180:183], a[92:95], a[44:47], v[180:183]
  buffer_load_dwordx4 v3, s[8:11], s45 offen lds
  v_mfma_f32_16x16x32_bf16 v[180:183], a[88:91], a[40:43], v[180:183]
  v_mfma_f32_16x16x32_bf16 v[184:187], a[88:91], a[48:51], v[184:187]
  v_mfma_f32_16x16x32_bf16 v[184:187], a[92:95], a[52:55], v[184:187]
  v_mfma_f32_16x16x32_bf16 v[188:191], a[92:95], a[60:63], v[188:191]
  s_xor_b32 m0, s49, 37888
  v_mfma_f32_16x16x32_bf16 v[188:191], a[88:91], a[56:59], v[188:191]
  s_waitcnt lgkmcnt(6)
  ds_read_b64_tr_b16 a[80:81], v11 offset:16384
  ds_read_b64_tr_b16 a[82:83], v11 offset:16640
  v_mfma_f32_16x16x32_bf16 v[192:195], a[64:67], a[32:35], v[192:195]
  s_waitcnt lgkmcnt(6)
  ds_read_b64_tr_b16 a[84:85], v11 offset:20480
  ds_read_b64_tr_b16 a[86:87], v11 offset:20736
  v_mfma_f32_16x16x32_bf16 v[192:195], a[68:71], a[36:39], v[192:195]
  buffer_load_dwordx4 v3, s[8:11], s46 offen lds
  v_mfma_f32_16x16x32_bf16 v[196:199], a[68:71], a[44:47], v[196:199]
  s_waitcnt vmcnt(13)
  ds_read_b128 a[0:3], v8 offset:0
  v_mfma_f32_16x16x32_bf16 v[196:199], a[64:67], a[40:43], v[196:199]
  ds_read_b128 a[4:7], v9 offset:0
  v_mfma_f32_16x16x32_bf16 v[200:203], a[64:67], a[48:51], v[200:203]
  ds_read_b128 a[8:11], v8 offset:2048
  v_mfma_f32_16x16x32_bf16 v[200:203], a[68:71], a[52:55], v[200:203]
  s_xor_b32 m0, s49, 39936
  ds_read_b128 a[12:15], v9 offset:2048
  v_mfma_f32_16x16x32_bf16 v[204:207], a[68:71], a[60:63], v[204:207]
  v_mfma_f32_16x16x32_bf16 v[204:207], a[64:67], a[56:59], v[204:207]
  s_waitcnt lgkmcnt(10)
  ds_read_b64_tr_b16 a[88:89], v11 offset:16896
  ds_read_b64_tr_b16 a[90:91], v11 offset:17152
  v_mfma_f32_16x16x32_bf16 v[208:211], a[72:75], a[32:35], v[208:211]
  s_waitcnt lgkmcnt(10)
  ds_read_b64_tr_b16 a[92:93], v11 offset:20992
  ds_read_b64_tr_b16 a[94:95], v11 offset:21248
  v_mfma_f32_16x16x32_bf16 v[208:211], a[76:79], a[36:39], v[208:211]
  buffer_load_dwordx4 v3, s[8:11], s47 offen lds
  v_mfma_f32_16x16x32_bf16 v[212:215], a[76:79], a[44:47], v[212:215]
  ds_read_b128 a[16:19], v8 offset:4096
  v_lshl_add_u32 v3, s51, 6, v3
  v_mfma_f32_16x16x32_bf16 v[212:215], a[72:75], a[40:43], v[212:215]
  ds_read_b128 a[20:23], v9 offset:4096
  v_mfma_f32_16x16x32_bf16 v[216:219], a[72:75], a[48:51], v[216:219]
  ds_read_b128 a[24:27], v8 offset:6144
  v_mfma_f32_16x16x32_bf16 v[216:219], a[76:79], a[52:55], v[216:219]
  ds_read_b128 a[28:31], v9 offset:6144
  v_mfma_f32_16x16x32_bf16 v[220:223], a[76:79], a[60:63], v[220:223]
  v_mfma_f32_16x16x32_bf16 v[220:223], a[72:75], a[56:59], v[220:223]
  s_waitcnt lgkmcnt(14)
  v_mfma_f32_16x16x32_bf16 v[224:227], a[80:83], a[32:35], v[224:227]
  s_waitcnt lgkmcnt(12)
  v_mfma_f32_16x16x32_bf16 v[224:227], a[84:87], a[36:39], v[224:227]
  s_waitcnt lgkmcnt(0)
  s_barrier
  ds_read_b64_tr_b16 a[64:65], v10 offset:24576
  v_mfma_f32_16x16x32_bf16 v[228:231], a[84:87], a[44:47], v[228:231]
  s_cmp_eq_u32 s50, 3
  s_cselect_b64 s[56:57], s[54:55], s[52:53]
  s_cselect_b32 s51, -18, 2
  ds_read_b64_tr_b16 a[66:67], v10 offset:24832
  v_mfma_f32_16x16x32_bf16 v[228:231], a[80:83], a[40:43], v[228:231]
  s_add_u32 m0, s98, 65536
  ds_read_b64_tr_b16 a[68:69], v10 offset:28672
  v_mfma_f32_16x16x32_bf16 v[232:235], a[80:83], a[48:51], v[232:235]
  ds_read_b64_tr_b16 a[70:71], v10 offset:28928
  v_mfma_f32_16x16x32_bf16 v[232:235], a[84:87], a[52:55], v[232:235]
  global_load_lds_dwordx4 v[4:5], off offset:0
  v_mfma_f32_16x16x32_bf16 v[236:239], a[84:87], a[60:63], v[236:239]
  s_add_u32 m0, s98, 73664
  buffer_load_dwordx4 v[40:43], v38, s[12:15], s64 offen sc1
  v_mfma_f32_16x16x32_bf16 v[236:239], a[80:83], a[56:59], v[236:239]
  s_waitcnt lgkmcnt(4)
  ds_read_b64_tr_b16 a[72:73], v10 offset:25088
  ds_read_b64_tr_b16 a[74:75], v10 offset:25344
  v_mfma_f32_16x16x32_bf16 v[240:243], a[88:91], a[32:35], v[240:243]
  s_waitcnt lgkmcnt(6)
  ds_read_b64_tr_b16 a[76:77], v10 offset:29184
  ds_read_b64_tr_b16 a[78:79], v10 offset:29440
  v_mfma_f32_16x16x32_bf16 v[240:243], a[92:95], a[36:39], v[240:243]
  global_load_lds_dwordx4 v[4:5], off offset:64
  v_mfma_f32_16x16x32_bf16 v[244:247], a[92:95], a[44:47], v[244:247]
  buffer_load_dwordx4 v[44:47], v38, s[12:15], s65 offen sc1
  v_mfma_f32_16x16x32_bf16 v[244:247], a[88:91], a[40:43], v[244:247]
  buffer_load_dwordx2 v[48:49], v62, s[12:15], s66 offen sc1
  v_mfma_f32_16x16x32_bf16 v[248:251], a[88:91], a[48:51], v[248:251]
  v_mfma_f32_16x16x32_bf16 v[248:251], a[92:95], a[52:55], v[248:251]
  s_add_u32 m0, s98, 81792
  v_mfma_f32_16x16x32_bf16 v[252:255], a[92:95], a[60:63], v[252:255]
  v_mfma_f32_16x16x32_bf16 v[252:255], a[88:91], a[56:59], v[252:255]
  s_waitcnt lgkmcnt(6)
  ds_read_b64_tr_b16 a[80:81], v11 offset:24576
  ds_read_b64_tr_b16 a[82:83], v11 offset:24832
  v_mfma_f32_16x16x32_bf16 v[64:67], a[64:67], a[0:3], v[64:67]
  s_waitcnt lgkmcnt(6)
  ds_read_b64_tr_b16 a[84:85], v11 offset:28672
  ds_read_b64_tr_b16 a[86:87], v11 offset:28928
  v_mfma_f32_16x16x32_bf16 v[64:67], a[68:71], a[4:7], v[64:67]
  global_load_lds_dwordx4 v[4:5], off offset:128
  v_mfma_f32_16x16x32_bf16 v[68:71], a[68:71], a[12:15], v[68:71]
  v_mfma_f32_16x16x32_bf16 v[68:71], a[64:67], a[8:11], v[68:71]
  v_lshl_add_u64 v[4:5], v[4:5], 0, s[56:57]
  s_xor_b32 m0, s49, 0
  v_mfma_f32_16x16x32_bf16 v[72:75], a[64:67], a[16:19], v[72:75]
  v_mfma_f32_16x16x32_bf16 v[72:75], a[68:71], a[20:23], v[72:75]
  buffer_load_dwordx4 v2, s[8:11], s44 offen lds
  v_mfma_f32_16x16x32_bf16 v[76:79], a[68:71], a[28:31], v[76:79]
  v_mfma_f32_16x16x32_bf16 v[76:79], a[64:67], a[24:27], v[76:79]
  s_waitcnt lgkmcnt(6)
  ds_read_b64_tr_b16 a[88:89], v11 offset:25088
  ds_read_b64_tr_b16 a[90:91], v11 offset:25344
  v_mfma_f32_16x16x32_bf16 v[80:83], a[72:75], a[0:3], v[80:83]
  s_waitcnt lgkmcnt(6)
  ds_read_b64_tr_b16 a[92:93], v11 offset:29184
  ds_read_b64_tr_b16 a[94:95], v11 offset:29440
  v_mfma_f32_16x16x32_bf16 v[80:83], a[76:79], a[4:7], v[80:83]
  v_mfma_f32_16x16x32_bf16 v[84:87], a[76:79], a[12:15], v[84:87]
  s_xor_b32 m0, s49, 2048
  v_mfma_f32_16x16x32_bf16 v[84:87], a[72:75], a[8:11], v[84:87]
  v_mfma_f32_16x16x32_bf16 v[88:91], a[72:75], a[16:19], v[88:91]
  buffer_load_dwordx4 v2, s[8:11], s45 offen lds
  v_mfma_f32_16x16x32_bf16 v[88:91], a[76:79], a[20:23], v[88:91]
  v_mfma_f32_16x16x32_bf16 v[92:95], a[76:79], a[28:31], v[92:95]
  v_mfma_f32_16x16x32_bf16 v[92:95], a[72:75], a[24:27], v[92:95]
  s_waitcnt lgkmcnt(6)
  ds_read_b64_tr_b16 a[64:65], v10 offset:32768
  ds_read_b64_tr_b16 a[66:67], v10 offset:33024
  v_mfma_f32_16x16x32_bf16 v[96:99], a[80:83], a[0:3], v[96:99]
  s_waitcnt lgkmcnt(6)
  ds_read_b64_tr_b16 a[68:69], v10 offset:36864
  ds_read_b64_tr_b16 a[70:71], v10 offset:37120
  v_mfma_f32_16x16x32_bf16 v[96:99], a[84:87], a[4:7], v[96:99]
  s_xor_b32 m0, s49, 4096
  v_mfma_f32_16x16x32_bf16 v[100:103], a[84:87], a[12:15], v[100:103]
  buffer_load_dwordx4 v2, s[8:11], s46 offen lds
  v_mfma_f32_16x16x32_bf16 v[100:103], a[80:83], a[8:11], v[100:103]
  v_mfma_f32_16x16x32_bf16 v[104:107], a[80:83], a[16:19], v[104:107]
  v_mfma_f32_16x16x32_bf16 v[104:107], a[84:87], a[20:23], v[104:107]
  v_mfma_f32_16x16x32_bf16 v[108:111], a[84:87], a[28:31], v[108:111]
  v_mfma_f32_16x16x32_bf16 v[108:111], a[80:83], a[24:27], v[108:111]
  s_waitcnt lgkmcnt(6)
  ds_read_b64_tr_b16 a[72:73], v10 offset:33280
  ds_read_b64_tr_b16 a[74:75], v10 offset:33536
  v_mfma_f32_16x16x32_bf16 v[112:115], a[88:91], a[0:3], v[112:115]
  s_waitcnt lgkmcnt(6)
  ds_read_b64_tr_b16 a[76:77], v10 offset:37376
  ds_read_b64_tr_b16 a[78:79], v10 offset:37632
  v_mfma_f32_16x16x32_bf16 v[112:115], a[92:95], a[4:7], v[112:115]
  s_xor_b32 m0, s49, 6144
  v_mfma_f32_16x16x32_bf16 v[116:119], a[92:95], a[12:15], v[116:119]
  buffer_load_dwordx4 v2, s[8:11], s47 offen lds
  v_mfma_f32_16x16x32_bf16 v[116:119], a[88:91], a[8:11], v[116:119]
  v_mfma_f32_16x16x32_bf16 v[120:123], a[88:91], a[16:19], v[120:123]
  v_mfma_f32_16x16x32_bf16 v[120:123], a[92:95], a[20:23], v[120:123]
  v_mfma_f32_16x16x32_bf16 v[124:127], a[92:95], a[28:31], v[124:127]
  v_lshl_add_u32 v2, s51, 6, v2
  s_add_u32 m0, s99, 65536
  v_mfma_f32_16x16x32_bf16 v[124:127], a[88:91], a[24:27], v[124:127]
  s_waitcnt lgkmcnt(6)
  ds_read_b64_tr_b16 a[80:81], v11 offset:32768
  ds_read_b64_tr_b16 a[82:83], v11 offset:33024
  v_mfma_f32_16x16x32_bf16 v[128:131], a[64:67], a[0:3], v[128:131]
  s_waitcnt lgkmcnt(6)
  ds_read_b64_tr_b16 a[84:85], v11 offset:36864
  ds_read_b64_tr_b16 a[86:87], v11 offset:37120
  v_mfma_f32_16x16x32_bf16 v[128:131], a[68:71], a[4:7], v[128:131]
L_hop_ffn1:
  s_cbranch_execz L_retffn1
  global_load_lds_dwordx4 v[6:7], off offset:0
  v_mfma_f32_16x16x32_bf16 v[132:135], a[68:71], a[12:15], v[132:135]
  v_mfma_f32_16x16x32_bf16 v[132:135], a[64:67], a[8:11], v[132:135]
  v_mfma_f32_16x16x32_bf16 v[136:139], a[64:67], a[16:19], v[136:139]
  s_add_u32 m0, s99, 73664
  v_mfma_f32_16x16x32_bf16 v[136:139], a[68:71], a[20:23], v[136:139]
  v_mfma_f32_16x16x32_bf16 v[140:143], a[68:71], a[28:31], v[140:143]
  global_load_lds_dwordx4 v[6:7], off offset:64
  v_mfma_f32_16x16x32_bf16 v[140:143], a[64:67], a[24:27], v[140:143]
  s_waitcnt lgkmcnt(6)
  ds_read_b64_tr_b16 a[88:89], v11 offset:33280
  ds_read_b64_tr_b16 a[90:91], v11 offset:33536
  v_mfma_f32_16x16x32_bf16 v[144:147], a[72:75], a[0:3], v[144:147]
  s_waitcnt lgkmcnt(6)
  ds_read_b64_tr_b16 a[92:93], v11 offset:37376
  ds_read_b64_tr_b16 a[94:95], v11 offset:37632
  v_mfma_f32_16x16x32_bf16 v[144:147], a[76:79], a[4:7], v[144:147]
  v_mfma_f32_16x16x32_bf16 v[148:151], a[76:79], a[12:15], v[148:151]
  v_mfma_f32_16x16x32_bf16 v[148:151], a[72:75], a[8:11], v[148:151]
  s_add_u32 m0, s99, 81792
  v_mfma_f32_16x16x32_bf16 v[152:155], a[72:75], a[16:19], v[152:155]
  v_mfma_f32_16x16x32_bf16 v[152:155], a[76:79], a[20:23], v[152:155]
  global_load_lds_dwordx4 v[6:7], off offset:128
  v_mfma_f32_16x16x32_bf16 v[156:159], a[76:79], a[28:31], v[156:159]
  v_mfma_f32_16x16x32_bf16 v[156:159], a[72:75], a[24:27], v[156:159]
  s_waitcnt lgkmcnt(6)
  ds_read_b64_tr_b16 a[64:65], v10 offset:40960
  ds_read_b64_tr_b16 a[66:67], v10 offset:41216
  v_mfma_f32_16x16x32_bf16 v[160:163], a[80:83], a[0:3], v[160:163]
  s_waitcnt lgkmcnt(6)
  ds_read_b64_tr_b16 a[68:69], v10 offset:45056
  ds_read_b64_tr_b16 a[70:71], v10 offset:45312
  v_mfma_f32_16x16x32_bf16 v[160:163], a[84:87], a[4:7], v[160:163]
  v_lshl_add_u64 v[6:7], v[6:7], 0, s[56:57]
  s_xor_b32 m0, s49, 1024
  v_mfma_f32_16x16x32_bf16 v[164:167], a[84:87], a[12:15], v[164:167]
  v_mfma_f32_16x16x32_bf16 v[164:167], a[80:83], a[8:11], v[164:167]
  s_waitcnt vmcnt(8)
  buffer_load_dwordx4 v3, s[8:11], s44 offen lds
  v_mfma_f32_16x16x32_bf16 v[168:171], a[80:83], a[16:19], v[168:171]
  v_xor_b32 v39, s61, v43
  v_bitop3_b32 v39, v47, s61, v39 bitop3:0xbe
  v_mfma_f32_16x16x32_bf16 v[168:171], a[84:87], a[20:23], v[168:171]
  v_bitop3_b32 v39, v49, s61, v39 bitop3:0xbe
  v_cmp_ne_u32 vcc, 0, v39
  v_mfma_f32_16x16x32_bf16 v[172:175], a[84:87], a[28:31], v[172:175]
  v_mfma_f32_16x16x32_bf16 v[172:175], a[80:83], a[24:27], v[172:175]
  s_waitcnt lgkmcnt(6)
  ds_read_b64_tr_b16 a[72:73], v10 offset:41472
  ds_read_b64_tr_b16 a[74:75], v10 offset:41728
  v_mfma_f32_16x16x32_bf16 v[176:179], a[88:91], a[0:3], v[176:179]
  s_waitcnt lgkmcnt(6)
  ds_read_b64_tr_b16 a[76:77], v10 offset:45568
  ds_read_b64_tr_b16 a[78:79], v10 offset:45824
  v_mfma_f32_16x16x32_bf16 v[176:179], a[92:95], a[4:7], v[176:179]
  s_xor_b32 m0, s49, 3072
  s_cbranch_vccnz L_slow_8
L_back_9:
  v_add_f32 v40, v40, v44
  v_mfma_f32_16x16x32_bf16 v[180:183], a[92:95], a[12:15], v[180:183]
  buffer_load_dwordx4 v3, s[8:11], s45 offen lds
  v_mfma_f32_16x16x32_bf16 v[180:183], a[88:91], a[8:11], v[180:183]
  v_add_f32 v42, v42, v46
  v_add_f32 v41, v41, v45
  v_mfma_f32_16x16x32_bf16 v[184:187], a[88:91], a[16:19], v[184:187]
  v_lshlrev_b32 v49, 16, v48
  v_and_b32 v48, 0xffff0000, v48
  v_mfma_f32_16x16x32_bf16 v[184:187], a[92:95], a[20:23], v[184:187]
  v_permlane32_swap_b32 v40, v42
  v_permlane32_swap_b32 v41, v43
  v_mfma_f32_16x16x32_bf16 v[188:191], a[92:95], a[28:31], v[188:191]
  s_xor_b32 m0, s49, 5120
  v_rcp_f32 v50, v49
  v_mfma_f32_16x16x32_bf16 v[188:191], a[88:91], a[24:27], v[188:191]
  s_waitcnt lgkmcnt(6)
  ds_read_b64_tr_b16 a[80:81], v11 offset:40960
  ds_read_b64_tr_b16 a[82:83], v11 offset:41216
  v_mfma_f32_16x16x32_bf16 v[192:195], a[64:67], a[0:3], v[192:195]
  s_waitcnt lgkmcnt(6)
  ds_read_b64_tr_b16 a[84:85], v11 offset:45056
  ds_read_b64_tr_b16 a[86:87], v11 offset:45312
  v_mfma_f32_16x16x32_bf16 v[192:195], a[68:71], a[4:7], v[192:195]
  buffer_load_dwordx4 v3, s[8:11], s46 offen lds
  v_mfma_f32_16x16x32_bf16 v[196:199], a[68:71], a[12:15], v[196:199]
  ds_read_b128 a[32:35], v8 offset:32768
  v_add_f32 v40, v40, v42
  v_mfma_f32_16x16x32_bf16 v[196:199], a[64:67], a[8:11], v[196:199]
  ds_read_b128 a[36:39], v9 offset:32768
  v_add_f32 v41, v41, v43
  v_mfma_f32_16x16x32_bf16 v[200:203], a[64:67], a[16:19], v[200:203]
  ds_read_b128 a[40:43], v8 offset:34816
  v_mul_f32 v51, v49, v49
  v_mfma_f32_16x16x32_bf16 v[200:203], a[68:71], a[20:23], v[200:203]
  s_xor_b32 m0, s49, 7168
  ds_read_b128 a[44:47], v9 offset:34816
  v_mul_f32 v50, 0xbfb8aa3b, v50
  v_mfma_f32_16x16x32_bf16 v[204:207], a[68:71], a[28:31], v[204:207]
  v_permlane16_swap_b32 v40, v41
  v_mfma_f32_16x16x32_bf16 v[204:207], a[64:67], a[24:27], v[204:207]
  s_waitcnt lgkmcnt(10)
  ds_read_b64_tr_b16 a[88:89], v11 offset:41472
  ds_read_b64_tr_b16 a[90:91], v11 offset:41728
  v_mfma_f32_16x16x32_bf16 v[208:211], a[72:75], a[0:3], v[208:211]
  s_waitcnt lgkmcnt(10)
  ds_read_b64_tr_b16 a[92:93], v11 offset:45568
  ds_read_b64_tr_b16 a[94:95], v11 offset:45824
  v_mfma_f32_16x16x32_bf16 v[208:211], a[76:79], a[4:7], v[208:211]
  buffer_load_dwordx4 v3, s[8:11], s47 offen lds
  v_mfma_f32_16x16x32_bf16 v[212:215], a[76:79], a[12:15], v[212:215]
  ds_read_b128 a[48:51], v8 offset:36864
  v_lshl_add_u32 v3, s51, 6, v3
  v_mfma_f32_16x16x32_bf16 v[212:215], a[72:75], a[8:11], v[212:215]
  ds_read_b128 a[52:55], v9 offset:36864
  v_add_f32 v40, v40, v41
  v_mfma_f32_16x16x32_bf16 v[216:219], a[72:75], a[16:19], v[216:219]
  ds_read_b128 a[56:59], v8 offset:38912
  v_mfma_f32_16x16x32_bf16 v[216:219], a[76:79], a[20:23], v[216:219]
  ds_read_b128 a[60:63], v9 offset:38912
  v_mfma_f32_16x16x32_bf16 v[220:223], a[76:79], a[28:31], v[220:223]
  ds_write_b32 v61, v40
  v_mfma_f32_16x16x32_bf16 v[220:223], a[72:75], a[24:27], v[220:223]
  s_waitcnt lgkmcnt(15)
  ds_write_b32 v56, v48
  v_mfma_f32_16x16x32_bf16 v[224:227], a[80:83], a[0:3], v[224:227]
  s_waitcnt lgkmcnt(14)
  ds_write_b32 v56, v50 offset:256
  v_mfma_f32_16x16x32_bf16 v[224:227], a[84:87], a[4:7], v[224:227]
  s_waitcnt lgkmcnt(0)
  s_barrier
  ds_read_b64_tr_b16 a[64:65], v12 offset:24576
  v_mfma_f32_16x16x32_bf16 v[228:231], a[84:87], a[12:15], v[228:231]
  s_cmp_eq_u32 s50, 2
  s_cselect_b64 s[56:57], s[54:55], s[52:53]
  s_cselect_b32 s51, -18, 2
  ds_read_b64_tr_b16 a[66:67], v12 offset:24832
  v_mfma_f32_16x16x32_bf16 v[228:231], a[80:83], a[8:11], v[228:231]
  s_add_u32 m0, s98, 90112
  ds_read_b64_tr_b16 a[68:69], v12 offset:28672
  v_mfma_f32_16x16x32_bf16 v[232:235], a[80:83], a[16:19], v[232:235]
  ds_read_b64_tr_b16 a[70:71], v12 offset:28928
  v_mfma_f32_16x16x32_bf16 v[232:235], a[84:87], a[20:23], v[232:235]
  global_load_lds_dwordx4 v[4:5], off offset:0
  v_mfma_f32_16x16x32_bf16 v[236:239], a[84:87], a[28:31], v[236:239]
  s_add_u32 m0, s98, 98240
  ds_write_b32 v56, v51 offset:512
  v_mfma_f32_16x16x32_bf16 v[236:239], a[80:83], a[24:27], v[236:239]
  s_waitcnt lgkmcnt(5)
  ds_read_b64_tr_b16 a[72:73], v12 offset:25088
  ds_read_b64_tr_b16 a[74:75], v12 offset:25344
  v_mfma_f32_16x16x32_bf16 v[240:243], a[88:91], a[0:3], v[240:243]
  s_waitcnt lgkmcnt(7)
  ds_read_b64_tr_b16 a[76:77], v12 offset:29184
  ds_read_b64_tr_b16 a[78:79], v12 offset:29440
  v_mfma_f32_16x16x32_bf16 v[240:243], a[92:95], a[4:7], v[240:243]
  global_load_lds_dwordx4 v[4:5], off offset:64
  v_mfma_f32_16x16x32_bf16 v[244:247], a[92:95], a[12:15], v[244:247]
  ds_read_b32 v52, v57 offset:0
  v_mfma_f32_16x16x32_bf16 v[244:247], a[88:91], a[8:11], v[244:247]
  ds_read2_b32 v[20:21], v57 offset0:64 offset1:128
  v_mfma_f32_16x16x32_bf16 v[248:251], a[88:91], a[16:19], v[248:251]
  ds_read_b32 v53, v57 offset:64
  v_mfma_f32_16x16x32_bf16 v[248:251], a[92:95], a[20:23], v[248:251]
  s_add_u32 m0, s98, 106368
  ds_read2_b32 v[22:23], v57 offset0:80 offset1:144
  ds_read_b32 v54, v57 offset:128
  v_mfma_f32_16x16x32_bf16 v[252:255], a[92:95], a[28:31], v[252:255]
  ds_read2_b32 v[24:25], v57 offset0:96 offset1:160
  v_mfma_f32_16x16x32_bf16 v[252:255], a[88:91], a[24:27], v[252:255]
  s_waitcnt lgkmcnt(13)
  ds_read_b64_tr_b16 a[80:81], v13 offset:24576
  ds_read_b64_tr_b16 a[82:83], v13 offset:24832
  v_mfma_f32_16x16x32_bf16 v[64:67], a[64:67], a[32:35], v[64:67]
  s_waitcnt lgkmcnt(13)
  ds_read_b64_tr_b16 a[84:85], v13 offset:28672
  ds_read_b64_tr_b16 a[86:87], v13 offset:28928
  v_mfma_f32_16x16x32_bf16 v[64:67], a[68:71], a[36:39], v[64:67]
  global_load_lds_dwordx4 v[4:5], off offset:128
  v_mfma_f32_16x16x32_bf16 v[68:71], a[68:71], a[44:47], v[68:71]
  ds_read_b32 v55, v57 offset:192
  v_mfma_f32_16x16x32_bf16 v[68:71], a[64:67], a[40:43], v[68:71]
  ds_read2_b32 v[26:27], v57 offset0:112 offset1:176
  v_lshl_add_u64 v[4:5], v[4:5], 0, s[56:57]
  v_mfma_f32_16x16x32_bf16 v[72:75], a[64:67], a[48:51], v[72:75]
  s_xor_b32 m0, s49, 32768
  ds_read_b128 v[28:31], v36 offset:8320
  v_mfma_f32_16x16x32_bf16 v[72:75], a[68:71], a[52:55], v[72:75]
  buffer_load_dwordx4 v2, s[8:11], s44 offen lds
  v_mfma_f32_16x16x32_bf16 v[76:79], a[68:71], a[60:63], v[76:79]
  ds_read_b128 v[32:35], v36 offset:8192
  s_waitcnt lgkmcnt(1)
  v_mfma_f32_16x16x32_bf16 v[76:79], a[64:67], a[56:59], v[76:79]
  s_waitcnt lgkmcnt(1)
  ds_read_b64_tr_b16 a[88:89], v13 offset:25088
  ds_read_b64_tr_b16 a[90:91], v13 offset:25344
  v_mfma_f32_16x16x32_bf16 v[80:83], a[72:75], a[32:35], v[80:83]
  s_waitcnt lgkmcnt(3)
  ds_read_b64_tr_b16 a[92:93], v13 offset:29184
  ds_read_b64_tr_b16 a[94:95], v13 offset:29440
  v_mfma_f32_16x16x32_bf16 v[80:83], a[76:79], a[36:39], v[80:83]
  v_fmac_f32 v128, v52, v28
  v_fmac_f32 v129, v52, v29
  v_mfma_f32_16x16x32_bf16 v[84:87], a[76:79], a[44:47], v[84:87]
  s_xor_b32 m0, s49, 34816
  v_fmac_f32 v130, v52, v30
  v_fmac_f32 v131, v52, v31
  v_mfma_f32_16x16x32_bf16 v[84:87], a[72:75], a[40:43], v[84:87]
  v_fmac_f32 v132, v53, v28
  v_fmac_f32 v133, v53, v29
  v_mfma_f32_16x16x32_bf16 v[88:91], a[72:75], a[48:51], v[88:91]
  buffer_load_dwordx4 v2, s[8:11], s45 offen lds
  v_mfma_f32_16x16x32_bf16 v[88:91], a[76:79], a[52:55], v[88:91]
  v_fmac_f32 v134, v53, v30
  v_fmac_f32 v135, v53, v31
  v_mfma_f32_16x16x32_bf16 v[92:95], a[76:79], a[60:63], v[92:95]
  v_fmac_f32 v136, v54, v28
  v_fmac_f32 v137, v54, v29
  v_mfma_f32_16x16x32_bf16 v[92:95], a[72:75], a[56:59], v[92:95]
  s_waitcnt lgkmcnt(5)
  ds_read_b64_tr_b16 a[64:65], v12 offset:32768
  ds_read_b64_tr_b16 a[66:67], v12 offset:33024
  v_mfma_f32_16x16x32_bf16 v[96:99], a[80:83], a[32:35], v[96:99]
  s_waitcnt lgkmcnt(7)
  ds_read_b64_tr_b16 a[68:69], v12 offset:36864
  ds_read_b64_tr_b16 a[70:71], v12 offset:37120
  v_mfma_f32_16x16x32_bf16 v[96:99], a[84:87], a[36:39], v[96:99]
  s_xor_b32 m0, s49, 36864
  v_fmac_f32 v138, v54, v30
  v_fmac_f32 v139, v54, v31
  v_mfma_f32_16x16x32_bf16 v[100:103], a[84:87], a[44:47], v[100:103]
  buffer_load_dwordx4 v2, s[8:11], s46 offen lds
  v_mfma_f32_16x16x32_bf16 v[100:103], a[80:83], a[40:43], v[100:103]
  v_fmac_f32 v140, v55, v28
  v_fmac_f32 v141, v55, v29
  v_mfma_f32_16x16x32_bf16 v[104:107], a[80:83], a[48:51], v[104:107]
  v_fmac_f32 v142, v55, v30
  v_fmac_f32 v143, v55, v31
  v_mfma_f32_16x16x32_bf16 v[104:107], a[84:87], a[52:55], v[104:107]
  v_mfma_f32_16x16x32_bf16 v[108:111], a[84:87], a[60:63], v[108:111]
  v_mfma_f32_16x16x32_bf16 v[108:111], a[80:83], a[56:59], v[108:111]
  s_waitcnt lgkmcnt(6)
  ds_read_b64_tr_b16 a[72:73], v12 offset:33280
  ds_read_b64_tr_b16 a[74:75], v12 offset:33536
  v_mfma_f32_16x16x32_bf16 v[112:115], a[88:91], a[32:35], v[112:115]
  s_waitcnt lgkmcnt(6)
  ds_read_b64_tr_b16 a[76:77], v12 offset:37376
  ds_read_b64_tr_b16 a[78:79], v12 offset:37632
  v_mfma_f32_16x16x32_bf16 v[112:115], a[92:95], a[36:39], v[112:115]
  s_xor_b32 m0, s49, 38912
  v_mfma_f32_16x16x32_bf16 v[116:119], a[92:95], a[44:47], v[116:119]
  buffer_load_dwordx4 v2, s[8:11], s47 offen lds
  v_mfma_f32_16x16x32_bf16 v[116:119], a[88:91], a[40:43], v[116:119]
  ds_read_b128 v[28:31], v36 offset:8576
  v_fmac_f32 v64, v52, v32
  v_mfma_f32_16x16x32_bf16 v[120:123], a[88:91], a[48:51], v[120:123]
  v_fmac_f32 v65, v52, v33
  v_fmac_f32 v66, v52, v34
  v_mfma_f32_16x16x32_bf16 v[120:123], a[92:95], a[52:55], v[120:123]
  v_fmac_f32 v67, v52, v35
  v_fmac_f32 v68, v53, v32
  v_mfma_f32_16x16x32_bf16 v[124:127], a[92:95], a[60:63], v[124:127]
  v_lshl_add_u32 v2, s51, 6, v2
  s_add_u32 m0, s99, 90112
  v_mfma_f32_16x16x32_bf16 v[124:127], a[88:91], a[56:59], v[124:127]
  s_waitcnt lgkmcnt(7)
  ds_read_b64_tr_b16 a[80:81], v13 offset:32768
  ds_read_b64_tr_b16 a[82:83], v13 offset:33024
  v_mfma_f32_16x16x32_bf16 v[128:131], a[64:67], a[32:35], v[128:131]
  s_waitcnt lgkmcnt(7)
  ds_read_b64_tr_b16 a[84:85], v13 offset:36864
  ds_read_b64_tr_b16 a[86:87], v13 offset:37120
  v_mfma_f32_16x16x32_bf16 v[128:131], a[68:71], a[36:39], v[128:131]
  global_load_lds_dwordx4 v[6:7], off offset:0
  v_mfma_f32_16x16x32_bf16 v[132:135], a[68:71], a[44:47], v[132:135]
  v_fmac_f32 v69, v53, v33
  v_fmac_f32 v70, v53, v34
  v_mfma_f32_16x16x32_bf16 v[132:135], a[64:67], a[40:43], v[132:135]
  v_fmac_f32 v71, v53, v35
  v_fmac_f32 v72, v54, v32
  v_mfma_f32_16x16x32_bf16 v[136:139], a[64:67], a[48:51], v[136:139]
  s_add_u32 m0, s99, 98240
  v_fmac_f32 v73, v54, v33
  v_fmac_f32 v74, v54, v34
  v_mfma_f32_16x16x32_bf16 v[136:139], a[68:71], a[52:55], v[136:139]
  v_fmac_f32 v75, v54, v35
  v_fmac_f32 v76, v55, v32
  v_mfma_f32_16x16x32_bf16 v[140:143], a[68:71], a[60:63], v[140:143]
  global_load_lds_dwordx4 v[6:7], off offset:64
  v_mfma_f32_16x16x32_bf16 v[140:143], a[64:67], a[56:59], v[140:143]
  s_waitcnt lgkmcnt(7)
  ds_read_b64_tr_b16 a[88:89], v13 offset:33280
  ds_read_b64_tr_b16 a[90:91], v13 offset:33536
  v_mfma_f32_16x16x32_bf16 v[144:147], a[72:75], a[32:35], v[144:147]
  s_waitcnt lgkmcnt(7)
  ds_read_b64_tr_b16 a[92:93], v13 offset:37376
  ds_read_b64_tr_b16 a[94:95], v13 offset:37632
  v_mfma_f32_16x16x32_bf16 v[144:147], a[76:79], a[36:39], v[144:147]
  v_fmac_f32 v77, v55, v33
  v_fmac_f32 v78, v55, v34
  v_mfma_f32_16x16x32_bf16 v[148:151], a[76:79], a[44:47], v[148:151]
  v_fmac_f32 v79, v55, v35
  v_mfma_f32_16x16x32_bf16 v[148:151], a[72:75], a[40:43], v[148:151]
  s_add_u32 m0, s99, 106368
  v_mfma_f32_16x16x32_bf16 v[152:155], a[72:75], a[48:51], v[152:155]
  v_mfma_f32_16x16x32_bf16 v[152:155], a[76:79], a[52:55], v[152:155]
  global_load_lds_dwordx4 v[6:7], off offset:128
  v_mfma_f32_16x16x32_bf16 v[156:159], a[76:79], a[60:63], v[156:159]
  v_mfma_f32_16x16x32_bf16 v[156:159], a[72:75], a[56:59], v[156:159]
  s_waitcnt lgkmcnt(6)
  ds_read_b64_tr_b16 a[64:65], v12 offset:40960
  ds_read_b64_tr_b16 a[66:67], v12 offset:41216
  v_mfma_f32_16x16x32_bf16 v[160:163], a[80:83], a[32:35], v[160:163]
  s_waitcnt lgkmcnt(6)
  ds_read_b64_tr_b16 a[68:69], v12 offset:45056
  ds_read_b64_tr_b16 a[70:71], v12 offset:45312
  v_mfma_f32_16x16x32_bf16 v[160:163], a[84:87], a[36:39], v[160:163]
  ds_read_b128 v[32:35], v36 offset:8256
  v_lshl_add_u64 v[6:7], v[6:7], 0, s[56:57]
  v_mfma_f32_16x16x32_bf16 v[164:167], a[84:87], a[44:47], v[164:167]
  s_xor_b32 m0, s49, 33792
  v_fmac_f32 v80, v52, v28
  v_fmac_f32 v81, v52, v29
  v_mfma_f32_16x16x32_bf16 v[164:167], a[80:83], a[40:43], v[164:167]
  buffer_load_dwordx4 v3, s[8:11], s44 offen lds
  v_mfma_f32_16x16x32_bf16 v[168:171], a[80:83], a[48:51], v[168:171]
  v_fmac_f32 v82, v52, v30
  v_fmac_f32 v83, v52, v31
  v_mfma_f32_16x16x32_bf16 v[168:171], a[84:87], a[52:55], v[168:171]
  v_fmac_f32 v84, v53, v28
  v_fmac_f32 v85, v53, v29
  v_mfma_f32_16x16x32_bf16 v[172:175], a[84:87], a[60:63], v[172:175]
  v_fmac_f32 v86, v53, v30
  v_fmac_f32 v87, v53, v31
  v_mfma_f32_16x16x32_bf16 v[172:175], a[80:83], a[56:59], v[172:175]
  s_waitcnt lgkmcnt(7)
  ds_read_b64_tr_b16 a[72:73], v12 offset:41472
  ds_read_b64_tr_b16 a[74:75], v12 offset:41728
  v_mfma_f32_16x16x32_bf16 v[176:179], a[88:91], a[32:35], v[176:179]
  s_waitcnt lgkmcnt(7)
  ds_read_b64_tr_b16 a[76:77], v12 offset:45568
  ds_read_b64_tr_b16 a[78:79], v12 offset:45824
  v_mfma_f32_16x16x32_bf16 v[176:179], a[92:95], a[36:39], v[176:179]
  s_xor_b32 m0, s49, 35840
  v_lshrrev_b32 v38, 3, v0
  v_bfe_u32 v39, v0, 2, 1
  v_mfma_f32_16x16x32_bf16 v[180:183], a[92:95], a[44:47], v[180:183]
  buffer_load_dwordx4 v3, s[8:11], s45 offen lds
  v_mfma_f32_16x16x32_bf16 v[180:183], a[88:91], a[40:43], v[180:183]
  v_mad_u32_u24 v38, v38, 32, v39
  v_add_lshl_u32 v38, v38, 30, 7
  v_mfma_f32_16x16x32_bf16 v[184:187], a[88:91], a[48:51], v[184:187]
  s_mov_b32 s62, 22020096
  buffer_load_dword v39, v38, s[12:15], s62 offen sc1
  v_mfma_f32_16x16x32_bf16 v[184:187], a[92:95], a[52:55], v[184:187]
  v_fmac_f32 v88, v54, v28
  v_fmac_f32 v89, v54, v29
  v_mfma_f32_16x16x32_bf16 v[188:191], a[92:95], a[60:63], v[188:191]
  s_xor_b32 m0, s49, 37888
  v_fmac_f32 v90, v54, v30
  v_fmac_f32 v91, v54, v31
  v_mfma_f32_16x16x32_bf16 v[188:191], a[88:91], a[56:59], v[188:191]
  s_waitcnt lgkmcnt(7)
  ds_read_b64_tr_b16 a[80:81], v13 offset:40960
  ds_read_b64_tr_b16 a[82:83], v13 offset:41216
  v_mfma_f32_16x16x32_bf16 v[192:195], a[64:67], a[32:35], v[192:195]
  s_waitcnt lgkmcnt(7)
  ds_read_b64_tr_b16 a[84:85], v13 offset:45056
  ds_read_b64_tr_b16 a[86:87], v13 offset:45312
  v_mfma_f32_16x16x32_bf16 v[192:195], a[68:71], a[36:39], v[192:195]
  buffer_load_dwordx4 v3, s[8:11], s46 offen lds
  v_mfma_f32_16x16x32_bf16 v[196:199], a[68:71], a[44:47], v[196:199]
  s_waitcnt vmcnt(14)
  ds_read_b128 a[0:3], v8 offset:0
  v_fmac_f32 v92, v55, v28
  v_mfma_f32_16x16x32_bf16 v[196:199], a[64:67], a[40:43], v[196:199]
  ds_read_b128 a[4:7], v9 offset:0
  v_fmac_f32 v93, v55, v29
  v_mfma_f32_16x16x32_bf16 v[200:203], a[64:67], a[48:51], v[200:203]
  ds_read_b128 a[8:11], v8 offset:2048
  v_fmac_f32 v94, v55, v30
  v_mfma_f32_16x16x32_bf16 v[200:203], a[68:71], a[52:55], v[200:203]
  s_xor_b32 m0, s49, 39936
  ds_read_b128 a[12:15], v9 offset:2048
  v_fmac_f32 v95, v55, v31
  v_mfma_f32_16x16x32_bf16 v[204:207], a[68:71], a[60:63], v[204:207]
  v_mfma_f32_16x16x32_bf16 v[204:207], a[64:67], a[56:59], v[204:207]
  s_waitcnt lgkmcnt(10)
  ds_read_b64_tr_b16 a[88:89], v13 offset:41472
  ds_read_b64_tr_b16 a[90:91], v13 offset:41728
  v_mfma_f32_16x16x32_bf16 v[208:211], a[72:75], a[32:35], v[208:211]
  s_waitcnt lgkmcnt(10)
  ds_read_b64_tr_b16 a[92:93], v13 offset:45568
  ds_read_b64_tr_b16 a[94:95], v13 offset:45824
  v_mfma_f32_16x16x32_bf16 v[208:211], a[76:79], a[36:39], v[208:211]
  buffer_load_dwordx4 v3, s[8:11], s47 offen lds
  v_mfma_f32_16x16x32_bf16 v[212:215], a[76:79], a[44:47], v[212:215]
  ds_read_b128 a[16:19], v8 offset:4096
  v_lshl_add_u32 v3, s51, 6, v3
  v_mfma_f32_16x16x32_bf16 v[212:215], a[72:75], a[40:43], v[212:215]
  ds_read_b128 a[20:23], v9 offset:4096
  v_mfma_f32_16x16x32_bf16 v[216:219], a[72:75], a[48:51], v[216:219]
  ds_read_b128 a[24:27], v8 offset:6144
  v_mfma_f32_16x16x32_bf16 v[216:219], a[76:79], a[52:55], v[216:219]
  ds_read_b128 a[28:31], v9 offset:6144
  v_mfma_f32_16x16x32_bf16 v[220:223], a[76:79], a[60:63], v[220:223]
  ds_read_b128 v[28:31], v36 offset:8640
  v_fmac_f32 v96, v52, v32
  v_mfma_f32_16x16x32_bf16 v[220:223], a[72:75], a[56:59], v[220:223]
  s_waitcnt lgkmcnt(15)
  v_fmac_f32 v97, v52, v33
  v_fmac_f32 v98, v52, v34
  v_mfma_f32_16x16x32_bf16 v[224:227], a[80:83], a[32:35], v[224:227]
  s_waitcnt lgkmcnt(13)
  v_fmac_f32 v99, v52, v35
  v_fmac_f32 v100, v53, v32
  v_mfma_f32_16x16x32_bf16 v[224:227], a[84:87], a[36:39], v[224:227]
  s_waitcnt lgkmcnt(0)
  s_barrier
  ds_read_b64_tr_b16 a[64:65], v10 offset:0
  v_mfma_f32_16x16x32_bf16 v[228:231], a[84:87], a[44:47], v[228:231]
  s_cmp_eq_u32 s50, 1
  s_cselect_b64 s[56:57], s[54:55], s[52:53]
  s_cselect_b32 s51, -18, 2
  ds_read_b64_tr_b16 a[66:67], v10 offset:256
  v_mfma_f32_16x16x32_bf16 v[228:231], a[80:83], a[40:43], v[228:231]
  s_add_u32 m0, s98, 114688
  ds_read_b64_tr_b16 a[68:69], v10 offset:4096
  v_fmac_f32 v101, v53, v33
  v_mfma_f32_16x16x32_bf16 v[232:235], a[80:83], a[48:51], v[232:235]
  ds_read_b64_tr_b16 a[70:71], v10 offset:4352
  v_fmac_f32 v102, v53, v34
  v_mfma_f32_16x16x32_bf16 v[232:235], a[84:87], a[52:55], v[232:235]
  global_load_lds_dwordx4 v[4:5], off offset:0
  v_mfma_f32_16x16x32_bf16 v[236:239], a[84:87], a[60:63], v[236:239]
  s_add_u32 m0, s98, 122816
  v_fmac_f32 v103, v53, v35
  v_fmac_f32 v104, v54, v32
  v_mfma_f32_16x16x32_bf16 v[236:239], a[80:83], a[56:59], v[236:239]
  s_waitcnt lgkmcnt(4)
  ds_read_b64_tr_b16 a[72:73], v10 offset:512
  ds_read_b64_tr_b16 a[74:75], v10 offset:768
  v_mfma_f32_16x16x32_bf16 v[240:243], a[88:91], a[32:35], v[240:243]
  s_waitcnt lgkmcnt(6)
  ds_read_b64_tr_b16 a[76:77], v10 offset:4608
  ds_read_b64_tr_b16 a[78:79], v10 offset:4864
  v_mfma_f32_16x16x32_bf16 v[240:243], a[92:95], a[36:39], v[240:243]
  global_load_lds_dwordx4 v[4:5], off offset:64
  v_mfma_f32_16x16x32_bf16 v[244:247], a[92:95], a[44:47], v[244:247]
  s_add_u32 m0, s98, 130944
  v_fmac_f32 v105, v54, v33
  v_fmac_f32 v106, v54, v34
  v_mfma_f32_16x16x32_bf16 v[244:247], a[88:91], a[40:43], v[244:247]
  v_fmac_f32 v107, v54, v35
  v_fmac_f32 v108, v55, v32
  v_mfma_f32_16x16x32_bf16 v[248:251], a[88:91], a[48:51], v[248:251]
  v_fmac_f32 v109, v55, v33
  v_fmac_f32 v110, v55, v34
  v_fmac_f32 v111, v55, v35
  v_mfma_f32_16x16x32_bf16 v[248:251], a[92:95], a[52:55], v[248:251]
  global_load_lds_dwordx4 v[4:5], off offset:128
  v_mfma_f32_16x16x32_bf16 v[252:255], a[92:95], a[60:63], v[252:255]
  ds_read_b128 v[32:35], v36 offset:8384
  v_fmac_f32 v112, v52, v28
  v_mfma_f32_16x16x32_bf16 v[252:255], a[88:91], a[56:59], v[252:255]
  s_waitcnt lgkmcnt(7)
  ds_read_b64_tr_b16 a[80:81], v11 offset:0
  ds_read_b64_tr_b16 a[82:83], v11 offset:256
  v_mfma_f32_16x16x32_bf16 v[64:67], a[64:67], a[0:3], v[64:67]
  s_waitcnt lgkmcnt(7)
  ds_read_b64_tr_b16 a[84:85], v11 offset:4096
  ds_read_b64_tr_b16 a[86:87], v11 offset:4352
  v_mfma_f32_16x16x32_bf16 v[64:67], a[68:71], a[4:7], v[64:67]
  v_lshl_add_u64 v[4:5], v[4:5], 0, s[56:57]
  s_xor_b32 m0, s49, 0
  v_mfma_f32_16x16x32_bf16 v[68:71], a[68:71], a[12:15], v[68:71]
  buffer_load_dwordx4 v2, s[8:11], s44 offen lds
  v_mfma_f32_16x16x32_bf16 v[68:71], a[64:67], a[8:11], v[68:71]
  v_fmac_f32 v113, v52, v29
  v_fmac_f32 v114, v52, v30
  v_mfma_f32_16x16x32_bf16 v[72:75], a[64:67], a[16:19], v[72:75]
  v_fmac_f32 v115, v52, v31
  v_fmac_f32 v116, v53, v28
  v_mfma_f32_16x16x32_bf16 v[72:75], a[68:71], a[20:23], v[72:75]
  s_xor_b32 m0, s49, 2048
  v_fmac_f32 v117, v53, v29
  v_fmac_f32 v118, v53, v30
  v_mfma_f32_16x16x32_bf16 v[76:79], a[68:71], a[28:31], v[76:79]
  v_fmac_f32 v119, v53, v31
  v_fmac_f32 v120, v54, v28
  v_mfma_f32_16x16x32_bf16 v[76:79], a[64:67], a[24:27], v[76:79]
  s_waitcnt lgkmcnt(7)
  ds_read_b64_tr_b16 a[88:89], v11 offset:512
  ds_read_b64_tr_b16 a[90:91], v11 offset:768
  v_mfma_f32_16x16x32_bf16 v[80:83], a[72:75], a[0:3], v[80:83]
  s_waitcnt lgkmcnt(7)
  ds_read_b64_tr_b16 a[92:93], v11 offset:4608
  ds_read_b64_tr_b16 a[94:95], v11 offset:4864
  v_mfma_f32_16x16x32_bf16 v[80:83], a[76:79], a[4:7], v[80:83]
  buffer_load_dwordx4 v2, s[8:11], s45 offen lds
  v_mfma_f32_16x16x32_bf16 v[84:87], a[76:79], a[12:15], v[84:87]
  s_xor_b32 m0, s49, 4096
  v_fmac_f32 v121, v54, v29
  v_fmac_f32 v122, v54, v30
  v_mfma_f32_16x16x32_bf16 v[84:87], a[72:75], a[8:11], v[84:87]
  v_fmac_f32 v123, v54, v31
  v_fmac_f32 v124, v55, v28
  v_mfma_f32_16x16x32_bf16 v[88:91], a[72:75], a[16:19], v[88:91]
  buffer_load_dwordx4 v2, s[8:11], s46 offen lds
  v_mfma_f32_16x16x32_bf16 v[88:91], a[76:79], a[20:23], v[88:91]
  v_fmac_f32 v125, v55, v29
  v_fmac_f32 v126, v55, v30
  v_mfma_f32_16x16x32_bf16 v[92:95], a[76:79], a[28:31], v[92:95]
  v_fmac_f32 v127, v55, v31
  v_mfma_f32_16x16x32_bf16 v[92:95], a[72:75], a[24:27], v[92:95]
  s_waitcnt lgkmcnt(6)
  ds_read_b64_tr_b16 a[64:65], v10 offset:8192
  ds_read_b64_tr_b16 a[66:67], v10 offset:8448
  v_mfma_f32_16x16x32_bf16 v[96:99], a[80:83], a[0:3], v[96:99]
  s_waitcnt lgkmcnt(6)
  ds_read_b64_tr_b16 a[68:69], v10 offset:12288
  ds_read_b64_tr_b16 a[70:71], v10 offset:12544
  v_mfma_f32_16x16x32_bf16 v[96:99], a[84:87], a[4:7], v[96:99]
  s_xor_b32 m0, s49, 6144
  v_mfma_f32_16x16x32_bf16 v[100:103], a[84:87], a[12:15], v[100:103]
  buffer_load_dwordx4 v2, s[8:11], s47 offen lds
  v_mfma_f32_16x16x32_bf16 v[100:103], a[80:83], a[8:11], v[100:103]
  ds_read_b128 v[28:31], v36 offset:8832
  v_fmac_f32 v160, v52, v32
  v_mfma_f32_16x16x32_bf16 v[104:107], a[80:83], a[16:19], v[104:107]
  v_fmac_f32 v161, v52, v33
  v_fmac_f32 v162, v52, v34
  v_mfma_f32_16x16x32_bf16 v[104:107], a[84:87], a[20:23], v[104:107]
  v_lshl_add_u32 v2, s51, 6, v2
  s_add_u32 m0, s99, 114688
  v_mfma_f32_16x16x32_bf16 v[108:111], a[84:87], a[28:31], v[108:111]
  v_fmac_f32 v163, v52, v35
  v_fmac_f32 v164, v53, v32
  v_mfma_f32_16x16x32_bf16 v[108:111], a[80:83], a[24:27], v[108:111]
  s_waitcnt lgkmcnt(7)
  ds_read_b64_tr_b16 a[72:73], v10 offset:8704
  ds_read_b64_tr_b16 a[74:75], v10 offset:8960
  v_mfma_f32_16x16x32_bf16 v[112:115], a[88:91], a[0:3], v[112:115]
  s_waitcnt lgkmcnt(7)
  ds_read_b64_tr_b16 a[76:77], v10 offset:12800
  ds_read_b64_tr_b16 a[78:79], v10 offset:13056
  v_mfma_f32_16x16x32_bf16 v[112:115], a[92:95], a[4:7], v[112:115]
  global_load_lds_dwordx4 v[6:7], off offset:0
  v_mfma_f32_16x16x32_bf16 v[116:119], a[92:95], a[12:15], v[116:119]
  s_add_u32 m0, s99, 122816
  v_fmac_f32 v165, v53, v33
  v_fmac_f32 v166, v53, v34
  v_mfma_f32_16x16x32_bf16 v[116:119], a[88:91], a[8:11], v[116:119]
  v_fmac_f32 v167, v53, v35
  v_fmac_f32 v168, v54, v32
  v_mfma_f32_16x16x32_bf16 v[120:123], a[88:91], a[16:19], v[120:123]
  s_waitcnt vmcnt(10)
  global_load_lds_dwordx4 v[6:7], off offset:64
  v_mfma_f32_16x16x32_bf16 v[120:123], a[92:95], a[20:23], v[120:123]
  v_cmp_ne_u32 vcc, s61, v39
  v_fmac_f32 v169, v54, v33
  v_mfma_f32_16x16x32_bf16 v[124:127], a[92:95], a[28:31], v[124:127]
  v_fmac_f32 v170, v54, v34
  v_fmac_f32 v171, v54, v35
  v_mfma_f32_16x16x32_bf16 v[124:127], a[88:91], a[24:27], v[124:127]
  s_waitcnt lgkmcnt(7)
  ds_read_b64_tr_b16 a[80:81], v11 offset:8192
  ds_read_b64_tr_b16 a[82:83], v11 offset:8448
  v_mfma_f32_16x16x32_bf16 v[128:131], a[64:67], a[0:3], v[128:131]
  s_waitcnt lgkmcnt(7)
  ds_read_b64_tr_b16 a[84:85], v11 offset:12288
  ds_read_b64_tr_b16 a[86:87], v11 offset:12544
  v_mfma_f32_16x16x32_bf16 v[128:131], a[68:71], a[4:7], v[128:131]
  s_add_u32 m0, s99, 130944
  s_cbranch_vccnz L_slow_10
L_back_11:
  s_add_u32 s23, s83, 0
  v_mfma_f32_16x16x32_bf16 v[132:135], a[68:71], a[12:15], v[132:135]
  global_load_lds_dwordx4 v[6:7], off offset:128
  v_mfma_f32_16x16x32_bf16 v[132:135], a[64:67], a[8:11], v[132:135]
  buffer_load_dwordx4 a[96:99], v59, s[12:15], s23 offen offset:0 sc1
  v_mfma_f32_16x16x32_bf16 v[136:139], a[64:67], a[16:19], v[136:139]
  v_lshl_add_u64 v[6:7], v[6:7], 0, s[56:57]
  s_xor_b32 m0, s49, 1024
  v_mfma_f32_16x16x32_bf16 v[136:139], a[68:71], a[20:23], v[136:139]
  v_fmac_f32 v172, v55, v32
  v_fmac_f32 v173, v55, v33
  v_mfma_f32_16x16x32_bf16 v[140:143], a[68:71], a[28:31], v[140:143]
  buffer_load_dwordx4 v3, s[8:11], s44 offen lds
  v_mfma_f32_16x16x32_bf16 v[140:143], a[64:67], a[24:27], v[140:143]
  s_waitcnt lgkmcnt(6)
  ds_read_b64_tr_b16 a[88:89], v11 offset:8704
  ds_read_b64_tr_b16 a[90:91], v11 offset:8960
  v_mfma_f32_16x16x32_bf16 v[144:147], a[72:75], a[0:3], v[144:147]
  s_waitcnt lgkmcnt(6)
  ds_read_b64_tr_b16 a[92:93], v11 offset:12800
  ds_read_b64_tr_b16 a[94:95], v11 offset:13056
  v_fmac_f32 v174, v55, v34
  v_fmac_f32 v175, v55, v35
  v_mfma_f32_16x16x32_bf16 v[144:147], a[76:79], a[4:7], v[144:147]
  ds_read_b128 v[32:35], v36 offset:8704
  v_fmac_f32 v208, v52, v28
  v_mfma_f32_16x16x32_bf16 v[148:151], a[76:79], a[12:15], v[148:151]
  s_xor_b32 m0, s49, 3072
  v_fmac_f32 v209, v52, v29
  v_fmac_f32 v210, v52, v30
  v_mfma_f32_16x16x32_bf16 v[148:151], a[72:75], a[8:11], v[148:151]
L_hop_ffn2:
  s_cbranch_execz L_retffn1
  v_fmac_f32 v211, v52, v31
  v_fmac_f32 v212, v53, v28
  v_mfma_f32_16x16x32_bf16 v[152:155], a[72:75], a[16:19], v[152:155]
  buffer_load_dwordx4 v3, s[8:11], s45 offen lds
  v_mfma_f32_16x16x32_bf16 v[152:155], a[76:79], a[20:23], v[152:155]
  v_fmac_f32 v213, v53, v29
  v_fmac_f32 v214, v53, v30
  v_mfma_f32_16x16x32_bf16 v[156:159], a[76:79], a[28:31], v[156:159]
  v_fmac_f32 v215, v53, v31
  v_fmac_f32 v216, v54, v28
  v_mfma_f32_16x16x32_bf16 v[156:159], a[72:75], a[24:27], v[156:159]
  s_waitcnt lgkmcnt(7)
  ds_read_b64_tr_b16 a[64:65], v10 offset:16384
  ds_read_b64_tr_b16 a[66:67], v10 offset:16640
  v_mfma_f32_16x16x32_bf16 v[160:163], a[80:83], a[0:3], v[160:163]
  s_waitcnt lgkmcnt(7)
  ds_read_b64_tr_b16 a[68:69], v10 offset:20480
  ds_read_b64_tr_b16 a[70:71], v10 offset:20736
  v_mfma_f32_16x16x32_bf16 v[160:163], a[84:87], a[4:7], v[160:163]
  s_xor_b32 m0, s49, 5120
  buffer_load_dwordx4 a[100:103], v59, s[12:15], s23 offen offset:1024 sc1
  v_mfma_f32_16x16x32_bf16 v[164:167], a[84:87], a[12:15], v[164:167]
  buffer_load_dwordx4 v3, s[8:11], s46 offen lds
  v_mfma_f32_16x16x32_bf16 v[164:167], a[80:83], a[8:11], v[164:167]
  v_fmac_f32 v217, v54, v29
  v_fmac_f32 v218, v54, v30
  v_mfma_f32_16x16x32_bf16 v[168:171], a[80:83], a[16:19], v[168:171]
  s_xor_b32 m0, s49, 7168
  v_fmac_f32 v219, v54, v31
  v_fmac_f32 v220, v55, v28
  v_mfma_f32_16x16x32_bf16 v[168:171], a[84:87], a[20:23], v[168:171]
  v_fmac_f32 v221, v55, v29
  v_fmac_f32 v222, v55, v30
  v_mfma_f32_16x16x32_bf16 v[172:175], a[84:87], a[28:31], v[172:175]
  buffer_load_dwordx4 v3, s[8:11], s47 offen lds
  v_mfma_f32_16x16x32_bf16 v[172:175], a[80:83], a[24:27], v[172:175]
  s_waitcnt lgkmcnt(7)
  ds_read_b64_tr_b16 a[72:73], v10 offset:16896
  ds_read_b64_tr_b16 a[74:75], v10 offset:17152
  v_mfma_f32_16x16x32_bf16 v[176:179], a[88:91], a[0:3], v[176:179]
  s_waitcnt lgkmcnt(7)
  ds_read_b64_tr_b16 a[76:77], v10 offset:20992
  ds_read_b64_tr_b16 a[78:79], v10 offset:21248
  v_mfma_f32_16x16x32_bf16 v[176:179], a[92:95], a[4:7], v[176:179]
  v_fmac_f32 v223, v55, v31
  v_mfma_f32_16x16x32_bf16 v[180:183], a[92:95], a[12:15], v[180:183]
  v_lshl_add_u32 v3, s51, 6, v3
  v_mfma_f32_16x16x32_bf16 v[180:183], a[88:91], a[8:11], v[180:183]
  v_mfma_f32_16x16x32_bf16 v[184:187], a[88:91], a[16:19], v[184:187]
  v_mfma_f32_16x16x32_bf16 v[184:187], a[92:95], a[20:23], v[184:187]
  v_mfma_f32_16x16x32_bf16 v[188:191], a[92:95], a[28:31], v[188:191]
  v_mfma_f32_16x16x32_bf16 v[188:191], a[88:91], a[24:27], v[188:191]
  s_waitcnt lgkmcnt(6)
  ds_read_b64_tr_b16 a[80:81], v11 offset:16384
  ds_read_b64_tr_b16 a[82:83], v11 offset:16640
  v_mfma_f32_16x16x32_bf16 v[192:195], a[64:67], a[0:3], v[192:195]
  s_waitcnt lgkmcnt(6)
  ds_read_b64_tr_b16 a[84:85], v11 offset:20480
  ds_read_b64_tr_b16 a[86:87], v11 offset:20736
  v_mfma_f32_16x16x32_bf16 v[192:195], a[68:71], a[4:7], v[192:195]
  buffer_load_dwordx4 a[104:107], v59, s[12:15], s23 offen offset:2048 sc1
  v_mfma_f32_16x16x32_bf16 v[196:199], a[68:71], a[12:15], v[196:199]
  s_waitcnt vmcnt(17)
  ds_read_b128 a[32:35], v8 offset:32768
  ds_read_b128 v[28:31], v36 offset:8768
  v_mfma_f32_16x16x32_bf16 v[196:199], a[64:67], a[8:11], v[196:199]
  ds_read_b128 a[36:39], v9 offset:32768
  v_fmac_f32 v144, v52, v32
  v_mfma_f32_16x16x32_bf16 v[200:203], a[64:67], a[16:19], v[200:203]
  ds_read_b128 a[40:43], v8 offset:34816
  v_fmac_f32 v145, v52, v33
  v_mfma_f32_16x16x32_bf16 v[200:203], a[68:71], a[20:23], v[200:203]
  ds_read_b128 a[44:47], v9 offset:34816
  v_fmac_f32 v146, v52, v34
  v_mfma_f32_16x16x32_bf16 v[204:207], a[68:71], a[28:31], v[204:207]
  v_fmac_f32 v147, v52, v35
  v_fmac_f32 v148, v53, v32
  v_mfma_f32_16x16x32_bf16 v[204:207], a[64:67], a[24:27], v[204:207]
  s_waitcnt lgkmcnt(11)
  ds_read_b64_tr_b16 a[88:89], v11 offset:16896
  ds_read_b64_tr_b16 a[90:91], v11 offset:17152
  v_mfma_f32_16x16x32_bf16 v[208:211], a[72:75], a[0:3], v[208:211]
  s_waitcnt lgkmcnt(11)
  ds_read_b64_tr_b16 a[92:93], v11 offset:20992
  ds_read_b64_tr_b16 a[94:95], v11 offset:21248
  v_mfma_f32_16x16x32_bf16 v[208:211], a[76:79], a[4:7], v[208:211]
  v_fmac_f32 v149, v53, v33
  v_fmac_f32 v150, v53, v34
  v_mfma_f32_16x16x32_bf16 v[212:215], a[76:79], a[12:15], v[212:215]
  ds_read_b128 a[48:51], v8 offset:36864
  v_fmac_f32 v151, v53, v35
  v_mfma_f32_16x16x32_bf16 v[212:215], a[72:75], a[8:11], v[212:215]
  ds_read_b128 a[52:55], v9 offset:36864
  v_fmac_f32 v152, v54, v32
  v_mfma_f32_16x16x32_bf16 v[216:219], a[72:75], a[16:19], v[216:219]
  ds_read_b128 a[56:59], v8 offset:38912
  v_fmac_f32 v153, v54, v33
  v_mfma_f32_16x16x32_bf16 v[216:219], a[76:79], a[20:23], v[216:219]
  ds_read_b128 a[60:63], v9 offset:38912
  v_fmac_f32 v154, v54, v34
  v_mfma_f32_16x16x32_bf16 v[220:223], a[76:79], a[28:31], v[220:223]
  v_fmac_f32 v155, v54, v35
  v_fmac_f32 v156, v55, v32
  v_mfma_f32_16x16x32_bf16 v[220:223], a[72:75], a[24:27], v[220:223]
  s_waitcnt lgkmcnt(15)
  buffer_load_dwordx4 a[108:111], v59, s[12:15], s23 offen offset:3072 sc1
  v_mfma_f32_16x16x32_bf16 v[224:227], a[80:83], a[0:3], v[224:227]
  s_waitcnt lgkmcnt(13)
  s_add_u32 m0, s98, 65536
  v_fmac_f32 v157, v55, v33
  v_mfma_f32_16x16x32_bf16 v[224:227], a[84:87], a[4:7], v[224:227]
  s_waitcnt lgkmcnt(0)
  s_barrier
  ds_read_b64_tr_b16 a[64:65], v10 offset:24576
  v_mfma_f32_16x16x32_bf16 v[228:231], a[84:87], a[12:15], v[228:231]
  ds_read_b64_tr_b16 a[66:67], v10 offset:24832
  v_fmac_f32 v158, v55, v34
  v_mfma_f32_16x16x32_bf16 v[228:231], a[80:83], a[8:11], v[228:231]
  ds_read_b64_tr_b16 a[68:69], v10 offset:28672
  v_fmac_f32 v159, v55, v35
  v_mfma_f32_16x16x32_bf16 v[232:235], a[80:83], a[16:19], v[232:235]
  ds_read_b64_tr_b16 a[70:71], v10 offset:28928
  v_mfma_f32_16x16x32_bf16 v[232:235], a[84:87], a[20:23], v[232:235]
  global_load_lds_dwordx4 v[4:5], off offset:0
  v_mfma_f32_16x16x32_bf16 v[236:239], a[84:87], a[28:31], v[236:239]
  s_add_u32 m0, s98, 73664
  ds_read_b128 v[32:35], v36 offset:8448
  v_fmac_f32 v176, v52, v28
  v_mfma_f32_16x16x32_bf16 v[236:239], a[80:83], a[24:27], v[236:239]
  s_waitcnt lgkmcnt(5)
  ds_read_b64_tr_b16 a[72:73], v10 offset:25088
  ds_read_b64_tr_b16 a[74:75], v10 offset:25344
  v_mfma_f32_16x16x32_bf16 v[240:243], a[88:91], a[0:3], v[240:243]
  s_waitcnt lgkmcnt(7)
  ds_read_b64_tr_b16 a[76:77], v10 offset:29184
  ds_read_b64_tr_b16 a[78:79], v10 offset:29440
  v_mfma_f32_16x16x32_bf16 v[240:243], a[92:95], a[4:7], v[240:243]
  global_load_lds_dwordx4 v[4:5], off offset:64
  v_mfma_f32_16x16x32_bf16 v[244:247], a[92:95], a[12:15], v[244:247]
  s_add_u32 m0, s98, 81792
  v_fmac_f32 v177, v52, v29
  v_fmac_f32 v178, v52, v30
  v_mfma_f32_16x16x32_bf16 v[244:247], a[88:91], a[8:11], v[244:247]
  v_fmac_f32 v179, v52, v31
  v_fmac_f32 v180, v53, v28
  v_mfma_f32_16x16x32_bf16 v[248:251], a[88:91], a[16:19], v[248:251]
  global_load_lds_dwordx4 v[4:5], off offset:128
  v_mfma_f32_16x16x32_bf16 v[248:251], a[92:95], a[20:23], v[248:251]
  v_fmac_f32 v181, v53, v29
  v_fmac_f32 v182, v53, v30
  v_mfma_f32_16x16x32_bf16 v[252:255], a[92:95], a[28:31], v[252:255]
  buffer_load_dwordx4 a[112:115], v60, s[12:15], s23 offen offset:0 sc1
  v_mfma_f32_16x16x32_bf16 v[252:255], a[88:91], a[24:27], v[252:255]
  s_waitcnt lgkmcnt(7)
  ds_read_b64_tr_b16 a[80:81], v11 offset:24576
  ds_read_b64_tr_b16 a[82:83], v11 offset:24832
  v_mfma_f32_16x16x32_bf16 v[64:67], a[64:67], a[32:35], v[64:67]
  s_waitcnt lgkmcnt(7)
  ds_read_b64_tr_b16 a[84:85], v11 offset:28672
  ds_read_b64_tr_b16 a[86:87], v11 offset:28928
  v_mfma_f32_16x16x32_bf16 v[64:67], a[68:71], a[36:39], v[64:67]
  s_xor_b32 m0, s49, 32768
  v_fmac_f32 v183, v53, v31
  v_fmac_f32 v184, v54, v28
  v_mfma_f32_16x16x32_bf16 v[68:71], a[68:71], a[44:47], v[68:71]
  buffer_load_dwordx4 v2, s[8:11], s44 offen lds
  v_mfma_f32_16x16x32_bf16 v[68:71], a[64:67], a[40:43], v[68:71]
  v_fmac_f32 v185, v54, v29
  v_fmac_f32 v186, v54, v30
  v_mfma_f32_16x16x32_bf16 v[72:75], a[64:67], a[48:51], v[72:75]
  v_fmac_f32 v187, v54, v31
  v_fmac_f32 v188, v55, v28
  v_mfma_f32_16x16x32_bf16 v[72:75], a[68:71], a[52:55], v[72:75]
  s_xor_b32 m0, s49, 34816
  v_fmac_f32 v189, v55, v29
  v_fmac_f32 v190, v55, v30
  v_mfma_f32_16x16x32_bf16 v[76:79], a[68:71], a[60:63], v[76:79]
  v_fmac_f32 v191, v55, v31
  v_mfma_f32_16x16x32_bf16 v[76:79], a[64:67], a[56:59], v[76:79]
  s_waitcnt lgkmcnt(6)
  ds_read_b64_tr_b16 a[88:89], v11 offset:25088
  ds_read_b64_tr_b16 a[90:91], v11 offset:25344
  v_mfma_f32_16x16x32_bf16 v[80:83], a[72:75], a[32:35], v[80:83]
  s_waitcnt lgkmcnt(6)
  ds_read_b64_tr_b16 a[92:93], v11 offset:29184
  ds_read_b64_tr_b16 a[94:95], v11 offset:29440
  v_mfma_f32_16x16x32_bf16 v[80:83], a[76:79], a[36:39], v[80:83]
  buffer_load_dwordx4 v2, s[8:11], s45 offen lds
  v_mfma_f32_16x16x32_bf16 v[84:87], a[76:79], a[44:47], v[84:87]
  s_xor_b32 m0, s49, 36864
  v_mfma_f32_16x16x32_bf16 v[84:87], a[72:75], a[40:43], v[84:87]
  ds_read_b128 v[28:31], v36 offset:8512
  v_fmac_f32 v192, v52, v32
  v_mfma_f32_16x16x32_bf16 v[88:91], a[72:75], a[48:51], v[88:91]
  s_add_u32 s23, s83, 163840
  buffer_load_dwordx4 v2, s[8:11], s46 offen lds
  v_mfma_f32_16x16x32_bf16 v[88:91], a[76:79], a[52:55], v[88:91]
  buffer_load_dwordx4 a[116:119], v59, s[12:15], s23 offen offset:0 sc1
  v_mfma_f32_16x16x32_bf16 v[92:95], a[76:79], a[60:63], v[92:95]
  v_fmac_f32 v193, v52, v33
  v_fmac_f32 v194, v52, v34
  v_mfma_f32_16x16x32_bf16 v[92:95], a[72:75], a[56:59], v[92:95]
  s_waitcnt lgkmcnt(7)
  ds_read_b64_tr_b16 a[64:65], v10 offset:32768
  ds_read_b64_tr_b16 a[66:67], v10 offset:33024
  v_mfma_f32_16x16x32_bf16 v[96:99], a[80:83], a[32:35], v[96:99]
  s_waitcnt lgkmcnt(7)
  ds_read_b64_tr_b16 a[68:69], v10 offset:36864
  ds_read_b64_tr_b16 a[70:71], v10 offset:37120
  v_mfma_f32_16x16x32_bf16 v[96:99], a[84:87], a[36:39], v[96:99]
  s_xor_b32 m0, s49, 38912
  v_fmac_f32 v195, v52, v35
  v_fmac_f32 v196, v53, v32
  v_mfma_f32_16x16x32_bf16 v[100:103], a[84:87], a[44:47], v[100:103]
  buffer_load_dwordx4 v2, s[8:11], s47 offen lds
  v_mfma_f32_16x16x32_bf16 v[100:103], a[80:83], a[40:43], v[100:103]
  v_fmac_f32 v197, v53, v33
  v_fmac_f32 v198, v53, v34
  v_mfma_f32_16x16x32_bf16 v[104:107], a[80:83], a[48:51], v[104:107]
  v_fmac_f32 v199, v53, v35
  v_fmac_f32 v200, v54, v32
  v_mfma_f32_16x16x32_bf16 v[104:107], a[84:87], a[52:55], v[104:107]
  s_add_u32 m0, s99, 65536
  v_fmac_f32 v201, v54, v33
  v_fmac_f32 v202, v54, v34
  v_mfma_f32_16x16x32_bf16 v[108:111], a[84:87], a[60:63], v[108:111]
  v_fmac_f32 v203, v54, v35
  v_fmac_f32 v204, v55, v32
  v_mfma_f32_16x16x32_bf16 v[108:111], a[80:83], a[56:59], v[108:111]
  s_waitcnt lgkmcnt(7)
  ds_read_b64_tr_b16 a[72:73], v10 offset:33280
  ds_read_b64_tr_b16 a[74:75], v10 offset:33536
  v_mfma_f32_16x16x32_bf16 v[112:115], a[88:91], a[32:35], v[112:115]
  s_waitcnt lgkmcnt(7)
  ds_read_b64_tr_b16 a[76:77], v10 offset:37376
  ds_read_b64_tr_b16 a[78:79], v10 offset:37632
  v_mfma_f32_16x16x32_bf16 v[112:115], a[92:95], a[36:39], v[112:115]
  global_load_lds_dwordx4 v[6:7], off offset:0
  v_mfma_f32_16x16x32_bf16 v[116:119], a[92:95], a[44:47], v[116:119]
  s_add_u32 m0, s99, 73664
  v_fmac_f32 v205, v55, v33
  v_fmac_f32 v206, v55, v34
  v_mfma_f32_16x16x32_bf16 v[116:119], a[88:91], a[40:43], v[116:119]
  v_fmac_f32 v207, v55, v35
  v_mfma_f32_16x16x32_bf16 v[120:123], a[88:91], a[48:51], v[120:123]
  global_load_lds_dwordx4 v[6:7], off offset:64
  v_mfma_f32_16x16x32_bf16 v[120:123], a[92:95], a[52:55], v[120:123]
  buffer_load_dwordx4 a[120:123], v59, s[12:15], s23 offen offset:1024 sc1
  v_mfma_f32_16x16x32_bf16 v[124:127], a[92:95], a[60:63], v[124:127]
  v_mfma_f32_16x16x32_bf16 v[124:127], a[88:91], a[56:59], v[124:127]
  s_waitcnt lgkmcnt(6)
  ds_read_b64_tr_b16 a[80:81], v11 offset:32768
  ds_read_b64_tr_b16 a[82:83], v11 offset:33024
  v_mfma_f32_16x16x32_bf16 v[128:131], a[64:67], a[32:35], v[128:131]
  s_waitcnt lgkmcnt(6)
  ds_read_b64_tr_b16 a[84:85], v11 offset:36864
  ds_read_b64_tr_b16 a[86:87], v11 offset:37120
  v_mfma_f32_16x16x32_bf16 v[128:131], a[68:71], a[36:39], v[128:131]
  s_add_u32 m0, s99, 81792
  ds_read_b128 v[32:35], v36 offset:8896
  v_fmac_f32 v224, v52, v28
  v_mfma_f32_16x16x32_bf16 v[132:135], a[68:71], a[44:47], v[132:135]
  global_load_lds_dwordx4 v[6:7], off offset:128
  v_mfma_f32_16x16x32_bf16 v[132:135], a[64:67], a[40:43], v[132:135]
  v_fmac_f32 v225, v52, v29
  v_fmac_f32 v226, v52, v30
  v_mfma_f32_16x16x32_bf16 v[136:139], a[64:67], a[48:51], v[136:139]
  s_xor_b32 m0, s49, 33792
  v_fmac_f32 v227, v52, v31
  v_fmac_f32 v228, v53, v28
  v_mfma_f32_16x16x32_bf16 v[136:139], a[68:71], a[52:55], v[136:139]
  v_fmac_f32 v229, v53, v29
  v_fmac_f32 v230, v53, v30
  v_mfma_f32_16x16x32_bf16 v[140:143], a[68:71], a[60:63], v[140:143]
  buffer_load_dwordx4 v3, s[8:11], s44 offen lds
  v_mfma_f32_16x16x32_bf16 v[140:143], a[64:67], a[56:59], v[140:143]
  s_waitcnt lgkmcnt(7)
  ds_read_b64_tr_b16 a[88:89], v11 offset:33280
  ds_read_b64_tr_b16 a[90:91], v11 offset:33536
  v_mfma_f32_16x16x32_bf16 v[144:147], a[72:75], a[32:35], v[144:147]
  s_waitcnt lgkmcnt(7)
  ds_read_b64_tr_b16 a[92:93], v11 offset:37376
  ds_read_b64_tr_b16 a[94:95], v11 offset:37632
  v_mfma_f32_16x16x32_bf16 v[144:147], a[76:79], a[36:39], v[144:147]
  v_fmac_f32 v231, v53, v31
  v_fmac_f32 v232, v54, v28
  v_mfma_f32_16x16x32_bf16 v[148:151], a[76:79], a[44:47], v[148:151]
  s_xor_b32 m0, s49, 35840
  v_fmac_f32 v233, v54, v29
  v_fmac_f32 v234, v54, v30
  v_mfma_f32_16x16x32_bf16 v[148:151], a[72:75], a[40:43], v[148:151]
  buffer_load_dwordx4 a[124:127], v59, s[12:15], s23 offen offset:2048 sc1
  v_mfma_f32_16x16x32_bf16 v[152:155], a[72:75], a[48:51], v[152:155]
  buffer_load_dwordx4 v3, s[8:11], s45 offen lds
  v_mfma_f32_16x16x32_bf16 v[152:155], a[76:79], a[52:55], v[152:155]
  v_fmac_f32 v235, v54, v31
  v_fmac_f32 v236, v55, v28
  v_mfma_f32_16x16x32_bf16 v[156:159], a[76:79], a[60:63], v[156:159]
  v_fmac_f32 v237, v55, v29
  v_fmac_f32 v238, v55, v30
  v_mfma_f32_16x16x32_bf16 v[156:159], a[72:75], a[56:59], v[156:159]
  s_waitcnt lgkmcnt(7)
  ds_read_b64_tr_b16 a[64:65], v10 offset:40960
  ds_read_b64_tr_b16 a[66:67], v10 offset:41216
  v_mfma_f32_16x16x32_bf16 v[160:163], a[80:83], a[32:35], v[160:163]
  s_waitcnt lgkmcnt(7)
  ds_read_b64_tr_b16 a[68:69], v10 offset:45056
  ds_read_b64_tr_b16 a[70:71], v10 offset:45312
  v_mfma_f32_16x16x32_bf16 v[160:163], a[84:87], a[36:39], v[160:163]
  s_xor_b32 m0, s49, 37888
  v_fmac_f32 v239, v55, v31
  v_mfma_f32_16x16x32_bf16 v[164:167], a[84:87], a[44:47], v[164:167]
  buffer_load_dwordx4 v3, s[8:11], s46 offen lds
  v_mfma_f32_16x16x32_bf16 v[164:167], a[80:83], a[40:43], v[164:167]
  v_mfma_f32_16x16x32_bf16 v[168:171], a[80:83], a[48:51], v[168:171]
  s_xor_b32 m0, s49, 39936
  v_mfma_f32_16x16x32_bf16 v[168:171], a[84:87], a[52:55], v[168:171]
  v_mfma_f32_16x16x32_bf16 v[172:175], a[84:87], a[60:63], v[172:175]
  buffer_load_dwordx4 v3, s[8:11], s47 offen lds
  v_mfma_f32_16x16x32_bf16 v[172:175], a[80:83], a[56:59], v[172:175]
  s_waitcnt lgkmcnt(6)
  ds_read_b64_tr_b16 a[72:73], v10 offset:41472
  ds_read_b64_tr_b16 a[74:75], v10 offset:41728
  v_mfma_f32_16x16x32_bf16 v[176:179], a[88:91], a[32:35], v[176:179]
  s_waitcnt lgkmcnt(6)
  ds_read_b64_tr_b16 a[76:77], v10 offset:45568
  ds_read_b64_tr_b16 a[78:79], v10 offset:45824
  v_mfma_f32_16x16x32_bf16 v[176:179], a[92:95], a[36:39], v[176:179]
  v_fmac_f32 v240, v52, v32
  v_fmac_f32 v241, v52, v33
  v_mfma_f32_16x16x32_bf16 v[180:183], a[92:95], a[44:47], v[180:183]
  buffer_load_dwordx4 a[128:131], v59, s[12:15], s23 offen offset:3072 sc1
  v_mfma_f32_16x16x32_bf16 v[180:183], a[88:91], a[40:43], v[180:183]
  v_fmac_f32 v242, v52, v34
  v_fmac_f32 v243, v52, v35
  v_mfma_f32_16x16x32_bf16 v[184:187], a[88:91], a[48:51], v[184:187]
  v_fmac_f32 v244, v53, v32
  v_fmac_f32 v245, v53, v33
  v_mfma_f32_16x16x32_bf16 v[184:187], a[92:95], a[52:55], v[184:187]
  v_fmac_f32 v246, v53, v34
  v_fmac_f32 v247, v53, v35
  v_mfma_f32_16x16x32_bf16 v[188:191], a[92:95], a[60:63], v[188:191]
  buffer_load_dwordx4 a[132:135], v60, s[12:15], s23 offen offset:0 sc1
  v_mfma_f32_16x16x32_bf16 v[188:191], a[88:91], a[56:59], v[188:191]
  s_waitcnt lgkmcnt(6)
  ds_read_b64_tr_b16 a[80:81], v11 offset:40960
  ds_read_b64_tr_b16 a[82:83], v11 offset:41216
  v_mfma_f32_16x16x32_bf16 v[192:195], a[64:67], a[32:35], v[192:195]
  s_waitcnt lgkmcnt(6)
  ds_read_b64_tr_b16 a[84:85], v11 offset:45056
  ds_read_b64_tr_b16 a[86:87], v11 offset:45312
  v_mfma_f32_16x16x32_bf16 v[192:195], a[68:71], a[36:39], v[192:195]
  v_fmac_f32 v248, v54, v32
  v_fmac_f32 v249, v54, v33
  v_mfma_f32_16x16x32_bf16 v[196:199], a[68:71], a[44:47], v[196:199]
  s_waitcnt vmcnt(22)
  ds_read_b128 a[0:3], v8 offset:0
  s_add_u32 s23, s83, 327680
  v_mfma_f32_16x16x32_bf16 v[196:199], a[64:67], a[40:43], v[196:199]
  ds_read_b128 a[4:7], v9 offset:0
  v_fmac_f32 v250, v54, v34
  v_mfma_f32_16x16x32_bf16 v[200:203], a[64:67], a[48:51], v[200:203]
  ds_read_b128 a[8:11], v8 offset:2048
  v_fmac_f32 v251, v54, v35
  v_mfma_f32_16x16x32_bf16 v[200:203], a[68:71], a[52:55], v[200:203]
  ds_read_b128 a[12:15], v9 offset:2048
  v_fmac_f32 v252, v55, v32
  v_mfma_f32_16x16x32_bf16 v[204:207], a[68:71], a[60:63], v[204:207]
  buffer_load_dwordx4 a[136:139], v59, s[12:15], s23 offen offset:0 sc1
  v_mfma_f32_16x16x32_bf16 v[204:207], a[64:67], a[56:59], v[204:207]
  s_waitcnt lgkmcnt(10)
  ds_read_b64_tr_b16 a[88:89], v11 offset:41472
  ds_read_b64_tr_b16 a[90:91], v11 offset:41728
  v_mfma_f32_16x16x32_bf16 v[208:211], a[72:75], a[32:35], v[208:211]
  s_waitcnt lgkmcnt(10)
  ds_read_b64_tr_b16 a[92:93], v11 offset:45568
  ds_read_b64_tr_b16 a[94:95], v11 offset:45824
  v_mfma_f32_16x16x32_bf16 v[208:211], a[76:79], a[36:39], v[208:211]
  buffer_load_dwordx4 a[140:143], v59, s[12:15], s23 offen offset:1024 sc1
  v_mfma_f32_16x16x32_bf16 v[212:215], a[76:79], a[44:47], v[212:215]
  ds_read_b128 a[16:19], v8 offset:4096
  v_fmac_f32 v253, v55, v33
  v_mfma_f32_16x16x32_bf16 v[212:215], a[72:75], a[40:43], v[212:215]
  ds_read_b128 a[20:23], v9 offset:4096
  v_fmac_f32 v254, v55, v34
  v_mfma_f32_16x16x32_bf16 v[216:219], a[72:75], a[48:51], v[216:219]
  ds_read_b128 a[24:27], v8 offset:6144
  v_fmac_f32 v255, v55, v35
  v_mfma_f32_16x16x32_bf16 v[216:219], a[76:79], a[52:55], v[216:219]
  s_lshl_b32 s67, s4, 2
  ds_read_b128 a[28:31], v9 offset:6144
  s_add_u32 s67, s67, s3
  v_mfma_f32_16x16x32_bf16 v[220:223], a[76:79], a[60:63], v[220:223]
  s_mul_i32 s67, s67, 311296
  buffer_load_dwordx4 a[144:147], v59, s[12:15], s23 offen offset:2048 sc1
  v_mfma_f32_16x16x32_bf16 v[220:223], a[72:75], a[56:59], v[220:223]
  s_waitcnt lgkmcnt(14)
  s_add_u32 s67, s67, 5242880
  s_mul_i32 s68, s5, 3
  v_mfma_f32_16x16x32_bf16 v[224:227], a[80:83], a[32:35], v[224:227]
  s_waitcnt lgkmcnt(12)
  s_and_b32 s69, s68, 3
  s_mul_i32 s69, s69, 19
  v_mfma_f32_16x16x32_bf16 v[224:227], a[84:87], a[36:39], v[224:227]
  s_waitcnt lgkmcnt(0)
  s_barrier
  ds_read_b64_tr_b16 a[64:65], v12 offset:24576
  v_mfma_f32_16x16x32_bf16 v[228:231], a[84:87], a[44:47], v[228:231]
  s_lshr_b32 s64, s68, 2
  ds_read_b64_tr_b16 a[66:67], v12 offset:24832
  s_add_u32 s69, s69, s64
  v_mfma_f32_16x16x32_bf16 v[228:231], a[80:83], a[40:43], v[228:231]
  s_lshl_b32 s69, s69, 10
  ds_read_b64_tr_b16 a[68:69], v12 offset:28672
  s_add_u32 s64, s67, s69
  v_mfma_f32_16x16x32_bf16 v[232:235], a[80:83], a[48:51], v[232:235]
  s_add_u32 s68, s68, 1
  ds_read_b64_tr_b16 a[70:71], v12 offset:28928
  s_and_b32 s69, s68, 3
  v_mfma_f32_16x16x32_bf16 v[232:235], a[84:87], a[52:55], v[232:235]
  s_mul_i32 s69, s69, 19
  buffer_load_dwordx4 a[148:151], v59, s[12:15], s23 offen offset:3072 sc1
  v_mfma_f32_16x16x32_bf16 v[236:239], a[84:87], a[60:63], v[236:239]
  s_lshr_b32 s65, s68, 2
  buffer_load_dwordx4 a[152:155], v60, s[12:15], s23 offen offset:0 sc1
  v_mfma_f32_16x16x32_bf16 v[236:239], a[80:83], a[56:59], v[236:239]
  s_waitcnt lgkmcnt(4)
  ds_read_b64_tr_b16 a[72:73], v12 offset:25088
  ds_read_b64_tr_b16 a[74:75], v12 offset:25344
  v_mfma_f32_16x16x32_bf16 v[240:243], a[88:91], a[32:35], v[240:243]
  s_waitcnt lgkmcnt(6)
  ds_read_b64_tr_b16 a[76:77], v12 offset:29184
  ds_read_b64_tr_b16 a[78:79], v12 offset:29440
  v_mfma_f32_16x16x32_bf16 v[240:243], a[92:95], a[36:39], v[240:243]
  s_add_u32 s69, s69, s65
  s_lshl_b32 s69, s69, 10
  s_add_u32 s65, s67, s69
  v_mfma_f32_16x16x32_bf16 v[244:247], a[92:95], a[44:47], v[244:247]
  s_add_u32 s23, s83, 491520
  s_add_u32 s68, s68, 1
  s_and_b32 s69, s68, 3
  v_mfma_f32_16x16x32_bf16 v[244:247], a[88:91], a[40:43], v[244:247]
  s_mul_i32 s69, s69, 19
  buffer_load_dwordx4 a[156:159], v59, s[12:15], s23 offen offset:0 sc1
  v_mfma_f32_16x16x32_bf16 v[248:251], a[88:91], a[48:51], v[248:251]
  s_lshr_b32 s66, s68, 2
  s_add_u32 s69, s69, s66
  s_lshl_b32 s69, s69, 10
  v_mfma_f32_16x16x32_bf16 v[248:251], a[92:95], a[52:55], v[248:251]
  s_add_u32 s66, s67, s69
  s_add_u32 s68, s68, 1
  v_mfma_f32_16x16x32_bf16 v[252:255], a[92:95], a[60:63], v[252:255]
  v_mfma_f32_16x16x32_bf16 v[252:255], a[88:91], a[56:59], v[252:255]
  s_waitcnt lgkmcnt(6)
  ds_read_b64_tr_b16 a[80:81], v13 offset:24576
  ds_read_b64_tr_b16 a[82:83], v13 offset:24832
  v_mfma_f32_16x16x32_bf16 v[64:67], a[64:67], a[0:3], v[64:67]
  s_waitcnt lgkmcnt(6)
  ds_read_b64_tr_b16 a[84:85], v13 offset:28672
  ds_read_b64_tr_b16 a[86:87], v13 offset:28928
  v_mfma_f32_16x16x32_bf16 v[64:67], a[68:71], a[4:7], v[64:67]
  buffer_load_dwordx4 a[160:163], v59, s[12:15], s23 offen offset:1024 sc1
  v_mfma_f32_16x16x32_bf16 v[68:71], a[68:71], a[12:15], v[68:71]
  s_waitcnt vmcnt(9)
  ds_read_b128 a[32:35], v8 offset:32768
  v_mfma_f32_16x16x32_bf16 v[68:71], a[64:67], a[8:11], v[68:71]
  ds_read_b128 a[36:39], v9 offset:32768
  v_mfma_f32_16x16x32_bf16 v[72:75], a[64:67], a[16:19], v[72:75]
  ds_read_b128 a[40:43], v8 offset:34816
  v_mfma_f32_16x16x32_bf16 v[72:75], a[68:71], a[20:23], v[72:75]
  ds_read_b128 a[44:47], v9 offset:34816
  v_mfma_f32_16x16x32_bf16 v[76:79], a[68:71], a[28:31], v[76:79]
  buffer_load_dwordx4 a[164:167], v59, s[12:15], s23 offen offset:2048 sc1
  v_mfma_f32_16x16x32_bf16 v[76:79], a[64:67], a[24:27], v[76:79]
  s_waitcnt lgkmcnt(10)
  ds_read_b64_tr_b16 a[88:89], v13 offset:25088
  ds_read_b64_tr_b16 a[90:91], v13 offset:25344
  v_mfma_f32_16x16x32_bf16 v[80:83], a[72:75], a[0:3], v[80:83]
  s_waitcnt lgkmcnt(10)
  ds_read_b64_tr_b16 a[92:93], v13 offset:29184
  ds_read_b64_tr_b16 a[94:95], v13 offset:29440
  v_mfma_f32_16x16x32_bf16 v[80:83], a[76:79], a[4:7], v[80:83]
  buffer_load_dwordx4 a[168:171], v59, s[12:15], s23 offen offset:3072 sc1
  v_mfma_f32_16x16x32_bf16 v[84:87], a[76:79], a[12:15], v[84:87]
  ds_read_b128 a[48:51], v8 offset:36864
  v_mfma_f32_16x16x32_bf16 v[84:87], a[72:75], a[8:11], v[84:87]
  ds_read_b128 a[52:55], v9 offset:36864
  v_mfma_f32_16x16x32_bf16 v[88:91], a[72:75], a[16:19], v[88:91]
  ds_read_b128 a[56:59], v8 offset:38912
  v_mfma_f32_16x16x32_bf16 v[88:91], a[76:79], a[20:23], v[88:91]
  ds_read_b128 a[60:63], v9 offset:38912
  v_mfma_f32_16x16x32_bf16 v[92:95], a[76:79], a[28:31], v[92:95]
  buffer_load_dwordx4 a[172:175], v60, s[12:15], s23 offen offset:0 sc1
  v_mfma_f32_16x16x32_bf16 v[92:95], a[72:75], a[24:27], v[92:95]
  s_waitcnt lgkmcnt(14)
  v_mfma_f32_16x16x32_bf16 v[96:99], a[80:83], a[0:3], v[96:99]
  s_waitcnt lgkmcnt(12)
  v_mfma_f32_16x16x32_bf16 v[96:99], a[84:87], a[4:7], v[96:99]
  s_waitcnt lgkmcnt(0)
  s_barrier
  ds_read_b64_tr_b16 a[64:65], v10 offset:0
  v_mfma_f32_16x16x32_bf16 v[100:103], a[84:87], a[12:15], v[100:103]
  s_add_u32 s23, s83, 655360
  ds_read_b64_tr_b16 a[66:67], v10 offset:256
  v_mfma_f32_16x16x32_bf16 v[100:103], a[80:83], a[8:11], v[100:103]
  ds_read_b64_tr_b16 a[68:69], v10 offset:4096
  v_mfma_f32_16x16x32_bf16 v[104:107], a[80:83], a[16:19], v[104:107]
  ds_read_b64_tr_b16 a[70:71], v10 offset:4352
  v_mfma_f32_16x16x32_bf16 v[104:107], a[84:87], a[20:23], v[104:107]
  buffer_load_dwordx4 a[176:179], v59, s[12:15], s23 offen offset:0 sc1
  v_mfma_f32_16x16x32_bf16 v[108:111], a[84:87], a[28:31], v[108:111]
  v_mfma_f32_16x16x32_bf16 v[108:111], a[80:83], a[24:27], v[108:111]
  s_waitcnt lgkmcnt(4)
  ds_read_b64_tr_b16 a[72:73], v12 offset:32768
  ds_read_b64_tr_b16 a[74:75], v12 offset:33024
  v_mfma_f32_16x16x32_bf16 v[112:115], a[88:91], a[0:3], v[112:115]
  s_waitcnt lgkmcnt(6)
  ds_read_b64_tr_b16 a[76:77], v12 offset:36864
  ds_read_b64_tr_b16 a[78:79], v12 offset:37120
  v_mfma_f32_16x16x32_bf16 v[112:115], a[92:95], a[4:7], v[112:115]
  buffer_load_dwordx4 a[180:183], v59, s[12:15], s23 offen offset:1024 sc1
  v_mfma_f32_16x16x32_bf16 v[116:119], a[92:95], a[12:15], v[116:119]
  v_mfma_f32_16x16x32_bf16 v[116:119], a[88:91], a[8:11], v[116:119]
  v_mfma_f32_16x16x32_bf16 v[120:123], a[88:91], a[16:19], v[120:123]
  v_mfma_f32_16x16x32_bf16 v[120:123], a[92:95], a[20:23], v[120:123]
  buffer_load_dwordx4 a[184:187], v59, s[12:15], s23 offen offset:2048 sc1
  v_mfma_f32_16x16x32_bf16 v[124:127], a[92:95], a[28:31], v[124:127]
  v_mfma_f32_16x16x32_bf16 v[124:127], a[88:91], a[24:27], v[124:127]
  s_waitcnt lgkmcnt(6)
  ds_read_b64_tr_b16 a[80:81], v10 offset:512
  ds_read_b64_tr_b16 a[82:83], v10 offset:768
  v_mfma_f32_16x16x32_bf16 v[64:67], a[64:67], a[32:35], v[64:67]
  s_waitcnt lgkmcnt(6)
  ds_read_b64_tr_b16 a[84:85], v10 offset:4608
  ds_read_b64_tr_b16 a[86:87], v10 offset:4864
  v_mfma_f32_16x16x32_bf16 v[64:67], a[68:71], a[36:39], v[64:67]
  buffer_load_dwordx4 a[188:191], v59, s[12:15], s23 offen offset:3072 sc1
  v_mfma_f32_16x16x32_bf16 v[68:71], a[68:71], a[44:47], v[68:71]
  v_mfma_f32_16x16x32_bf16 v[68:71], a[64:67], a[40:43], v[68:71]
  v_mfma_f32_16x16x32_bf16 v[72:75], a[64:67], a[48:51], v[72:75]
  v_mfma_f32_16x16x32_bf16 v[72:75], a[68:71], a[52:55], v[72:75]
  v_mfma_f32_16x16x32_bf16 v[76:79], a[68:71], a[60:63], v[76:79]
  buffer_load_dwordx4 a[192:195], v60, s[12:15], s23 offen offset:0 sc1
  v_mfma_f32_16x16x32_bf16 v[76:79], a[64:67], a[56:59], v[76:79]
  s_waitcnt lgkmcnt(6)
  ds_read_b64_tr_b16 a[88:89], v12 offset:33280
  ds_read_b64_tr_b16 a[90:91], v12 offset:33536
  v_mfma_f32_16x16x32_bf16 v[128:131], a[72:75], a[0:3], v[128:131]
  s_waitcnt lgkmcnt(6)
  ds_read_b64_tr_b16 a[92:93], v12 offset:37376
  ds_read_b64_tr_b16 a[94:95], v12 offset:37632
  v_mfma_f32_16x16x32_bf16 v[128:131], a[76:79], a[4:7], v[128:131]
  v_mfma_f32_16x16x32_bf16 v[132:135], a[76:79], a[12:15], v[132:135]
  s_add_u32 s23, s83, 819200
  v_mfma_f32_16x16x32_bf16 v[132:135], a[72:75], a[8:11], v[132:135]
  buffer_load_dwordx4 a[196:199], v59, s[12:15], s23 offen offset:0 sc1
  v_mfma_f32_16x16x32_bf16 v[136:139], a[72:75], a[16:19], v[136:139]
  v_mfma_f32_16x16x32_bf16 v[136:139], a[76:79], a[20:23], v[136:139]
  s_mov_b32 s62, 24117248
  buffer_load_dword v39, v38, s[12:15], s62 offen sc1
  v_mfma_f32_16x16x32_bf16 v[140:143], a[76:79], a[28:31], v[140:143]
  v_mfma_f32_16x16x32_bf16 v[140:143], a[72:75], a[24:27], v[140:143]
  s_waitcnt lgkmcnt(6)
  ds_read_b64_tr_b16 a[64:65], v11 offset:0
  ds_read_b64_tr_b16 a[66:67], v11 offset:256
  v_mfma_f32_16x16x32_bf16 v[80:83], a[80:83], a[32:35], v[80:83]
  s_waitcnt lgkmcnt(6)
  ds_read_b64_tr_b16 a[68:69], v11 offset:4096
  ds_read_b64_tr_b16 a[70:71], v11 offset:4352
  v_mfma_f32_16x16x32_bf16 v[80:83], a[84:87], a[36:39], v[80:83]
  buffer_load_dwordx4 a[200:203], v59, s[12:15], s23 offen offset:1024 sc1
  v_mfma_f32_16x16x32_bf16 v[84:87], a[84:87], a[44:47], v[84:87]
  v_mfma_f32_16x16x32_bf16 v[84:87], a[80:83], a[40:43], v[84:87]
  v_mfma_f32_16x16x32_bf16 v[88:91], a[80:83], a[48:51], v[88:91]
  v_mfma_f32_16x16x32_bf16 v[88:91], a[84:87], a[52:55], v[88:91]
  buffer_load_dwordx4 a[204:207], v59, s[12:15], s23 offen offset:2048 sc1
  v_mfma_f32_16x16x32_bf16 v[92:95], a[84:87], a[60:63], v[92:95]
  v_mfma_f32_16x16x32_bf16 v[92:95], a[80:83], a[56:59], v[92:95]
  s_waitcnt lgkmcnt(6)
  ds_read_b64_tr_b16 a[72:73], v13 offset:32768
  ds_read_b64_tr_b16 a[74:75], v13 offset:33024
  v_mfma_f32_16x16x32_bf16 v[144:147], a[88:91], a[0:3], v[144:147]
  s_waitcnt lgkmcnt(6)
  ds_read_b64_tr_b16 a[76:77], v13 offset:36864
  ds_read_b64_tr_b16 a[78:79], v13 offset:37120
  v_mfma_f32_16x16x32_bf16 v[144:147], a[92:95], a[4:7], v[144:147]
  buffer_load_dwordx4 a[208:211], v59, s[12:15], s23 offen offset:3072 sc1
  v_mfma_f32_16x16x32_bf16 v[148:151], a[92:95], a[12:15], v[148:151]
  v_mul_f32 v40, v20, v64
  v_mul_f32 v41, v20, v65
  v_mfma_f32_16x16x32_bf16 v[148:151], a[88:91], a[8:11], v[148:151]
  v_mul_f32 v42, v20, v66
  v_mul_f32 v43, v20, v67
  v_mfma_f32_16x16x32_bf16 v[152:155], a[88:91], a[16:19], v[152:155]
  v_exp_f32 v40, v40
  v_mfma_f32_16x16x32_bf16 v[152:155], a[92:95], a[20:23], v[152:155]
  v_exp_f32 v41, v41
  v_mfma_f32_16x16x32_bf16 v[156:159], a[92:95], a[28:31], v[156:159]
  buffer_load_dwordx4 a[212:215], v60, s[12:15], s23 offen offset:0 sc1
  v_mfma_f32_16x16x32_bf16 v[156:159], a[88:91], a[24:27], v[156:159]
  s_waitcnt lgkmcnt(6)
  ds_read_b64_tr_b16 a[80:81], v11 offset:512
  ds_read_b64_tr_b16 a[82:83], v11 offset:768
  v_mfma_f32_16x16x32_bf16 v[96:99], a[64:67], a[32:35], v[96:99]
  s_waitcnt lgkmcnt(6)
  ds_read_b64_tr_b16 a[84:85], v11 offset:4608
L_hop_ffn3:
  s_cbranch_execz L_retffn1
  ds_read_b64_tr_b16 a[86:87], v11 offset:4864
  v_mfma_f32_16x16x32_bf16 v[96:99], a[68:71], a[36:39], v[96:99]
  v_exp_f32 v42, v42
  v_mfma_f32_16x16x32_bf16 v[100:103], a[68:71], a[44:47], v[100:103]
  s_add_u32 s23, s83, 983040
  v_exp_f32 v43, v43
  v_mfma_f32_16x16x32_bf16 v[100:103], a[64:67], a[40:43], v[100:103]
  buffer_load_dwordx4 a[216:219], v59, s[12:15], s23 offen offset:0 sc1
  v_mfma_f32_16x16x32_bf16 v[104:107], a[64:67], a[48:51], v[104:107]
  v_fma_f32 v40, v40, v21, v21
  v_fma_f32 v41, v41, v21, v21
  v_mfma_f32_16x16x32_bf16 v[104:107], a[68:71], a[52:55], v[104:107]
  v_fma_f32 v42, v42, v21, v21
  v_fma_f32 v43, v43, v21, v21
  v_mfma_f32_16x16x32_bf16 v[108:111], a[68:71], a[60:63], v[108:111]
  v_rcp_f32 v40, v40
  v_mfma_f32_16x16x32_bf16 v[108:111], a[64:67], a[56:59], v[108:111]
  s_waitcnt lgkmcnt(6)
  ds_read_b64_tr_b16 a[88:89], v13 offset:33280
  ds_read_b64_tr_b16 a[90:91], v13 offset:33536
  v_mfma_f32_16x16x32_bf16 v[160:163], a[72:75], a[0:3], v[160:163]
  s_waitcnt lgkmcnt(6)
  ds_read_b64_tr_b16 a[92:93], v13 offset:37376
  ds_read_b64_tr_b16 a[94:95], v13 offset:37632
  v_mfma_f32_16x16x32_bf16 v[160:163], a[76:79], a[4:7], v[160:163]
  buffer_load_dwordx4 a[220:223], v59, s[12:15], s23 offen offset:1024 sc1
  v_mfma_f32_16x16x32_bf16 v[164:167], a[76:79], a[12:15], v[164:167]
  v_rcp_f32 v41, v41
  v_mfma_f32_16x16x32_bf16 v[164:167], a[72:75], a[8:11], v[164:167]
  v_rcp_f32 v42, v42
  v_mfma_f32_16x16x32_bf16 v[168:171], a[72:75], a[16:19], v[168:171]
  v_rcp_f32 v43, v43
  v_mfma_f32_16x16x32_bf16 v[168:171], a[76:79], a[20:23], v[168:171]
  buffer_load_dwordx4 a[224:227], v59, s[12:15], s23 offen offset:2048 sc1
  v_mfma_f32_16x16x32_bf16 v[172:175], a[76:79], a[28:31], v[172:175]
  v_mul_f32 v64, v64, v80
  v_mul_f32 v65, v65, v81
  v_mfma_f32_16x16x32_bf16 v[172:175], a[72:75], a[24:27], v[172:175]
  s_waitcnt lgkmcnt(6)
  ds_read_b64_tr_b16 a[64:65], v10 offset:8192
  ds_read_b64_tr_b16 a[66:67], v10 offset:8448
  v_mfma_f32_16x16x32_bf16 v[112:115], a[80:83], a[32:35], v[112:115]
  s_waitcnt lgkmcnt(6)
  ds_read_b64_tr_b16 a[68:69], v10 offset:12288
  ds_read_b64_tr_b16 a[70:71], v10 offset:12544
  v_mfma_f32_16x16x32_bf16 v[112:115], a[84:87], a[36:39], v[112:115]
  buffer_load_dwordx4 a[228:231], v59, s[12:15], s23 offen offset:3072 sc1
  v_mfma_f32_16x16x32_bf16 v[116:119], a[84:87], a[44:47], v[116:119]
  v_mul_f32 v66, v66, v82
  v_mul_f32 v67, v67, v83
  v_mfma_f32_16x16x32_bf16 v[116:119], a[80:83], a[40:43], v[116:119]
  v_mul_f32 v64, v64, v40
  v_mul_f32 v65, v65, v41
  v_mfma_f32_16x16x32_bf16 v[120:123], a[80:83], a[48:51], v[120:123]
  v_mul_f32 v66, v66, v42
  v_mul_f32 v67, v67, v43
  v_mfma_f32_16x16x32_bf16 v[120:123], a[84:87], a[52:55], v[120:123]
  v_cvt_pk_bf16_f32 v80, v64, v65
  v_cvt_pk_bf16_f32 v81, v66, v67
  v_mfma_f32_16x16x32_bf16 v[124:127], a[84:87], a[60:63], v[124:127]
  buffer_load_dwordx4 a[232:235], v60, s[12:15], s23 offen offset:0 sc1
  v_mfma_f32_16x16x32_bf16 v[124:127], a[80:83], a[56:59], v[124:127]
  s_waitcnt lgkmcnt(6)
  ds_read_b64_tr_b16 a[72:73], v12 offset:40960
  ds_read_b64_tr_b16 a[74:75], v12 offset:41216
  v_mfma_f32_16x16x32_bf16 v[176:179], a[88:91], a[0:3], v[176:179]
  s_waitcnt lgkmcnt(6)
  ds_read_b64_tr_b16 a[76:77], v12 offset:45056
  ds_read_b64_tr_b16 a[78:79], v12 offset:45312
  v_mfma_f32_16x16x32_bf16 v[176:179], a[92:95], a[4:7], v[176:179]
  v_mul_f32 v44, v22, v68
  v_mul_f32 v45, v22, v69
  v_mfma_f32_16x16x32_bf16 v[180:183], a[92:95], a[12:15], v[180:183]
  s_add_u32 s23, s83, 1146880
  v_mul_f32 v46, v22, v70
  v_mul_f32 v47, v22, v71
  v_mfma_f32_16x16x32_bf16 v[180:183], a[88:91], a[8:11], v[180:183]
  buffer_load_dwordx4 a[236:239], v59, s[12:15], s23 offen offset:0 sc1
  v_mfma_f32_16x16x32_bf16 v[184:187], a[88:91], a[16:19], v[184:187]
  v_exp_f32 v44, v44
  v_mfma_f32_16x16x32_bf16 v[184:187], a[92:95], a[20:23], v[184:187]
  v_exp_f32 v45, v45
  v_mfma_f32_16x16x32_bf16 v[188:191], a[92:95], a[28:31], v[188:191]
  v_exp_f32 v46, v46
  v_mfma_f32_16x16x32_bf16 v[188:191], a[88:91], a[24:27], v[188:191]
  s_waitcnt lgkmcnt(6)
  ds_read_b64_tr_b16 a[80:81], v10 offset:8704
  ds_read_b64_tr_b16 a[82:83], v10 offset:8960
  v_mfma_f32_16x16x32_bf16 v[128:131], a[64:67], a[32:35], v[128:131]
  s_waitcnt lgkmcnt(6)
  ds_read_b64_tr_b16 a[84:85], v10 offset:12800
  ds_read_b64_tr_b16 a[86:87], v10 offset:13056
  v_mfma_f32_16x16x32_bf16 v[128:131], a[68:71], a[36:39], v[128:131]
  buffer_load_dwordx4 a[240:243], v59, s[12:15], s23 offen offset:1024 sc1
  v_mfma_f32_16x16x32_bf16 v[132:135], a[68:71], a[44:47], v[132:135]
  v_exp_f32 v47, v47
  v_mfma_f32_16x16x32_bf16 v[132:135], a[64:67], a[40:43], v[132:135]
  v_fma_f32 v44, v44, v23, v23
  v_fma_f32 v45, v45, v23, v23
  v_mfma_f32_16x16x32_bf16 v[136:139], a[64:67], a[48:51], v[136:139]
  buffer_load_dwordx4 a[244:247], v59, s[12:15], s23 offen offset:2048 sc1
  v_mfma_f32_16x16x32_bf16 v[136:139], a[68:71], a[52:55], v[136:139]
  v_fma_f32 v46, v46, v23, v23
  v_fma_f32 v47, v47, v23, v23
  v_mfma_f32_16x16x32_bf16 v[140:143], a[68:71], a[60:63], v[140:143]
  v_rcp_f32 v44, v44
  v_mfma_f32_16x16x32_bf16 v[140:143], a[64:67], a[56:59], v[140:143]
  s_waitcnt lgkmcnt(6)
  ds_read_b64_tr_b16 a[88:89], v12 offset:41472
  ds_read_b64_tr_b16 a[90:91], v12 offset:41728
  v_mfma_f32_16x16x32_bf16 v[192:195], a[72:75], a[0:3], v[192:195]
  s_waitcnt lgkmcnt(6)
  ds_read_b64_tr_b16 a[92:93], v12 offset:45568
  ds_read_b64_tr_b16 a[94:95], v12 offset:45824
  v_mfma_f32_16x16x32_bf16 v[192:195], a[76:79], a[4:7], v[192:195]
  buffer_load_dwordx4 a[248:251], v59, s[12:15], s23 offen offset:3072 sc1
  v_mfma_f32_16x16x32_bf16 v[196:199], a[76:79], a[12:15], v[196:199]
  v_rcp_f32 v45, v45
  v_mfma_f32_16x16x32_bf16 v[196:199], a[72:75], a[8:11], v[196:199]
  v_rcp_f32 v46, v46
  v_mfma_f32_16x16x32_bf16 v[200:203], a[72:75], a[16:19], v[200:203]
  v_rcp_f32 v47, v47
  v_mfma_f32_16x16x32_bf16 v[200:203], a[76:79], a[20:23], v[200:203]
  s_waitcnt vmcnt(13)
  v_cmp_ne_u32 vcc, s61, v39
  v_mul_f32 v68, v68, v84
  v_mfma_f32_16x16x32_bf16 v[204:207], a[76:79], a[28:31], v[204:207]
  buffer_load_dwordx4 a[252:255], v60, s[12:15], s23 offen offset:0 sc1
  v_mfma_f32_16x16x32_bf16 v[204:207], a[72:75], a[24:27], v[204:207]
  s_waitcnt lgkmcnt(6)
  ds_read_b64_tr_b16 a[64:65], v11 offset:8192
  ds_read_b64_tr_b16 a[66:67], v11 offset:8448
  v_mfma_f32_16x16x32_bf16 v[144:147], a[80:83], a[32:35], v[144:147]
  s_waitcnt lgkmcnt(6)
  ds_read_b64_tr_b16 a[68:69], v11 offset:12288
  ds_read_b64_tr_b16 a[70:71], v11 offset:12544
  v_mfma_f32_16x16x32_bf16 v[144:147], a[84:87], a[36:39], v[144:147]
  s_cbranch_vccnz L_slow_12
L_back_13:
  v_mul_f32 v69, v69, v85
  v_mul_f32 v70, v70, v86
  v_mfma_f32_16x16x32_bf16 v[148:151], a[84:87], a[44:47], v[148:151]
  s_add_u32 s23, s83, 1310720
  s_add_u32 m0, s48, 0
  v_mul_f32 v71, v71, v87
  v_mfma_f32_16x16x32_bf16 v[148:151], a[80:83], a[40:43], v[148:151]
  buffer_load_dwordx4 v59, s[12:15], s23 offen offset:0 sc1 lds
  v_mfma_f32_16x16x32_bf16 v[152:155], a[80:83], a[48:51], v[152:155]
  v_mul_f32 v68, v68, v44
  v_mul_f32 v69, v69, v45
  v_mfma_f32_16x16x32_bf16 v[152:155], a[84:87], a[52:55], v[152:155]
  v_mul_f32 v70, v70, v46
  v_mul_f32 v71, v71, v47
  v_mfma_f32_16x16x32_bf16 v[156:159], a[84:87], a[60:63], v[156:159]
  v_cvt_pk_bf16_f32 v84, v68, v69
  v_cvt_pk_bf16_f32 v85, v70, v71
  v_mfma_f32_16x16x32_bf16 v[156:159], a[80:83], a[56:59], v[156:159]
  s_waitcnt lgkmcnt(6)
  ds_read_b64_tr_b16 a[72:73], v13 offset:40960
  ds_read_b64_tr_b16 a[74:75], v13 offset:41216
  v_mfma_f32_16x16x32_bf16 v[208:211], a[88:91], a[0:3], v[208:211]
  s_waitcnt lgkmcnt(6)
  ds_read_b64_tr_b16 a[76:77], v13 offset:45056
  ds_read_b64_tr_b16 a[78:79], v13 offset:45312
  v_mfma_f32_16x16x32_bf16 v[208:211], a[92:95], a[4:7], v[208:211]
  s_add_u32 m0, s48, 0
  v_mul_f32 v40, v24, v72
  v_mul_f32 v41, v24, v73
  v_mfma_f32_16x16x32_bf16 v[212:215], a[92:95], a[12:15], v[212:215]
  buffer_load_dwordx4 v59, s[12:15], s23 offen offset:1024 sc1 lds
  v_mfma_f32_16x16x32_bf16 v[212:215], a[88:91], a[8:11], v[212:215]
  s_add_u32 m0, s48, 0
  v_mul_f32 v42, v24, v74
  v_mul_f32 v43, v24, v75
  v_mfma_f32_16x16x32_bf16 v[216:219], a[88:91], a[16:19], v[216:219]
  buffer_load_dwordx4 v59, s[12:15], s23 offen offset:2048 sc1 lds
  v_mfma_f32_16x16x32_bf16 v[216:219], a[92:95], a[20:23], v[216:219]
  v_exp_f32 v40, v40
  v_mfma_f32_16x16x32_bf16 v[220:223], a[92:95], a[28:31], v[220:223]
  v_exp_f32 v41, v41
  v_mfma_f32_16x16x32_bf16 v[220:223], a[88:91], a[24:27], v[220:223]
  s_waitcnt lgkmcnt(6)
  ds_read_b64_tr_b16 a[80:81], v11 offset:8704
  ds_read_b64_tr_b16 a[82:83], v11 offset:8960
  v_mfma_f32_16x16x32_bf16 v[160:163], a[64:67], a[32:35], v[160:163]
  s_waitcnt lgkmcnt(6)
  ds_read_b64_tr_b16 a[84:85], v11 offset:12800
  ds_read_b64_tr_b16 a[86:87], v11 offset:13056
  v_mfma_f32_16x16x32_bf16 v[160:163], a[68:71], a[36:39], v[160:163]
  s_add_u32 m0, s48, 0
  v_exp_f32 v42, v42
  v_mfma_f32_16x16x32_bf16 v[164:167], a[68:71], a[44:47], v[164:167]
  buffer_load_dwordx4 v59, s[12:15], s23 offen offset:3072 sc1 lds
  v_mfma_f32_16x16x32_bf16 v[164:167], a[64:67], a[40:43], v[164:167]
  v_exp_f32 v43, v43
  v_mfma_f32_16x16x32_bf16 v[168:171], a[64:67], a[48:51], v[168:171]
  v_fma_f32 v40, v40, v25, v25
  v_fma_f32 v41, v41, v25, v25
  v_mfma_f32_16x16x32_bf16 v[168:171], a[68:71], a[52:55], v[168:171]
  s_add_u32 m0, s48, 4096
  v_fma_f32 v42, v42, v25, v25
  v_fma_f32 v43, v43, v25, v25
  v_mfma_f32_16x16x32_bf16 v[172:175], a[68:71], a[60:63], v[172:175]
  buffer_load_dwordx4 v60, s[12:15], s23 offen offset:0 sc1 lds
  v_mfma_f32_16x16x32_bf16 v[172:175], a[64:67], a[56:59], v[172:175]
  s_waitcnt lgkmcnt(6)
  ds_read_b64_tr_b16 a[88:89], v13 offset:41472
  ds_read_b64_tr_b16 a[90:91], v13 offset:41728
  v_mfma_f32_16x16x32_bf16 v[224:227], a[72:75], a[0:3], v[224:227]
  s_waitcnt lgkmcnt(6)
  ds_read_b64_tr_b16 a[92:93], v13 offset:45568
  ds_read_b64_tr_b16 a[94:95], v13 offset:45824
  v_mfma_f32_16x16x32_bf16 v[224:227], a[76:79], a[4:7], v[224:227]
  v_rcp_f32 v40, v40
  v_mfma_f32_16x16x32_bf16 v[228:231], a[76:79], a[12:15], v[228:231]
  s_add_u32 s23, s83, 1474560
  s_add_u32 m0, s48, 5120
  v_mfma_f32_16x16x32_bf16 v[228:231], a[72:75], a[8:11], v[228:231]
  buffer_load_dwordx4 v59, s[12:15], s23 offen offset:0 sc1 lds
  v_mfma_f32_16x16x32_bf16 v[232:235], a[72:75], a[16:19], v[232:235]
  v_rcp_f32 v41, v41
  v_mfma_f32_16x16x32_bf16 v[232:235], a[76:79], a[20:23], v[232:235]
  v_rcp_f32 v42, v42
  v_mfma_f32_16x16x32_bf16 v[236:239], a[76:79], a[28:31], v[236:239]
  v_rcp_f32 v43, v43
  v_mfma_f32_16x16x32_bf16 v[236:239], a[72:75], a[24:27], v[236:239]
  s_waitcnt lgkmcnt(6)
  ds_read_b64_tr_b16 a[64:65], v10 offset:16384
  ds_read_b64_tr_b16 a[66:67], v10 offset:16640
  v_mfma_f32_16x16x32_bf16 v[176:179], a[80:83], a[32:35], v[176:179]
  s_waitcnt lgkmcnt(6)
  ds_read_b64_tr_b16 a[68:69], v10 offset:20480
  ds_read_b64_tr_b16 a[70:71], v10 offset:20736
  v_mfma_f32_16x16x32_bf16 v[176:179], a[84:87], a[36:39], v[176:179]
  s_add_u32 m0, s48, 5120
  v_mul_f32 v72, v72, v88
  v_mul_f32 v73, v73, v89
  v_mfma_f32_16x16x32_bf16 v[180:183], a[84:87], a[44:47], v[180:183]
  buffer_load_dwordx4 v59, s[12:15], s23 offen offset:1024 sc1 lds
  v_mfma_f32_16x16x32_bf16 v[180:183], a[80:83], a[40:43], v[180:183]
  s_add_u32 m0, s48, 5120
  s_mov_b32 s62, 26214400
  buffer_load_dword v39, v38, s[12:15], s62 offen sc1
  v_mfma_f32_16x16x32_bf16 v[184:187], a[80:83], a[48:51], v[184:187]
  buffer_load_dwordx4 v59, s[12:15], s23 offen offset:2048 sc1 lds
  v_mfma_f32_16x16x32_bf16 v[184:187], a[84:87], a[52:55], v[184:187]
  v_mul_f32 v74, v74, v90
  v_mul_f32 v75, v75, v91
  v_mfma_f32_16x16x32_bf16 v[188:191], a[84:87], a[60:63], v[188:191]
  v_mul_f32 v72, v72, v40
  v_mul_f32 v73, v73, v41
  v_mfma_f32_16x16x32_bf16 v[188:191], a[80:83], a[56:59], v[188:191]
  s_waitcnt lgkmcnt(6)
  ds_read_b64_tr_b16 a[72:73], v10 offset:16896
  ds_read_b64_tr_b16 a[74:75], v10 offset:17152
  v_mfma_f32_16x16x32_bf16 v[240:243], a[88:91], a[0:3], v[240:243]
  s_waitcnt lgkmcnt(6)
  ds_read_b64_tr_b16 a[76:77], v10 offset:20992
  ds_read_b64_tr_b16 a[78:79], v10 offset:21248
  v_mfma_f32_16x16x32_bf16 v[240:243], a[92:95], a[4:7], v[240:243]
  s_add_u32 m0, s48, 29696
  v_mul_f32 v74, v74, v42
  v_mul_f32 v75, v75, v43
  v_mfma_f32_16x16x32_bf16 v[244:247], a[92:95], a[12:15], v[244:247]
  buffer_load_dwordx4 v59, s[12:15], s23 offen offset:3072 sc1 lds
  v_mfma_f32_16x16x32_bf16 v[244:247], a[88:91], a[8:11], v[244:247]
  v_cvt_pk_bf16_f32 v88, v72, v73
  v_cvt_pk_bf16_f32 v89, v74, v75
  v_mfma_f32_16x16x32_bf16 v[248:251], a[88:91], a[16:19], v[248:251]
  v_mul_f32 v44, v26, v76
  v_mul_f32 v45, v26, v77
  v_mfma_f32_16x16x32_bf16 v[248:251], a[92:95], a[20:23], v[248:251]
  s_add_u32 m0, s48, 33792
  v_mul_f32 v46, v26, v78
  v_mul_f32 v47, v26, v79
  v_mfma_f32_16x16x32_bf16 v[252:255], a[92:95], a[28:31], v[252:255]
  buffer_load_dwordx4 v60, s[12:15], s23 offen offset:0 sc1 lds
  v_mfma_f32_16x16x32_bf16 v[252:255], a[88:91], a[24:27], v[252:255]
  s_waitcnt lgkmcnt(6)
  ds_read_b64_tr_b16 a[80:81], v11 offset:16384
  ds_read_b64_tr_b16 a[82:83], v11 offset:16640
  v_mfma_f32_16x16x32_bf16 v[192:195], a[64:67], a[32:35], v[192:195]
  s_waitcnt lgkmcnt(6)
  ds_read_b64_tr_b16 a[84:85], v11 offset:20480
  ds_read_b64_tr_b16 a[86:87], v11 offset:20736
  v_mfma_f32_16x16x32_bf16 v[192:195], a[68:71], a[36:39], v[192:195]
  v_exp_f32 v44, v44
  v_mfma_f32_16x16x32_bf16 v[196:199], a[68:71], a[44:47], v[196:199]
  s_add_u32 s23, s83, 1638400
  s_add_u32 m0, s48, 34816
  v_mfma_f32_16x16x32_bf16 v[196:199], a[64:67], a[40:43], v[196:199]
  buffer_load_dwordx4 v59, s[12:15], s23 offen offset:0 sc1 lds
  v_mfma_f32_16x16x32_bf16 v[200:203], a[64:67], a[48:51], v[200:203]
  v_exp_f32 v45, v45
  v_mfma_f32_16x16x32_bf16 v[200:203], a[68:71], a[52:55], v[200:203]
  v_exp_f32 v46, v46
  v_mfma_f32_16x16x32_bf16 v[204:207], a[68:71], a[60:63], v[204:207]
  v_exp_f32 v47, v47
  v_mfma_f32_16x16x32_bf16 v[204:207], a[64:67], a[56:59], v[204:207]
  s_waitcnt lgkmcnt(6)
  ds_read_b64_tr_b16 a[88:89], v11 offset:16896
  ds_read_b64_tr_b16 a[90:91], v11 offset:17152
  v_mfma_f32_16x16x32_bf16 v[208:211], a[72:75], a[32:35], v[208:211]
  s_waitcnt lgkmcnt(6)
  ds_read_b64_tr_b16 a[92:93], v11 offset:20992
  ds_read_b64_tr_b16 a[94:95], v11 offset:21248
  v_mfma_f32_16x16x32_bf16 v[208:211], a[76:79], a[36:39], v[208:211]
  s_add_u32 m0, s48, 34816
  v_fma_f32 v44, v44, v27, v27
  v_fma_f32 v45, v45, v27, v27
  v_mfma_f32_16x16x32_bf16 v[212:215], a[76:79], a[44:47], v[212:215]
  buffer_load_dwordx4 v59, s[12:15], s23 offen offset:1024 sc1 lds
  v_mfma_f32_16x16x32_bf16 v[212:215], a[72:75], a[40:43], v[212:215]
  s_add_u32 m0, s48, 34816
  v_fma_f32 v46, v46, v27, v27
  v_fma_f32 v47, v47, v27, v27
  v_mfma_f32_16x16x32_bf16 v[216:219], a[72:75], a[48:51], v[216:219]
  buffer_load_dwordx4 v59, s[12:15], s23 offen offset:2048 sc1 lds
  v_mfma_f32_16x16x32_bf16 v[216:219], a[76:79], a[52:55], v[216:219]
  v_rcp_f32 v44, v44
  v_mfma_f32_16x16x32_bf16 v[220:223], a[76:79], a[60:63], v[220:223]
  v_rcp_f32 v45, v45
  v_mfma_f32_16x16x32_bf16 v[220:223], a[72:75], a[56:59], v[220:223]
  s_waitcnt lgkmcnt(6)
  v_rcp_f32 v46, v46
  v_mfma_f32_16x16x32_bf16 v[224:227], a[80:83], a[32:35], v[224:227]
  s_waitcnt lgkmcnt(4)
  s_add_u32 m0, s48, 34816
  v_mfma_f32_16x16x32_bf16 v[224:227], a[84:87], a[36:39], v[224:227]
  buffer_load_dwordx4 v59, s[12:15], s23 offen offset:3072 sc1 lds
  v_mfma_f32_16x16x32_bf16 v[228:231], a[84:87], a[44:47], v[228:231]
  v_rcp_f32 v47, v47
  v_mfma_f32_16x16x32_bf16 v[228:231], a[80:83], a[40:43], v[228:231]
  v_mul_f32 v76, v76, v92
  v_mul_f32 v77, v77, v93
  v_mfma_f32_16x16x32_bf16 v[232:235], a[80:83], a[48:51], v[232:235]
  v_mul_f32 v78, v78, v94
  v_mul_f32 v79, v79, v95
  v_mfma_f32_16x16x32_bf16 v[232:235], a[84:87], a[52:55], v[232:235]
  s_add_u32 m0, s48, 38912
  v_mul_f32 v76, v76, v44
  v_mul_f32 v77, v77, v45
  v_mfma_f32_16x16x32_bf16 v[236:239], a[84:87], a[60:63], v[236:239]
  buffer_load_dwordx4 v60, s[12:15], s23 offen offset:0 sc1 lds
  v_mfma_f32_16x16x32_bf16 v[236:239], a[80:83], a[56:59], v[236:239]
  s_waitcnt lgkmcnt(2)
  v_mul_f32 v78, v78, v46
  v_mul_f32 v79, v79, v47
  v_mfma_f32_16x16x32_bf16 v[240:243], a[88:91], a[32:35], v[240:243]
  s_waitcnt lgkmcnt(0)
  v_cvt_pk_bf16_f32 v92, v76, v77
  v_cvt_pk_bf16_f32 v93, v78, v79
  v_mfma_f32_16x16x32_bf16 v[240:243], a[92:95], a[36:39], v[240:243]
  v_mul_f32 v40, v20, v96
  v_mul_f32 v41, v20, v97
  v_mfma_f32_16x16x32_bf16 v[244:247], a[92:95], a[44:47], v[244:247]
  s_waitcnt vmcnt(8)
  v_cmp_ne_u32 vcc, s61, v39
  v_mul_f32 v42, v20, v98
  v_mfma_f32_16x16x32_bf16 v[244:247], a[88:91], a[40:43], v[244:247]
  v_mul_f32 v43, v20, v99
  v_mfma_f32_16x16x32_bf16 v[248:251], a[88:91], a[48:51], v[248:251]
  s_cbranch_vccnz L_slow_14
L_back_15:
  v_exp_f32 v40, v40
  v_mfma_f32_16x16x32_bf16 v[248:251], a[92:95], a[52:55], v[248:251]
  v_exp_f32 v41, v41
  v_mfma_f32_16x16x32_bf16 v[252:255], a[92:95], a[60:63], v[252:255]
  v_exp_f32 v42, v42
  v_mfma_f32_16x16x32_bf16 v[252:255], a[88:91], a[56:59], v[252:255]
  v_exp_f32 v43, v43
  s_nop 7
  v_fma_f32 v40, v40, v21, v21
  v_fma_f32 v41, v41, v21, v21
  v_fma_f32 v42, v42, v21, v21
  v_fma_f32 v43, v43, v21, v21
  v_rcp_f32 v40, v40
  v_rcp_f32 v41, v41
  v_rcp_f32 v42, v42
  v_rcp_f32 v43, v43
  v_mul_f32 v96, v96, v112
  v_mul_f32 v97, v97, v113
  v_mul_f32 v98, v98, v114
  v_mul_f32 v99, v99, v115
  v_mul_f32 v96, v96, v40
  v_mul_f32 v97, v97, v41
  v_mul_f32 v98, v98, v42
  v_mul_f32 v99, v99, v43
  v_cvt_pk_bf16_f32 v82, v96, v97
  v_cvt_pk_bf16_f32 v83, v98, v99
  s_nop 0
  buffer_store_dwordx4 v[80:83], v59, s[12:15], s64 offen sc1
  s_add_u32 s64, s64, 77824
  v_pk_mul_f32 v[44:45], v[100:101], v[22:23] op_sel_hi:[1,0]
  v_pk_mul_f32 v[46:47], v[102:103], v[22:23] op_sel_hi:[1,0]
  v_exp_f32 v44, v44
  v_exp_f32 v45, v45
  v_exp_f32 v46, v46
  v_exp_f32 v47, v47
  v_pk_fma_f32 v[44:45], v[44:45], v[22:23], v[22:23] op_sel:[0,1,1] op_sel_hi:[1,1,1]
  v_pk_fma_f32 v[46:47], v[46:47], v[22:23], v[22:23] op_sel:[0,1,1] op_sel_hi:[1,1,1]
  v_rcp_f32 v44, v44
  v_rcp_f32 v45, v45
  v_rcp_f32 v46, v46
  v_rcp_f32 v47, v47
  v_pk_mul_f32 v[100:101], v[100:101], v[116:117]
  v_pk_mul_f32 v[102:103], v[102:103], v[118:119]
  v_pk_mul_f32 v[100:101], v[100:101], v[44:45]
  v_pk_mul_f32 v[102:103], v[102:103], v[46:47]
  v_cvt_pk_bf16_f32 v86, v100, v101
  v_cvt_pk_bf16_f32 v87, v102, v103
  buffer_store_dwordx4 v[84:87], v59, s[12:15], s64 offen sc1
  s_add_u32 s64, s64, 77824
  s_add_u32 s23, s83, 1802240
  buffer_load_dwordx4 a[0:3], v59, s[12:15], s23 offen offset:0 sc1
  v_pk_mul_f32 v[40:41], v[104:105], v[24:25] op_sel_hi:[1,0]
  v_pk_mul_f32 v[42:43], v[106:107], v[24:25] op_sel_hi:[1,0]
  v_exp_f32 v40, v40
  v_exp_f32 v41, v41
  v_exp_f32 v42, v42
  v_exp_f32 v43, v43
  v_pk_fma_f32 v[40:41], v[40:41], v[24:25], v[24:25] op_sel:[0,1,1] op_sel_hi:[1,1,1]
  v_pk_fma_f32 v[42:43], v[42:43], v[24:25], v[24:25] op_sel:[0,1,1] op_sel_hi:[1,1,1]
  v_rcp_f32 v40, v40
  v_rcp_f32 v41, v41
  v_rcp_f32 v42, v42
  v_rcp_f32 v43, v43
  v_pk_mul_f32 v[104:105], v[104:105], v[120:121]
  v_pk_mul_f32 v[106:107], v[106:107], v[122:123]
  v_pk_mul_f32 v[104:105], v[104:105], v[40:41]
  v_pk_mul_f32 v[106:107], v[106:107], v[42:43]
  v_cvt_pk_bf16_f32 v90, v104, v105
  v_cvt_pk_bf16_f32 v91, v106, v107
  buffer_store_dwordx4 v[88:91], v59, s[12:15], s64 offen sc1
  s_add_u32 s64, s64, 77824
  buffer_load_dwordx4 a[4:7], v59, s[12:15], s23 offen offset:1024 sc1
  v_pk_mul_f32 v[44:45], v[108:109], v[26:27] op_sel_hi:[1,0]
  v_pk_mul_f32 v[46:47], v[110:111], v[26:27] op_sel_hi:[1,0]
  v_exp_f32 v44, v44
  v_exp_f32 v45, v45
  v_exp_f32 v46, v46
  v_exp_f32 v47, v47
  v_pk_fma_f32 v[44:45], v[44:45], v[26:27], v[26:27] op_sel:[0,1,1] op_sel_hi:[1,1,1]
  v_pk_fma_f32 v[46:47], v[46:47], v[26:27], v[26:27] op_sel:[0,1,1] op_sel_hi:[1,1,1]
  v_rcp_f32 v44, v44
  v_rcp_f32 v45, v45
  v_rcp_f32 v46, v46
  v_rcp_f32 v47, v47
  v_pk_mul_f32 v[108:109], v[108:109], v[124:125]
  v_pk_mul_f32 v[110:111], v[110:111], v[126:127]
  v_pk_mul_f32 v[108:109], v[108:109], v[44:45]
  v_pk_mul_f32 v[110:111], v[110:111], v[46:47]
  v_cvt_pk_bf16_f32 v94, v108, v109
  v_cvt_pk_bf16_f32 v95, v110, v111
  buffer_store_dwordx4 v[92:95], v59, s[12:15], s64 offen sc1
  buffer_load_dwordx4 a[8:11], v59, s[12:15], s23 offen offset:2048 sc1
  v_pk_mul_f32 v[40:41], v[128:129], v[20:21] op_sel_hi:[1,0]
  v_pk_mul_f32 v[42:43], v[130:131], v[20:21] op_sel_hi:[1,0]
  v_exp_f32 v40, v40
  v_exp_f32 v41, v41
  v_exp_f32 v42, v42
  v_exp_f32 v43, v43
  v_pk_fma_f32 v[40:41], v[40:41], v[20:21], v[20:21] op_sel:[0,1,1] op_sel_hi:[1,1,1]
  v_pk_fma_f32 v[42:43], v[42:43], v[20:21], v[20:21] op_sel:[0,1,1] op_sel_hi:[1,1,1]
  v_rcp_f32 v40, v40
  v_rcp_f32 v41, v41
  v_rcp_f32 v42, v42
  v_rcp_f32 v43, v43
  v_pk_mul_f32 v[128:129], v[128:129], v[144:145]
  v_pk_mul_f32 v[130:131], v[130:131], v[146:147]
  v_pk_mul_f32 v[128:129], v[128:129], v[40:41]
  v_pk_mul_f32 v[130:131], v[130:131], v[42:43]
  v_cvt_pk_bf16_f32 v144, v128, v129
  v_cvt_pk_bf16_f32 v145, v130, v131
  buffer_load_dwordx4 a[12:15], v59, s[12:15], s23 offen offset:3072 sc1
  v_pk_mul_f32 v[44:45], v[132:133], v[22:23] op_sel_hi:[1,0]
  v_pk_mul_f32 v[46:47], v[134:135], v[22:23] op_sel_hi:[1,0]
  v_exp_f32 v44, v44
  v_exp_f32 v45, v45
  v_exp_f32 v46, v46
  v_exp_f32 v47, v47
  v_pk_fma_f32 v[44:45], v[44:45], v[22:23], v[22:23] op_sel:[0,1,1] op_sel_hi:[1,1,1]
  v_pk_fma_f32 v[46:47], v[46:47], v[22:23], v[22:23] op_sel:[0,1,1] op_sel_hi:[1,1,1]
  v_rcp_f32 v44, v44
  v_rcp_f32 v45, v45
  v_rcp_f32 v46, v46
  v_rcp_f32 v47, v47
  v_pk_mul_f32 v[132:133], v[132:133], v[148:149]
  v_pk_mul_f32 v[134:135], v[134:135], v[150:151]
  v_pk_mul_f32 v[132:133], v[132:133], v[44:45]
  v_pk_mul_f32 v[134:135], v[134:135], v[46:47]
  v_cvt_pk_bf16_f32 v148, v132, v133
  v_cvt_pk_bf16_f32 v149, v134, v135
  buffer_load_dwordx4 a[16:19], v60, s[12:15], s23 offen offset:0 sc1
  v_pk_mul_f32 v[40:41], v[136:137], v[24:25] op_sel_hi:[1,0]
  v_pk_mul_f32 v[42:43], v[138:139], v[24:25] op_sel_hi:[1,0]
  v_exp_f32 v40, v40
  v_exp_f32 v41, v41
  v_exp_f32 v42, v42
  v_exp_f32 v43, v43
  v_pk_fma_f32 v[40:41], v[40:41], v[24:25], v[24:25] op_sel:[0,1,1] op_sel_hi:[1,1,1]
  v_pk_fma_f32 v[42:43], v[42:43], v[24:25], v[24:25] op_sel:[0,1,1] op_sel_hi:[1,1,1]
  v_rcp_f32 v40, v40
  v_rcp_f32 v41, v41
  v_rcp_f32 v42, v42
  v_rcp_f32 v43, v43
  v_pk_mul_f32 v[136:137], v[136:137], v[152:153]
  v_pk_mul_f32 v[138:139], v[138:139], v[154:155]
  v_pk_mul_f32 v[136:137], v[136:137], v[40:41]
  v_pk_mul_f32 v[138:139], v[138:139], v[42:43]
  v_cvt_pk_bf16_f32 v152, v136, v137
  v_cvt_pk_bf16_f32 v153, v138, v139
  s_add_u32 s23, s83, 1966080
  buffer_load_dwordx4 a[20:23], v59, s[12:15], s23 offen offset:0 sc1
  v_pk_mul_f32 v[44:45], v[140:141], v[26:27] op_sel_hi:[1,0]
  v_pk_mul_f32 v[46:47], v[142:143], v[26:27] op_sel_hi:[1,0]
  v_exp_f32 v44, v44
  v_exp_f32 v45, v45
  v_exp_f32 v46, v46
  v_exp_f32 v47, v47
  v_pk_fma_f32 v[44:45], v[44:45], v[26:27], v[26:27] op_sel:[0,1,1] op_sel_hi:[1,1,1]
  v_pk_fma_f32 v[46:47], v[46:47], v[26:27], v[26:27] op_sel:[0,1,1] op_sel_hi:[1,1,1]
  v_rcp_f32 v44, v44
  v_rcp_f32 v45, v45
  v_rcp_f32 v46, v46
  v_rcp_f32 v47, v47
  v_pk_mul_f32 v[140:141], v[140:141], v[156:157]
  v_pk_mul_f32 v[142:143], v[142:143], v[158:159]
  v_pk_mul_f32 v[140:141], v[140:141], v[44:45]
  v_pk_mul_f32 v[142:143], v[142:143], v[46:47]
  v_cvt_pk_bf16_f32 v156, v140, v141
  v_cvt_pk_bf16_f32 v157, v142, v143
  buffer_load_dwordx4 a[24:27], v59, s[12:15], s23 offen offset:1024 sc1
  v_pk_mul_f32 v[40:41], v[160:161], v[20:21] op_sel_hi:[1,0]
  v_pk_mul_f32 v[42:43], v[162:163], v[20:21] op_sel_hi:[1,0]
  v_exp_f32 v40, v40
  v_exp_f32 v41, v41
  v_exp_f32 v42, v42
  v_exp_f32 v43, v43
  v_pk_fma_f32 v[40:41], v[40:41], v[20:21], v[20:21] op_sel:[0,1,1] op_sel_hi:[1,1,1]
  v_pk_fma_f32 v[42:43], v[42:43], v[20:21], v[20:21] op_sel:[0,1,1] op_sel_hi:[1,1,1]
  v_rcp_f32 v40, v40
  v_rcp_f32 v41, v41
  v_rcp_f32 v42, v42
  v_rcp_f32 v43, v43
  v_pk_mul_f32 v[160:161], v[160:161], v[176:177]
  v_pk_mul_f32 v[162:163], v[162:163], v[178:179]
  v_pk_mul_f32 v[160:161], v[160:161], v[40:41]
  v_pk_mul_f32 v[162:163], v[162:163], v[42:43]
  v_cvt_pk_bf16_f32 v146, v160, v161
  v_cvt_pk_bf16_f32 v147, v162, v163
  buffer_store_dwordx4 v[144:147], v59, s[12:15], s65 offen sc1
  s_add_u32 s65, s65, 77824
  buffer_load_dwordx4 a[28:31], v59, s[12:15], s23 offen offset:2048 sc1
  v_pk_mul_f32 v[44:45], v[164:165], v[22:23] op_sel_hi:[1,0]
  v_pk_mul_f32 v[46:47], v[166:167], v[22:23] op_sel_hi:[1,0]
  v_exp_f32 v44, v44
  v_exp_f32 v45, v45
  v_exp_f32 v46, v46
  v_exp_f32 v47, v47
  v_pk_fma_f32 v[44:45], v[44:45], v[22:23], v[22:23] op_sel:[0,1,1] op_sel_hi:[1,1,1]
  v_pk_fma_f32 v[46:47], v[46:47], v[22:23], v[22:23] op_sel:[0,1,1] op_sel_hi:[1,1,1]
  v_rcp_f32 v44, v44
  v_rcp_f32 v45, v45
  v_rcp_f32 v46, v46
  v_rcp_f32 v47, v47
  v_pk_mul_f32 v[164:165], v[164:165], v[180:181]
  v_pk_mul_f32 v[166:167], v[166:167], v[182:183]
  v_pk_mul_f32 v[164:165], v[164:165], v[44:45]
  v_pk_mul_f32 v[166:167], v[166:167], v[46:47]
  v_cvt_pk_bf16_f32 v150, v164, v165
  v_cvt_pk_bf16_f32 v151, v166, v167
  buffer_store_dwordx4 v[148:151], v59, s[12:15], s65 offen sc1
  s_add_u32 s65, s65, 77824
  buffer_load_dwordx4 a[32:35], v59, s[12:15], s23 offen offset:3072 sc1
  v_pk_mul_f32 v[40:41], v[168:169], v[24:25] op_sel_hi:[1,0]
  v_pk_mul_f32 v[42:43], v[170:171], v[24:25] op_sel_hi:[1,0]
  v_exp_f32 v40, v40
  v_exp_f32 v41, v41
  v_exp_f32 v42, v42
  v_exp_f32 v43, v43
  v_pk_fma_f32 v[40:41], v[40:41], v[24:25], v[24:25] op_sel:[0,1,1] op_sel_hi:[1,1,1]
  v_pk_fma_f32 v[42:43], v[42:43], v[24:25], v[24:25] op_sel:[0,1,1] op_sel_hi:[1,1,1]
  v_rcp_f32 v40, v40
  v_rcp_f32 v41, v41
  v_rcp_f32 v42, v42
  v_rcp_f32 v43, v43
  v_pk_mul_f32 v[168:169], v[168:169], v[184:185]
  v_pk_mul_f32 v[170:171], v[170:171], v[186:187]
  v_pk_mul_f32 v[168:169], v[168:169], v[40:41]
  v_pk_mul_f32 v[170:171], v[170:171], v[42:43]
  v_cvt_pk_bf16_f32 v154, v168, v169
  v_cvt_pk_bf16_f32 v155, v170, v171
  buffer_store_dwordx4 v[152:155], v59, s[12:15], s65 offen sc1
  s_add_u32 s65, s65, 77824
  buffer_load_dwordx4 a[36:39], v60, s[12:15], s23 offen offset:0 sc1
  v_pk_mul_f32 v[44:45], v[172:173], v[26:27] op_sel_hi:[1,0]
  v_pk_mul_f32 v[46:47], v[174:175], v[26:27] op_sel_hi:[1,0]
  v_exp_f32 v44, v44
  v_exp_f32 v45, v45
  v_exp_f32 v46, v46
  v_exp_f32 v47, v47
  v_pk_fma_f32 v[44:45], v[44:45], v[26:27], v[26:27] op_sel:[0,1,1] op_sel_hi:[1,1,1]
  v_pk_fma_f32 v[46:47], v[46:47], v[26:27], v[26:27] op_sel:[0,1,1] op_sel_hi:[1,1,1]
  v_rcp_f32 v44, v44
  v_rcp_f32 v45, v45
  v_rcp_f32 v46, v46
  v_rcp_f32 v47, v47
  v_pk_mul_f32 v[172:173], v[172:173], v[188:189]
  v_pk_mul_f32 v[174:175], v[174:175], v[190:191]
  v_pk_mul_f32 v[172:173], v[172:173], v[44:45]
  v_pk_mul_f32 v[174:175], v[174:175], v[46:47]
  v_cvt_pk_bf16_f32 v158, v172, v173
  v_cvt_pk_bf16_f32 v159, v174, v175
  buffer_store_dwordx4 v[156:159], v59, s[12:15], s65 offen sc1
  s_and_b32 s23, s3, 2
  s_mul_i32 s23, s23, 40960
  s_sub_u32 s23, s83, s23
  s_add_u32 s23, s23, 2129920
  buffer_load_dwordx4 a[40:43], v59, s[12:15], s23 offen offset:0 sc1
  v_pk_mul_f32 v[40:41], v[192:193], v[20:21] op_sel_hi:[1,0]
  v_pk_mul_f32 v[42:43], v[194:195], v[20:21] op_sel_hi:[1,0]
  v_exp_f32 v40, v40
  v_exp_f32 v41, v41
  v_exp_f32 v42, v42
  v_exp_f32 v43, v43
  v_pk_fma_f32 v[40:41], v[40:41], v[20:21], v[20:21] op_sel:[0,1,1] op_sel_hi:[1,1,1]
  v_pk_fma_f32 v[42:43], v[42:43], v[20:21], v[20:21] op_sel:[0,1,1] op_sel_hi:[1,1,1]
  v_rcp_f32 v40, v40
  v_rcp_f32 v41, v41
L_hop_ffn4:
  s_cbranch_execz L_retffn2
  v_rcp_f32 v42, v42
  v_rcp_f32 v43, v43
  v_pk_mul_f32 v[192:193], v[192:193], v[208:209]
  v_pk_mul_f32 v[194:195], v[194:195], v[210:211]
  v_pk_mul_f32 v[192:193], v[192:193], v[40:41]
  v_pk_mul_f32 v[194:195], v[194:195], v[42:43]
  v_cvt_pk_bf16_f32 v208, v192, v193
  v_cvt_pk_bf16_f32 v209, v194, v195
  buffer_load_dwordx4 a[44:47], v59, s[12:15], s23 offen offset:1024 sc1
  v_pk_mul_f32 v[44:45], v[196:197], v[22:23] op_sel_hi:[1,0]
  v_pk_mul_f32 v[46:47], v[198:199], v[22:23] op_sel_hi:[1,0]
  v_exp_f32 v44, v44
  v_exp_f32 v45, v45
  v_exp_f32 v46, v46
  v_exp_f32 v47, v47
  v_pk_fma_f32 v[44:45], v[44:45], v[22:23], v[22:23] op_sel:[0,1,1] op_sel_hi:[1,1,1]
  v_pk_fma_f32 v[46:47], v[46:47], v[22:23], v[22:23] op_sel:[0,1,1] op_sel_hi:[1,1,1]
  v_rcp_f32 v44, v44
  v_rcp_f32 v45, v45
  v_rcp_f32 v46, v46
  v_rcp_f32 v47, v47
  v_pk_mul_f32 v[196:197], v[196:197], v[212:213]
  v_pk_mul_f32 v[198:199], v[198:199], v[214:215]
  v_pk_mul_f32 v[196:197], v[196:197], v[44:45]
  v_pk_mul_f32 v[198:199], v[198:199], v[46:47]
  v_cvt_pk_bf16_f32 v212, v196, v197
  v_cvt_pk_bf16_f32 v213, v198, v199
  buffer_load_dwordx4 a[48:51], v59, s[12:15], s23 offen offset:2048 sc1
  v_pk_mul_f32 v[40:41], v[200:201], v[24:25] op_sel_hi:[1,0]
  v_pk_mul_f32 v[42:43], v[202:203], v[24:25] op_sel_hi:[1,0]
  v_exp_f32 v40, v40
  v_exp_f32 v41, v41
  v_exp_f32 v42, v42
  v_exp_f32 v43, v43
  v_pk_fma_f32 v[40:41], v[40:41], v[24:25], v[24:25] op_sel:[0,1,1] op_sel_hi:[1,1,1]
  v_pk_fma_f32 v[42:43], v[42:43], v[24:25], v[24:25] op_sel:[0,1,1] op_sel_hi:[1,1,1]
  v_rcp_f32 v40, v40
  v_rcp_f32 v41, v41
  v_rcp_f32 v42, v42
  v_rcp_f32 v43, v43
  v_pk_mul_f32 v[200:201], v[200:201], v[216:217]
  v_pk_mul_f32 v[202:203], v[202:203], v[218:219]
  v_pk_mul_f32 v[200:201], v[200:201], v[40:41]
  v_pk_mul_f32 v[202:203], v[202:203], v[42:43]
  v_cvt_pk_bf16_f32 v216, v200, v201
  v_cvt_pk_bf16_f32 v217, v202, v203
  buffer_load_dwordx4 a[52:55], v59, s[12:15], s23 offen offset:3072 sc1
  v_pk_mul_f32 v[44:45], v[204:205], v[26:27] op_sel_hi:[1,0]
  v_pk_mul_f32 v[46:47], v[206:207], v[26:27] op_sel_hi:[1,0]
  v_exp_f32 v44, v44
  v_exp_f32 v45, v45
  v_exp_f32 v46, v46
  v_exp_f32 v47, v47
  v_pk_fma_f32 v[44:45], v[44:45], v[26:27], v[26:27] op_sel:[0,1,1] op_sel_hi:[1,1,1]
  v_pk_fma_f32 v[46:47], v[46:47], v[26:27], v[26:27] op_sel:[0,1,1] op_sel_hi:[1,1,1]
  v_rcp_f32 v44, v44
  v_rcp_f32 v45, v45
  v_rcp_f32 v46, v46
  v_rcp_f32 v47, v47
  v_pk_mul_f32 v[204:205], v[204:205], v[220:221]
  v_pk_mul_f32 v[206:207], v[206:207], v[222:223]
  v_pk_mul_f32 v[204:205], v[204:205], v[44:45]
  v_pk_mul_f32 v[206:207], v[206:207], v[46:47]
  v_cvt_pk_bf16_f32 v220, v204, v205
  v_cvt_pk_bf16_f32 v221, v206, v207
  buffer_load_dwordx4 a[56:59], v60, s[12:15], s23 offen offset:0 sc1
  v_pk_mul_f32 v[40:41], v[224:225], v[20:21] op_sel_hi:[1,0]
  v_pk_mul_f32 v[42:43], v[226:227], v[20:21] op_sel_hi:[1,0]
  v_exp_f32 v40, v40
  v_exp_f32 v41, v41
  v_exp_f32 v42, v42
  v_exp_f32 v43, v43
  v_pk_fma_f32 v[40:41], v[40:41], v[20:21], v[20:21] op_sel:[0,1,1] op_sel_hi:[1,1,1]
  v_pk_fma_f32 v[42:43], v[42:43], v[20:21], v[20:21] op_sel:[0,1,1] op_sel_hi:[1,1,1]
  v_rcp_f32 v40, v40
  v_rcp_f32 v41, v41
  v_rcp_f32 v42, v42
  v_rcp_f32 v43, v43
  v_pk_mul_f32 v[224:225], v[224:225], v[240:241]
  v_pk_mul_f32 v[226:227], v[226:227], v[242:243]
  v_pk_mul_f32 v[224:225], v[224:225], v[40:41]
  v_pk_mul_f32 v[226:227], v[226:227], v[42:43]
  v_cvt_pk_bf16_f32 v210, v224, v225
  v_cvt_pk_bf16_f32 v211, v226, v227
  buffer_store_dwordx4 v[208:211], v59, s[12:15], s66 offen sc1
  s_add_u32 s66, s66, 77824
  v_pk_mul_f32 v[44:45], v[228:229], v[22:23] op_sel_hi:[1,0]
  v_pk_mul_f32 v[46:47], v[230:231], v[22:23] op_sel_hi:[1,0]
  v_exp_f32 v44, v44
  v_exp_f32 v45, v45
  v_exp_f32 v46, v46
  v_exp_f32 v47, v47
  v_pk_fma_f32 v[44:45], v[44:45], v[22:23], v[22:23] op_sel:[0,1,1] op_sel_hi:[1,1,1]
  v_pk_fma_f32 v[46:47], v[46:47], v[22:23], v[22:23] op_sel:[0,1,1] op_sel_hi:[1,1,1]
  v_rcp_f32 v44, v44
  v_rcp_f32 v45, v45
  v_rcp_f32 v46, v46
  v_rcp_f32 v47, v47
  v_pk_mul_f32 v[228:229], v[228:229], v[244:245]
  v_pk_mul_f32 v[230:231], v[230:231], v[246:247]
  v_pk_mul_f32 v[228:229], v[228:229], v[44:45]
  v_pk_mul_f32 v[230:231], v[230:231], v[46:47]
  v_cvt_pk_bf16_f32 v214, v228, v229
  v_cvt_pk_bf16_f32 v215, v230, v231
  buffer_store_dwordx4 v[212:215], v59, s[12:15], s66 offen sc1
  s_add_u32 s66, s66, 77824
  v_pk_mul_f32 v[40:41], v[232:233], v[24:25] op_sel_hi:[1,0]
  v_pk_mul_f32 v[42:43], v[234:235], v[24:25] op_sel_hi:[1,0]
  v_exp_f32 v40, v40
  v_exp_f32 v41, v41
  v_exp_f32 v42, v42
  v_exp_f32 v43, v43
  v_pk_fma_f32 v[40:41], v[40:41], v[24:25], v[24:25] op_sel:[0,1,1] op_sel_hi:[1,1,1]
  v_pk_fma_f32 v[42:43], v[42:43], v[24:25], v[24:25] op_sel:[0,1,1] op_sel_hi:[1,1,1]
  v_rcp_f32 v40, v40
  v_rcp_f32 v41, v41
  v_rcp_f32 v42, v42
  v_rcp_f32 v43, v43
  v_pk_mul_f32 v[232:233], v[232:233], v[248:249]
  v_pk_mul_f32 v[234:235], v[234:235], v[250:251]
  v_pk_mul_f32 v[232:233], v[232:233], v[40:41]
  v_pk_mul_f32 v[234:235], v[234:235], v[42:43]
  v_cvt_pk_bf16_f32 v218, v232, v233
  v_cvt_pk_bf16_f32 v219, v234, v235
  buffer_store_dwordx4 v[216:219], v59, s[12:15], s66 offen sc1
  s_add_u32 s66, s66, 77824
  v_pk_mul_f32 v[44:45], v[236:237], v[26:27] op_sel_hi:[1,0]
  v_pk_mul_f32 v[46:47], v[238:239], v[26:27] op_sel_hi:[1,0]
  v_exp_f32 v44, v44
  v_exp_f32 v45, v45
  v_exp_f32 v46, v46
  v_exp_f32 v47, v47
  v_pk_fma_f32 v[44:45], v[44:45], v[26:27], v[26:27] op_sel:[0,1,1] op_sel_hi:[1,1,1]
  v_pk_fma_f32 v[46:47], v[46:47], v[26:27], v[26:27] op_sel:[0,1,1] op_sel_hi:[1,1,1]
  v_rcp_f32 v44, v44
  v_rcp_f32 v45, v45
  v_rcp_f32 v46, v46
  v_rcp_f32 v47, v47
  v_pk_mul_f32 v[236:237], v[236:237], v[252:253]
  v_pk_mul_f32 v[238:239], v[238:239], v[254:255]
  v_pk_mul_f32 v[236:237], v[236:237], v[44:45]
  v_pk_mul_f32 v[238:239], v[238:239], v[46:47]
  v_cvt_pk_bf16_f32 v222, v236, v237
  v_cvt_pk_bf16_f32 v223, v238, v239
  buffer_store_dwordx4 v[220:223], v59, s[12:15], s66 offen sc1
  s_waitcnt vmcnt(0)
  s_barrier
  s_mov_b32 s62, 26214400
  v_mov_b32 v39, s61
  buffer_store_dword v39, v1, s[12:15], s62 offen sc1
  s_mov_b32 s62, 28311552
  buffer_load_dword v39, v38, s[12:15], s62 offen sc1
  s_add_u32 s23, s83, 2211840
  buffer_load_dwordx4 a[60:63], v59, s[12:15], s23 offen offset:0 sc1
  buffer_load_dwordx4 a[64:67], v59, s[12:15], s23 offen offset:1024 sc1
  buffer_load_dwordx4 a[68:71], v59, s[12:15], s23 offen offset:2048 sc1
  buffer_load_dwordx4 a[72:75], v59, s[12:15], s23 offen offset:3072 sc1
  buffer_load_dwordx4 a[76:79], v60, s[12:15], s23 offen offset:0 sc1
  s_add_u32 s23, s83, 2375680
  buffer_load_dwordx4 v[176:179], v59, s[12:15], s23 offen offset:0 sc1
  buffer_load_dwordx4 v[180:183], v59, s[12:15], s23 offen offset:1024 sc1
  buffer_load_dwordx4 v[184:187], v59, s[12:15], s23 offen offset:2048 sc1
  buffer_load_dwordx4 v[188:191], v59, s[12:15], s23 offen offset:3072 sc1
  buffer_load_dwordx4 v[192:195], v60, s[12:15], s23 offen offset:0 sc1
  s_waitcnt vmcnt(10)
  v_cmp_ne_u32 vcc, s61, v39
  s_nop 1
  s_cbranch_vccnz L_slow_16
L_back_17:
L_p2:
  s_add_u32 s23, s83, 2539520
  buffer_load_dwordx4 v[196:199], v59, s[12:15], s23 offen offset:0 sc1
  buffer_load_dwordx4 v[200:203], v59, s[12:15], s23 offen offset:1024 sc1
  s_mov_b64 exec, 0
  s_cmp_eq_u32 s3, 0
  s_cbranch_scc1 L_hop_p2b0
  s_cmp_eq_u32 s3, 1
  s_cbranch_scc1 L_ret3
  s_cmp_eq_u32 s3, 2
  s_cbranch_scc1 L_ret3
  s_cmp_eq_u32 s3, 3
  s_cbranch_scc1 L_ret3
L_ret3:
  s_mov_b64 exec, -1
  buffer_load_dwordx4 v[204:207], v59, s[12:15], s23 offen offset:2048 sc1
  s_lshr_b32 s71, s80, 2
  s_mul_i32 s71, s71, 32
  v_lshrrev_b32 v38, 1, v0
  v_min_u32 v38, 17, v38
  s_and_b32 s62, s80, 0
  s_lshl_b32 s62, s62, 9
  s_add_u32 s62, s62, s71
  v_add_lshl_u32 v38, v38, s62, 7
  v_lshlrev_b32 v6, 4, v0
  s_xor_b32 s64, s3, 0
  s_mul_i32 s64, s64, 77824
  v_add_u32 v2, s64, v6
  s_xor_b32 s64, s3, 1
  buffer_load_dwordx4 v[208:211], v59, s[12:15], s23 offen offset:3072 sc1
  s_mul_i32 s64, s64, 77824
  v_add_u32 v3, s64, v6
  s_xor_b32 s64, s3, 2
  s_mul_i32 s64, s64, 77824
  v_add_u32 v4, s64, v6
  s_xor_b32 s64, s3, 3
  s_mul_i32 s64, s64, 77824
  v_add_u32 v5, s64, v6
  s_add_u32 s72, s82, 4096
  s_add_u32 s73, s82, 8192
  s_add_u32 s74, s82, 12288
  s_add_u32 s75, s82, 16384
  v_add_u32 v7, s48, v6
  buffer_load_dwordx4 v[212:215], v60, s[12:15], s23 offen offset:0 sc1
  s_and_b32 s76, s3, 2
  s_mul_i32 s76, s76, 19456
  s_sub_u32 s76, s74, s76
  s_add_u32 s77, s74, 0
  s_add_u32 s78, s75, 0
  s_xor_b32 s64, s3, 0
  s_mul_i32 s65, s64, 5120
  s_add_u32 s65, s65, 65536
  v_add_u32 v14, s65, v6
  s_mul_i32 s64, s64, 77824
  v_lshl_add_u32 v24, v0, 3, s64
  s_xor_b32 s64, s3, 1
  s_mul_i32 s65, s64, 5120
  s_add_u32 s23, s83, 2703360
  buffer_load_dwordx4 v[216:219], v59, s[12:15], s23 offen offset:0 sc1
  s_add_u32 s65, s65, 65536
  v_add_u32 v15, s65, v6
  s_mul_i32 s64, s64, 77824
  v_lshl_add_u32 v25, v0, 3, s64
  s_xor_b32 s64, s3, 2
  s_mul_i32 s65, s64, 5120
  s_add_u32 s65, s65, 65536
  v_add_u32 v16, s65, v6
  s_mul_i32 s64, s64, 77824
  v_lshl_add_u32 v26, v0, 3, s64
  s_xor_b32 s64, s3, 3
  s_mul_i32 s64, s64, 77824
  v_lshl_add_u32 v27, v0, 3, s64
  buffer_load_dwordx4 v[220:223], v59, s[12:15], s23 offen offset:1024 sc1
  s_mul_i32 s64, s3, 5376
  s_add_u32 s64, s64, 131072
  v_add_u32 v20, 0, v0
  v_mul_u32_u24 v21, 205, v20
  v_lshrrev_b32 v21, 11, v21
  v_mul_u32_u24 v22, 10, v21
  v_sub_u32 v22, v20, v22
  v_mul_u32_u24 v23, 1280, v21
  v_lshl_add_u32 v8, v22, 4, v23
  v_mul_u32_u24 v23, 336, v21
  v_lshl_add_u32 v23, v22, 5, v23
  v_add_u32 v11, s64, v23
  v_add_u32 v20, 64, v0
  buffer_load_dwordx4 v[224:227], v59, s[12:15], s23 offen offset:2048 sc1
  v_mul_u32_u24 v21, 205, v20
  v_lshrrev_b32 v21, 11, v21
  v_mul_u32_u24 v22, 10, v21
  v_sub_u32 v22, v20, v22
  v_mul_u32_u24 v23, 1280, v21
  v_lshl_add_u32 v9, v22, 4, v23
  v_mul_u32_u24 v23, 336, v21
  v_lshl_add_u32 v23, v22, 5, v23
  v_add_u32 v12, s64, v23
  v_add_u32 v20, 128, v0
  v_mul_u32_u24 v21, 205, v20
  v_lshrrev_b32 v21, 11, v21
  v_mul_u32_u24 v22, 10, v21
  buffer_load_dwordx4 v[228:231], v59, s[12:15], s23 offen offset:3072 sc1
  v_sub_u32 v22, v20, v22
  v_mul_u32_u24 v23, 1280, v21
  v_lshl_add_u32 v10, v22, 4, v23
  v_mul_u32_u24 v23, 336, v21
  v_lshl_add_u32 v23, v22, 5, v23
  v_add_u32 v13, s64, v23
  v_and_b32 v20, 15, v0
  v_mul_u32_u24 v20, 336, v20
  v_lshrrev_b32 v21, 4, v0
  v_lshl_add_u32 v20, v21, 4, v20
  v_add_u32 v28, s64, v20
  v_lshrrev_b32 v20, 5, v0
  v_lshl_add_u32 v10, v20, 30, v10
  buffer_load_dwordx4 v[232:235], v60, s[12:15], s23 offen offset:0 sc1
  v_mov_b32 v29, 0x00003f80
  v_mov_b32 v30, 0x3f800000
  s_lshl_b32 s64, s80, 2
  s_add_u32 s64, s64, s3
  s_mul_i32 s70, s64, 20480
  s_mul_i32 s64, s81, 160
  s_add_u32 s70, s70, s64
  v_lshrrev_b32 v18, 2, v0
  v_min_u32 v18, 11, v18
  s_add_u32 s71, s71, 18
  v_add_lshl_u32 v18, v18, s71, 7
  s_or_b32 s64, s2, s3
  s_cmp_eq_u32 s64, 0
  s_mov_b32 s64, 1073741824
  s_cselect_b32 s64, 32768, s64
  s_add_u32 s23, s83, 2867200
  buffer_load_dwordx4 v[236:239], v59, s[12:15], s23 offen offset:0 sc1
  v_mov_b32 v20, s64
  v_mov_b32 v21, s61
  s_cmp_lg_u32 s3, 0
  s_cbranch_scc1 L_np_18
  s_mov_b32 s62, 26214400
  buffer_load_dword v39, v38, s[12:15], s62 offen sc1
L_np_18:
  buffer_load_dwordx4 v[240:243], v59, s[12:15], s23 offen offset:1024 sc1
  buffer_load_dwordx4 v[244:247], v59, s[12:15], s23 offen offset:2048 sc1
  buffer_load_dwordx4 v[248:251], v59, s[12:15], s23 offen offset:3072 sc1
  buffer_load_dwordx4 v[252:255], v60, s[12:15], s23 offen offset:0 sc1
  s_cmp_lg_u32 s3, 0
  s_cbranch_scc1 L_go_19
  s_waitcnt vmcnt(4)
  v_cmp_ne_u32 vcc, s61, v39
  s_nop 1
  s_cbranch_vccz L_go_19
  s_mov_b32 s59, 131072
  s_branch L_first_22
L_spin_20:
  s_sleep 2
L_first_22:
  s_mov_b32 s62, 26214400
  buffer_load_dword v39, v38, s[12:15], s62 offen sc1
  s_waitcnt vmcnt(0)
  v_cmp_ne_u32 vcc, s61, v39
  s_sub_u32 s59, s59, 1
  s_cbranch_scc1 L_spun_21
  s_cbranch_vccnz L_spin_20
L_spun_21:
L_go_19:
  s_barrier
L_p2b:
  buffer_load_dwordx4 a[80:83], v5, s[12:15], s82 offen offset:0 sc1
  buffer_load_dwordx4 a[84:87], v5, s[12:15], s82 offen offset:1024 sc1
  buffer_load_dwordx4 a[88:91], v5, s[12:15], s82 offen offset:2048 sc1
  buffer_load_dwordx4 a[92:95], v5, s[12:15], s82 offen offset:3072 sc1
  buffer_load_dwordx4 v[32:35], v5, s[12:15], s72 offen offset:0 sc1
  buffer_load_dwordx4 v[36:39], v5, s[12:15], s72 offen offset:1024 sc1
  buffer_load_dwordx4 v[40:43], v5, s[12:15], s72 offen offset:2048 sc1
  buffer_load_dwordx4 v[44:47], v5, s[12:15], s72 offen offset:3072 sc1
  s_waitcnt vmcnt(7)
  v_mfma_f32_16x16x32_bf16 v[64:67], a[96:99], a[80:83], 0
  buffer_load_dwordx4 v[48:51], v5, s[12:15], s73 offen offset:0 sc1
  v_mfma_f32_16x16x32_bf16 v[68:71], a[100:103], a[80:83], 0
  v_mfma_f32_16x16x32_bf16 v[72:75], a[104:107], a[80:83], 0
  v_mfma_f32_16x16x32_bf16 v[76:79], a[108:111], a[80:83], 0
  buffer_load_dwordx4 v[52:55], v5, s[12:15], s73 offen offset:1024 sc1
  v_mfma_f32_16x16x32_bf16 v[80:83], a[112:115], a[80:83], 0
  s_waitcnt vmcnt(8)
  v_mfma_f32_16x16x32_bf16 v[80:83], a[132:135], a[84:87], v[80:83]
  v_mfma_f32_16x16x32_bf16 v[76:79], a[128:131], a[84:87], v[76:79]
  v_mfma_f32_16x16x32_bf16 v[72:75], a[124:127], a[84:87], v[72:75]
  buffer_load_dwordx4 v[56:59], v5, s[12:15], s73 offen offset:2048 sc1
  v_mfma_f32_16x16x32_bf16 v[68:71], a[120:123], a[84:87], v[68:71]
  ds_read_b128 v[116:119], v7 offset:0
  v_mfma_f32_16x16x32_bf16 v[64:67], a[116:119], a[84:87], v[64:67]
  s_waitcnt vmcnt(8)
  ds_read_b128 v[120:123], v7 offset:1024
  v_mfma_f32_16x16x32_bf16 v[64:67], a[136:139], a[88:91], v[64:67]
  buffer_load_dwordx4 v[60:63], v5, s[12:15], s73 offen offset:3072 sc1
  v_mfma_f32_16x16x32_bf16 v[68:71], a[140:143], a[88:91], v[68:71]
  ds_read_b128 v[124:127], v7 offset:2048
  v_mfma_f32_16x16x32_bf16 v[72:75], a[144:147], a[88:91], v[72:75]
  ds_read_b128 v[128:131], v7 offset:3072
  v_mfma_f32_16x16x32_bf16 v[76:79], a[148:151], a[88:91], v[76:79]
  ds_read_b128 v[132:135], v7 offset:4096
  v_mfma_f32_16x16x32_bf16 v[80:83], a[152:155], a[88:91], v[80:83]
  s_waitcnt vmcnt(8)
  buffer_load_dwordx4 a[80:83], v5, s[12:15], s74 offen offset:0 sc1
  v_mfma_f32_16x16x32_bf16 v[80:83], a[172:175], a[92:95], v[80:83]
  ds_read_b128 v[136:139], v7 offset:5120
  v_mfma_f32_16x16x32_bf16 v[76:79], a[168:171], a[92:95], v[76:79]
  ds_read_b128 v[140:143], v7 offset:6144
  v_mfma_f32_16x16x32_bf16 v[72:75], a[164:167], a[92:95], v[72:75]
  buffer_load_dwordx4 a[84:87], v4, s[12:15], s82 offen offset:0 sc1
  v_mfma_f32_16x16x32_bf16 v[68:71], a[160:163], a[92:95], v[68:71]
  ds_read_b128 v[144:147], v7 offset:7168
  v_mfma_f32_16x16x32_bf16 v[64:67], a[156:159], a[92:95], v[64:67]
  s_waitcnt vmcnt(9)
  ds_read_b128 v[148:151], v7 offset:32768
  ds_read_b128 v[152:155], v7 offset:33792
  v_mfma_f32_16x16x32_bf16 v[64:67], a[176:179], v[32:35], v[64:67]
  ds_read_b128 v[156:159], v7 offset:34816
  v_mfma_f32_16x16x32_bf16 v[68:71], a[180:183], v[32:35], v[68:71]
  buffer_load_dwordx4 a[88:91], v4, s[12:15], s82 offen offset:1024 sc1
  v_mfma_f32_16x16x32_bf16 v[72:75], a[184:187], v[32:35], v[72:75]
  ds_read_b128 v[160:163], v7 offset:35840
  v_mfma_f32_16x16x32_bf16 v[76:79], a[188:191], v[32:35], v[76:79]
  ds_read_b128 v[164:167], v7 offset:36864
  v_mfma_f32_16x16x32_bf16 v[80:83], a[192:195], v[32:35], v[80:83]
  s_waitcnt vmcnt(9)
  buffer_load_dwordx4 a[92:95], v4, s[12:15], s82 offen offset:2048 sc1
  v_mfma_f32_16x16x32_bf16 v[80:83], a[212:215], v[36:39], v[80:83]
  ds_read_b128 v[168:171], v7 offset:37888
  v_mfma_f32_16x16x32_bf16 v[76:79], a[208:211], v[36:39], v[76:79]
  ds_read_b128 v[172:175], v7 offset:38912
  v_mfma_f32_16x16x32_bf16 v[72:75], a[204:207], v[36:39], v[72:75]
  v_mfma_f32_16x16x32_bf16 v[68:71], a[200:203], v[36:39], v[68:71]
  buffer_load_dwordx4 v[32:35], v4, s[12:15], s82 offen offset:3072 sc1
  v_mfma_f32_16x16x32_bf16 v[64:67], a[196:199], v[36:39], v[64:67]
  s_waitcnt vmcnt(10)
  v_mfma_f32_16x16x32_bf16 v[64:67], a[216:219], v[40:43], v[64:67]
  v_mfma_f32_16x16x32_bf16 v[68:71], a[220:223], v[40:43], v[68:71]
  buffer_load_dwordx4 v[36:39], v4, s[12:15], s72 offen offset:0 sc1
  v_mfma_f32_16x16x32_bf16 v[72:75], a[224:227], v[40:43], v[72:75]
  v_mfma_f32_16x16x32_bf16 v[76:79], a[228:231], v[40:43], v[76:79]
  v_mfma_f32_16x16x32_bf16 v[80:83], a[232:235], v[40:43], v[80:83]
  s_waitcnt vmcnt(10)
  v_mfma_f32_16x16x32_bf16 v[80:83], a[252:255], v[44:47], v[80:83]
  buffer_load_dwordx4 v[40:43], v4, s[12:15], s72 offen offset:1024 sc1
  v_mfma_f32_16x16x32_bf16 v[76:79], a[248:251], v[44:47], v[76:79]
  v_mfma_f32_16x16x32_bf16 v[72:75], a[244:247], v[44:47], v[72:75]
  v_mfma_f32_16x16x32_bf16 v[68:71], a[240:243], v[44:47], v[68:71]
  s_waitcnt lgkmcnt(0)
  v_mfma_f32_16x16x32_bf16 v[64:67], a[236:239], v[44:47], v[64:67]
  s_waitcnt vmcnt(10)
  v_mfma_f32_16x16x32_bf16 v[64:67], v[116:119], v[48:51], v[64:67]
  buffer_load_dwordx4 v[44:47], v4, s[12:15], s72 offen offset:2048 sc1
  v_mfma_f32_16x16x32_bf16 v[68:71], v[120:123], v[48:51], v[68:71]
  v_mfma_f32_16x16x32_bf16 v[72:75], v[124:127], v[48:51], v[72:75]
  v_mfma_f32_16x16x32_bf16 v[76:79], v[128:131], v[48:51], v[76:79]
  v_mfma_f32_16x16x32_bf16 v[80:83], v[132:135], v[48:51], v[80:83]
  s_waitcnt vmcnt(10)
  v_mfma_f32_16x16x32_bf16 v[80:83], v[152:155], v[52:55], v[80:83]
  buffer_load_dwordx4 v[48:51], v4, s[12:15], s72 offen offset:3072 sc1
  v_mfma_f32_16x16x32_bf16 v[76:79], v[148:151], v[52:55], v[76:79]
  v_mfma_f32_16x16x32_bf16 v[72:75], v[144:147], v[52:55], v[72:75]
  v_mfma_f32_16x16x32_bf16 v[68:71], v[140:143], v[52:55], v[68:71]
  v_mfma_f32_16x16x32_bf16 v[64:67], v[136:139], v[52:55], v[64:67]
  s_waitcnt vmcnt(10)
  v_mfma_f32_16x16x32_bf16 v[64:67], v[156:159], v[56:59], v[64:67]
  buffer_load_dwordx4 v[52:55], v4, s[12:15], s73 offen offset:0 sc1
  v_mfma_f32_16x16x32_bf16 v[68:71], v[160:163], v[56:59], v[68:71]
  v_mfma_f32_16x16x32_bf16 v[72:75], v[164:167], v[56:59], v[72:75]
  v_mfma_f32_16x16x32_bf16 v[76:79], v[168:171], v[56:59], v[76:79]
  v_mfma_f32_16x16x32_bf16 v[80:83], v[172:175], v[56:59], v[80:83]
  s_waitcnt vmcnt(10)
  v_mfma_f32_16x16x32_bf16 v[80:83], a[16:19], v[60:63], v[80:83]
  buffer_load_dwordx4 v[56:59], v4, s[12:15], s73 offen offset:1024 sc1
  v_mfma_f32_16x16x32_bf16 v[76:79], a[12:15], v[60:63], v[76:79]
  v_mfma_f32_16x16x32_bf16 v[72:75], a[8:11], v[60:63], v[72:75]
  v_mfma_f32_16x16x32_bf16 v[68:71], a[4:7], v[60:63], v[68:71]
  v_mfma_f32_16x16x32_bf16 v[64:67], a[0:3], v[60:63], v[64:67]
  s_waitcnt vmcnt(10)
  v_mfma_f32_16x16x32_bf16 v[64:67], a[20:23], a[80:83], v[64:67]
  buffer_load_dwordx4 v[60:63], v4, s[12:15], s73 offen offset:2048 sc1
  v_mfma_f32_16x16x32_bf16 v[68:71], a[24:27], a[80:83], v[68:71]
  v_mfma_f32_16x16x32_bf16 v[72:75], a[28:31], a[80:83], v[72:75]
  v_mfma_f32_16x16x32_bf16 v[76:79], a[32:35], a[80:83], v[76:79]
  v_mfma_f32_16x16x32_bf16 v[80:83], a[36:39], a[80:83], v[80:83]
  s_waitcnt vmcnt(10)
  v_mfma_f32_16x16x32_bf16 v[100:103], a[112:115], a[84:87], 0
  buffer_load_dwordx4 a[80:83], v4, s[12:15], s73 offen offset:3072 sc1
  v_mfma_f32_16x16x32_bf16 v[96:99], a[108:111], a[84:87], 0
  v_mfma_f32_16x16x32_bf16 v[92:95], a[104:107], a[84:87], 0
  v_mfma_f32_16x16x32_bf16 v[88:91], a[100:103], a[84:87], 0
  ds_write_b32 v16, v64 offset:0
  v_mfma_f32_16x16x32_bf16 v[84:87], a[96:99], a[84:87], 0
  s_waitcnt vmcnt(10)
  v_mfma_f32_16x16x32_bf16 v[84:87], a[116:119], a[88:91], v[84:87]
  buffer_load_dwordx4 a[84:87], v4, s[12:15], s74 offen offset:0 sc1
  v_mfma_f32_16x16x32_bf16 v[88:91], a[120:123], a[88:91], v[88:91]
  ds_write_b32 v16, v65 offset:4
  v_mfma_f32_16x16x32_bf16 v[92:95], a[124:127], a[88:91], v[92:95]
  v_mfma_f32_16x16x32_bf16 v[96:99], a[128:131], a[88:91], v[96:99]
  ds_write_b32 v16, v66 offset:8
  v_mfma_f32_16x16x32_bf16 v[100:103], a[132:135], a[88:91], v[100:103]
  s_waitcnt vmcnt(10)
  v_mfma_f32_16x16x32_bf16 v[100:103], a[152:155], a[92:95], v[100:103]
  buffer_load_dwordx4 a[88:91], v3, s[12:15], s82 offen offset:0 sc1
  v_mfma_f32_16x16x32_bf16 v[96:99], a[148:151], a[92:95], v[96:99]
  ds_write_b32 v16, v67 offset:12
  v_mfma_f32_16x16x32_bf16 v[92:95], a[144:147], a[92:95], v[92:95]
  v_mfma_f32_16x16x32_bf16 v[88:91], a[140:143], a[92:95], v[88:91]
  ds_write_b32 v16, v68 offset:1024
  v_mfma_f32_16x16x32_bf16 v[84:87], a[136:139], a[92:95], v[84:87]
  s_waitcnt vmcnt(10)
  v_mfma_f32_16x16x32_bf16 v[84:87], a[156:159], v[32:35], v[84:87]
  buffer_load_dwordx4 a[92:95], v3, s[12:15], s82 offen offset:1024 sc1
  v_mfma_f32_16x16x32_bf16 v[88:91], a[160:163], v[32:35], v[88:91]
  ds_write_b32 v16, v69 offset:1028
  v_mfma_f32_16x16x32_bf16 v[92:95], a[164:167], v[32:35], v[92:95]
  v_mfma_f32_16x16x32_bf16 v[96:99], a[168:171], v[32:35], v[96:99]
  ds_write_b32 v16, v70 offset:1032
  v_mfma_f32_16x16x32_bf16 v[100:103], a[172:175], v[32:35], v[100:103]
  s_waitcnt vmcnt(10)
  v_mfma_f32_16x16x32_bf16 v[100:103], a[192:195], v[36:39], v[100:103]
  buffer_load_dwordx4 v[32:35], v3, s[12:15], s82 offen offset:2048 sc1
  v_mfma_f32_16x16x32_bf16 v[96:99], a[188:191], v[36:39], v[96:99]
  ds_write_b32 v16, v71 offset:1036
  v_mfma_f32_16x16x32_bf16 v[92:95], a[184:187], v[36:39], v[92:95]
  v_mfma_f32_16x16x32_bf16 v[88:91], a[180:183], v[36:39], v[88:91]
  ds_write_b32 v16, v72 offset:2048
  v_mfma_f32_16x16x32_bf16 v[84:87], a[176:179], v[36:39], v[84:87]
  s_waitcnt vmcnt(10)
  v_mfma_f32_16x16x32_bf16 v[84:87], a[196:199], v[40:43], v[84:87]
  buffer_load_dwordx4 v[36:39], v3, s[12:15], s82 offen offset:3072 sc1
  v_mfma_f32_16x16x32_bf16 v[88:91], a[200:203], v[40:43], v[88:91]
  ds_write_b32 v16, v73 offset:2052
  v_mfma_f32_16x16x32_bf16 v[92:95], a[204:207], v[40:43], v[92:95]
  v_mfma_f32_16x16x32_bf16 v[96:99], a[208:211], v[40:43], v[96:99]
  ds_write_b32 v16, v74 offset:2056
  v_mfma_f32_16x16x32_bf16 v[100:103], a[212:215], v[40:43], v[100:103]
  s_waitcnt vmcnt(10)
  v_mfma_f32_16x16x32_bf16 v[100:103], a[232:235], v[44:47], v[100:103]
  buffer_load_dwordx4 v[40:43], v3, s[12:15], s72 offen offset:0 sc1
  v_mfma_f32_16x16x32_bf16 v[96:99], a[228:231], v[44:47], v[96:99]
  ds_write_b32 v16, v75 offset:2060
  v_mfma_f32_16x16x32_bf16 v[92:95], a[224:227], v[44:47], v[92:95]
  v_mfma_f32_16x16x32_bf16 v[88:91], a[220:223], v[44:47], v[88:91]
  ds_write_b32 v16, v76 offset:3072
  v_mfma_f32_16x16x32_bf16 v[84:87], a[216:219], v[44:47], v[84:87]
  s_waitcnt vmcnt(10)
  v_mfma_f32_16x16x32_bf16 v[84:87], a[236:239], v[48:51], v[84:87]
  buffer_load_dwordx4 v[44:47], v3, s[12:15], s72 offen offset:1024 sc1
  v_mfma_f32_16x16x32_bf16 v[88:91], a[240:243], v[48:51], v[88:91]
  ds_write_b32 v16, v77 offset:3076
  v_mfma_f32_16x16x32_bf16 v[92:95], a[244:247], v[48:51], v[92:95]
  v_mfma_f32_16x16x32_bf16 v[96:99], a[248:251], v[48:51], v[96:99]
  ds_write_b32 v16, v78 offset:3080
  v_mfma_f32_16x16x32_bf16 v[100:103], a[252:255], v[48:51], v[100:103]
  s_waitcnt vmcnt(10)
  v_mfma_f32_16x16x32_bf16 v[100:103], v[132:135], v[52:55], v[100:103]
  buffer_load_dwordx4 v[48:51], v3, s[12:15], s72 offen offset:2048 sc1
  v_mfma_f32_16x16x32_bf16 v[96:99], v[128:131], v[52:55], v[96:99]
  ds_write_b32 v16, v79 offset:3084
  v_mfma_f32_16x16x32_bf16 v[92:95], v[124:127], v[52:55], v[92:95]
  v_mfma_f32_16x16x32_bf16 v[88:91], v[120:123], v[52:55], v[88:91]
  ds_write_b32 v16, v80 offset:4096
  v_mfma_f32_16x16x32_bf16 v[84:87], v[116:119], v[52:55], v[84:87]
  s_waitcnt vmcnt(10)
  v_mfma_f32_16x16x32_bf16 v[84:87], v[136:139], v[56:59], v[84:87]
  buffer_load_dwordx4 v[52:55], v3, s[12:15], s72 offen offset:3072 sc1
  v_mfma_f32_16x16x32_bf16 v[88:91], v[140:143], v[56:59], v[88:91]
  ds_write_b32 v16, v81 offset:4100
  v_mfma_f32_16x16x32_bf16 v[92:95], v[144:147], v[56:59], v[92:95]
  v_mfma_f32_16x16x32_bf16 v[96:99], v[148:151], v[56:59], v[96:99]
  ds_write_b32 v16, v82 offset:4104
  v_mfma_f32_16x16x32_bf16 v[100:103], v[152:155], v[56:59], v[100:103]
  s_waitcnt vmcnt(10)
  v_mfma_f32_16x16x32_bf16 v[100:103], v[172:175], v[60:63], v[100:103]
  buffer_load_dwordx4 v[56:59], v3, s[12:15], s73 offen offset:0 sc1
  v_mfma_f32_16x16x32_bf16 v[96:99], v[168:171], v[60:63], v[96:99]
  ds_write_b32 v16, v83 offset:4108
  v_mfma_f32_16x16x32_bf16 v[92:95], v[164:167], v[60:63], v[92:95]
  v_mfma_f32_16x16x32_bf16 v[88:91], v[160:163], v[60:63], v[88:91]
  v_mfma_f32_16x16x32_bf16 v[84:87], v[156:159], v[60:63], v[84:87]
  s_waitcnt vmcnt(10)
  s_waitcnt lgkmcnt(0)
  s_barrier
  v_mfma_f32_16x16x32_bf16 v[84:87], a[0:3], a[80:83], v[84:87]
  buffer_load_dwordx4 v[60:63], v3, s[12:15], s73 offen offset:1024 sc1
  v_mfma_f32_16x16x32_bf16 v[88:91], a[4:7], a[80:83], v[88:91]
  ds_read_b128 v[64:67], v14 offset:0
  v_mfma_f32_16x16x32_bf16 v[92:95], a[8:11], a[80:83], v[92:95]
  ds_read_b128 v[68:71], v14 offset:1024
  v_mfma_f32_16x16x32_bf16 v[96:99], a[12:15], a[80:83], v[96:99]
  ds_read_b128 v[72:75], v14 offset:2048
  v_mfma_f32_16x16x32_bf16 v[100:103], a[16:19], a[80:83], v[100:103]
  s_waitcnt vmcnt(10)
  ds_read_b128 v[76:79], v14 offset:3072
  ds_read_b128 v[80:83], v14 offset:4096
  v_mfma_f32_16x16x32_bf16 v[100:103], a[36:39], a[84:87], v[100:103]
  buffer_load_dwordx4 a[80:83], v3, s[12:15], s73 offen offset:2048 sc1
  v_mfma_f32_16x16x32_bf16 v[96:99], a[32:35], a[84:87], v[96:99]
  v_mfma_f32_16x16x32_bf16 v[92:95], a[28:31], a[84:87], v[92:95]
  v_mfma_f32_16x16x32_bf16 v[88:91], a[24:27], a[84:87], v[88:91]
  v_mfma_f32_16x16x32_bf16 v[84:87], a[20:23], a[84:87], v[84:87]
  s_waitcnt vmcnt(10)
  s_waitcnt lgkmcnt(4)
  v_mfma_f32_16x16x32_bf16 v[64:67], a[96:99], a[88:91], v[64:67]
  s_waitcnt lgkmcnt(3)
  buffer_load_dwordx4 a[84:87], v3, s[12:15], s73 offen offset:3072 sc1
  v_mfma_f32_16x16x32_bf16 v[68:71], a[100:103], a[88:91], v[68:71]
  s_waitcnt lgkmcnt(2)
  v_mfma_f32_16x16x32_bf16 v[72:75], a[104:107], a[88:91], v[72:75]
  s_waitcnt lgkmcnt(1)
  v_mfma_f32_16x16x32_bf16 v[76:79], a[108:111], a[88:91], v[76:79]
  s_waitcnt lgkmcnt(0)
  ds_write_b32 v16, v100 offset:24576
  v_mfma_f32_16x16x32_bf16 v[80:83], a[112:115], a[88:91], v[80:83]
  s_waitcnt vmcnt(10)
  v_mfma_f32_16x16x32_bf16 v[80:83], a[132:135], a[92:95], v[80:83]
  buffer_load_dwordx4 a[88:91], v3, s[12:15], s74 offen offset:0 sc1
  v_mfma_f32_16x16x32_bf16 v[76:79], a[128:131], a[92:95], v[76:79]
  ds_write_b32 v16, v101 offset:24580
  v_mfma_f32_16x16x32_bf16 v[72:75], a[124:127], a[92:95], v[72:75]
  v_mfma_f32_16x16x32_bf16 v[68:71], a[120:123], a[92:95], v[68:71]
  ds_write_b32 v16, v102 offset:24584
  v_mfma_f32_16x16x32_bf16 v[64:67], a[116:119], a[92:95], v[64:67]
  s_waitcnt vmcnt(10)
  v_mfma_f32_16x16x32_bf16 v[64:67], a[136:139], v[32:35], v[64:67]
  buffer_load_dwordx4 a[92:95], v3, s[12:15], s76 offen offset:1024 sc1
  v_mfma_f32_16x16x32_bf16 v[68:71], a[140:143], v[32:35], v[68:71]
  ds_write_b32 v16, v103 offset:24588
  v_mfma_f32_16x16x32_bf16 v[72:75], a[144:147], v[32:35], v[72:75]
  v_mfma_f32_16x16x32_bf16 v[76:79], a[148:151], v[32:35], v[76:79]
  ds_write_b32 v16, v96 offset:23552
  v_mfma_f32_16x16x32_bf16 v[80:83], a[152:155], v[32:35], v[80:83]
  s_waitcnt vmcnt(10)
  v_mfma_f32_16x16x32_bf16 v[80:83], a[172:175], v[36:39], v[80:83]
  buffer_load_dwordx4 v[32:35], v2, s[12:15], s82 offen offset:0 sc1
  v_mfma_f32_16x16x32_bf16 v[76:79], a[168:171], v[36:39], v[76:79]
  ds_write_b32 v16, v97 offset:23556
  v_mfma_f32_16x16x32_bf16 v[72:75], a[164:167], v[36:39], v[72:75]
L_hop_p2b0:
  s_cbranch_execz L_ret3
  v_mfma_f32_16x16x32_bf16 v[68:71], a[160:163], v[36:39], v[68:71]
  ds_write_b32 v16, v98 offset:23560
  v_mfma_f32_16x16x32_bf16 v[64:67], a[156:159], v[36:39], v[64:67]
  s_waitcnt vmcnt(10)
  v_mfma_f32_16x16x32_bf16 v[64:67], a[176:179], v[40:43], v[64:67]
  buffer_load_dwordx4 v[36:39], v2, s[12:15], s82 offen offset:1024 sc1
  v_mfma_f32_16x16x32_bf16 v[68:71], a[180:183], v[40:43], v[68:71]
  ds_write_b32 v16, v99 offset:23564
  v_mfma_f32_16x16x32_bf16 v[72:75], a[184:187], v[40:43], v[72:75]
  v_mfma_f32_16x16x32_bf16 v[76:79], a[188:191], v[40:43], v[76:79]
  ds_write_b32 v16, v92 offset:22528
  v_mfma_f32_16x16x32_bf16 v[80:83], a[192:195], v[40:43], v[80:83]
  s_waitcnt vmcnt(10)
  v_mfma_f32_16x16x32_bf16 v[80:83], a[212:215], v[44:47], v[80:83]
  buffer_load_dwordx4 v[40:43], v2, s[12:15], s82 offen offset:2048 sc1
  v_mfma_f32_16x16x32_bf16 v[76:79], a[208:211], v[44:47], v[76:79]
  ds_write_b32 v16, v93 offset:22532
  v_mfma_f32_16x16x32_bf16 v[72:75], a[204:207], v[44:47], v[72:75]
  v_mfma_f32_16x16x32_bf16 v[68:71], a[200:203], v[44:47], v[68:71]
  ds_write_b32 v16, v94 offset:22536
  v_mfma_f32_16x16x32_bf16 v[64:67], a[196:199], v[44:47], v[64:67]
  s_waitcnt vmcnt(10)
  v_mfma_f32_16x16x32_bf16 v[64:67], a[216:219], v[48:51], v[64:67]
  buffer_load_dwordx4 v[44:47], v2, s[12:15], s82 offen offset:3072 sc1
  v_mfma_f32_16x16x32_bf16 v[68:71], a[220:223], v[48:51], v[68:71]
  ds_write_b32 v16, v95 offset:22540
  v_mfma_f32_16x16x32_bf16 v[72:75], a[224:227], v[48:51], v[72:75]
  v_mfma_f32_16x16x32_bf16 v[76:79], a[228:231], v[48:51], v[76:79]
  ds_write_b32 v16, v88 offset:21504
  v_mfma_f32_16x16x32_bf16 v[80:83], a[232:235], v[48:51], v[80:83]
  s_waitcnt vmcnt(10)
  v_mfma_f32_16x16x32_bf16 v[80:83], a[252:255], v[52:55], v[80:83]
  buffer_load_dwordx4 v[48:51], v2, s[12:15], s72 offen offset:0 sc1
  v_mfma_f32_16x16x32_bf16 v[76:79], a[248:251], v[52:55], v[76:79]
  ds_write_b32 v16, v89 offset:21508
  v_mfma_f32_16x16x32_bf16 v[72:75], a[244:247], v[52:55], v[72:75]
  v_mfma_f32_16x16x32_bf16 v[68:71], a[240:243], v[52:55], v[68:71]
  ds_write_b32 v16, v90 offset:21512
  v_mfma_f32_16x16x32_bf16 v[64:67], a[236:239], v[52:55], v[64:67]
  s_waitcnt vmcnt(10)
  v_mfma_f32_16x16x32_bf16 v[64:67], v[116:119], v[56:59], v[64:67]
  buffer_load_dwordx4 v[52:55], v2, s[12:15], s72 offen offset:1024 sc1
  v_mfma_f32_16x16x32_bf16 v[68:71], v[120:123], v[56:59], v[68:71]
  ds_write_b32 v16, v91 offset:21516
  v_mfma_f32_16x16x32_bf16 v[72:75], v[124:127], v[56:59], v[72:75]
  v_mfma_f32_16x16x32_bf16 v[76:79], v[128:131], v[56:59], v[76:79]
  ds_write_b32 v16, v84 offset:20480
  v_mfma_f32_16x16x32_bf16 v[80:83], v[132:135], v[56:59], v[80:83]
  s_waitcnt vmcnt(10)
  v_mfma_f32_16x16x32_bf16 v[80:83], v[152:155], v[60:63], v[80:83]
  buffer_load_dwordx4 v[56:59], v2, s[12:15], s72 offen offset:2048 sc1
  v_mfma_f32_16x16x32_bf16 v[76:79], v[148:151], v[60:63], v[76:79]
  ds_write_b32 v16, v85 offset:20484
  v_mfma_f32_16x16x32_bf16 v[72:75], v[144:147], v[60:63], v[72:75]
  v_mfma_f32_16x16x32_bf16 v[68:71], v[140:143], v[60:63], v[68:71]
  ds_write_b32 v16, v86 offset:20488
  v_mfma_f32_16x16x32_bf16 v[64:67], v[136:139], v[60:63], v[64:67]
  s_waitcnt vmcnt(10)
  v_mfma_f32_16x16x32_bf16 v[64:67], v[156:159], a[80:83], v[64:67]
  buffer_load_dwordx4 v[60:63], v2, s[12:15], s72 offen offset:3072 sc1
  v_mfma_f32_16x16x32_bf16 v[68:71], v[160:163], a[80:83], v[68:71]
  ds_write_b32 v16, v87 offset:20492
  v_mfma_f32_16x16x32_bf16 v[72:75], v[164:167], a[80:83], v[72:75]
  v_mfma_f32_16x16x32_bf16 v[76:79], v[168:171], a[80:83], v[76:79]
  v_mfma_f32_16x16x32_bf16 v[80:83], v[172:175], a[80:83], v[80:83]
  s_waitcnt vmcnt(10)
  s_waitcnt lgkmcnt(0)
  s_barrier
  v_mfma_f32_16x16x32_bf16 v[80:83], a[16:19], a[84:87], v[80:83]
  buffer_load_dwordx4 a[80:83], v2, s[12:15], s73 offen offset:0 sc1
  v_mfma_f32_16x16x32_bf16 v[76:79], a[12:15], a[84:87], v[76:79]
  ds_read_b128 v[84:87], v14 offset:20480
  v_mfma_f32_16x16x32_bf16 v[72:75], a[8:11], a[84:87], v[72:75]
  ds_read_b128 v[88:91], v14 offset:21504
  v_mfma_f32_16x16x32_bf16 v[68:71], a[4:7], a[84:87], v[68:71]
  ds_read_b128 v[92:95], v14 offset:22528
  v_mfma_f32_16x16x32_bf16 v[64:67], a[0:3], a[84:87], v[64:67]
  s_waitcnt vmcnt(10)
  ds_read_b128 v[96:99], v14 offset:23552
  ds_read_b128 v[100:103], v14 offset:24576
  v_mfma_f32_16x16x32_bf16 v[64:67], a[20:23], a[88:91], v[64:67]
  buffer_load_dwordx4 a[84:87], v2, s[12:15], s73 offen offset:1024 sc1
  v_mfma_f32_16x16x32_bf16 v[68:71], a[24:27], a[88:91], v[68:71]
  v_mfma_f32_16x16x32_bf16 v[72:75], a[28:31], a[88:91], v[72:75]
  v_mfma_f32_16x16x32_bf16 v[76:79], a[32:35], a[88:91], v[76:79]
  v_mfma_f32_16x16x32_bf16 v[80:83], a[36:39], a[88:91], v[80:83]
  s_waitcnt vmcnt(10)
  v_mfma_f32_16x16x32_bf16 v[80:83], a[56:59], a[92:95], v[80:83]
  buffer_load_dwordx4 a[88:91], v2, s[12:15], s73 offen offset:2048 sc1
  v_mfma_f32_16x16x32_bf16 v[76:79], a[52:55], a[92:95], v[76:79]
  v_mfma_f32_16x16x32_bf16 v[72:75], a[48:51], a[92:95], v[72:75]
  v_mfma_f32_16x16x32_bf16 v[68:71], a[44:47], a[92:95], v[68:71]
  v_mfma_f32_16x16x32_bf16 v[64:67], a[40:43], a[92:95], v[64:67]
  s_waitcnt vmcnt(10)
  s_waitcnt lgkmcnt(4)
  v_mfma_f32_16x16x32_bf16 v[84:87], a[96:99], v[32:35], v[84:87]
  s_waitcnt lgkmcnt(3)
  buffer_load_dwordx4 a[92:95], v2, s[12:15], s73 offen offset:3072 sc1
  v_mfma_f32_16x16x32_bf16 v[88:91], a[100:103], v[32:35], v[88:91]
  s_waitcnt lgkmcnt(2)
  s_mov_b32 s62, 26214400
  buffer_load_dword v19, v18, s[12:15], s62 offen sc1
  v_mfma_f32_16x16x32_bf16 v[92:95], a[104:107], v[32:35], v[92:95]
  s_waitcnt lgkmcnt(1)
  v_mfma_f32_16x16x32_bf16 v[96:99], a[108:111], v[32:35], v[96:99]
  s_waitcnt lgkmcnt(0)
  ds_write_b32 v15, v80 offset:45056
  v_mfma_f32_16x16x32_bf16 v[100:103], a[112:115], v[32:35], v[100:103]
  s_waitcnt vmcnt(11)
  ds_write_b32 v15, v81 offset:45060
  v_mfma_f32_16x16x32_bf16 v[100:103], a[132:135], v[36:39], v[100:103]
  buffer_load_dwordx4 v[32:35], v2, s[12:15], s74 offen offset:0 sc1
  v_mfma_f32_16x16x32_bf16 v[96:99], a[128:131], v[36:39], v[96:99]
  ds_write_b32 v15, v82 offset:45064
  v_mfma_f32_16x16x32_bf16 v[92:95], a[124:127], v[36:39], v[92:95]
  ds_write_b32 v15, v83 offset:45068
  v_mfma_f32_16x16x32_bf16 v[88:91], a[120:123], v[36:39], v[88:91]
  ds_write_b32 v15, v76 offset:44032
  v_mfma_f32_16x16x32_bf16 v[84:87], a[116:119], v[36:39], v[84:87]
  s_waitcnt vmcnt(11)
  ds_write_b32 v15, v77 offset:44036
  v_mfma_f32_16x16x32_bf16 v[84:87], a[136:139], v[40:43], v[84:87]
  buffer_load_dwordx4 v[36:39], v2, s[12:15], s76 offen offset:1024 sc1
  v_mfma_f32_16x16x32_bf16 v[88:91], a[140:143], v[40:43], v[88:91]
  ds_write_b32 v15, v78 offset:44040
  v_mfma_f32_16x16x32_bf16 v[92:95], a[144:147], v[40:43], v[92:95]
  ds_write_b32 v15, v79 offset:44044
  v_mfma_f32_16x16x32_bf16 v[96:99], a[148:151], v[40:43], v[96:99]
  ds_write_b32 v15, v72 offset:43008
  v_mfma_f32_16x16x32_bf16 v[100:103], a[152:155], v[40:43], v[100:103]
  s_waitcnt vmcnt(11)
  ds_write_b32 v15, v73 offset:43012
  v_mfma_f32_16x16x32_bf16 v[100:103], a[172:175], v[44:47], v[100:103]
  ds_write_b32 v15, v74 offset:43016
  v_mfma_f32_16x16x32_bf16 v[96:99], a[168:171], v[44:47], v[96:99]
  ds_write_b32 v15, v75 offset:43020
  v_mfma_f32_16x16x32_bf16 v[92:95], a[164:167], v[44:47], v[92:95]
  ds_write_b32 v15, v68 offset:41984
  v_mfma_f32_16x16x32_bf16 v[88:91], a[160:163], v[44:47], v[88:91]
  ds_write_b32 v15, v69 offset:41988
  v_mfma_f32_16x16x32_bf16 v[84:87], a[156:159], v[44:47], v[84:87]
  s_waitcnt vmcnt(10)
  ds_write_b32 v15, v70 offset:41992
  v_mfma_f32_16x16x32_bf16 v[84:87], a[176:179], v[48:51], v[84:87]
  ds_write_b32 v15, v71 offset:41996
  v_mfma_f32_16x16x32_bf16 v[88:91], a[180:183], v[48:51], v[88:91]
  ds_write_b32 v15, v64 offset:40960
  v_mfma_f32_16x16x32_bf16 v[92:95], a[184:187], v[48:51], v[92:95]
  ds_write_b32 v15, v65 offset:40964
  v_mfma_f32_16x16x32_bf16 v[96:99], a[188:191], v[48:51], v[96:99]
  ds_write_b32 v15, v66 offset:40968
  v_mfma_f32_16x16x32_bf16 v[100:103], a[192:195], v[48:51], v[100:103]
  s_waitcnt vmcnt(9)
  ds_write_b32 v15, v67 offset:40972
  v_mfma_f32_16x16x32_bf16 v[100:103], a[212:215], v[52:55], v[100:103]
  v_mfma_f32_16x16x32_bf16 v[96:99], a[208:211], v[52:55], v[96:99]
  v_mfma_f32_16x16x32_bf16 v[92:95], a[204:207], v[52:55], v[92:95]
  s_waitcnt lgkmcnt(0)
  s_barrier
  ds_read_b128 v[64:67], v14 offset:40960
  v_mfma_f32_16x16x32_bf16 v[88:91], a[200:203], v[52:55], v[88:91]
  ds_read_b128 v[68:71], v14 offset:41984
  v_mfma_f32_16x16x32_bf16 v[84:87], a[196:199], v[52:55], v[84:87]
  s_waitcnt vmcnt(8)
  ds_read_b128 v[72:75], v14 offset:43008
  ds_read_b128 v[76:79], v14 offset:44032
  v_mfma_f32_16x16x32_bf16 v[84:87], a[216:219], v[56:59], v[84:87]
  ds_read_b128 v[80:83], v14 offset:45056
  v_mfma_f32_16x16x32_bf16 v[88:91], a[220:223], v[56:59], v[88:91]
  v_mfma_f32_16x16x32_bf16 v[92:95], a[224:227], v[56:59], v[92:95]
  v_mfma_f32_16x16x32_bf16 v[96:99], a[228:231], v[56:59], v[96:99]
  v_mfma_f32_16x16x32_bf16 v[100:103], a[232:235], v[56:59], v[100:103]
  s_waitcnt vmcnt(7)
  v_mfma_f32_16x16x32_bf16 v[100:103], a[252:255], v[60:63], v[100:103]
  v_mfma_f32_16x16x32_bf16 v[96:99], a[248:251], v[60:63], v[96:99]
  s_waitcnt vmcnt(2)
  v_cmp_ne_u32 vcc, s61, v19
  v_mfma_f32_16x16x32_bf16 v[92:95], a[244:247], v[60:63], v[92:95]
  v_mfma_f32_16x16x32_bf16 v[88:91], a[240:243], v[60:63], v[88:91]
  s_cbranch_vccnz L_slow_23
L_back_24:
  v_mfma_f32_16x16x32_bf16 v[84:87], a[236:239], v[60:63], v[84:87]
  buffer_load_dwordx4 a[96:99], v5, s[12:15], s77 offen offset:2048 sc1
  v_mfma_f32_16x16x32_bf16 v[84:87], v[116:119], a[80:83], v[84:87]
  v_mfma_f32_16x16x32_bf16 v[84:87], v[136:139], a[84:87], v[84:87]
  v_mfma_f32_16x16x32_bf16 v[84:87], v[156:159], a[88:91], v[84:87]
  v_mfma_f32_16x16x32_bf16 v[84:87], a[0:3], a[92:95], v[84:87]
  s_waitcnt vmcnt(2)
  buffer_load_dwordx4 a[100:103], v5, s[12:15], s77 offen offset:3072 sc1
  v_mfma_f32_16x16x32_bf16 v[84:87], a[20:23], v[32:35], v[84:87]
  s_waitcnt vmcnt(2)
  v_mfma_f32_16x16x32_bf16 v[84:87], a[40:43], v[36:39], v[84:87]
  v_mfma_f32_16x16x32_bf16 v[88:91], v[120:123], a[80:83], v[88:91]
  v_mfma_f32_16x16x32_bf16 v[88:91], v[140:143], a[84:87], v[88:91]
  buffer_load_dwordx4 a[104:107], v5, s[12:15], s78 offen offset:0 sc1
  v_mfma_f32_16x16x32_bf16 v[88:91], v[160:163], a[88:91], v[88:91]
  v_mfma_f32_16x16x32_bf16 v[88:91], a[4:7], a[92:95], v[88:91]
  v_mfma_f32_16x16x32_bf16 v[88:91], a[24:27], v[32:35], v[88:91]
  v_mfma_f32_16x16x32_bf16 v[88:91], a[44:47], v[36:39], v[88:91]
  buffer_load_dwordx4 a[108:111], v5, s[12:15], s78 offen offset:1024 sc1
  v_mfma_f32_16x16x32_bf16 v[92:95], v[124:127], a[80:83], v[92:95]
  v_mfma_f32_16x16x32_bf16 v[92:95], v[144:147], a[84:87], v[92:95]
  s_waitcnt lgkmcnt(4)
  v_add_f32 v84, v84, v64
  v_add_f32 v85, v85, v65
  v_mfma_f32_16x16x32_bf16 v[92:95], v[164:167], a[88:91], v[92:95]
  v_add_f32 v86, v86, v66
  v_add_f32 v87, v87, v67
  v_mfma_f32_16x16x32_bf16 v[92:95], a[8:11], a[92:95], v[92:95]
  buffer_load_dwordx2 a[112:113], v27, s[12:15], s78 offen offset:2048 sc1
  v_mfma_f32_16x16x32_bf16 v[92:95], a[28:31], v[32:35], v[92:95]
  buffer_load_dwordx2 a[114:115], v27, s[12:15], s78 offen offset:2560 sc1
  v_mfma_f32_16x16x32_bf16 v[92:95], a[48:51], v[36:39], v[92:95]
  v_mul_f32 v64, 0xbfb8aa3b, v84
  v_mul_f32 v65, 0xbfb8aa3b, v85
  v_mfma_f32_16x16x32_bf16 v[96:99], v[128:131], a[80:83], v[96:99]
  v_mul_f32 v66, 0xbfb8aa3b, v86
  v_mul_f32 v67, 0xbfb8aa3b, v87
  v_mfma_f32_16x16x32_bf16 v[96:99], v[148:151], a[84:87], v[96:99]
  s_waitcnt lgkmcnt(3)
  buffer_load_dwordx4 a[116:119], v4, s[12:15], s77 offen offset:2048 sc1
  v_mfma_f32_16x16x32_bf16 v[96:99], v[168:171], a[88:91], v[96:99]
  v_exp_f32 v64, v64
  v_mfma_f32_16x16x32_bf16 v[96:99], a[12:15], a[92:95], v[96:99]
  v_exp_f32 v65, v65
  v_mfma_f32_16x16x32_bf16 v[96:99], a[32:35], v[32:35], v[96:99]
  v_exp_f32 v66, v66
  v_mfma_f32_16x16x32_bf16 v[96:99], a[52:55], v[36:39], v[96:99]
  buffer_load_dwordx4 a[120:123], v4, s[12:15], s77 offen offset:3072 sc1
  v_mfma_f32_16x16x32_bf16 v[100:103], v[132:135], a[80:83], v[100:103]
  v_exp_f32 v67, v67
  v_mfma_f32_16x16x32_bf16 v[100:103], v[152:155], a[84:87], v[100:103]
  v_add_f32 v64, 1.0, v64
  v_add_f32 v65, 1.0, v65
  v_mfma_f32_16x16x32_bf16 v[100:103], v[172:175], a[88:91], v[100:103]
  v_add_f32 v66, 1.0, v66
  v_add_f32 v67, 1.0, v67
  v_mfma_f32_16x16x32_bf16 v[100:103], a[16:19], a[92:95], v[100:103]
  buffer_load_dwordx4 a[124:127], v4, s[12:15], s78 offen offset:0 sc1
  v_mfma_f32_16x16x32_bf16 v[100:103], a[36:39], v[32:35], v[100:103]
  v_rcp_f32 v64, v64
  v_mfma_f32_16x16x32_bf16 v[100:103], a[56:59], v[36:39], v[100:103]
  s_waitcnt vmcnt(8)
  v_rcp_f32 v65, v65
  v_mfma_f32_16x16x32_bf16 v[116:119], a[60:63], a[96:99], 0
  s_waitcnt vmcnt(7)
  v_rcp_f32 v66, v66
  v_mfma_f32_16x16x32_bf16 v[116:119], v[176:179], a[100:103], v[116:119]
  s_waitcnt vmcnt(6)
  buffer_load_dwordx4 a[128:131], v4, s[12:15], s78 offen offset:1024 sc1
  v_mfma_f32_16x16x32_bf16 v[116:119], v[196:199], a[104:107], v[116:119]
  s_waitcnt vmcnt(6)
  v_rcp_f32 v67, v67
  v_mfma_f32_16x16x32_bf16 v[116:119], v[216:219], a[108:111], v[116:119]
  s_waitcnt vmcnt(4)
  v_mul_f32 v84, v84, v64
  v_mul_f32 v85, v85, v65
  v_mfma_f32_16x16x32_bf16 v[116:119], v[236:239], a[112:115], v[116:119]
  v_mul_f32 v86, v86, v66
  v_mul_f32 v87, v87, v67
  v_mfma_f32_16x16x32_bf16 v[120:123], a[64:67], a[96:99], 0
  s_waitcnt lgkmcnt(2)
  buffer_load_dwordx2 a[132:133], v26, s[12:15], s78 offen offset:2048 sc1
  v_mfma_f32_16x16x32_bf16 v[120:123], v[180:183], a[100:103], v[120:123]
  buffer_load_dwordx2 a[134:135], v26, s[12:15], s78 offen offset:2560 sc1
  v_mfma_f32_16x16x32_bf16 v[120:123], v[200:203], a[104:107], v[120:123]
  v_add_f32 v92, v92, v72
  v_add_f32 v93, v93, v73
  v_mfma_f32_16x16x32_bf16 v[120:123], v[220:223], a[108:111], v[120:123]
  v_add_f32 v94, v94, v74
  v_add_f32 v95, v95, v75
  v_mfma_f32_16x16x32_bf16 v[120:123], v[240:243], a[112:115], v[120:123]
  buffer_load_dwordx4 a[136:139], v3, s[12:15], s77 offen offset:2048 sc1
  v_mfma_f32_16x16x32_bf16 v[124:127], a[68:71], a[96:99], 0
  v_mul_f32 v72, 0xbfb8aa3b, v92
  v_mul_f32 v73, 0xbfb8aa3b, v93
  v_mfma_f32_16x16x32_bf16 v[124:127], v[184:187], a[100:103], v[124:127]
  v_mul_f32 v74, 0xbfb8aa3b, v94
  v_mul_f32 v75, 0xbfb8aa3b, v95
  v_mfma_f32_16x16x32_bf16 v[124:127], v[204:207], a[104:107], v[124:127]
  ds_write_b128 v16, v[116:119] offset:0
  v_mfma_f32_16x16x32_bf16 v[124:127], v[224:227], a[108:111], v[124:127]
  buffer_load_dwordx4 a[140:143], v3, s[12:15], s77 offen offset:3072 sc1
  v_mfma_f32_16x16x32_bf16 v[124:127], v[244:247], a[112:115], v[124:127]
  v_exp_f32 v72, v72
  v_mfma_f32_16x16x32_bf16 v[128:131], a[72:75], a[96:99], 0
  v_exp_f32 v73, v73
  v_mfma_f32_16x16x32_bf16 v[128:131], v[188:191], a[100:103], v[128:131]
  v_exp_f32 v74, v74
  v_mfma_f32_16x16x32_bf16 v[128:131], v[208:211], a[104:107], v[128:131]
  buffer_load_dwordx4 a[144:147], v3, s[12:15], s78 offen offset:0 sc1
  v_mfma_f32_16x16x32_bf16 v[128:131], v[228:231], a[108:111], v[128:131]
  ds_write_b128 v16, v[120:123] offset:1024
  v_mfma_f32_16x16x32_bf16 v[128:131], v[248:251], a[112:115], v[128:131]
  v_exp_f32 v75, v75
  v_mfma_f32_16x16x32_bf16 v[132:135], a[76:79], a[96:99], 0
  v_add_f32 v72, 1.0, v72
  v_add_f32 v73, 1.0, v73
  v_mfma_f32_16x16x32_bf16 v[132:135], v[192:195], a[100:103], v[132:135]
  buffer_load_dwordx4 a[148:151], v3, s[12:15], s78 offen offset:1024 sc1
  v_mfma_f32_16x16x32_bf16 v[132:135], v[212:215], a[104:107], v[132:135]
  ds_write_b128 v16, v[124:127] offset:2048
  v_mfma_f32_16x16x32_bf16 v[132:135], v[232:235], a[108:111], v[132:135]
  v_add_f32 v74, 1.0, v74
  v_add_f32 v75, 1.0, v75
  v_mfma_f32_16x16x32_bf16 v[132:135], v[252:255], a[112:115], v[132:135]
  s_waitcnt vmcnt(9)
  v_rcp_f32 v72, v72
  v_mfma_f32_16x16x32_bf16 v[136:139], a[60:63], a[116:119], 0
  s_waitcnt vmcnt(8)
  buffer_load_dwordx2 a[152:153], v25, s[12:15], s78 offen offset:2048 sc1
  v_mfma_f32_16x16x32_bf16 v[136:139], v[176:179], a[120:123], v[136:139]
  s_waitcnt vmcnt(8)
  buffer_load_dwordx2 a[154:155], v25, s[12:15], s78 offen offset:2560 sc1
  v_mfma_f32_16x16x32_bf16 v[136:139], v[196:199], a[124:127], v[136:139]
  s_waitcnt vmcnt(8)
  ds_write_b128 v16, v[128:131] offset:3072
  v_mfma_f32_16x16x32_bf16 v[136:139], v[216:219], a[128:131], v[136:139]
  s_waitcnt vmcnt(6)
  v_rcp_f32 v73, v73
  v_mfma_f32_16x16x32_bf16 v[136:139], v[236:239], a[132:135], v[136:139]
  buffer_load_dwordx4 a[156:159], v2, s[12:15], s77 offen offset:2048 sc1
  v_mfma_f32_16x16x32_bf16 v[140:143], a[64:67], a[116:119], 0
  v_rcp_f32 v74, v74
  v_mfma_f32_16x16x32_bf16 v[140:143], v[180:183], a[120:123], v[140:143]
  v_rcp_f32 v75, v75
  v_mfma_f32_16x16x32_bf16 v[140:143], v[200:203], a[124:127], v[140:143]
  s_waitcnt lgkmcnt(4)
  ds_write_b128 v16, v[132:135] offset:4096
  v_mfma_f32_16x16x32_bf16 v[140:143], v[220:223], a[128:131], v[140:143]
  buffer_load_dwordx4 a[160:163], v2, s[12:15], s77 offen offset:3072 sc1
  v_mfma_f32_16x16x32_bf16 v[140:143], v[240:243], a[132:135], v[140:143]
  v_add_f32 v100, v100, v80
  v_add_f32 v101, v101, v81
  v_mfma_f32_16x16x32_bf16 v[144:147], a[68:71], a[116:119], 0
  s_waitcnt lgkmcnt(0)
  s_barrier
  ds_read_b128 v[116:119], v14 offset:0
  v_mfma_f32_16x16x32_bf16 v[144:147], v[184:187], a[120:123], v[144:147]
  ds_read_b128 v[120:123], v14 offset:1024
  v_add_f32 v102, v102, v82
  v_mfma_f32_16x16x32_bf16 v[144:147], v[204:207], a[124:127], v[144:147]
  buffer_load_dwordx4 a[164:167], v2, s[12:15], s78 offen offset:0 sc1
  v_mfma_f32_16x16x32_bf16 v[144:147], v[224:227], a[128:131], v[144:147]
  ds_read_b128 v[124:127], v14 offset:2048
  v_add_f32 v103, v103, v83
  v_mfma_f32_16x16x32_bf16 v[144:147], v[244:247], a[132:135], v[144:147]
  ds_read_b128 v[128:131], v14 offset:3072
  v_mul_f32 v80, 0xbfb8aa3b, v100
  v_mfma_f32_16x16x32_bf16 v[148:151], a[72:75], a[116:119], 0
  ds_read_b128 v[132:135], v14 offset:4096
  v_mul_f32 v81, 0xbfb8aa3b, v101
  v_mfma_f32_16x16x32_bf16 v[148:151], v[188:191], a[120:123], v[148:151]
  buffer_load_dwordx4 a[168:171], v2, s[12:15], s78 offen offset:1024 sc1
  v_mfma_f32_16x16x32_bf16 v[148:151], v[208:211], a[124:127], v[148:151]
  ds_write_b128 v16, v[136:139] offset:20480
  v_mfma_f32_16x16x32_bf16 v[148:151], v[228:231], a[128:131], v[148:151]
  v_mul_f32 v82, 0xbfb8aa3b, v102
  v_mul_f32 v83, 0xbfb8aa3b, v103
  v_mfma_f32_16x16x32_bf16 v[148:151], v[248:251], a[132:135], v[148:151]
  ds_write_b128 v16, v[140:143] offset:21504
  v_mfma_f32_16x16x32_bf16 v[152:155], a[76:79], a[116:119], 0
  buffer_load_dwordx2 a[172:173], v24, s[12:15], s78 offen offset:2048 sc1
  v_mfma_f32_16x16x32_bf16 v[152:155], v[192:195], a[120:123], v[152:155]
  buffer_load_dwordx2 a[174:175], v24, s[12:15], s78 offen offset:2560 sc1
  v_mfma_f32_16x16x32_bf16 v[152:155], v[212:215], a[124:127], v[152:155]
  ds_write_b128 v16, v[144:147] offset:22528
  v_mfma_f32_16x16x32_bf16 v[152:155], v[232:235], a[128:131], v[152:155]
  v_exp_f32 v80, v80
  v_mfma_f32_16x16x32_bf16 v[152:155], v[252:255], a[132:135], v[152:155]
  s_waitcnt vmcnt(11)
  s_waitcnt lgkmcnt(7)
  v_add_f32 v88, v88, v68
  v_mfma_f32_16x16x32_bf16 v[116:119], a[60:63], a[136:139], v[116:119]
  s_waitcnt vmcnt(10)
  v_exp_f32 v81, v81
  v_mfma_f32_16x16x32_bf16 v[116:119], v[176:179], a[140:143], v[116:119]
  s_waitcnt vmcnt(9)
  v_exp_f32 v82, v82
  v_mfma_f32_16x16x32_bf16 v[116:119], v[196:199], a[144:147], v[116:119]
  s_waitcnt vmcnt(8)
  ds_write_b128 v16, v[148:151] offset:23552
  v_mfma_f32_16x16x32_bf16 v[116:119], v[216:219], a[148:151], v[116:119]
  s_waitcnt vmcnt(6)
  v_exp_f32 v83, v83
  v_mfma_f32_16x16x32_bf16 v[116:119], v[236:239], a[152:155], v[116:119]
  s_waitcnt lgkmcnt(7)
  v_add_f32 v80, 1.0, v80
  v_add_f32 v81, 1.0, v81
  v_mfma_f32_16x16x32_bf16 v[120:123], a[64:67], a[136:139], v[120:123]
  v_add_f32 v82, 1.0, v82
  v_add_f32 v83, 1.0, v83
  v_mfma_f32_16x16x32_bf16 v[120:123], v[180:183], a[140:143], v[120:123]
  buffer_load_dwordx4 v[104:107], v8, s[8:11], s70 offen
  v_mfma_f32_16x16x32_bf16 v[120:123], v[200:203], a[144:147], v[120:123]
  ds_write_b128 v16, v[152:155] offset:24576
  v_mfma_f32_16x16x32_bf16 v[120:123], v[220:223], a[148:151], v[120:123]
  v_rcp_f32 v80, v80
  v_mfma_f32_16x16x32_bf16 v[120:123], v[240:243], a[152:155], v[120:123]
  s_waitcnt lgkmcnt(7)
  v_rcp_f32 v81, v81
  v_mfma_f32_16x16x32_bf16 v[124:127], a[68:71], a[136:139], v[124:127]
  s_waitcnt lgkmcnt(0)
  s_barrier
  ds_read_b128 v[136:139], v14 offset:20480
  v_mfma_f32_16x16x32_bf16 v[124:127], v[184:187], a[140:143], v[124:127]
  buffer_load_dwordx4 v[108:111], v9, s[8:11], s70 offen
  v_mfma_f32_16x16x32_bf16 v[124:127], v[204:207], a[144:147], v[124:127]
  ds_read_b128 v[140:143], v14 offset:21504
  v_add_f32 v89, v89, v69
  v_mfma_f32_16x16x32_bf16 v[124:127], v[224:227], a[148:151], v[124:127]
  ds_read_b128 v[144:147], v14 offset:22528
  v_add_f32 v90, v90, v70
  v_mfma_f32_16x16x32_bf16 v[124:127], v[244:247], a[152:155], v[124:127]
  ds_read_b128 v[148:151], v14 offset:23552
  v_add_f32 v91, v91, v71
  v_mfma_f32_16x16x32_bf16 v[128:131], a[72:75], a[136:139], v[128:131]
  ds_read_b128 v[152:155], v14 offset:24576
  v_mul_f32 v68, 0xbfb8aa3b, v88
  v_mfma_f32_16x16x32_bf16 v[128:131], v[188:191], a[140:143], v[128:131]
  buffer_load_dwordx4 v[112:115], v10, s[8:11], s70 offen
  v_mfma_f32_16x16x32_bf16 v[128:131], v[208:211], a[144:147], v[128:131]
  ds_write_b128 v15, v[116:119] offset:40960
  v_mfma_f32_16x16x32_bf16 v[128:131], v[228:231], a[148:151], v[128:131]
  v_rcp_f32 v82, v82
  v_mfma_f32_16x16x32_bf16 v[128:131], v[248:251], a[152:155], v[128:131]
  ds_write_b128 v15, v[120:123] offset:41984
  v_mfma_f32_16x16x32_bf16 v[132:135], a[76:79], a[136:139], v[132:135]
  buffer_store_dword v21, v20, s[12:15], 0 offen sc1
  v_mfma_f32_16x16x32_bf16 v[132:135], v[192:195], a[140:143], v[132:135]
  v_rcp_f32 v83, v83
  v_mfma_f32_16x16x32_bf16 v[132:135], v[212:215], a[144:147], v[132:135]
  ds_write_b128 v15, v[124:127] offset:43008
  v_mfma_f32_16x16x32_bf16 v[132:135], v[232:235], a[148:151], v[132:135]
  v_mul_f32 v69, 0xbfb8aa3b, v89
  v_mul_f32 v70, 0xbfb8aa3b, v90
  v_mfma_f32_16x16x32_bf16 v[132:135], v[252:255], a[152:155], v[132:135]
  s_waitcnt vmcnt(9)
  s_waitcnt lgkmcnt(7)
  v_mul_f32 v71, 0xbfb8aa3b, v91
  v_mfma_f32_16x16x32_bf16 v[136:139], a[60:63], a[156:159], v[136:139]
  s_waitcnt vmcnt(8)
  v_exp_f32 v68, v68
  v_mfma_f32_16x16x32_bf16 v[136:139], v[176:179], a[160:163], v[136:139]
  s_waitcnt vmcnt(7)
  v_exp_f32 v69, v69
  v_mfma_f32_16x16x32_bf16 v[136:139], v[196:199], a[164:167], v[136:139]
  s_waitcnt vmcnt(6)
  ds_write_b128 v15, v[128:131] offset:44032
  v_mfma_f32_16x16x32_bf16 v[136:139], v[216:219], a[168:171], v[136:139]
  s_waitcnt vmcnt(4)
  v_exp_f32 v70, v70
  v_mfma_f32_16x16x32_bf16 v[136:139], v[236:239], a[172:175], v[136:139]
  s_waitcnt lgkmcnt(7)
  v_exp_f32 v71, v71
  v_mfma_f32_16x16x32_bf16 v[140:143], a[64:67], a[156:159], v[140:143]
  v_add_f32 v68, 1.0, v68
  v_add_f32 v69, 1.0, v69
  v_mfma_f32_16x16x32_bf16 v[140:143], v[180:183], a[160:163], v[140:143]
  v_add_f32 v70, 1.0, v70
  v_add_f32 v71, 1.0, v71
  v_mfma_f32_16x16x32_bf16 v[140:143], v[200:203], a[164:167], v[140:143]
  ds_write_b128 v15, v[132:135] offset:45056
  v_mfma_f32_16x16x32_bf16 v[140:143], v[220:223], a[168:171], v[140:143]
  v_rcp_f32 v68, v68
  v_mfma_f32_16x16x32_bf16 v[140:143], v[240:243], a[172:175], v[140:143]
  s_waitcnt lgkmcnt(7)
  v_rcp_f32 v69, v69
  v_mfma_f32_16x16x32_bf16 v[144:147], a[68:71], a[156:159], v[144:147]
  s_waitcnt lgkmcnt(0)
  s_barrier
  ds_read_b128 v[116:119], v14 offset:40960
  v_mfma_f32_16x16x32_bf16 v[144:147], v[184:187], a[160:163], v[144:147]
  ds_read_b128 v[120:123], v14 offset:41984
  v_mfma_f32_16x16x32_bf16 v[144:147], v[204:207], a[164:167], v[144:147]
  ds_read_b128 v[124:127], v14 offset:43008
  v_mfma_f32_16x16x32_bf16 v[144:147], v[224:227], a[168:171], v[144:147]
  ds_read_b128 v[128:131], v14 offset:44032
  v_mfma_f32_16x16x32_bf16 v[144:147], v[244:247], a[172:175], v[144:147]
  ds_read_b128 v[132:135], v14 offset:45056
  v_mfma_f32_16x16x32_bf16 v[148:151], a[72:75], a[156:159], v[148:151]
  v_rcp_f32 v70, v70
  v_mfma_f32_16x16x32_bf16 v[148:151], v[188:191], a[160:163], v[148:151]
  v_rcp_f32 v71, v71
  v_mfma_f32_16x16x32_bf16 v[148:151], v[208:211], a[164:167], v[148:151]
  v_add_f32 v96, v96, v76
  v_add_f32 v97, v97, v77
  v_mfma_f32_16x16x32_bf16 v[148:151], v[228:231], a[168:171], v[148:151]
  v_add_f32 v98, v98, v78
  v_add_f32 v99, v99, v79
  v_mfma_f32_16x16x32_bf16 v[148:151], v[248:251], a[172:175], v[148:151]
  v_mul_f32 v76, 0xbfb8aa3b, v96
  v_mul_f32 v77, 0xbfb8aa3b, v97
  v_mfma_f32_16x16x32_bf16 v[152:155], a[76:79], a[156:159], v[152:155]
  v_mul_f32 v78, 0xbfb8aa3b, v98
  v_mul_f32 v79, 0xbfb8aa3b, v99
  v_mfma_f32_16x16x32_bf16 v[152:155], v[192:195], a[160:163], v[152:155]
  v_exp_f32 v76, v76
  v_mfma_f32_16x16x32_bf16 v[152:155], v[212:215], a[164:167], v[152:155]
  v_exp_f32 v77, v77
  v_mfma_f32_16x16x32_bf16 v[152:155], v[232:235], a[168:171], v[152:155]
  v_exp_f32 v78, v78
  v_mfma_f32_16x16x32_bf16 v[152:155], v[252:255], a[172:175], v[152:155]
  v_exp_f32 v79, v79
  v_add_f32 v76, 1.0, v76
  v_add_f32 v77, 1.0, v77
  v_add_f32 v78, 1.0, v78
  v_add_f32 v79, 1.0, v79
  v_rcp_f32 v76, v76
  v_rcp_f32 v77, v77
  v_rcp_f32 v78, v78
  v_rcp_f32 v79, v79
  s_nop 0
  v_pk_mul_f32 v[88:89], v[88:89], v[68:69]
  v_pk_mul_f32 v[90:91], v[90:91], v[70:71]
  v_pk_mul_f32 v[92:93], v[92:93], v[72:73]
  v_pk_mul_f32 v[94:95], v[94:95], v[74:75]
  v_pk_mul_f32 v[96:97], v[96:97], v[76:77]
  v_pk_mul_f32 v[98:99], v[98:99], v[78:79]
  v_pk_mul_f32 v[100:101], v[100:101], v[80:81]
  v_pk_mul_f32 v[102:103], v[102:103], v[82:83]
  s_waitcnt lgkmcnt(0)
  v_pk_add_f32 v[136:137], v[136:137], v[116:117]
  v_pk_add_f32 v[138:139], v[138:139], v[118:119]
  v_pk_add_f32 v[140:141], v[140:141], v[120:121]
  v_pk_add_f32 v[142:143], v[142:143], v[122:123]
  v_pk_add_f32 v[144:145], v[144:145], v[124:125]
  v_pk_add_f32 v[146:147], v[146:147], v[126:127]
  v_pk_add_f32 v[148:149], v[148:149], v[128:129]
  v_pk_add_f32 v[150:151], v[150:151], v[130:131]
  v_pk_add_f32 v[152:153], v[152:153], v[132:133]
  v_pk_add_f32 v[154:155], v[154:155], v[134:135]
  v_pk_mul_f32 v[136:137], v[136:137], v[84:85]
  v_pk_mul_f32 v[138:139], v[138:139], v[86:87]
  v_pk_mul_f32 v[140:141], v[140:141], v[88:89]
  v_pk_mul_f32 v[142:143], v[142:143], v[90:91]
  v_pk_mul_f32 v[144:145], v[144:145], v[92:93]
  v_pk_mul_f32 v[146:147], v[146:147], v[94:95]
  v_pk_mul_f32 v[148:149], v[148:149], v[96:97]
  v_pk_mul_f32 v[150:151], v[150:151], v[98:99]
  v_pk_mul_f32 v[152:153], v[152:153], v[100:101]
  v_pk_mul_f32 v[154:155], v[154:155], v[102:103]
  ds_write_b128 v28, v[136:139] offset:0
  ds_write_b128 v28, v[140:143] offset:64
  ds_write_b128 v28, v[144:147] offset:128
  ds_write_b128 v28, v[148:151] offset:192
  ds_write_b128 v28, v[152:155] offset:256
  ds_read_b128 v[32:35], v11
  ds_read_b128 v[36:39], v11 offset:16
  ds_read_b128 v[40:43], v12
  ds_read_b128 v[44:47], v12 offset:16
  ds_read_b128 v[48:51], v13
  ds_read_b128 v[52:55], v13 offset:16
  s_waitcnt vmcnt(1)
  s_waitcnt lgkmcnt(4)
  v_dot2c_f32_bf16 v32, v104, v29
  v_dot2c_f32_bf16 v33, v104, v30
  v_dot2c_f32_bf16 v34, v105, v29
  v_dot2c_f32_bf16 v35, v105, v30
  v_dot2c_f32_bf16 v36, v106, v29
  v_dot2c_f32_bf16 v37, v106, v30
  v_dot2c_f32_bf16 v38, v107, v29
  v_dot2c_f32_bf16 v39, v107, v30
  s_nop 0
  v_cvt_pk_bf16_f32 v104, v32, v33
  v_cvt_pk_bf16_f32 v105, v34, v35
  v_cvt_pk_bf16_f32 v106, v36, v37
  v_cvt_pk_bf16_f32 v107, v38, v39
  buffer_store_dwordx4 v[104:107], v8, s[16:19], s70 offen
  s_waitcnt lgkmcnt(2)
  v_dot2c_f32_bf16 v40, v108, v29
  v_dot2c_f32_bf16 v41, v108, v30
  v_dot2c_f32_bf16 v42, v109, v29
  v_dot2c_f32_bf16 v43, v109, v30
  v_dot2c_f32_bf16 v44, v110, v29
  v_dot2c_f32_bf16 v45, v110, v30
  v_dot2c_f32_bf16 v46, v111, v29
  v_dot2c_f32_bf16 v47, v111, v30
  s_nop 0
  v_cvt_pk_bf16_f32 v108, v40, v41
  v_cvt_pk_bf16_f32 v109, v42, v43
  v_cvt_pk_bf16_f32 v110, v44, v45
  v_cvt_pk_bf16_f32 v111, v46, v47
  buffer_store_dwordx4 v[108:111], v9, s[16:19], s70 offen
  s_waitcnt lgkmcnt(0)
  v_dot2c_f32_bf16 v48, v112, v29
  v_dot2c_f32_bf16 v49, v112, v30
  v_dot2c_f32_bf16 v50, v113, v29
  v_dot2c_f32_bf16 v51, v113, v30
  v_dot2c_f32_bf16 v52, v114, v29
  v_dot2c_f32_bf16 v53, v114, v30
  v_dot2c_f32_bf16 v54, v115, v29
  v_dot2c_f32_bf16 v55, v115, v30
  s_nop 0
  v_cvt_pk_bf16_f32 v112, v48, v49
  v_cvt_pk_bf16_f32 v113, v50, v51
  v_cvt_pk_bf16_f32 v114, v52, v53
  v_cvt_pk_bf16_f32 v115, v54, v55
  buffer_store_dwordx4 v[112:115], v10, s[16:19], s70 offen
  s_endpgm
L_slow_23:
  s_mov_b32 s59, 131072
  s_branch L_first_26
L_spin_25:
  s_sleep 2
L_first_26:
  s_mov_b32 s62, 26214400
  buffer_load_dword v19, v18, s[12:15], s62 offen sc1
  s_waitcnt vmcnt(0)
  v_cmp_ne_u32 vcc, s61, v19
  s_sub_u32 s59, s59, 1
  s_cbranch_scc1 L_back_24
  s_cbranch_vccnz L_spin_25
  s_branch L_back_24
L_slow_8:
  s_mov_b32 s59, 131072
  s_branch L_first_28
L_spin_27:
  s_sleep 2
L_first_28:
  buffer_load_dwordx4 v[40:43], v38, s[12:15], s64 offen sc1
  buffer_load_dwordx4 v[44:47], v38, s[12:15], s65 offen sc1
  buffer_load_dwordx2 v[48:49], v62, s[12:15], s66 offen sc1
  s_waitcnt vmcnt(0)
  v_xor_b32 v39, s61, v43
  v_bitop3_b32 v39, v47, s61, v39 bitop3:0xbe
  v_bitop3_b32 v39, v49, s61, v39 bitop3:0xbe
  v_cmp_ne_u32 vcc, 0, v39
  s_sub_u32 s59, s59, 1
  s_cbranch_scc1 L_back_9
  s_cbranch_vccnz L_spin_27
  s_branch L_back_9
L_slow_10:
  s_mov_b32 s59, 131072
  s_branch L_first_30
L_spin_29:
  s_sleep 2
L_first_30:
  s_mov_b32 s62, 22020096
  buffer_load_dword v39, v38, s[12:15], s62 offen sc1
  s_waitcnt vmcnt(0)
  v_cmp_ne_u32 vcc, s61, v39
  s_sub_u32 s59, s59, 1
  s_cbranch_scc1 L_back_11
  s_cbranch_vccnz L_spin_29
  s_branch L_back_11
L_slow_12:
  s_mov_b32 s59, 131072
  s_branch L_first_32
L_spin_31:
  s_sleep 2
L_first_32:
  s_mov_b32 s62, 24117248
  buffer_load_dword v39, v38, s[12:15], s62 offen sc1
  s_waitcnt vmcnt(0)
  v_cmp_ne_u32 vcc, s61, v39
  s_sub_u32 s59, s59, 1
  s_cbranch_scc1 L_back_13
  s_cbranch_vccnz L_spin_31
  s_branch L_back_13
L_slow_14:
  s_mov_b32 s59, 131072
  s_branch L_first_34
L_spin_33:
  s_sleep 2
L_first_34:
  s_mov_b32 s62, 26214400
  buffer_load_dword v39, v38, s[12:15], s62 offen sc1
  s_waitcnt vmcnt(0)
  v_cmp_ne_u32 vcc, s61, v39
  s_sub_u32 s59, s59, 1
  s_cbranch_scc1 L_back_15
  s_cbranch_vccnz L_spin_33
  s_branch L_back_15
L_slow_16:
  s_mov_b32 s59, 131072
  s_branch L_first_36
L_spin_35:
  s_sleep 2
L_first_36:
  s_mov_b32 s62, 28311552
  buffer_load_dword v39, v38, s[12:15], s62 offen sc1
  s_waitcnt vmcnt(0)
  v_cmp_ne_u32 vcc, s61, v39
  s_sub_u32 s59, s59, 1
  s_cbranch_scc1 L_back_17
  s_cbranch_vccnz L_spin_35
  s_branch L_back_17
L_touch4:
  s_mov_b64 exec, 0
  s_cmp_eq_u32 s3, 0
  s_cbranch_scc1 L_hop_p2c0
  s_cmp_eq_u32 s3, 1
  s_cbranch_scc1 L_ret4
  s_cmp_eq_u32 s3, 2
  s_cbranch_scc1 L_ret4
  s_cmp_eq_u32 s3, 3
  s_cbranch_scc1 L_ret4
L_ret4:
  s_mov_b64 exec, -1
  s_cmp_eq_u32 s6, 2
  s_cbranch_scc1 L_qback
  s_branch L_kvback
L_p2c:
  v_mfma_f32_16x16x32_bf16 v[64:67], a[96:99], a[80:83], 0
  v_lshlrev_b32 v6, 4, v0
  s_xor_b32 s64, s3, 0
  v_mfma_f32_16x16x32_bf16 v[68:71], a[100:103], a[80:83], 0
  s_mul_i32 s64, s64, 77824
  v_add_u32 v2, s64, v6
  s_xor_b32 s64, s3, 1
  v_mfma_f32_16x16x32_bf16 v[72:75], a[104:107], a[80:83], 0
  s_mul_i32 s64, s64, 77824
  v_add_u32 v3, s64, v6
  s_xor_b32 s64, s3, 2
  v_mfma_f32_16x16x32_bf16 v[76:79], a[108:111], a[80:83], 0
  s_mul_i32 s64, s64, 77824
  v_add_u32 v4, s64, v6
  s_xor_b32 s64, s3, 3
  v_mfma_f32_16x16x32_bf16 v[80:83], a[112:115], a[80:83], 0
  s_mul_i32 s64, s64, 77824
  v_add_u32 v5, s64, v6
  s_add_u32 s72, s82, 4096
  v_mfma_f32_16x16x32_bf16 v[80:83], a[132:135], a[84:87], v[80:83]
  s_add_u32 s73, s82, 8192
  s_add_u32 s74, s82, 12288
  s_add_u32 s75, s82, 16384
  v_mfma_f32_16x16x32_bf16 v[76:79], a[128:131], a[84:87], v[76:79]
  v_add_u32 v7, s48, v6
  v_mov_b32 v17, s61
  v_mfma_f32_16x16x32_bf16 v[72:75], a[124:127], a[84:87], v[72:75]
  s_mov_b32 s62, 26214400
  buffer_load_dwordx4 a[80:83], v5, s[12:15], s74 offen offset:0 sc1
  v_mfma_f32_16x16x32_bf16 v[68:71], a[120:123], a[84:87], v[68:71]
  s_and_b32 s76, s3, 2
  ds_read_b128 v[116:119], v7 offset:0
  s_mul_i32 s76, s76, 19456
  v_mfma_f32_16x16x32_bf16 v[64:67], a[116:119], a[84:87], v[64:67]
  s_sub_u32 s76, s74, s76
  ds_read_b128 v[120:123], v7 offset:1024
  s_add_u32 s77, s74, 0
  v_mfma_f32_16x16x32_bf16 v[64:67], a[136:139], a[88:91], v[64:67]
  s_add_u32 s78, s75, 0
  buffer_load_dwordx4 a[84:87], v4, s[12:15], s82 offen offset:0 sc1
  v_mfma_f32_16x16x32_bf16 v[68:71], a[140:143], a[88:91], v[68:71]
  s_xor_b32 s64, s3, 0
  ds_read_b128 v[124:127], v7 offset:2048
  ds_read_b128 v[128:131], v7 offset:3072
  v_mfma_f32_16x16x32_bf16 v[72:75], a[144:147], a[88:91], v[72:75]
  s_mul_i32 s65, s64, 5120
  ds_read_b128 v[132:135], v7 offset:4096
  s_add_u32 s65, s65, 65536
  v_mfma_f32_16x16x32_bf16 v[76:79], a[148:151], a[88:91], v[76:79]
  ds_read_b128 v[136:139], v7 offset:5120
  v_add_u32 v14, s65, v6
  v_mfma_f32_16x16x32_bf16 v[80:83], a[152:155], a[88:91], v[80:83]
  s_mul_i32 s64, s64, 77824
  ds_read_b128 v[140:143], v7 offset:6144
  v_lshl_add_u32 v24, v0, 3, s64
  v_mfma_f32_16x16x32_bf16 v[80:83], a[172:175], a[92:95], v[80:83]
  s_xor_b32 s64, s3, 1
  buffer_load_dwordx4 a[88:91], v4, s[12:15], s82 offen offset:1024 sc1
  v_mfma_f32_16x16x32_bf16 v[76:79], a[168:171], a[92:95], v[76:79]
  s_mul_i32 s65, s64, 5120
  ds_read_b128 v[144:147], v7 offset:7168
  ds_read_b128 v[148:151], v7 offset:32768
  v_mfma_f32_16x16x32_bf16 v[72:75], a[164:167], a[92:95], v[72:75]
  s_add_u32 s65, s65, 65536
  ds_read_b128 v[152:155], v7 offset:33792
  v_add_u32 v15, s65, v6
  v_mfma_f32_16x16x32_bf16 v[68:71], a[160:163], a[92:95], v[68:71]
  s_mul_i32 s64, s64, 77824
  ds_read_b128 v[156:159], v7 offset:34816
  v_lshl_add_u32 v25, v0, 3, s64
  v_mfma_f32_16x16x32_bf16 v[64:67], a[156:159], a[92:95], v[64:67]
  s_xor_b32 s64, s3, 2
  ds_read_b128 v[160:163], v7 offset:35840
  s_mul_i32 s65, s64, 5120
  v_mfma_f32_16x16x32_bf16 v[64:67], a[176:179], v[32:35], v[64:67]
  s_add_u32 s65, s65, 65536
  buffer_load_dwordx4 a[92:95], v4, s[12:15], s82 offen offset:2048 sc1
  v_mfma_f32_16x16x32_bf16 v[68:71], a[180:183], v[32:35], v[68:71]
  ds_read_b128 v[164:167], v7 offset:36864
  v_add_u32 v16, s65, v6
  v_mfma_f32_16x16x32_bf16 v[72:75], a[184:187], v[32:35], v[72:75]
  s_mul_i32 s64, s64, 77824
  ds_read_b128 v[168:171], v7 offset:37888
  ds_read_b128 v[172:175], v7 offset:38912
  v_mfma_f32_16x16x32_bf16 v[76:79], a[188:191], v[32:35], v[76:79]
  v_lshl_add_u32 v26, v0, 3, s64
  s_xor_b32 s64, s3, 3
  v_mfma_f32_16x16x32_bf16 v[80:83], a[192:195], v[32:35], v[80:83]
  s_mul_i32 s64, s64, 77824
  v_lshl_add_u32 v27, v0, 3, s64
  s_mul_i32 s64, s3, 5376
  v_mfma_f32_16x16x32_bf16 v[80:83], a[212:215], v[36:39], v[80:83]
  s_add_u32 s64, s64, 131072
  buffer_load_dwordx4 v[32:35], v4, s[12:15], s82 offen offset:3072 sc1
  v_mfma_f32_16x16x32_bf16 v[76:79], a[208:211], v[36:39], v[76:79]
  v_add_u32 v20, 0, v0
  v_mul_u32_u24 v21, 205, v20
  v_mfma_f32_16x16x32_bf16 v[72:75], a[204:207], v[36:39], v[72:75]
  v_lshrrev_b32 v21, 11, v21
  v_mul_u32_u24 v22, 10, v21
  v_mfma_f32_16x16x32_bf16 v[68:71], a[200:203], v[36:39], v[68:71]
  v_sub_u32 v22, v20, v22
  v_mul_u32_u24 v23, 1280, v21
  v_mfma_f32_16x16x32_bf16 v[64:67], a[196:199], v[36:39], v[64:67]
  v_lshl_add_u32 v8, v22, 4, v23
  v_mul_u32_u24 v23, 336, v21
  v_mfma_f32_16x16x32_bf16 v[64:67], a[216:219], v[40:43], v[64:67]
  buffer_load_dwordx4 v[36:39], v4, s[12:15], s72 offen offset:0 sc1
  v_mfma_f32_16x16x32_bf16 v[68:71], a[220:223], v[40:43], v[68:71]
  v_lshl_add_u32 v23, v22, 5, v23
  v_add_u32 v11, s64, v23
  v_mfma_f32_16x16x32_bf16 v[72:75], a[224:227], v[40:43], v[72:75]
  v_add_u32 v20, 64, v0
  v_mul_u32_u24 v21, 205, v20
  v_mfma_f32_16x16x32_bf16 v[76:79], a[228:231], v[40:43], v[76:79]
  v_lshrrev_b32 v21, 11, v21
  v_mul_u32_u24 v22, 10, v21
  v_mfma_f32_16x16x32_bf16 v[80:83], a[232:235], v[40:43], v[80:83]
  v_sub_u32 v22, v20, v22
  v_mul_u32_u24 v23, 1280, v21
  v_mfma_f32_16x16x32_bf16 v[80:83], a[252:255], v[44:47], v[80:83]
  buffer_load_dwordx4 v[40:43], v4, s[12:15], s72 offen offset:1024 sc1
  v_mfma_f32_16x16x32_bf16 v[76:79], a[248:251], v[44:47], v[76:79]
  v_lshl_add_u32 v9, v22, 4, v23
  v_mul_u32_u24 v23, 336, v21
  v_mfma_f32_16x16x32_bf16 v[72:75], a[244:247], v[44:47], v[72:75]
  v_lshl_add_u32 v23, v22, 5, v23
  v_add_u32 v12, s64, v23
  v_mfma_f32_16x16x32_bf16 v[68:71], a[240:243], v[44:47], v[68:71]
  s_waitcnt lgkmcnt(0)
  v_add_u32 v20, 128, v0
  v_mul_u32_u24 v21, 205, v20
  v_mfma_f32_16x16x32_bf16 v[64:67], a[236:239], v[44:47], v[64:67]
  v_lshrrev_b32 v21, 11, v21
  v_mul_u32_u24 v22, 10, v21
  v_mfma_f32_16x16x32_bf16 v[64:67], v[116:119], v[48:51], v[64:67]
  buffer_load_dwordx4 v[44:47], v4, s[12:15], s72 offen offset:2048 sc1
  v_mfma_f32_16x16x32_bf16 v[68:71], v[120:123], v[48:51], v[68:71]
  v_sub_u32 v22, v20, v22
  v_mul_u32_u24 v23, 1280, v21
  v_mfma_f32_16x16x32_bf16 v[72:75], v[124:127], v[48:51], v[72:75]
  v_lshl_add_u32 v10, v22, 4, v23
  v_mul_u32_u24 v23, 336, v21
  v_mfma_f32_16x16x32_bf16 v[76:79], v[128:131], v[48:51], v[76:79]
  v_lshl_add_u32 v23, v22, 5, v23
  v_add_u32 v13, s64, v23
  v_mfma_f32_16x16x32_bf16 v[80:83], v[132:135], v[48:51], v[80:83]
  v_and_b32 v20, 15, v0
  v_mul_u32_u24 v20, 336, v20
  v_mfma_f32_16x16x32_bf16 v[80:83], v[152:155], v[52:55], v[80:83]
  buffer_load_dwordx4 v[48:51], v4, s[12:15], s72 offen offset:3072 sc1
  v_mfma_f32_16x16x32_bf16 v[76:79], v[148:151], v[52:55], v[76:79]
  v_lshrrev_b32 v21, 4, v0
  v_lshl_add_u32 v20, v21, 4, v20
  v_mfma_f32_16x16x32_bf16 v[72:75], v[144:147], v[52:55], v[72:75]
  v_add_u32 v28, s64, v20
  v_lshrrev_b32 v20, 5, v0
  v_mfma_f32_16x16x32_bf16 v[68:71], v[140:143], v[52:55], v[68:71]
  v_lshl_add_u32 v10, v20, 30, v10
  v_mov_b32 v29, 0x00003f80
  v_mfma_f32_16x16x32_bf16 v[64:67], v[136:139], v[52:55], v[64:67]
  v_mov_b32 v30, 0x3f800000
  s_lshl_b32 s64, s80, 2
  v_mfma_f32_16x16x32_bf16 v[64:67], v[156:159], v[56:59], v[64:67]
  s_add_u32 s64, s64, s3
  buffer_load_dwordx4 v[52:55], v4, s[12:15], s73 offen offset:0 sc1
  v_mfma_f32_16x16x32_bf16 v[68:71], v[160:163], v[56:59], v[68:71]
  s_mul_i32 s70, s64, 20480
  s_mul_i32 s64, s81, 160
  s_add_u32 s70, s70, s64
  v_mfma_f32_16x16x32_bf16 v[72:75], v[164:167], v[56:59], v[72:75]
  v_lshrrev_b32 v18, 2, v0
  v_min_u32 v18, 11, v18
  v_mfma_f32_16x16x32_bf16 v[76:79], v[168:171], v[56:59], v[76:79]
  s_add_u32 s71, s71, 18
  v_add_lshl_u32 v18, v18, s71, 7
  v_mfma_f32_16x16x32_bf16 v[80:83], v[172:175], v[56:59], v[80:83]
  v_mfma_f32_16x16x32_bf16 v[80:83], a[16:19], v[60:63], v[80:83]
  buffer_load_dwordx4 v[56:59], v4, s[12:15], s73 offen offset:1024 sc1
  v_mfma_f32_16x16x32_bf16 v[76:79], a[12:15], v[60:63], v[76:79]
  s_waitcnt vmcnt(11)
  s_barrier
  v_mfma_f32_16x16x32_bf16 v[72:75], a[8:11], v[60:63], v[72:75]
  buffer_store_dword v17, v1, s[12:15], s62 offen sc1
  v_mfma_f32_16x16x32_bf16 v[68:71], a[4:7], v[60:63], v[68:71]
  v_mfma_f32_16x16x32_bf16 v[64:67], a[0:3], v[60:63], v[64:67]
  s_waitcnt vmcnt(11)
  v_mfma_f32_16x16x32_bf16 v[64:67], a[20:23], a[80:83], v[64:67]
  buffer_load_dwordx4 v[60:63], v4, s[12:15], s73 offen offset:2048 sc1
  v_mfma_f32_16x16x32_bf16 v[68:71], a[24:27], a[80:83], v[68:71]
  v_mfma_f32_16x16x32_bf16 v[72:75], a[28:31], a[80:83], v[72:75]
  v_mfma_f32_16x16x32_bf16 v[76:79], a[32:35], a[80:83], v[76:79]
  v_mfma_f32_16x16x32_bf16 v[80:83], a[36:39], a[80:83], v[80:83]
  s_waitcnt vmcnt(11)
  v_mfma_f32_16x16x32_bf16 v[100:103], a[112:115], a[84:87], 0
  buffer_load_dwordx4 a[80:83], v4, s[12:15], s73 offen offset:3072 sc1
  v_mfma_f32_16x16x32_bf16 v[96:99], a[108:111], a[84:87], 0
  v_mfma_f32_16x16x32_bf16 v[92:95], a[104:107], a[84:87], 0
  v_mfma_f32_16x16x32_bf16 v[88:91], a[100:103], a[84:87], 0
  ds_write_b32 v16, v64 offset:0
  v_mfma_f32_16x16x32_bf16 v[84:87], a[96:99], a[84:87], 0
  s_waitcnt vmcnt(11)
  v_mfma_f32_16x16x32_bf16 v[84:87], a[116:119], a[88:91], v[84:87]
  buffer_load_dwordx4 a[84:87], v4, s[12:15], s74 offen offset:0 sc1
  v_mfma_f32_16x16x32_bf16 v[88:91], a[120:123], a[88:91], v[88:91]
  ds_write_b32 v16, v65 offset:4
  v_mfma_f32_16x16x32_bf16 v[92:95], a[124:127], a[88:91], v[92:95]
  v_mfma_f32_16x16x32_bf16 v[96:99], a[128:131], a[88:91], v[96:99]
  ds_write_b32 v16, v66 offset:8
  v_mfma_f32_16x16x32_bf16 v[100:103], a[132:135], a[88:91], v[100:103]
  s_waitcnt vmcnt(11)
  v_mfma_f32_16x16x32_bf16 v[100:103], a[152:155], a[92:95], v[100:103]
  buffer_load_dwordx4 a[88:91], v3, s[12:15], s82 offen offset:0 sc1
  v_mfma_f32_16x16x32_bf16 v[96:99], a[148:151], a[92:95], v[96:99]
  ds_write_b32 v16, v67 offset:12
  v_mfma_f32_16x16x32_bf16 v[92:95], a[144:147], a[92:95], v[92:95]
  v_mfma_f32_16x16x32_bf16 v[88:91], a[140:143], a[92:95], v[88:91]
  ds_write_b32 v16, v68 offset:1024
  v_mfma_f32_16x16x32_bf16 v[84:87], a[136:139], a[92:95], v[84:87]
  s_waitcnt vmcnt(11)
  v_mfma_f32_16x16x32_bf16 v[84:87], a[156:159], v[32:35], v[84:87]
  buffer_load_dwordx4 a[92:95], v3, s[12:15], s82 offen offset:1024 sc1
  v_mfma_f32_16x16x32_bf16 v[88:91], a[160:163], v[32:35], v[88:91]
  ds_write_b32 v16, v69 offset:1028
  v_mfma_f32_16x16x32_bf16 v[92:95], a[164:167], v[32:35], v[92:95]
  v_mfma_f32_16x16x32_bf16 v[96:99], a[168:171], v[32:35], v[96:99]
  ds_write_b32 v16, v70 offset:1032
  v_mfma_f32_16x16x32_bf16 v[100:103], a[172:175], v[32:35], v[100:103]
  s_waitcnt vmcnt(11)
  v_mfma_f32_16x16x32_bf16 v[100:103], a[192:195], v[36:39], v[100:103]
  buffer_load_dwordx4 v[32:35], v3, s[12:15], s82 offen offset:2048 sc1
  v_mfma_f32_16x16x32_bf16 v[96:99], a[188:191], v[36:39], v[96:99]
  ds_write_b32 v16, v71 offset:1036
  v_mfma_f32_16x16x32_bf16 v[92:95], a[184:187], v[36:39], v[92:95]
  v_mfma_f32_16x16x32_bf16 v[88:91], a[180:183], v[36:39], v[88:91]
  ds_write_b32 v16, v72 offset:2048
  v_mfma_f32_16x16x32_bf16 v[84:87], a[176:179], v[36:39], v[84:87]
  s_waitcnt vmcnt(11)
  v_mfma_f32_16x16x32_bf16 v[84:87], a[196:199], v[40:43], v[84:87]
  buffer_load_dwordx4 v[36:39], v3, s[12:15], s82 offen offset:3072 sc1
  v_mfma_f32_16x16x32_bf16 v[88:91], a[200:203], v[40:43], v[88:91]
  ds_write_b32 v16, v73 offset:2052
  v_mfma_f32_16x16x32_bf16 v[92:95], a[204:207], v[40:43], v[92:95]
  v_mfma_f32_16x16x32_bf16 v[96:99], a[208:211], v[40:43], v[96:99]
  ds_write_b32 v16, v74 offset:2056
  v_mfma_f32_16x16x32_bf16 v[100:103], a[212:215], v[40:43], v[100:103]
  s_waitcnt vmcnt(11)
  v_mfma_f32_16x16x32_bf16 v[100:103], a[232:235], v[44:47], v[100:103]
  buffer_load_dwordx4 v[40:43], v3, s[12:15], s72 offen offset:0 sc1
  v_mfma_f32_16x16x32_bf16 v[96:99], a[228:231], v[44:47], v[96:99]
  ds_write_b32 v16, v75 offset:2060
  v_mfma_f32_16x16x32_bf16 v[92:95], a[224:227], v[44:47], v[92:95]
  v_mfma_f32_16x16x32_bf16 v[88:91], a[220:223], v[44:47], v[88:91]
  ds_write_b32 v16, v76 offset:3072
  v_mfma_f32_16x16x32_bf16 v[84:87], a[216:219], v[44:47], v[84:87]
  s_waitcnt vmcnt(11)
  v_mfma_f32_16x16x32_bf16 v[84:87], a[236:239], v[48:51], v[84:87]
  buffer_load_dwordx4 v[44:47], v3, s[12:15], s72 offen offset:1024 sc1
  v_mfma_f32_16x16x32_bf16 v[88:91], a[240:243], v[48:51], v[88:91]
  ds_write_b32 v16, v77 offset:3076
  v_mfma_f32_16x16x32_bf16 v[92:95], a[244:247], v[48:51], v[92:95]
  v_mfma_f32_16x16x32_bf16 v[96:99], a[248:251], v[48:51], v[96:99]
  ds_write_b32 v16, v78 offset:3080
  v_mfma_f32_16x16x32_bf16 v[100:103], a[252:255], v[48:51], v[100:103]
  s_waitcnt vmcnt(11)
  v_mfma_f32_16x16x32_bf16 v[100:103], v[132:135], v[52:55], v[100:103]
  buffer_load_dwordx4 v[48:51], v3, s[12:15], s72 offen offset:2048 sc1
  v_mfma_f32_16x16x32_bf16 v[96:99], v[128:131], v[52:55], v[96:99]
  ds_write_b32 v16, v79 offset:3084
  v_mfma_f32_16x16x32_bf16 v[92:95], v[124:127], v[52:55], v[92:95]
  v_mfma_f32_16x16x32_bf16 v[88:91], v[120:123], v[52:55], v[88:91]
  ds_write_b32 v16, v80 offset:4096
  v_mfma_f32_16x16x32_bf16 v[84:87], v[116:119], v[52:55], v[84:87]
  s_waitcnt vmcnt(11)
  v_mfma_f32_16x16x32_bf16 v[84:87], v[136:139], v[56:59], v[84:87]
  buffer_load_dwordx4 v[52:55], v3, s[12:15], s72 offen offset:3072 sc1
  v_mfma_f32_16x16x32_bf16 v[88:91], v[140:143], v[56:59], v[88:91]
  ds_write_b32 v16, v81 offset:4100
  v_mfma_f32_16x16x32_bf16 v[92:95], v[144:147], v[56:59], v[92:95]
  v_mfma_f32_16x16x32_bf16 v[96:99], v[148:151], v[56:59], v[96:99]
  ds_write_b32 v16, v82 offset:4104
  v_mfma_f32_16x16x32_bf16 v[100:103], v[152:155], v[56:59], v[100:103]
  s_waitcnt vmcnt(10)
  v_mfma_f32_16x16x32_bf16 v[100:103], v[172:175], v[60:63], v[100:103]
  buffer_load_dwordx4 v[56:59], v3, s[12:15], s73 offen offset:0 sc1
  v_mfma_f32_16x16x32_bf16 v[96:99], v[168:171], v[60:63], v[96:99]
  ds_write_b32 v16, v83 offset:4108
  v_mfma_f32_16x16x32_bf16 v[92:95], v[164:167], v[60:63], v[92:95]
  v_mfma_f32_16x16x32_bf16 v[88:91], v[160:163], v[60:63], v[88:91]
  v_mfma_f32_16x16x32_bf16 v[84:87], v[156:159], v[60:63], v[84:87]
  s_waitcnt vmcnt(10)
  s_waitcnt lgkmcnt(0)
  s_barrier
  v_mfma_f32_16x16x32_bf16 v[84:87], a[0:3], a[80:83], v[84:87]
  buffer_load_dwordx4 v[60:63], v3, s[12:15], s73 offen offset:1024 sc1
  v_mfma_f32_16x16x32_bf16 v[88:91], a[4:7], a[80:83], v[88:91]
  ds_read_b128 v[64:67], v14 offset:0
  v_mfma_f32_16x16x32_bf16 v[92:95], a[8:11], a[80:83], v[92:95]
  ds_read_b128 v[68:71], v14 offset:1024
  v_mfma_f32_16x16x32_bf16 v[96:99], a[12:15], a[80:83], v[96:99]
  ds_read_b128 v[72:75], v14 offset:2048
  v_mfma_f32_16x16x32_bf16 v[100:103], a[16:19], a[80:83], v[100:103]
  s_waitcnt vmcnt(10)
  ds_read_b128 v[76:79], v14 offset:3072
  ds_read_b128 v[80:83], v14 offset:4096
  v_mfma_f32_16x16x32_bf16 v[100:103], a[36:39], a[84:87], v[100:103]
  buffer_load_dwordx4 a[80:83], v3, s[12:15], s73 offen offset:2048 sc1
  v_mfma_f32_16x16x32_bf16 v[96:99], a[32:35], a[84:87], v[96:99]
  v_mfma_f32_16x16x32_bf16 v[92:95], a[28:31], a[84:87], v[92:95]
  v_mfma_f32_16x16x32_bf16 v[88:91], a[24:27], a[84:87], v[88:91]
  v_mfma_f32_16x16x32_bf16 v[84:87], a[20:23], a[84:87], v[84:87]
  s_waitcnt vmcnt(10)
  s_waitcnt lgkmcnt(4)
  v_mfma_f32_16x16x32_bf16 v[64:67], a[96:99], a[88:91], v[64:67]
  s_waitcnt lgkmcnt(3)
  buffer_load_dwordx4 a[84:87], v3, s[12:15], s73 offen offset:3072 sc1
  v_mfma_f32_16x16x32_bf16 v[68:71], a[100:103], a[88:91], v[68:71]
  s_waitcnt lgkmcnt(2)
  v_mfma_f32_16x16x32_bf16 v[72:75], a[104:107], a[88:91], v[72:75]
  s_waitcnt lgkmcnt(1)
  v_mfma_f32_16x16x32_bf16 v[76:79], a[108:111], a[88:91], v[76:79]
  s_waitcnt lgkmcnt(0)
  ds_write_b32 v16, v100 offset:24576
  v_mfma_f32_16x16x32_bf16 v[80:83], a[112:115], a[88:91], v[80:83]
  s_waitcnt vmcnt(10)
  v_mfma_f32_16x16x32_bf16 v[80:83], a[132:135], a[92:95], v[80:83]
  buffer_load_dwordx4 a[88:91], v3, s[12:15], s74 offen offset:0 sc1
  v_mfma_f32_16x16x32_bf16 v[76:79], a[128:131], a[92:95], v[76:79]
  ds_write_b32 v16, v101 offset:24580
  v_mfma_f32_16x16x32_bf16 v[72:75], a[124:127], a[92:95], v[72:75]
  v_mfma_f32_16x16x32_bf16 v[68:71], a[120:123], a[92:95], v[68:71]
  ds_write_b32 v16, v102 offset:24584
  v_mfma_f32_16x16x32_bf16 v[64:67], a[116:119], a[92:95], v[64:67]
  s_waitcnt vmcnt(10)
  v_mfma_f32_16x16x32_bf16 v[64:67], a[136:139], v[32:35], v[64:67]
  buffer_load_dwordx4 a[92:95], v3, s[12:15], s76 offen offset:1024 sc1
  v_mfma_f32_16x16x32_bf16 v[68:71], a[140:143], v[32:35], v[68:71]
  ds_write_b32 v16, v103 offset:24588
  v_mfma_f32_16x16x32_bf16 v[72:75], a[144:147], v[32:35], v[72:75]
  v_mfma_f32_16x16x32_bf16 v[76:79], a[148:151], v[32:35], v[76:79]
  ds_write_b32 v16, v96 offset:23552
  v_mfma_f32_16x16x32_bf16 v[80:83], a[152:155], v[32:35], v[80:83]
  s_waitcnt vmcnt(10)
  v_mfma_f32_16x16x32_bf16 v[80:83], a[172:175], v[36:39], v[80:83]
  buffer_load_dwordx4 v[32:35], v2, s[12:15], s82 offen offset:0 sc1
  v_mfma_f32_16x16x32_bf16 v[76:79], a[168:171], v[36:39], v[76:79]
  ds_write_b32 v16, v97 offset:23556
  v_mfma_f32_16x16x32_bf16 v[72:75], a[164:167], v[36:39], v[72:75]
  v_mfma_f32_16x16x32_bf16 v[68:71], a[160:163], v[36:39], v[68:71]
  ds_write_b32 v16, v98 offset:23560
  v_mfma_f32_16x16x32_bf16 v[64:67], a[156:159], v[36:39], v[64:67]
  s_waitcnt vmcnt(10)
  v_mfma_f32_16x16x32_bf16 v[64:67], a[176:179], v[40:43], v[64:67]
  buffer_load_dwordx4 v[36:39], v2, s[12:15], s82 offen offset:1024 sc1
  v_mfma_f32_16x16x32_bf16 v[68:71], a[180:183], v[40:43], v[68:71]
  ds_write_b32 v16, v99 offset:23564
  v_mfma_f32_16x16x32_bf16 v[72:75], a[184:187], v[40:43], v[72:75]
  v_mfma_f32_16x16x32_bf16 v[76:79], a[188:191], v[40:43], v[76:79]
  ds_write_b32 v16, v92 offset:22528
  v_mfma_f32_16x16x32_bf16 v[80:83], a[192:195], v[40:43], v[80:83]
  s_waitcnt vmcnt(10)
  v_mfma_f32_16x16x32_bf16 v[80:83], a[212:215], v[44:47], v[80:83]
  buffer_load_dwordx4 v[40:43], v2, s[12:15], s82 offen offset:2048 sc1
  v_mfma_f32_16x16x32_bf16 v[76:79], a[208:211], v[44:47], v[76:79]
  ds_write_b32 v16, v93 offset:22532
  v_mfma_f32_16x16x32_bf16 v[72:75], a[204:207], v[44:47], v[72:75]
  v_mfma_f32_16x16x32_bf16 v[68:71], a[200:203], v[44:47], v[68:71]
  ds_write_b32 v16, v94 offset:22536
  v_mfma_f32_16x16x32_bf16 v[64:67], a[196:199], v[44:47], v[64:67]
  s_waitcnt vmcnt(10)
  v_mfma_f32_16x16x32_bf16 v[64:67], a[216:219], v[48:51], v[64:67]
  buffer_load_dwordx4 v[44:47], v2, s[12:15], s82 offen offset:3072 sc1
  v_mfma_f32_16x16x32_bf16 v[68:71], a[220:223], v[48:51], v[68:71]
  ds_write_b32 v16, v95 offset:22540
  v_mfma_f32_16x16x32_bf16 v[72:75], a[224:227], v[48:51], v[72:75]
  v_mfma_f32_16x16x32_bf16 v[76:79], a[228:231], v[48:51], v[76:79]
  ds_write_b32 v16, v88 offset:21504
  v_mfma_f32_16x16x32_bf16 v[80:83], a[232:235], v[48:51], v[80:83]
  s_waitcnt vmcnt(10)
  v_mfma_f32_16x16x32_bf16 v[80:83], a[252:255], v[52:55], v[80:83]
  buffer_load_dwordx4 v[48:51], v2, s[12:15], s72 offen offset:0 sc1
  v_mfma_f32_16x16x32_bf16 v[76:79], a[248:251], v[52:55], v[76:79]
  ds_write_b32 v16, v89 offset:21508
  v_mfma_f32_16x16x32_bf16 v[72:75], a[244:247], v[52:55], v[72:75]
  v_mfma_f32_16x16x32_bf16 v[68:71], a[240:243], v[52:55], v[68:71]
  ds_write_b32 v16, v90 offset:21512
  v_mfma_f32_16x16x32_bf16 v[64:67], a[236:239], v[52:55], v[64:67]
  s_waitcnt vmcnt(10)
  v_mfma_f32_16x16x32_bf16 v[64:67], v[116:119], v[56:59], v[64:67]
  buffer_load_dwordx4 v[52:55], v2, s[12:15], s72 offen offset:1024 sc1
  v_mfma_f32_16x16x32_bf16 v[68:71], v[120:123], v[56:59], v[68:71]
  ds_write_b32 v16, v91 offset:21516
  v_mfma_f32_16x16x32_bf16 v[72:75], v[124:127], v[56:59], v[72:75]
  v_mfma_f32_16x16x32_bf16 v[76:79], v[128:131], v[56:59], v[76:79]
  ds_write_b32 v16, v84 offset:20480
  v_mfma_f32_16x16x32_bf16 v[80:83], v[132:135], v[56:59], v[80:83]
  s_waitcnt vmcnt(10)
  v_mfma_f32_16x16x32_bf16 v[80:83], v[152:155], v[60:63], v[80:83]
  buffer_load_dwordx4 v[56:59], v2, s[12:15], s72 offen offset:2048 sc1
  v_mfma_f32_16x16x32_bf16 v[76:79], v[148:151], v[60:63], v[76:79]
  ds_write_b32 v16, v85 offset:20484
  v_mfma_f32_16x16x32_bf16 v[72:75], v[144:147], v[60:63], v[72:75]
  v_mfma_f32_16x16x32_bf16 v[68:71], v[140:143], v[60:63], v[68:71]
  ds_write_b32 v16, v86 offset:20488
  v_mfma_f32_16x16x32_bf16 v[64:67], v[136:139], v[60:63], v[64:67]
  s_waitcnt vmcnt(10)
  v_mfma_f32_16x16x32_bf16 v[64:67], v[156:159], a[80:83], v[64:67]
  buffer_load_dwordx4 v[60:63], v2, s[12:15], s72 offen offset:3072 sc1
  v_mfma_f32_16x16x32_bf16 v[68:71], v[160:163], a[80:83], v[68:71]
  ds_write_b32 v16, v87 offset:20492
  v_mfma_f32_16x16x32_bf16 v[72:75], v[164:167], a[80:83], v[72:75]
  v_mfma_f32_16x16x32_bf16 v[76:79], v[168:171], a[80:83], v[76:79]
  v_mfma_f32_16x16x32_bf16 v[80:83], v[172:175], a[80:83], v[80:83]
  s_waitcnt vmcnt(10)
  s_waitcnt lgkmcnt(0)
  s_barrier
  v_mfma_f32_16x16x32_bf16 v[80:83], a[16:19], a[84:87], v[80:83]
  buffer_load_dwordx4 a[80:83], v2, s[12:15], s73 offen offset:0 sc1
  v_mfma_f32_16x16x32_bf16 v[76:79], a[12:15], a[84:87], v[76:79]
  ds_read_b128 v[84:87], v14 offset:20480
  v_mfma_f32_16x16x32_bf16 v[72:75], a[8:11], a[84:87], v[72:75]
  ds_read_b128 v[88:91], v14 offset:21504
  v_mfma_f32_16x16x32_bf16 v[68:71], a[4:7], a[84:87], v[68:71]
  ds_read_b128 v[92:95], v14 offset:22528
  v_mfma_f32_16x16x32_bf16 v[64:67], a[0:3], a[84:87], v[64:67]
  s_waitcnt vmcnt(10)
  ds_read_b128 v[96:99], v14 offset:23552
  ds_read_b128 v[100:103], v14 offset:24576
  v_mfma_f32_16x16x32_bf16 v[64:67], a[20:23], a[88:91], v[64:67]
  buffer_load_dwordx4 a[84:87], v2, s[12:15], s73 offen offset:1024 sc1
  v_mfma_f32_16x16x32_bf16 v[68:71], a[24:27], a[88:91], v[68:71]
  v_mfma_f32_16x16x32_bf16 v[72:75], a[28:31], a[88:91], v[72:75]
  s_mov_b32 s62, 26214400
  buffer_load_dword v19, v18, s[12:15], s62 offen sc1
  v_mfma_f32_16x16x32_bf16 v[76:79], a[32:35], a[88:91], v[76:79]
  v_mfma_f32_16x16x32_bf16 v[80:83], a[36:39], a[88:91], v[80:83]
  s_waitcnt vmcnt(11)
  v_mfma_f32_16x16x32_bf16 v[80:83], a[56:59], a[92:95], v[80:83]
  buffer_load_dwordx4 a[88:91], v2, s[12:15], s73 offen offset:2048 sc1
  v_mfma_f32_16x16x32_bf16 v[76:79], a[52:55], a[92:95], v[76:79]
  v_mfma_f32_16x16x32_bf16 v[72:75], a[48:51], a[92:95], v[72:75]
  v_mfma_f32_16x16x32_bf16 v[68:71], a[44:47], a[92:95], v[68:71]
  v_mfma_f32_16x16x32_bf16 v[64:67], a[40:43], a[92:95], v[64:67]
  s_waitcnt vmcnt(11)
  s_waitcnt lgkmcnt(4)
  v_mfma_f32_16x16x32_bf16 v[84:87], a[96:99], v[32:35], v[84:87]
  s_waitcnt lgkmcnt(3)
  buffer_load_dwordx4 a[92:95], v2, s[12:15], s73 offen offset:3072 sc1
  v_mfma_f32_16x16x32_bf16 v[88:91], a[100:103], v[32:35], v[88:91]
  s_waitcnt lgkmcnt(2)
  v_mfma_f32_16x16x32_bf16 v[92:95], a[104:107], v[32:35], v[92:95]
  s_waitcnt lgkmcnt(1)
  v_mfma_f32_16x16x32_bf16 v[96:99], a[108:111], v[32:35], v[96:99]
  s_waitcnt lgkmcnt(0)
  ds_write_b32 v15, v80 offset:45056
  v_mfma_f32_16x16x32_bf16 v[100:103], a[112:115], v[32:35], v[100:103]
  s_waitcnt vmcnt(11)
  ds_write_b32 v15, v81 offset:45060
  v_mfma_f32_16x16x32_bf16 v[100:103], a[132:135], v[36:39], v[100:103]
  buffer_load_dwordx4 v[32:35], v2, s[12:15], s74 offen offset:0 sc1
  v_mfma_f32_16x16x32_bf16 v[96:99], a[128:131], v[36:39], v[96:99]
  ds_write_b32 v15, v82 offset:45064
  v_mfma_f32_16x16x32_bf16 v[92:95], a[124:127], v[36:39], v[92:95]
  ds_write_b32 v15, v83 offset:45068
  v_mfma_f32_16x16x32_bf16 v[88:91], a[120:123], v[36:39], v[88:91]
  ds_write_b32 v15, v76 offset:44032
  v_mfma_f32_16x16x32_bf16 v[84:87], a[116:119], v[36:39], v[84:87]
  s_waitcnt vmcnt(11)
  ds_write_b32 v15, v77 offset:44036
  v_mfma_f32_16x16x32_bf16 v[84:87], a[136:139], v[40:43], v[84:87]
  buffer_load_dwordx4 v[36:39], v2, s[12:15], s76 offen offset:1024 sc1
  v_mfma_f32_16x16x32_bf16 v[88:91], a[140:143], v[40:43], v[88:91]
  ds_write_b32 v15, v78 offset:44040
  v_mfma_f32_16x16x32_bf16 v[92:95], a[144:147], v[40:43], v[92:95]
  ds_write_b32 v15, v79 offset:44044
  v_mfma_f32_16x16x32_bf16 v[96:99], a[148:151], v[40:43], v[96:99]
  ds_write_b32 v15, v72 offset:43008
  v_mfma_f32_16x16x32_bf16 v[100:103], a[152:155], v[40:43], v[100:103]
  s_waitcnt vmcnt(11)
  ds_write_b32 v15, v73 offset:43012
  v_mfma_f32_16x16x32_bf16 v[100:103], a[172:175], v[44:47], v[100:103]
  ds_write_b32 v15, v74 offset:43016
  v_mfma_f32_16x16x32_bf16 v[96:99], a[168:171], v[44:47], v[96:99]
  ds_write_b32 v15, v75 offset:43020
  v_mfma_f32_16x16x32_bf16 v[92:95], a[164:167], v[44:47], v[92:95]
  ds_write_b32 v15, v68 offset:41984
  v_mfma_f32_16x16x32_bf16 v[88:91], a[160:163], v[44:47], v[88:91]
  ds_write_b32 v15, v69 offset:41988
  v_mfma_f32_16x16x32_bf16 v[84:87], a[156:159], v[44:47], v[84:87]
  s_waitcnt vmcnt(10)
  ds_write_b32 v15, v70 offset:41992
  v_mfma_f32_16x16x32_bf16 v[84:87], a[176:179], v[48:51], v[84:87]
  ds_write_b32 v15, v71 offset:41996
  v_mfma_f32_16x16x32_bf16 v[88:91], a[180:183], v[48:51], v[88:91]
  ds_write_b32 v15, v64 offset:40960
  v_mfma_f32_16x16x32_bf16 v[92:95], a[184:187], v[48:51], v[92:95]
  ds_write_b32 v15, v65 offset:40964
  v_mfma_f32_16x16x32_bf16 v[96:99], a[188:191], v[48:51], v[96:99]
  ds_write_b32 v15, v66 offset:40968
  v_mfma_f32_16x16x32_bf16 v[100:103], a[192:195], v[48:51], v[100:103]
  s_waitcnt vmcnt(9)
  ds_write_b32 v15, v67 offset:40972
  v_mfma_f32_16x16x32_bf16 v[100:103], a[212:215], v[52:55], v[100:103]
  v_mfma_f32_16x16x32_bf16 v[96:99], a[208:211], v[52:55], v[96:99]
  v_mfma_f32_16x16x32_bf16 v[92:95], a[204:207], v[52:55], v[92:95]
  s_waitcnt lgkmcnt(0)
  s_barrier
  ds_read_b128 v[64:67], v14 offset:40960
  v_mfma_f32_16x16x32_bf16 v[88:91], a[200:203], v[52:55], v[88:91]
  s_waitcnt vmcnt(4)
  ds_read_b128 v[68:71], v14 offset:41984
  ds_read_b128 v[72:75], v14 offset:43008
  v_mfma_f32_16x16x32_bf16 v[84:87], a[196:199], v[52:55], v[84:87]
  ds_read_b128 v[76:79], v14 offset:44032
  v_cmp_ne_u32 vcc, s61, v19
  v_mfma_f32_16x16x32_bf16 v[84:87], a[216:219], v[56:59], v[84:87]
  ds_read_b128 v[80:83], v14 offset:45056
  v_mfma_f32_16x16x32_bf16 v[88:91], a[220:223], v[56:59], v[88:91]
  s_cbranch_vccnz L_slow_37
L_back_38:
  buffer_load_dwordx4 a[96:99], v5, s[12:15], s77 offen offset:2048 sc1
  v_mfma_f32_16x16x32_bf16 v[92:95], a[224:227], v[56:59], v[92:95]
L_hop_p2c0:
  s_cbranch_execz L_ret4
  v_mfma_f32_16x16x32_bf16 v[96:99], a[228:231], v[56:59], v[96:99]
  v_mfma_f32_16x16x32_bf16 v[100:103], a[232:235], v[56:59], v[100:103]
  v_mfma_f32_16x16x32_bf16 v[100:103], a[252:255], v[60:63], v[100:103]
  buffer_load_dwordx4 a[100:103], v5, s[12:15], s77 offen offset:3072 sc1
  v_mfma_f32_16x16x32_bf16 v[96:99], a[248:251], v[60:63], v[96:99]
  v_mfma_f32_16x16x32_bf16 v[92:95], a[244:247], v[60:63], v[92:95]
  v_mfma_f32_16x16x32_bf16 v[88:91], a[240:243], v[60:63], v[88:91]
  v_mfma_f32_16x16x32_bf16 v[84:87], a[236:239], v[60:63], v[84:87]
  buffer_load_dwordx4 a[104:107], v5, s[12:15], s78 offen offset:0 sc1
  v_mfma_f32_16x16x32_bf16 v[84:87], v[116:119], a[80:83], v[84:87]
  v_mfma_f32_16x16x32_bf16 v[84:87], v[136:139], a[84:87], v[84:87]
  s_waitcnt vmcnt(6)
  v_mfma_f32_16x16x32_bf16 v[84:87], v[156:159], a[88:91], v[84:87]
  s_waitcnt vmcnt(5)
  v_mfma_f32_16x16x32_bf16 v[84:87], a[0:3], a[92:95], v[84:87]
  s_waitcnt vmcnt(4)
  buffer_load_dwordx4 a[108:111], v5, s[12:15], s78 offen offset:1024 sc1
  v_mfma_f32_16x16x32_bf16 v[84:87], a[20:23], v[32:35], v[84:87]
  s_waitcnt vmcnt(4)
  v_mfma_f32_16x16x32_bf16 v[84:87], a[40:43], v[36:39], v[84:87]
  v_mfma_f32_16x16x32_bf16 v[88:91], v[120:123], a[80:83], v[88:91]
  v_mfma_f32_16x16x32_bf16 v[88:91], v[140:143], a[84:87], v[88:91]
  buffer_load_dwordx2 a[112:113], v27, s[12:15], s78 offen offset:2048 sc1
  v_mfma_f32_16x16x32_bf16 v[88:91], v[160:163], a[88:91], v[88:91]
  buffer_load_dwordx2 a[114:115], v27, s[12:15], s78 offen offset:2560 sc1
  v_mfma_f32_16x16x32_bf16 v[88:91], a[4:7], a[92:95], v[88:91]
  v_mfma_f32_16x16x32_bf16 v[88:91], a[24:27], v[32:35], v[88:91]
  v_mfma_f32_16x16x32_bf16 v[88:91], a[44:47], v[36:39], v[88:91]
  buffer_load_dwordx4 a[116:119], v4, s[12:15], s77 offen offset:2048 sc1
  v_mfma_f32_16x16x32_bf16 v[92:95], v[124:127], a[80:83], v[92:95]
  v_mfma_f32_16x16x32_bf16 v[92:95], v[144:147], a[84:87], v[92:95]
  s_waitcnt lgkmcnt(4)
  v_add_f32 v84, v84, v64
  v_add_f32 v85, v85, v65
  v_mfma_f32_16x16x32_bf16 v[92:95], v[164:167], a[88:91], v[92:95]
  v_add_f32 v86, v86, v66
  v_add_f32 v87, v87, v67
  v_mfma_f32_16x16x32_bf16 v[92:95], a[8:11], a[92:95], v[92:95]
  buffer_load_dwordx4 a[120:123], v4, s[12:15], s77 offen offset:3072 sc1
  v_mfma_f32_16x16x32_bf16 v[92:95], a[28:31], v[32:35], v[92:95]
  v_mul_f32 v64, 0xbfb8aa3b, v84
  v_mul_f32 v65, 0xbfb8aa3b, v85
  v_mfma_f32_16x16x32_bf16 v[92:95], a[48:51], v[36:39], v[92:95]
  v_mul_f32 v66, 0xbfb8aa3b, v86
  v_mul_f32 v67, 0xbfb8aa3b, v87
  v_mfma_f32_16x16x32_bf16 v[96:99], v[128:131], a[80:83], v[96:99]
  v_exp_f32 v64, v64
  v_mfma_f32_16x16x32_bf16 v[96:99], v[148:151], a[84:87], v[96:99]
  s_waitcnt lgkmcnt(3)
  buffer_load_dwordx4 a[124:127], v4, s[12:15], s78 offen offset:0 sc1
  v_mfma_f32_16x16x32_bf16 v[96:99], v[168:171], a[88:91], v[96:99]
  v_exp_f32 v65, v65
  v_mfma_f32_16x16x32_bf16 v[96:99], a[12:15], a[92:95], v[96:99]
  v_exp_f32 v66, v66
  v_mfma_f32_16x16x32_bf16 v[96:99], a[32:35], v[32:35], v[96:99]
  v_exp_f32 v67, v67
  v_mfma_f32_16x16x32_bf16 v[96:99], a[52:55], v[36:39], v[96:99]
  buffer_load_dwordx4 a[128:131], v4, s[12:15], s78 offen offset:1024 sc1
  v_mfma_f32_16x16x32_bf16 v[100:103], v[132:135], a[80:83], v[100:103]
  v_add_f32 v64, 1.0, v64
  v_add_f32 v65, 1.0, v65
  v_mfma_f32_16x16x32_bf16 v[100:103], v[152:155], a[84:87], v[100:103]
  v_add_f32 v66, 1.0, v66
  v_add_f32 v67, 1.0, v67
  v_mfma_f32_16x16x32_bf16 v[100:103], v[172:175], a[88:91], v[100:103]
  v_rcp_f32 v64, v64
  v_mfma_f32_16x16x32_bf16 v[100:103], a[16:19], a[92:95], v[100:103]
  buffer_load_dwordx2 a[132:133], v26, s[12:15], s78 offen offset:2048 sc1
  v_mfma_f32_16x16x32_bf16 v[100:103], a[36:39], v[32:35], v[100:103]
  buffer_load_dwordx2 a[134:135], v26, s[12:15], s78 offen offset:2560 sc1
  v_mfma_f32_16x16x32_bf16 v[100:103], a[56:59], v[36:39], v[100:103]
  s_waitcnt vmcnt(11)
  v_rcp_f32 v65, v65
  v_mfma_f32_16x16x32_bf16 v[116:119], a[60:63], a[96:99], 0
  s_waitcnt vmcnt(10)
  v_rcp_f32 v66, v66
  v_mfma_f32_16x16x32_bf16 v[116:119], v[176:179], a[100:103], v[116:119]
  s_waitcnt vmcnt(9)
  buffer_load_dwordx4 a[136:139], v3, s[12:15], s77 offen offset:2048 sc1
  v_mfma_f32_16x16x32_bf16 v[116:119], v[196:199], a[104:107], v[116:119]
  s_waitcnt vmcnt(9)
  v_rcp_f32 v67, v67
  v_mfma_f32_16x16x32_bf16 v[116:119], v[216:219], a[108:111], v[116:119]
  s_waitcnt vmcnt(7)
  v_mul_f32 v84, v84, v64
  v_mul_f32 v85, v85, v65
  v_mfma_f32_16x16x32_bf16 v[116:119], v[236:239], a[112:115], v[116:119]
  v_mul_f32 v86, v86, v66
  v_mul_f32 v87, v87, v67
  v_mfma_f32_16x16x32_bf16 v[120:123], a[64:67], a[96:99], 0
  s_waitcnt lgkmcnt(2)
  buffer_load_dwordx4 a[140:143], v3, s[12:15], s77 offen offset:3072 sc1
  v_mfma_f32_16x16x32_bf16 v[120:123], v[180:183], a[100:103], v[120:123]
  v_add_f32 v92, v92, v72
  v_add_f32 v93, v93, v73
  v_mfma_f32_16x16x32_bf16 v[120:123], v[200:203], a[104:107], v[120:123]
  v_add_f32 v94, v94, v74
  v_add_f32 v95, v95, v75
  v_mfma_f32_16x16x32_bf16 v[120:123], v[220:223], a[108:111], v[120:123]
  v_mul_f32 v72, 0xbfb8aa3b, v92
  v_mul_f32 v73, 0xbfb8aa3b, v93
  v_mfma_f32_16x16x32_bf16 v[120:123], v[240:243], a[112:115], v[120:123]
  buffer_load_dwordx4 a[144:147], v3, s[12:15], s78 offen offset:0 sc1
  v_mfma_f32_16x16x32_bf16 v[124:127], a[68:71], a[96:99], 0
  v_mul_f32 v74, 0xbfb8aa3b, v94
  v_mul_f32 v75, 0xbfb8aa3b, v95
  v_mfma_f32_16x16x32_bf16 v[124:127], v[184:187], a[100:103], v[124:127]
  v_exp_f32 v72, v72
  v_mfma_f32_16x16x32_bf16 v[124:127], v[204:207], a[104:107], v[124:127]
  ds_write_b128 v16, v[116:119] offset:0
  v_mfma_f32_16x16x32_bf16 v[124:127], v[224:227], a[108:111], v[124:127]
  buffer_load_dwordx4 a[148:151], v3, s[12:15], s78 offen offset:1024 sc1
  v_mfma_f32_16x16x32_bf16 v[124:127], v[244:247], a[112:115], v[124:127]
  v_exp_f32 v73, v73
  v_mfma_f32_16x16x32_bf16 v[128:131], a[72:75], a[96:99], 0
  v_exp_f32 v74, v74
  v_mfma_f32_16x16x32_bf16 v[128:131], v[188:191], a[100:103], v[128:131]
  v_exp_f32 v75, v75
  v_mfma_f32_16x16x32_bf16 v[128:131], v[208:211], a[104:107], v[128:131]
  buffer_load_dwordx2 a[152:153], v25, s[12:15], s78 offen offset:2048 sc1
  v_mfma_f32_16x16x32_bf16 v[128:131], v[228:231], a[108:111], v[128:131]
  buffer_load_dwordx2 a[154:155], v25, s[12:15], s78 offen offset:2560 sc1
  v_mfma_f32_16x16x32_bf16 v[128:131], v[248:251], a[112:115], v[128:131]
  ds_write_b128 v16, v[120:123] offset:1024
  v_mfma_f32_16x16x32_bf16 v[132:135], a[76:79], a[96:99], 0
  v_add_f32 v72, 1.0, v72
  v_add_f32 v73, 1.0, v73
  v_mfma_f32_16x16x32_bf16 v[132:135], v[192:195], a[100:103], v[132:135]
  buffer_load_dwordx4 a[156:159], v2, s[12:15], s77 offen offset:2048 sc1
  v_mfma_f32_16x16x32_bf16 v[132:135], v[212:215], a[104:107], v[132:135]
  ds_write_b128 v16, v[124:127] offset:2048
  v_mfma_f32_16x16x32_bf16 v[132:135], v[232:235], a[108:111], v[132:135]
  v_add_f32 v74, 1.0, v74
  v_add_f32 v75, 1.0, v75
  v_mfma_f32_16x16x32_bf16 v[132:135], v[252:255], a[112:115], v[132:135]
  s_waitcnt vmcnt(12)
  v_rcp_f32 v72, v72
  v_mfma_f32_16x16x32_bf16 v[136:139], a[60:63], a[116:119], 0
  s_waitcnt vmcnt(11)
  buffer_load_dwordx4 a[160:163], v2, s[12:15], s77 offen offset:3072 sc1
  v_mfma_f32_16x16x32_bf16 v[136:139], v[176:179], a[120:123], v[136:139]
  s_waitcnt vmcnt(11)
  v_rcp_f32 v73, v73
  v_mfma_f32_16x16x32_bf16 v[136:139], v[196:199], a[124:127], v[136:139]
  s_waitcnt vmcnt(10)
  ds_write_b128 v16, v[128:131] offset:3072
  v_mfma_f32_16x16x32_bf16 v[136:139], v[216:219], a[128:131], v[136:139]
  s_waitcnt vmcnt(8)
  v_rcp_f32 v74, v74
  v_mfma_f32_16x16x32_bf16 v[136:139], v[236:239], a[132:135], v[136:139]
  buffer_load_dwordx4 a[164:167], v2, s[12:15], s78 offen offset:0 sc1
  v_mfma_f32_16x16x32_bf16 v[140:143], a[64:67], a[116:119], 0
  v_rcp_f32 v75, v75
  v_mfma_f32_16x16x32_bf16 v[140:143], v[180:183], a[120:123], v[140:143]
  s_waitcnt lgkmcnt(4)
  v_add_f32 v100, v100, v80
  v_add_f32 v101, v101, v81
  v_mfma_f32_16x16x32_bf16 v[140:143], v[200:203], a[124:127], v[140:143]
  ds_write_b128 v16, v[132:135] offset:4096
  v_mfma_f32_16x16x32_bf16 v[140:143], v[220:223], a[128:131], v[140:143]
  buffer_load_dwordx4 a[168:171], v2, s[12:15], s78 offen offset:1024 sc1
  v_mfma_f32_16x16x32_bf16 v[140:143], v[240:243], a[132:135], v[140:143]
  v_add_f32 v102, v102, v82
  v_add_f32 v103, v103, v83
  v_mfma_f32_16x16x32_bf16 v[144:147], a[68:71], a[116:119], 0
  s_waitcnt lgkmcnt(0)
  s_barrier
  ds_read_b128 v[116:119], v14 offset:0
  v_mfma_f32_16x16x32_bf16 v[144:147], v[184:187], a[120:123], v[144:147]
  ds_read_b128 v[120:123], v14 offset:1024
  v_mul_f32 v80, 0xbfb8aa3b, v100
  v_mfma_f32_16x16x32_bf16 v[144:147], v[204:207], a[124:127], v[144:147]
  buffer_load_dwordx2 a[172:173], v24, s[12:15], s78 offen offset:2048 sc1
  v_mfma_f32_16x16x32_bf16 v[144:147], v[224:227], a[128:131], v[144:147]
  buffer_load_dwordx2 a[174:175], v24, s[12:15], s78 offen offset:2560 sc1
  v_mfma_f32_16x16x32_bf16 v[144:147], v[244:247], a[132:135], v[144:147]
  ds_read_b128 v[124:127], v14 offset:2048
  v_mul_f32 v81, 0xbfb8aa3b, v101
  v_mfma_f32_16x16x32_bf16 v[148:151], a[72:75], a[116:119], 0
  buffer_load_dwordx4 v[104:107], v8, s[8:11], s70 offen
  v_mfma_f32_16x16x32_bf16 v[148:151], v[188:191], a[120:123], v[148:151]
  ds_read_b128 v[128:131], v14 offset:3072
  v_mul_f32 v82, 0xbfb8aa3b, v102
  v_mfma_f32_16x16x32_bf16 v[148:151], v[208:211], a[124:127], v[148:151]
  ds_read_b128 v[132:135], v14 offset:4096
  v_mul_f32 v83, 0xbfb8aa3b, v103
  v_mfma_f32_16x16x32_bf16 v[148:151], v[228:231], a[128:131], v[148:151]
  v_exp_f32 v80, v80
  v_mfma_f32_16x16x32_bf16 v[148:151], v[248:251], a[132:135], v[148:151]
  ds_write_b128 v16, v[136:139] offset:20480
  v_mfma_f32_16x16x32_bf16 v[152:155], a[76:79], a[116:119], 0
  buffer_load_dwordx4 v[108:111], v9, s[8:11], s70 offen
  v_mfma_f32_16x16x32_bf16 v[152:155], v[192:195], a[120:123], v[152:155]
  ds_write_b128 v16, v[140:143] offset:21504
  v_mfma_f32_16x16x32_bf16 v[152:155], v[212:215], a[124:127], v[152:155]
  v_exp_f32 v81, v81
  v_mfma_f32_16x16x32_bf16 v[152:155], v[232:235], a[128:131], v[152:155]
  ds_write_b128 v16, v[144:147] offset:22528
  v_mfma_f32_16x16x32_bf16 v[152:155], v[252:255], a[132:135], v[152:155]
  s_waitcnt vmcnt(13)
  s_waitcnt lgkmcnt(7)
  v_add_f32 v88, v88, v68
  v_mfma_f32_16x16x32_bf16 v[116:119], a[60:63], a[136:139], v[116:119]
  s_waitcnt vmcnt(12)
  buffer_load_dwordx4 v[112:115], v10, s[8:11], s70 offen
  v_mfma_f32_16x16x32_bf16 v[116:119], v[176:179], a[140:143], v[116:119]
  s_waitcnt vmcnt(12)
  v_exp_f32 v82, v82
  v_mfma_f32_16x16x32_bf16 v[116:119], v[196:199], a[144:147], v[116:119]
  s_waitcnt vmcnt(11)
  ds_write_b128 v16, v[148:151] offset:23552
  v_mfma_f32_16x16x32_bf16 v[116:119], v[216:219], a[148:151], v[116:119]
  s_waitcnt vmcnt(9)
  v_exp_f32 v83, v83
  v_mfma_f32_16x16x32_bf16 v[116:119], v[236:239], a[152:155], v[116:119]
  s_waitcnt lgkmcnt(7)
  v_add_f32 v80, 1.0, v80
  v_add_f32 v81, 1.0, v81
  v_mfma_f32_16x16x32_bf16 v[120:123], a[64:67], a[136:139], v[120:123]
  v_add_f32 v82, 1.0, v82
  v_add_f32 v83, 1.0, v83
  v_mfma_f32_16x16x32_bf16 v[120:123], v[180:183], a[140:143], v[120:123]
  v_rcp_f32 v80, v80
  v_mfma_f32_16x16x32_bf16 v[120:123], v[200:203], a[144:147], v[120:123]
  ds_write_b128 v16, v[152:155] offset:24576
  v_mfma_f32_16x16x32_bf16 v[120:123], v[220:223], a[148:151], v[120:123]
  v_rcp_f32 v81, v81
  v_mfma_f32_16x16x32_bf16 v[120:123], v[240:243], a[152:155], v[120:123]
  s_waitcnt lgkmcnt(7)
  v_rcp_f32 v82, v82
  v_mfma_f32_16x16x32_bf16 v[124:127], a[68:71], a[136:139], v[124:127]
  s_waitcnt lgkmcnt(0)
  s_barrier
  ds_read_b128 v[136:139], v14 offset:20480
  v_mfma_f32_16x16x32_bf16 v[124:127], v[184:187], a[140:143], v[124:127]
  ds_read_b128 v[140:143], v14 offset:21504
  v_add_f32 v89, v89, v69
  v_mfma_f32_16x16x32_bf16 v[124:127], v[204:207], a[144:147], v[124:127]
  ds_read_b128 v[144:147], v14 offset:22528
  v_add_f32 v90, v90, v70
  v_mfma_f32_16x16x32_bf16 v[124:127], v[224:227], a[148:151], v[124:127]
  ds_read_b128 v[148:151], v14 offset:23552
  v_add_f32 v91, v91, v71
  v_mfma_f32_16x16x32_bf16 v[124:127], v[244:247], a[152:155], v[124:127]
  ds_read_b128 v[152:155], v14 offset:24576
  v_mul_f32 v68, 0xbfb8aa3b, v88
  v_mfma_f32_16x16x32_bf16 v[128:131], a[72:75], a[136:139], v[128:131]
  v_rcp_f32 v83, v83
  v_mfma_f32_16x16x32_bf16 v[128:131], v[188:191], a[140:143], v[128:131]
  ds_write_b128 v15, v[116:119] offset:40960
  v_mfma_f32_16x16x32_bf16 v[128:131], v[208:211], a[144:147], v[128:131]
  v_mul_f32 v69, 0xbfb8aa3b, v89
  v_mul_f32 v70, 0xbfb8aa3b, v90
  v_mfma_f32_16x16x32_bf16 v[128:131], v[228:231], a[148:151], v[128:131]
  ds_write_b128 v15, v[120:123] offset:41984
  v_mfma_f32_16x16x32_bf16 v[128:131], v[248:251], a[152:155], v[128:131]
  v_mul_f32 v71, 0xbfb8aa3b, v91
  v_mfma_f32_16x16x32_bf16 v[132:135], a[76:79], a[136:139], v[132:135]
  v_exp_f32 v68, v68
  v_mfma_f32_16x16x32_bf16 v[132:135], v[192:195], a[140:143], v[132:135]
  v_exp_f32 v69, v69
  v_mfma_f32_16x16x32_bf16 v[132:135], v[212:215], a[144:147], v[132:135]
  ds_write_b128 v15, v[124:127] offset:43008
  v_mfma_f32_16x16x32_bf16 v[132:135], v[232:235], a[148:151], v[132:135]
  v_exp_f32 v70, v70
  v_mfma_f32_16x16x32_bf16 v[132:135], v[252:255], a[152:155], v[132:135]
  s_waitcnt vmcnt(8)
  s_waitcnt lgkmcnt(7)
  v_mfma_f32_16x16x32_bf16 v[136:139], a[60:63], a[156:159], v[136:139]
  s_waitcnt vmcnt(7)
  v_exp_f32 v71, v71
  v_mfma_f32_16x16x32_bf16 v[136:139], v[176:179], a[160:163], v[136:139]
  s_waitcnt vmcnt(6)
  v_add_f32 v68, 1.0, v68
  v_add_f32 v69, 1.0, v69
  v_mfma_f32_16x16x32_bf16 v[136:139], v[196:199], a[164:167], v[136:139]
  s_waitcnt vmcnt(5)
  ds_write_b128 v15, v[128:131] offset:44032
  v_mfma_f32_16x16x32_bf16 v[136:139], v[216:219], a[168:171], v[136:139]
  s_waitcnt vmcnt(3)
  v_add_f32 v70, 1.0, v70
  v_add_f32 v71, 1.0, v71
  v_mfma_f32_16x16x32_bf16 v[136:139], v[236:239], a[172:175], v[136:139]
  s_waitcnt lgkmcnt(7)
  v_rcp_f32 v68, v68
  v_mfma_f32_16x16x32_bf16 v[140:143], a[64:67], a[156:159], v[140:143]
  v_rcp_f32 v69, v69
  v_mfma_f32_16x16x32_bf16 v[140:143], v[180:183], a[160:163], v[140:143]
  v_rcp_f32 v70, v70
  v_mfma_f32_16x16x32_bf16 v[140:143], v[200:203], a[164:167], v[140:143]
  ds_write_b128 v15, v[132:135] offset:45056
  v_mfma_f32_16x16x32_bf16 v[140:143], v[220:223], a[168:171], v[140:143]
  v_rcp_f32 v71, v71
  v_mfma_f32_16x16x32_bf16 v[140:143], v[240:243], a[172:175], v[140:143]
  s_waitcnt lgkmcnt(7)
  v_add_f32 v96, v96, v76
  v_add_f32 v97, v97, v77
  v_mfma_f32_16x16x32_bf16 v[144:147], a[68:71], a[156:159], v[144:147]
  s_waitcnt lgkmcnt(0)
  s_barrier
  ds_read_b128 v[116:119], v14 offset:40960
  v_mfma_f32_16x16x32_bf16 v[144:147], v[184:187], a[160:163], v[144:147]
  ds_read_b128 v[120:123], v14 offset:41984
  v_add_f32 v98, v98, v78
  v_mfma_f32_16x16x32_bf16 v[144:147], v[204:207], a[164:167], v[144:147]
  ds_read_b128 v[124:127], v14 offset:43008
  v_add_f32 v99, v99, v79
  v_mfma_f32_16x16x32_bf16 v[144:147], v[224:227], a[168:171], v[144:147]
  ds_read_b128 v[128:131], v14 offset:44032
  v_mul_f32 v76, 0xbfb8aa3b, v96
  v_mfma_f32_16x16x32_bf16 v[144:147], v[244:247], a[172:175], v[144:147]
  ds_read_b128 v[132:135], v14 offset:45056
  v_mul_f32 v77, 0xbfb8aa3b, v97
  v_mfma_f32_16x16x32_bf16 v[148:151], a[72:75], a[156:159], v[148:151]
  v_mul_f32 v78, 0xbfb8aa3b, v98
  v_mul_f32 v79, 0xbfb8aa3b, v99
  v_mfma_f32_16x16x32_bf16 v[148:151], v[188:191], a[160:163], v[148:151]
  v_exp_f32 v76, v76
  v_mfma_f32_16x16x32_bf16 v[148:151], v[208:211], a[164:167], v[148:151]
  v_exp_f32 v77, v77
  v_mfma_f32_16x16x32_bf16 v[148:151], v[228:231], a[168:171], v[148:151]
  v_exp_f32 v78, v78
  v_mfma_f32_16x16x32_bf16 v[148:151], v[248:251], a[172:175], v[148:151]
  v_exp_f32 v79, v79
  v_mfma_f32_16x16x32_bf16 v[152:155], a[76:79], a[156:159], v[152:155]
  v_add_f32 v76, 1.0, v76
  v_add_f32 v77, 1.0, v77
  v_mfma_f32_16x16x32_bf16 v[152:155], v[192:195], a[160:163], v[152:155]
  v_add_f32 v78, 1.0, v78
  v_add_f32 v79, 1.0, v79
  v_mfma_f32_16x16x32_bf16 v[152:155], v[212:215], a[164:167], v[152:155]
  v_rcp_f32 v76, v76
  v_mfma_f32_16x16x32_bf16 v[152:155], v[232:235], a[168:171], v[152:155]
  v_rcp_f32 v77, v77
  v_mfma_f32_16x16x32_bf16 v[152:155], v[252:255], a[172:175], v[152:155]
  v_rcp_f32 v78, v78
  v_rcp_f32 v79, v79
  s_nop 0
  v_pk_mul_f32 v[88:89], v[88:89], v[68:69]
  v_pk_mul_f32 v[90:91], v[90:91], v[70:71]
  v_pk_mul_f32 v[92:93], v[92:93], v[72:73]
  v_pk_mul_f32 v[94:95], v[94:95], v[74:75]
  v_pk_mul_f32 v[96:97], v[96:97], v[76:77]
  v_pk_mul_f32 v[98:99], v[98:99], v[78:79]
  v_pk_mul_f32 v[100:101], v[100:101], v[80:81]
  v_pk_mul_f32 v[102:103], v[102:103], v[82:83]
  s_waitcnt lgkmcnt(0)
  v_pk_add_f32 v[136:137], v[136:137], v[116:117]
  v_pk_add_f32 v[138:139], v[138:139], v[118:119]
  v_pk_add_f32 v[140:141], v[140:141], v[120:121]
  v_pk_add_f32 v[142:143], v[142:143], v[122:123]
  v_pk_add_f32 v[144:145], v[144:145], v[124:125]
  v_pk_add_f32 v[146:147], v[146:147], v[126:127]
  v_pk_add_f32 v[148:149], v[148:149], v[128:129]
  v_pk_add_f32 v[150:151], v[150:151], v[130:131]
  v_pk_add_f32 v[152:153], v[152:153], v[132:133]
  v_pk_add_f32 v[154:155], v[154:155], v[134:135]
  v_pk_mul_f32 v[136:137], v[136:137], v[84:85]
  v_pk_mul_f32 v[138:139], v[138:139], v[86:87]
  v_pk_mul_f32 v[140:141], v[140:141], v[88:89]
  v_pk_mul_f32 v[142:143], v[142:143], v[90:91]
  v_pk_mul_f32 v[144:145], v[144:145], v[92:93]
  v_pk_mul_f32 v[146:147], v[146:147], v[94:95]
  v_pk_mul_f32 v[148:149], v[148:149], v[96:97]
  v_pk_mul_f32 v[150:151], v[150:151], v[98:99]
  v_pk_mul_f32 v[152:153], v[152:153], v[100:101]
  v_pk_mul_f32 v[154:155], v[154:155], v[102:103]
  ds_write_b128 v28, v[136:139] offset:0
  ds_write_b128 v28, v[140:143] offset:64
  ds_write_b128 v28, v[144:147] offset:128
  ds_write_b128 v28, v[148:151] offset:192
  ds_write_b128 v28, v[152:155] offset:256
  ds_read_b128 v[32:35], v11
  ds_read_b128 v[36:39], v11 offset:16
  ds_read_b128 v[40:43], v12
  ds_read_b128 v[44:47], v12 offset:16
  ds_read_b128 v[48:51], v13
  ds_read_b128 v[52:55], v13 offset:16
  s_waitcnt vmcnt(0)
  s_waitcnt lgkmcnt(4)
  v_dot2c_f32_bf16 v32, v104, v29
  v_dot2c_f32_bf16 v33, v104, v30
  v_dot2c_f32_bf16 v34, v105, v29
  v_dot2c_f32_bf16 v35, v105, v30
  v_dot2c_f32_bf16 v36, v106, v29
  v_dot2c_f32_bf16 v37, v106, v30
  v_dot2c_f32_bf16 v38, v107, v29
  v_dot2c_f32_bf16 v39, v107, v30
  s_nop 0
  v_cvt_pk_bf16_f32 v104, v32, v33
  v_cvt_pk_bf16_f32 v105, v34, v35
  v_cvt_pk_bf16_f32 v106, v36, v37
  v_cvt_pk_bf16_f32 v107, v38, v39
  buffer_store_dwordx4 v[104:107], v8, s[16:19], s70 offen
  s_waitcnt lgkmcnt(2)
  v_dot2c_f32_bf16 v40, v108, v29
  v_dot2c_f32_bf16 v41, v108, v30
  v_dot2c_f32_bf16 v42, v109, v29
  v_dot2c_f32_bf16 v43, v109, v30
  v_dot2c_f32_bf16 v44, v110, v29
  v_dot2c_f32_bf16 v45, v110, v30
  v_dot2c_f32_bf16 v46, v111, v29
  v_dot2c_f32_bf16 v47, v111, v30
  s_nop 0
  v_cvt_pk_bf16_f32 v108, v40, v41
  v_cvt_pk_bf16_f32 v109, v42, v43
  v_cvt_pk_bf16_f32 v110, v44, v45
  v_cvt_pk_bf16_f32 v111, v46, v47
  buffer_store_dwordx4 v[108:111], v9, s[16:19], s70 offen
  s_waitcnt lgkmcnt(0)
  v_dot2c_f32_bf16 v48, v112, v29
  v_dot2c_f32_bf16 v49, v112, v30
  v_dot2c_f32_bf16 v50, v113, v29
  v_dot2c_f32_bf16 v51, v113, v30
  v_dot2c_f32_bf16 v52, v114, v29
  v_dot2c_f32_bf16 v53, v114, v30
  v_dot2c_f32_bf16 v54, v115, v29
  v_dot2c_f32_bf16 v55, v115, v30
  s_nop 0
  v_cvt_pk_bf16_f32 v112, v48, v49
  v_cvt_pk_bf16_f32 v113, v50, v51
  v_cvt_pk_bf16_f32 v114, v52, v53
  v_cvt_pk_bf16_f32 v115, v54, v55
  buffer_store_dwordx4 v[112:115], v10, s[16:19], s70 offen
  s_endpgm
L_slow_37:
  s_mov_b32 s59, 131072
  s_branch L_first_40
L_spin_39:
  s_sleep 2
L_first_40:
  s_mov_b32 s62, 26214400
  buffer_load_dword v19, v18, s[12:15], s62 offen sc1
  s_waitcnt vmcnt(0)
  v_cmp_ne_u32 vcc, s61, v19
  s_sub_u32 s59, s59, 1
  s_cbranch_scc1 L_back_38
  s_cbranch_vccnz L_spin_39
  s_branch L_back_38
  .p2align 12
L_kv:
  s_and_b32 s64, s5, 1
  s_lshl_b32 s64, s64, 5
  v_lshl_add_u32 v23, v22, 3, s64
  v_add_u32 v23, 0, v23
  v_lshrrev_b32 v24, 6, v23
  v_and_b32 v25, 63, v23
  v_xor_b32 v25, v25, v21
  v_lshl_add_u32 v24, v24, 13, v20
  v_add_u32 v10, v24, v25
  v_lshl_add_u32 v23, v22, 3, s64
  v_add_u32 v23, 40, v23
  v_lshrrev_b32 v24, 6, v23
  v_and_b32 v25, 63, v23
  v_xor_b32 v25, v25, v21
  v_lshl_add_u32 v24, v24, 13, v20
  v_add_u32 v11, v24, v25
  v_lshl_add_u32 v23, v22, 3, s64
  v_add_u32 v23, 80, v23
  v_lshrrev_b32 v24, 6, v23
  v_and_b32 v25, 63, v23
  v_xor_b32 v25, v25, v21
  v_lshl_add_u32 v24, v24, 13, v20
  v_add_u32 v12, v24, v25
  v_lshl_add_u32 v23, v22, 3, s64
  v_add_u32 v23, 120, v23
  v_lshrrev_b32 v24, 6, v23
  v_and_b32 v25, 63, v23
  v_xor_b32 v25, v25, v21
  v_lshl_add_u32 v24, v24, 13, v20
  v_add_u32 v13, v24, v25
  v_mul_u32_u24 v23, 40, v22
  v_add_u32 v23, s64, v23
  v_add_u32 v23, 32, v23
  v_lshrrev_b32 v24, 6, v23
  v_and_b32 v25, 63, v23
  v_xor_b32 v25, v25, v21
  v_lshl_add_u32 v24, v24, 13, v20
  v_add_u32 v14, v24, v25
  s_lshl_b32 s64, s64, 1
  s_add_u32 s64, s64, 0x20000
  v_and_b32 v23, 15, v0
  v_lshl_add_u32 v36, v23, 2, s64
  v_lshrrev_b32 v23, 2, v23
  v_mul_u32_u24 v23, 80, v23
  v_lshl_add_u32 v23, v22, 2, v23
  v_add_u32 v37, s64, v23
  s_cmp_eq_u32 s50, 8
  s_cselect_b64 s[56:57], s[54:55], s[52:53]
  s_cselect_b32 s51, -18, 2
  s_add_u32 m0, s98, 90112
  s_nop 0
  global_load_lds_dwordx4 v[4:5], off offset:0
  s_add_u32 m0, s98, 98240
  s_nop 0
  global_load_lds_dwordx4 v[4:5], off offset:64
  s_add_u32 m0, s98, 106368
  s_nop 0
  global_load_lds_dwordx4 v[4:5], off offset:128
  v_lshl_add_u64 v[4:5], v[4:5], 0, s[56:57]
  s_xor_b32 m0, s49, 32768
  s_nop 0
  buffer_load_dwordx4 v2, s[8:11], s44 offen lds
  s_xor_b32 m0, s49, 34816
  s_nop 0
  buffer_load_dwordx4 v2, s[8:11], s45 offen lds
  s_xor_b32 m0, s49, 36864
  s_nop 0
  buffer_load_dwordx4 v2, s[8:11], s46 offen lds
  s_xor_b32 m0, s49, 38912
  s_nop 0
  buffer_load_dwordx4 v2, s[8:11], s47 offen lds
  s_waitcnt vmcnt(7)
  s_barrier
  ds_read_b64_tr_b16 a[64:65], v10 offset:0
  ds_read_b64_tr_b16 a[66:67], v10 offset:256
  ds_read_b64_tr_b16 a[68:69], v10 offset:4096
  ds_read_b64_tr_b16 a[70:71], v10 offset:4352
  ds_read_b128 a[0:3], v8 offset:0
  ds_read_b128 a[4:7], v9 offset:0
  ds_read_b128 a[8:11], v8 offset:2048
  ds_read_b128 a[12:15], v9 offset:2048
  ds_read_b128 a[16:19], v8 offset:4096
  ds_read_b128 a[20:23], v9 offset:4096
  ds_read_b128 a[24:27], v8 offset:6144
  ds_read_b128 a[28:31], v9 offset:6144
  ds_read_b64_tr_b16 a[72:73], v11 offset:0
  ds_read_b64_tr_b16 a[74:75], v11 offset:256
  ds_read_b64_tr_b16 a[76:77], v11 offset:4096
  ds_read_b64_tr_b16 a[78:79], v11 offset:4352
  s_waitcnt lgkmcnt(4)
  v_mfma_f32_16x16x32_bf16 v[64:67], a[0:3], a[64:67], 0
  ds_read_b64_tr_b16 a[80:81], v12 offset:0
  ds_read_b64_tr_b16 a[82:83], v12 offset:256
  v_mfma_f32_16x16x32_bf16 v[64:67], a[4:7], a[68:71], v[64:67]
  s_waitcnt lgkmcnt(6)
  ds_read_b64_tr_b16 a[84:85], v12 offset:4096
  ds_read_b64_tr_b16 a[86:87], v12 offset:4352
  v_mfma_f32_16x16x32_bf16 v[68:71], a[12:15], a[68:71], 0
  ds_read_b64_tr_b16 a[96:97], v56 offset:0
  ds_read_b64_tr_b16 a[98:99], v56 offset:256
  ds_read_b64_tr_b16 a[100:101], v56 offset:4096
  ds_read_b64_tr_b16 a[102:103], v56 offset:4352
  v_mfma_f32_16x16x32_bf16 v[68:71], a[8:11], a[64:67], v[68:71]
  v_lshl_add_u32 v2, s51, 6, v2
  s_add_u32 m0, s99, 90112
  v_mfma_f32_16x16x32_bf16 v[72:75], a[16:19], a[64:67], 0
  v_mfma_f32_16x16x32_bf16 v[72:75], a[20:23], a[68:71], v[72:75]
  global_load_lds_dwordx4 v[6:7], off offset:0
  v_mfma_f32_16x16x32_bf16 v[76:79], a[28:31], a[68:71], 0
  v_mfma_f32_16x16x32_bf16 v[76:79], a[24:27], a[64:67], v[76:79]
  s_waitcnt lgkmcnt(8)
  ds_read_b64_tr_b16 a[88:89], v13 offset:0
  ds_read_b64_tr_b16 a[90:91], v13 offset:256
  ds_read_b64_tr_b16 a[92:93], v13 offset:4096
  ds_read_b64_tr_b16 a[94:95], v13 offset:4352
  v_mfma_f32_16x16x32_bf16 v[80:83], a[0:3], a[72:75], 0
  s_add_u32 m0, s99, 98240
  v_mfma_f32_16x16x32_bf16 v[80:83], a[4:7], a[76:79], v[80:83]
  v_mfma_f32_16x16x32_bf16 v[84:87], a[12:15], a[76:79], 0
  ds_read_b64_tr_b16 a[104:105], v57 offset:0
  ds_read_b64_tr_b16 a[106:107], v57 offset:256
  ds_read_b64_tr_b16 a[108:109], v57 offset:4096
  ds_read_b64_tr_b16 a[110:111], v57 offset:4352
  v_mfma_f32_16x16x32_bf16 v[84:87], a[8:11], a[72:75], v[84:87]
  global_load_lds_dwordx4 v[6:7], off offset:64
  v_mfma_f32_16x16x32_bf16 v[88:91], a[16:19], a[72:75], 0
  v_mfma_f32_16x16x32_bf16 v[88:91], a[20:23], a[76:79], v[88:91]
  s_add_u32 m0, s99, 106368
  v_mfma_f32_16x16x32_bf16 v[92:95], a[28:31], a[76:79], 0
  v_mfma_f32_16x16x32_bf16 v[92:95], a[24:27], a[72:75], v[92:95]
  s_waitcnt lgkmcnt(12)
  ds_read_b64_tr_b16 a[64:65], v14 offset:0
  ds_read_b64_tr_b16 a[66:67], v14 offset:256
  ds_read_b64_tr_b16 a[68:69], v14 offset:4096
  ds_read_b64_tr_b16 a[70:71], v14 offset:4352
  v_mfma_f32_16x16x32_bf16 v[96:99], a[0:3], a[80:83], 0
  global_load_lds_dwordx4 v[6:7], off offset:128
  v_mfma_f32_16x16x32_bf16 v[96:99], a[4:7], a[84:87], v[96:99]
  v_mfma_f32_16x16x32_bf16 v[100:103], a[12:15], a[84:87], 0
  ds_read_b64_tr_b16 a[112:113], v58 offset:0
  ds_read_b64_tr_b16 a[114:115], v58 offset:256
  ds_read_b64_tr_b16 a[116:117], v58 offset:4096
  ds_read_b64_tr_b16 a[118:119], v58 offset:4352
  v_mfma_f32_16x16x32_bf16 v[100:103], a[8:11], a[80:83], v[100:103]
  v_lshl_add_u64 v[6:7], v[6:7], 0, s[56:57]
  s_xor_b32 m0, s49, 33792
  v_mfma_f32_16x16x32_bf16 v[104:107], a[16:19], a[80:83], 0
  v_mfma_f32_16x16x32_bf16 v[104:107], a[20:23], a[84:87], v[104:107]
  buffer_load_dwordx4 v3, s[8:11], s44 offen lds
  v_mfma_f32_16x16x32_bf16 v[108:111], a[28:31], a[84:87], 0
  v_mfma_f32_16x16x32_bf16 v[108:111], a[24:27], a[80:83], v[108:111]
  s_waitcnt lgkmcnt(12)
  ds_read_b64_tr_b16 a[72:73], v10 offset:512
  ds_read_b64_tr_b16 a[74:75], v10 offset:768
  ds_read_b64_tr_b16 a[76:77], v10 offset:4608
  ds_read_b64_tr_b16 a[78:79], v10 offset:4864
  v_mfma_f32_16x16x32_bf16 v[112:115], a[0:3], a[88:91], 0
  s_xor_b32 m0, s49, 35840
  v_mfma_f32_16x16x32_bf16 v[112:115], a[4:7], a[92:95], v[112:115]
  v_mfma_f32_16x16x32_bf16 v[116:119], a[12:15], a[92:95], 0
  buffer_load_dwordx4 v3, s[8:11], s45 offen lds
  v_mfma_f32_16x16x32_bf16 v[116:119], a[8:11], a[88:91], v[116:119]
  v_mfma_f32_16x16x32_bf16 v[120:123], a[16:19], a[88:91], 0
  v_mfma_f32_16x16x32_bf16 v[120:123], a[20:23], a[92:95], v[120:123]
  s_xor_b32 m0, s49, 37888
  v_mfma_f32_16x16x32_bf16 v[124:127], a[28:31], a[92:95], 0
  v_mfma_f32_16x16x32_bf16 v[124:127], a[24:27], a[88:91], v[124:127]
  s_waitcnt lgkmcnt(4)
  buffer_load_dwordx4 v3, s[8:11], s46 offen lds
  v_mfma_f32_16x16x32_bf16 v[40:43], v[52:55], a[96:99], 0
  v_mfma_f32_16x16x32_bf16 v[40:43], v[52:55], a[100:103], v[40:43]
  v_mfma_f32_16x16x32_bf16 v[44:47], v[52:55], a[104:107], 0
  v_mfma_f32_16x16x32_bf16 v[44:47], v[52:55], a[108:111], v[44:47]
  s_xor_b32 m0, s49, 39936
  v_mfma_f32_16x16x32_bf16 v[48:51], v[52:55], a[112:115], 0
  v_mfma_f32_16x16x32_bf16 v[48:51], v[52:55], a[116:119], v[48:51]
  ds_read_b64_tr_b16 a[80:81], v11 offset:512
  ds_read_b64_tr_b16 a[82:83], v11 offset:768
  ds_read_b64_tr_b16 a[84:85], v11 offset:4608
  ds_read_b64_tr_b16 a[86:87], v11 offset:4864
  v_mfma_f32_16x16x32_bf16 v[128:131], a[0:3], a[64:67], 0
  buffer_load_dwordx4 v3, s[8:11], s47 offen lds
  v_mfma_f32_16x16x32_bf16 v[128:131], a[4:7], a[68:71], v[128:131]
  v_mov_b32 v52, s21
  v_mov_b32 v53, s21
  v_mfma_f32_16x16x32_bf16 v[132:135], a[12:15], a[68:71], 0
  v_lshl_add_u32 v3, s51, 6, v3
  v_mov_b32 v54, s21
  v_mfma_f32_16x16x32_bf16 v[132:135], a[8:11], a[64:67], v[132:135]
  s_cmp_eq_u32 s50, 7
  s_cselect_b64 s[56:57], s[54:55], s[52:53]
  s_cselect_b32 s51, -18, 2
  v_mfma_f32_16x16x32_bf16 v[136:139], a[16:19], a[64:67], 0
  s_add_u32 m0, s98, 114688
  v_mov_b32 v55, s21
  v_lshrrev_b32 v61, 4, v0
  v_mfma_f32_16x16x32_bf16 v[136:139], a[20:23], a[68:71], v[136:139]
  global_load_lds_dwordx4 v[4:5], off offset:0
  v_mfma_f32_16x16x32_bf16 v[140:143], a[28:31], a[68:71], 0
  v_and_b32 v62, 15, v0
  v_lshlrev_b32 v62, 4, v62
  v_mfma_f32_16x16x32_bf16 v[140:143], a[24:27], a[64:67], v[140:143]
  s_waitcnt lgkmcnt(4)
  ds_read_b64_tr_b16 a[88:89], v12 offset:512
  ds_read_b64_tr_b16 a[90:91], v12 offset:768
  ds_read_b64_tr_b16 a[92:93], v12 offset:4608
  ds_read_b64_tr_b16 a[94:95], v12 offset:4864
  v_mfma_f32_16x16x32_bf16 v[144:147], a[0:3], a[72:75], 0
  s_add_u32 m0, s98, 122816
  v_lshl_add_u32 v38, v61, 10, v62
  v_lshl_add_u32 v61, v61, 28, v62
  v_mfma_f32_16x16x32_bf16 v[144:147], a[4:7], a[76:79], v[144:147]
  s_lshl_b32 s64, s7, 13
  global_load_lds_dwordx4 v[4:5], off offset:64
  v_mfma_f32_16x16x32_bf16 v[148:151], a[12:15], a[76:79], 0
  s_lshl_b32 s66, s3, 8
  s_add_u32 s64, s64, s66
  s_add_u32 s64, s64, 98304
  v_mfma_f32_16x16x32_bf16 v[148:151], a[8:11], a[72:75], v[148:151]
  s_lshl_b32 s65, s4, 10
  s_add_u32 s65, s65, s64
  v_mfma_f32_16x16x32_bf16 v[152:155], a[16:19], a[72:75], 0
  s_add_u32 m0, s98, 130944
  v_mfma_f32_16x16x32_bf16 v[152:155], a[20:23], a[76:79], v[152:155]
  v_mfma_f32_16x16x32_bf16 v[156:159], a[28:31], a[76:79], 0
  global_load_lds_dwordx4 v[4:5], off offset:128
  v_mfma_f32_16x16x32_bf16 v[156:159], a[24:27], a[72:75], v[156:159]
  s_waitcnt lgkmcnt(4)
  ds_read_b64_tr_b16 a[64:65], v13 offset:512
  ds_read_b64_tr_b16 a[66:67], v13 offset:768
  ds_read_b64_tr_b16 a[68:69], v13 offset:4608
  ds_read_b64_tr_b16 a[70:71], v13 offset:4864
  v_mfma_f32_16x16x32_bf16 v[160:163], a[0:3], a[80:83], 0
  v_mfma_f32_16x16x32_bf16 v[160:163], a[4:7], a[84:87], v[160:163]
  v_mfma_f32_16x16x32_bf16 v[164:167], a[12:15], a[84:87], 0
  s_waitcnt lgkmcnt(0)
  s_and_b32 s61, s62, -8
  s_add_u32 s61, s61, 8
  s_mov_b64 exec, 0
  s_cmp_eq_u32 s3, 0
  s_cbranch_scc1 L_hop_kv0
  s_cmp_eq_u32 s3, 1
  s_cbranch_scc1 L_hop_kv1
  s_cmp_eq_u32 s3, 2
  s_cbranch_scc1 L_hop_kv2
  s_cmp_eq_u32 s3, 3
  s_cbranch_scc1 L_hop_kv3
L_retkv1:
  s_mov_b64 exec, -1
  s_mov_b64 exec, 0
  s_cmp_eq_u32 s3, 0
  s_cbranch_scc1 L_hop_kv4
  s_cmp_eq_u32 s3, 1
  s_cbranch_scc1 L_retkv2
  s_cmp_eq_u32 s3, 2
  s_cbranch_scc1 L_retkv2
  s_cmp_eq_u32 s3, 3
  s_cbranch_scc1 L_retkv2
L_retkv2:
  s_mov_b64 exec, -1
  s_waitcnt vmcnt(3)
  ds_read_b128 a[32:35], v8 offset:32768
  ds_read_b128 a[36:39], v9 offset:32768
  ds_read_b128 a[40:43], v8 offset:34816
  ds_read_b128 a[44:47], v9 offset:34816
  v_mfma_f32_16x16x32_bf16 v[164:167], a[8:11], a[80:83], v[164:167]
  v_lshl_add_u64 v[4:5], v[4:5], 0, s[56:57]
  s_xor_b32 m0, s49, 0
  v_mfma_f32_16x16x32_bf16 v[168:171], a[16:19], a[80:83], 0
  buffer_load_dwordx4 v2, s[8:11], s44 offen lds
  v_mfma_f32_16x16x32_bf16 v[168:171], a[20:23], a[84:87], v[168:171]
  v_mfma_f32_16x16x32_bf16 v[172:175], a[28:31], a[84:87], 0
  v_mfma_f32_16x16x32_bf16 v[172:175], a[24:27], a[80:83], v[172:175]
  s_xor_b32 m0, s49, 2048
  ds_read_b64_tr_b16 a[72:73], v14 offset:512
  ds_read_b64_tr_b16 a[74:75], v14 offset:768
  ds_read_b64_tr_b16 a[76:77], v14 offset:4608
  ds_read_b64_tr_b16 a[78:79], v14 offset:4864
  v_mfma_f32_16x16x32_bf16 v[176:179], a[0:3], a[88:91], 0
  v_mfma_f32_16x16x32_bf16 v[176:179], a[4:7], a[92:95], v[176:179]
  buffer_load_dwordx4 v2, s[8:11], s45 offen lds
  v_mfma_f32_16x16x32_bf16 v[180:183], a[12:15], a[92:95], 0
  ds_read_b128 a[48:51], v8 offset:36864
  ds_read_b128 a[52:55], v9 offset:36864
  ds_read_b128 a[56:59], v8 offset:38912
  ds_read_b128 a[60:63], v9 offset:38912
  v_mfma_f32_16x16x32_bf16 v[180:183], a[8:11], a[88:91], v[180:183]
  v_mfma_f32_16x16x32_bf16 v[184:187], a[16:19], a[88:91], 0
  s_xor_b32 m0, s49, 4096
  v_mfma_f32_16x16x32_bf16 v[184:187], a[20:23], a[92:95], v[184:187]
  v_mfma_f32_16x16x32_bf16 v[188:191], a[28:31], a[92:95], 0
  buffer_load_dwordx4 v2, s[8:11], s46 offen lds
  v_mfma_f32_16x16x32_bf16 v[188:191], a[24:27], a[88:91], v[188:191]
  v_mfma_f32_16x16x32_bf16 v[192:195], a[0:3], a[64:67], 0
  v_mfma_f32_16x16x32_bf16 v[192:195], a[4:7], a[68:71], v[192:195]
  s_waitcnt lgkmcnt(0)
  s_barrier
  ds_read_b64_tr_b16 a[80:81], v10 offset:24576
  v_mfma_f32_16x16x32_bf16 v[196:199], a[12:15], a[68:71], 0
  s_xor_b32 m0, s49, 6144
  ds_read_b64_tr_b16 a[82:83], v10 offset:24832
  v_mfma_f32_16x16x32_bf16 v[196:199], a[8:11], a[64:67], v[196:199]
  ds_read_b64_tr_b16 a[84:85], v10 offset:28672
  v_mfma_f32_16x16x32_bf16 v[200:203], a[16:19], a[64:67], 0
  ds_read_b64_tr_b16 a[86:87], v10 offset:28928
  v_mfma_f32_16x16x32_bf16 v[200:203], a[20:23], a[68:71], v[200:203]
  buffer_load_dwordx4 v2, s[8:11], s47 offen lds
  v_mfma_f32_16x16x32_bf16 v[204:207], a[28:31], a[68:71], 0
  v_mfma_f32_16x16x32_bf16 v[204:207], a[24:27], a[64:67], v[204:207]
  ds_read_b64_tr_b16 a[88:89], v11 offset:24576
  ds_read_b64_tr_b16 a[90:91], v11 offset:24832
  ds_read_b64_tr_b16 a[92:93], v11 offset:28672
  ds_read_b64_tr_b16 a[94:95], v11 offset:28928
  v_mfma_f32_16x16x32_bf16 v[208:211], a[0:3], a[72:75], 0
  v_lshl_add_u32 v2, s51, 6, v2
  s_add_u32 m0, s99, 114688
  v_mfma_f32_16x16x32_bf16 v[208:211], a[4:7], a[76:79], v[208:211]
  global_load_lds_dwordx4 v[6:7], off offset:0
  v_mfma_f32_16x16x32_bf16 v[212:215], a[12:15], a[76:79], 0
  v_mfma_f32_16x16x32_bf16 v[212:215], a[8:11], a[72:75], v[212:215]
  v_mfma_f32_16x16x32_bf16 v[216:219], a[16:19], a[72:75], 0
  s_add_u32 m0, s99, 122816
  v_mfma_f32_16x16x32_bf16 v[216:219], a[20:23], a[76:79], v[216:219]
  v_mfma_f32_16x16x32_bf16 v[220:223], a[28:31], a[76:79], 0
  global_load_lds_dwordx4 v[6:7], off offset:64
  v_mfma_f32_16x16x32_bf16 v[220:223], a[24:27], a[72:75], v[220:223]
  s_waitcnt lgkmcnt(4)
  ds_read_b64_tr_b16 a[64:65], v12 offset:24576
  ds_read_b64_tr_b16 a[66:67], v12 offset:24832
  ds_read_b64_tr_b16 a[68:69], v12 offset:28672
  ds_read_b64_tr_b16 a[70:71], v12 offset:28928
  v_mfma_f32_16x16x32_bf16 v[64:67], a[32:35], a[80:83], v[64:67]
  v_mfma_f32_16x16x32_bf16 v[64:67], a[36:39], a[84:87], v[64:67]
  v_mfma_f32_16x16x32_bf16 v[68:71], a[44:47], a[84:87], v[68:71]
  s_add_u32 m0, s99, 130944
  ds_read_b64_tr_b16 a[96:97], v56 offset:24576
  ds_read_b64_tr_b16 a[98:99], v56 offset:24832
  ds_read_b64_tr_b16 a[100:101], v56 offset:28672
  ds_read_b64_tr_b16 a[102:103], v56 offset:28928
  v_mfma_f32_16x16x32_bf16 v[68:71], a[40:43], a[80:83], v[68:71]
  v_mfma_f32_16x16x32_bf16 v[72:75], a[48:51], a[80:83], v[72:75]
  global_load_lds_dwordx4 v[6:7], off offset:128
  v_mfma_f32_16x16x32_bf16 v[72:75], a[52:55], a[84:87], v[72:75]
  v_mfma_f32_16x16x32_bf16 v[76:79], a[60:63], a[84:87], v[76:79]
  v_mfma_f32_16x16x32_bf16 v[76:79], a[56:59], a[80:83], v[76:79]
  s_waitcnt lgkmcnt(8)
  ds_read_b64_tr_b16 a[72:73], v13 offset:24576
  ds_read_b64_tr_b16 a[74:75], v13 offset:24832
  ds_read_b64_tr_b16 a[76:77], v13 offset:28672
  ds_read_b64_tr_b16 a[78:79], v13 offset:28928
  v_mfma_f32_16x16x32_bf16 v[80:83], a[32:35], a[88:91], v[80:83]
  v_lshl_add_u64 v[6:7], v[6:7], 0, s[56:57]
  s_xor_b32 m0, s49, 1024
  v_mfma_f32_16x16x32_bf16 v[80:83], a[36:39], a[92:95], v[80:83]
  buffer_load_dwordx4 v3, s[8:11], s44 offen lds
  v_mfma_f32_16x16x32_bf16 v[84:87], a[44:47], a[92:95], v[84:87]
  ds_read_b64_tr_b16 a[104:105], v57 offset:24576
  ds_read_b64_tr_b16 a[106:107], v57 offset:24832
  ds_read_b64_tr_b16 a[108:109], v57 offset:28672
  ds_read_b64_tr_b16 a[110:111], v57 offset:28928
  v_mfma_f32_16x16x32_bf16 v[84:87], a[40:43], a[88:91], v[84:87]
  v_mfma_f32_16x16x32_bf16 v[88:91], a[48:51], a[88:91], v[88:91]
  s_xor_b32 m0, s49, 3072
  v_mfma_f32_16x16x32_bf16 v[88:91], a[52:55], a[92:95], v[88:91]
  v_mfma_f32_16x16x32_bf16 v[92:95], a[60:63], a[92:95], v[92:95]
  buffer_load_dwordx4 v3, s[8:11], s45 offen lds
  v_mfma_f32_16x16x32_bf16 v[92:95], a[56:59], a[88:91], v[92:95]
  s_waitcnt lgkmcnt(12)
  ds_read_b64_tr_b16 a[80:81], v14 offset:24576
  ds_read_b64_tr_b16 a[82:83], v14 offset:24832
  ds_read_b64_tr_b16 a[84:85], v14 offset:28672
  ds_read_b64_tr_b16 a[86:87], v14 offset:28928
  v_mfma_f32_16x16x32_bf16 v[96:99], a[32:35], a[64:67], v[96:99]
  v_mfma_f32_16x16x32_bf16 v[96:99], a[36:39], a[68:71], v[96:99]
  s_xor_b32 m0, s49, 5120
  v_mfma_f32_16x16x32_bf16 v[100:103], a[44:47], a[68:71], v[100:103]
  ds_read_b64_tr_b16 a[112:113], v58 offset:24576
  ds_read_b64_tr_b16 a[114:115], v58 offset:24832
  ds_read_b64_tr_b16 a[116:117], v58 offset:28672
  ds_read_b64_tr_b16 a[118:119], v58 offset:28928
  v_mfma_f32_16x16x32_bf16 v[100:103], a[40:43], a[64:67], v[100:103]
  buffer_load_dwordx4 v3, s[8:11], s46 offen lds
  v_mfma_f32_16x16x32_bf16 v[104:107], a[48:51], a[64:67], v[104:107]
  v_mfma_f32_16x16x32_bf16 v[104:107], a[52:55], a[68:71], v[104:107]
  v_mfma_f32_16x16x32_bf16 v[108:111], a[60:63], a[68:71], v[108:111]
  v_mfma_f32_16x16x32_bf16 v[108:111], a[56:59], a[64:67], v[108:111]
  s_waitcnt lgkmcnt(12)
  ds_read_b64_tr_b16 a[88:89], v10 offset:25088
  ds_read_b64_tr_b16 a[90:91], v10 offset:25344
  ds_read_b64_tr_b16 a[92:93], v10 offset:29184
  ds_read_b64_tr_b16 a[94:95], v10 offset:29440
  v_mfma_f32_16x16x32_bf16 v[112:115], a[32:35], a[72:75], v[112:115]
  s_xor_b32 m0, s49, 7168
  v_mfma_f32_16x16x32_bf16 v[112:115], a[36:39], a[76:79], v[112:115]
  buffer_load_dwordx4 v3, s[8:11], s47 offen lds
  v_mfma_f32_16x16x32_bf16 v[116:119], a[44:47], a[76:79], v[116:119]
  v_mfma_f32_16x16x32_bf16 v[116:119], a[40:43], a[72:75], v[116:119]
  v_mfma_f32_16x16x32_bf16 v[120:123], a[48:51], a[72:75], v[120:123]
  v_lshl_add_u32 v3, s51, 6, v3
  v_mfma_f32_16x16x32_bf16 v[120:123], a[52:55], a[76:79], v[120:123]
  s_cmp_eq_u32 s50, 6
  s_cselect_b64 s[56:57], s[54:55], s[52:53]
  s_cselect_b32 s51, -18, 2
  v_mfma_f32_16x16x32_bf16 v[124:127], a[60:63], a[76:79], v[124:127]
  s_add_u32 m0, s98, 65536
  v_mfma_f32_16x16x32_bf16 v[124:127], a[56:59], a[72:75], v[124:127]
  s_waitcnt lgkmcnt(4)
  global_load_lds_dwordx4 v[4:5], off offset:0
  v_mfma_f32_16x16x32_bf16 v[40:43], v[52:55], a[96:99], v[40:43]
  v_mfma_f32_16x16x32_bf16 v[40:43], v[52:55], a[100:103], v[40:43]
  s_add_u32 m0, s98, 73664
  v_mfma_f32_16x16x32_bf16 v[44:47], v[52:55], a[104:107], v[44:47]
  v_mfma_f32_16x16x32_bf16 v[44:47], v[52:55], a[108:111], v[44:47]
  global_load_lds_dwordx4 v[4:5], off offset:64
  v_mfma_f32_16x16x32_bf16 v[48:51], v[52:55], a[112:115], v[48:51]
  v_mfma_f32_16x16x32_bf16 v[48:51], v[52:55], a[116:119], v[48:51]
  ds_read_b64_tr_b16 a[64:65], v11 offset:25088
  ds_read_b64_tr_b16 a[66:67], v11 offset:25344
  ds_read_b64_tr_b16 a[68:69], v11 offset:29184
  ds_read_b64_tr_b16 a[70:71], v11 offset:29440
  v_mfma_f32_16x16x32_bf16 v[128:131], a[32:35], a[80:83], v[128:131]
  v_mov_b32 v52, s22
  v_mov_b32 v53, s22
  v_mfma_f32_16x16x32_bf16 v[128:131], a[36:39], a[84:87], v[128:131]
  s_add_u32 m0, s98, 81792
  v_mov_b32 v54, s22
  v_mov_b32 v55, s22
  v_mfma_f32_16x16x32_bf16 v[132:135], a[44:47], a[84:87], v[132:135]
  v_mfma_f32_16x16x32_bf16 v[132:135], a[40:43], a[80:83], v[132:135]
  global_load_lds_dwordx4 v[4:5], off offset:128
  v_mfma_f32_16x16x32_bf16 v[136:139], a[48:51], a[80:83], v[136:139]
  v_mfma_f32_16x16x32_bf16 v[136:139], a[52:55], a[84:87], v[136:139]
  v_mfma_f32_16x16x32_bf16 v[140:143], a[60:63], a[84:87], v[140:143]
  v_lshl_add_u64 v[4:5], v[4:5], 0, s[56:57]
  s_xor_b32 m0, s49, 32768
  v_mfma_f32_16x16x32_bf16 v[140:143], a[56:59], a[80:83], v[140:143]
  s_waitcnt lgkmcnt(4)
  ds_read_b64_tr_b16 a[72:73], v12 offset:25088
  ds_read_b64_tr_b16 a[74:75], v12 offset:25344
  ds_read_b64_tr_b16 a[76:77], v12 offset:29184
  ds_read_b64_tr_b16 a[78:79], v12 offset:29440
  v_mfma_f32_16x16x32_bf16 v[144:147], a[32:35], a[88:91], v[144:147]
  buffer_load_dwordx4 v2, s[8:11], s44 offen lds
  v_mfma_f32_16x16x32_bf16 v[144:147], a[36:39], a[92:95], v[144:147]
  v_mfma_f32_16x16x32_bf16 v[148:151], a[44:47], a[92:95], v[148:151]
  v_mfma_f32_16x16x32_bf16 v[148:151], a[40:43], a[88:91], v[148:151]
  s_xor_b32 m0, s49, 34816
  v_mfma_f32_16x16x32_bf16 v[152:155], a[48:51], a[88:91], v[152:155]
  v_mfma_f32_16x16x32_bf16 v[152:155], a[52:55], a[92:95], v[152:155]
  buffer_load_dwordx4 v2, s[8:11], s45 offen lds
  v_mfma_f32_16x16x32_bf16 v[156:159], a[60:63], a[92:95], v[156:159]
  v_mfma_f32_16x16x32_bf16 v[156:159], a[56:59], a[88:91], v[156:159]
  s_waitcnt lgkmcnt(4)
  ds_read_b64_tr_b16 a[80:81], v13 offset:25088
  ds_read_b64_tr_b16 a[82:83], v13 offset:25344
  ds_read_b64_tr_b16 a[84:85], v13 offset:29184
  ds_read_b64_tr_b16 a[86:87], v13 offset:29440
  v_mfma_f32_16x16x32_bf16 v[160:163], a[32:35], a[64:67], v[160:163]
  v_mfma_f32_16x16x32_bf16 v[160:163], a[36:39], a[68:71], v[160:163]
  s_xor_b32 m0, s49, 36864
  v_mfma_f32_16x16x32_bf16 v[164:167], a[44:47], a[68:71], v[164:167]
  s_waitcnt vmcnt(5)
  ds_read_b128 a[0:3], v8 offset:0
  ds_read_b128 a[4:7], v9 offset:0
  ds_read_b128 a[8:11], v8 offset:2048
  ds_read_b128 a[12:15], v9 offset:2048
  v_mfma_f32_16x16x32_bf16 v[164:167], a[40:43], a[64:67], v[164:167]
  buffer_load_dwordx4 v2, s[8:11], s46 offen lds
  v_mfma_f32_16x16x32_bf16 v[168:171], a[48:51], a[64:67], v[168:171]
  v_mfma_f32_16x16x32_bf16 v[168:171], a[52:55], a[68:71], v[168:171]
  v_mfma_f32_16x16x32_bf16 v[172:175], a[60:63], a[68:71], v[172:175]
  s_xor_b32 m0, s49, 38912
  v_mfma_f32_16x16x32_bf16 v[172:175], a[56:59], a[64:67], v[172:175]
  s_waitcnt lgkmcnt(8)
  ds_read_b64_tr_b16 a[88:89], v14 offset:25088
  ds_read_b64_tr_b16 a[90:91], v14 offset:25344
  ds_read_b64_tr_b16 a[92:93], v14 offset:29184
  ds_read_b64_tr_b16 a[94:95], v14 offset:29440
  v_mfma_f32_16x16x32_bf16 v[176:179], a[32:35], a[72:75], v[176:179]
  buffer_load_dwordx4 v2, s[8:11], s47 offen lds
  v_mfma_f32_16x16x32_bf16 v[176:179], a[36:39], a[76:79], v[176:179]
  v_mfma_f32_16x16x32_bf16 v[180:183], a[44:47], a[76:79], v[180:183]
  ds_read_b128 a[16:19], v8 offset:4096
  ds_read_b128 a[20:23], v9 offset:4096
  ds_read_b128 a[24:27], v8 offset:6144
  ds_read_b128 a[28:31], v9 offset:6144
  v_mfma_f32_16x16x32_bf16 v[180:183], a[40:43], a[72:75], v[180:183]
  v_lshl_add_u32 v2, s51, 6, v2
  s_add_u32 m0, s99, 65536
  v_mfma_f32_16x16x32_bf16 v[184:187], a[48:51], a[72:75], v[184:187]
  v_mfma_f32_16x16x32_bf16 v[184:187], a[52:55], a[76:79], v[184:187]
  global_load_lds_dwordx4 v[6:7], off offset:0
  v_mfma_f32_16x16x32_bf16 v[188:191], a[60:63], a[76:79], v[188:191]
  v_mfma_f32_16x16x32_bf16 v[188:191], a[56:59], a[72:75], v[188:191]
  s_waitcnt lgkmcnt(14)
  v_mfma_f32_16x16x32_bf16 v[192:195], a[32:35], a[80:83], v[192:195]
  s_waitcnt lgkmcnt(12)
  v_mfma_f32_16x16x32_bf16 v[192:195], a[36:39], a[84:87], v[192:195]
  s_waitcnt lgkmcnt(0)
  s_barrier
  ds_read_b64_tr_b16 a[64:65], v10 offset:49152
  v_mfma_f32_16x16x32_bf16 v[196:199], a[44:47], a[84:87], v[196:199]
  s_add_u32 m0, s99, 73664
  ds_read_b64_tr_b16 a[66:67], v10 offset:49408
  v_mfma_f32_16x16x32_bf16 v[196:199], a[40:43], a[80:83], v[196:199]
  ds_read_b64_tr_b16 a[68:69], v10 offset:53248
  v_mfma_f32_16x16x32_bf16 v[200:203], a[48:51], a[80:83], v[200:203]
  ds_read_b64_tr_b16 a[70:71], v10 offset:53504
  v_mfma_f32_16x16x32_bf16 v[200:203], a[52:55], a[84:87], v[200:203]
  global_load_lds_dwordx4 v[6:7], off offset:64
  v_mfma_f32_16x16x32_bf16 v[204:207], a[60:63], a[84:87], v[204:207]
  s_add_u32 m0, s99, 81792
  v_mfma_f32_16x16x32_bf16 v[204:207], a[56:59], a[80:83], v[204:207]
  ds_read_b64_tr_b16 a[72:73], v11 offset:49152
  ds_read_b64_tr_b16 a[74:75], v11 offset:49408
  ds_read_b64_tr_b16 a[76:77], v11 offset:53248
  ds_read_b64_tr_b16 a[78:79], v11 offset:53504
  v_mfma_f32_16x16x32_bf16 v[208:211], a[32:35], a[88:91], v[208:211]
  global_load_lds_dwordx4 v[6:7], off offset:128
  v_mfma_f32_16x16x32_bf16 v[208:211], a[36:39], a[92:95], v[208:211]
  v_mfma_f32_16x16x32_bf16 v[212:215], a[44:47], a[92:95], v[212:215]
  v_mfma_f32_16x16x32_bf16 v[212:215], a[40:43], a[88:91], v[212:215]
  v_lshl_add_u64 v[6:7], v[6:7], 0, s[56:57]
  s_xor_b32 m0, s49, 33792
  v_mfma_f32_16x16x32_bf16 v[216:219], a[48:51], a[88:91], v[216:219]
  v_mfma_f32_16x16x32_bf16 v[216:219], a[52:55], a[92:95], v[216:219]
  buffer_load_dwordx4 v3, s[8:11], s44 offen lds
  v_mfma_f32_16x16x32_bf16 v[220:223], a[60:63], a[92:95], v[220:223]
  v_mfma_f32_16x16x32_bf16 v[220:223], a[56:59], a[88:91], v[220:223]
  s_waitcnt lgkmcnt(6)
  ds_read_b64_tr_b16 a[80:81], v12 offset:49152
  ds_read_b64_tr_b16 a[82:83], v12 offset:49408
  v_mfma_f32_16x16x32_bf16 v[64:67], a[0:3], a[64:67], v[64:67]
  s_waitcnt lgkmcnt(6)
  ds_read_b64_tr_b16 a[84:85], v12 offset:53248
  ds_read_b64_tr_b16 a[86:87], v12 offset:53504
  v_mfma_f32_16x16x32_bf16 v[64:67], a[4:7], a[68:71], v[64:67]
  s_xor_b32 m0, s49, 35840
  v_mfma_f32_16x16x32_bf16 v[68:71], a[12:15], a[68:71], v[68:71]
  ds_read_b64_tr_b16 a[96:97], v56 offset:49152
  v_mfma_f32_16x16x32_bf16 v[68:71], a[8:11], a[64:67], v[68:71]
  ds_read_b64_tr_b16 a[98:99], v56 offset:49408
  v_mfma_f32_16x16x32_bf16 v[72:75], a[16:19], a[64:67], v[72:75]
  ds_read_b64_tr_b16 a[100:101], v56 offset:53248
  v_mfma_f32_16x16x32_bf16 v[72:75], a[20:23], a[68:71], v[72:75]
  ds_read_b64_tr_b16 a[102:103], v56 offset:53504
  v_mfma_f32_16x16x32_bf16 v[76:79], a[28:31], a[68:71], v[76:79]
  buffer_load_dwordx4 v3, s[8:11], s45 offen lds
  v_mfma_f32_16x16x32_bf16 v[76:79], a[24:27], a[64:67], v[76:79]
  s_waitcnt lgkmcnt(10)
  ds_read_b64_tr_b16 a[88:89], v13 offset:49152
  ds_read_b64_tr_b16 a[90:91], v13 offset:49408
  v_mfma_f32_16x16x32_bf16 v[80:83], a[0:3], a[72:75], v[80:83]
  s_waitcnt lgkmcnt(10)
  ds_read_b64_tr_b16 a[92:93], v13 offset:53248
  ds_read_b64_tr_b16 a[94:95], v13 offset:53504
  v_mfma_f32_16x16x32_bf16 v[80:83], a[4:7], a[76:79], v[80:83]
  s_xor_b32 m0, s49, 37888
  v_mfma_f32_16x16x32_bf16 v[84:87], a[12:15], a[76:79], v[84:87]
  ds_read_b64_tr_b16 a[104:105], v57 offset:49152
  v_mfma_f32_16x16x32_bf16 v[84:87], a[8:11], a[72:75], v[84:87]
  ds_read_b64_tr_b16 a[106:107], v57 offset:49408
  v_mfma_f32_16x16x32_bf16 v[88:91], a[16:19], a[72:75], v[88:91]
  ds_read_b64_tr_b16 a[108:109], v57 offset:53248
  v_mfma_f32_16x16x32_bf16 v[88:91], a[20:23], a[76:79], v[88:91]
  ds_read_b64_tr_b16 a[110:111], v57 offset:53504
  v_mfma_f32_16x16x32_bf16 v[92:95], a[28:31], a[76:79], v[92:95]
  buffer_load_dwordx4 v3, s[8:11], s46 offen lds
  v_mfma_f32_16x16x32_bf16 v[92:95], a[24:27], a[72:75], v[92:95]
  s_waitcnt lgkmcnt(14)
  ds_read_b64_tr_b16 a[64:65], v14 offset:49152
  ds_read_b64_tr_b16 a[66:67], v14 offset:49408
  v_mfma_f32_16x16x32_bf16 v[96:99], a[0:3], a[80:83], v[96:99]
  s_waitcnt lgkmcnt(14)
  ds_read_b64_tr_b16 a[68:69], v14 offset:53248
  ds_read_b64_tr_b16 a[70:71], v14 offset:53504
  v_mfma_f32_16x16x32_bf16 v[96:99], a[4:7], a[84:87], v[96:99]
  s_xor_b32 m0, s49, 39936
  v_mfma_f32_16x16x32_bf16 v[100:103], a[12:15], a[84:87], v[100:103]
L_hop_kv0:
  s_cbranch_execz L_retkv1
  ds_read_b64_tr_b16 a[112:113], v58 offset:49152
  v_mfma_f32_16x16x32_bf16 v[100:103], a[8:11], a[80:83], v[100:103]
  ds_read_b64_tr_b16 a[114:115], v58 offset:49408
  v_mfma_f32_16x16x32_bf16 v[104:107], a[16:19], a[80:83], v[104:107]
  ds_read_b64_tr_b16 a[116:117], v58 offset:53248
  v_mfma_f32_16x16x32_bf16 v[104:107], a[20:23], a[84:87], v[104:107]
  ds_read_b64_tr_b16 a[118:119], v58 offset:53504
  v_mfma_f32_16x16x32_bf16 v[108:111], a[28:31], a[84:87], v[108:111]
  buffer_load_dwordx4 v3, s[8:11], s47 offen lds
  v_mfma_f32_16x16x32_bf16 v[108:111], a[24:27], a[80:83], v[108:111]
  s_waitcnt lgkmcnt(14)
  ds_read_b64_tr_b16 a[72:73], v10 offset:49664
  ds_read_b64_tr_b16 a[74:75], v10 offset:49920
  v_mfma_f32_16x16x32_bf16 v[112:115], a[0:3], a[88:91], v[112:115]
  s_waitcnt lgkmcnt(14)
  ds_read_b64_tr_b16 a[76:77], v10 offset:53760
  ds_read_b64_tr_b16 a[78:79], v10 offset:54016
  v_mfma_f32_16x16x32_bf16 v[112:115], a[4:7], a[92:95], v[112:115]
  v_lshl_add_u32 v3, s51, 6, v3
  v_mfma_f32_16x16x32_bf16 v[116:119], a[12:15], a[92:95], v[116:119]
  s_cmp_eq_u32 s50, 5
  s_cselect_b64 s[56:57], s[54:55], s[52:53]
  s_cselect_b32 s51, -18, 2
  v_mfma_f32_16x16x32_bf16 v[116:119], a[8:11], a[88:91], v[116:119]
  s_add_u32 m0, s98, 90112
  v_mfma_f32_16x16x32_bf16 v[120:123], a[16:19], a[88:91], v[120:123]
  global_load_lds_dwordx4 v[4:5], off offset:0
  v_mfma_f32_16x16x32_bf16 v[120:123], a[20:23], a[92:95], v[120:123]
  s_add_u32 m0, s98, 98240
  v_mfma_f32_16x16x32_bf16 v[124:127], a[28:31], a[92:95], v[124:127]
  global_load_lds_dwordx4 v[4:5], off offset:64
  v_mfma_f32_16x16x32_bf16 v[124:127], a[24:27], a[88:91], v[124:127]
  s_waitcnt lgkmcnt(4)
  s_add_u32 m0, s98, 106368
  v_mfma_f32_16x16x32_bf16 v[40:43], v[52:55], a[96:99], v[40:43]
  global_load_lds_dwordx4 v[4:5], off offset:128
  v_mfma_f32_16x16x32_bf16 v[40:43], v[52:55], a[100:103], v[40:43]
  v_lshl_add_u64 v[4:5], v[4:5], 0, s[56:57]
  s_xor_b32 m0, s49, 0
  v_mfma_f32_16x16x32_bf16 v[44:47], v[52:55], a[104:107], v[44:47]
  buffer_load_dwordx4 v2, s[8:11], s44 offen lds
  v_mfma_f32_16x16x32_bf16 v[44:47], v[52:55], a[108:111], v[44:47]
  v_mfma_f32_16x16x32_bf16 v[48:51], v[52:55], a[112:115], v[48:51]
  v_mfma_f32_16x16x32_bf16 v[48:51], v[52:55], a[116:119], v[48:51]
  s_waitcnt lgkmcnt(4)
  ds_read_b64_tr_b16 a[80:81], v11 offset:49664
  ds_read_b64_tr_b16 a[82:83], v11 offset:49920
  v_mfma_f32_16x16x32_bf16 v[128:131], a[0:3], a[64:67], v[128:131]
  s_waitcnt lgkmcnt(6)
  ds_read_b64_tr_b16 a[84:85], v11 offset:53760
  ds_read_b64_tr_b16 a[86:87], v11 offset:54016
  v_mfma_f32_16x16x32_bf16 v[128:131], a[4:7], a[68:71], v[128:131]
  s_xor_b32 m0, s49, 2048
  v_mfma_f32_16x16x32_bf16 v[132:135], a[12:15], a[68:71], v[132:135]
  buffer_load_dwordx4 v2, s[8:11], s45 offen lds
  v_mfma_f32_16x16x32_bf16 v[132:135], a[8:11], a[64:67], v[132:135]
  v_mfma_f32_16x16x32_bf16 v[136:139], a[16:19], a[64:67], v[136:139]
  v_mfma_f32_16x16x32_bf16 v[136:139], a[20:23], a[68:71], v[136:139]
  s_xor_b32 m0, s49, 4096
  v_mfma_f32_16x16x32_bf16 v[140:143], a[28:31], a[68:71], v[140:143]
  v_mfma_f32_16x16x32_bf16 v[140:143], a[24:27], a[64:67], v[140:143]
  s_waitcnt lgkmcnt(6)
  ds_read_b64_tr_b16 a[88:89], v12 offset:49664
  ds_read_b64_tr_b16 a[90:91], v12 offset:49920
  v_mfma_f32_16x16x32_bf16 v[144:147], a[0:3], a[72:75], v[144:147]
  s_waitcnt lgkmcnt(6)
  ds_read_b64_tr_b16 a[92:93], v12 offset:53760
  ds_read_b64_tr_b16 a[94:95], v12 offset:54016
  v_mfma_f32_16x16x32_bf16 v[144:147], a[4:7], a[76:79], v[144:147]
  buffer_load_dwordx4 v2, s[8:11], s46 offen lds
  v_mfma_f32_16x16x32_bf16 v[148:151], a[12:15], a[76:79], v[148:151]
  s_xor_b32 m0, s49, 6144
  v_mov_b32 v41, v44
  v_mov_b32 v42, v48
  v_mfma_f32_16x16x32_bf16 v[148:151], a[8:11], a[72:75], v[148:151]
  v_mov_b32 v43, s61
  v_mfma_f32_16x16x32_bf16 v[152:155], a[16:19], a[72:75], v[152:155]
  buffer_load_dwordx4 v2, s[8:11], s47 offen lds
  v_mfma_f32_16x16x32_bf16 v[152:155], a[20:23], a[76:79], v[152:155]
  buffer_store_dwordx4 v[40:43], v61, s[12:15], s65 offen sc1
  v_mfma_f32_16x16x32_bf16 v[156:159], a[28:31], a[76:79], v[156:159]
  v_not_b32 v39, v43
  s_mov_b32 s62, 19922944
  v_mfma_f32_16x16x32_bf16 v[156:159], a[24:27], a[72:75], v[156:159]
  s_waitcnt lgkmcnt(6)
  ds_read_b64_tr_b16 a[64:65], v13 offset:49664
  ds_read_b64_tr_b16 a[66:67], v13 offset:49920
  v_mfma_f32_16x16x32_bf16 v[160:163], a[0:3], a[80:83], v[160:163]
  s_waitcnt lgkmcnt(6)
  ds_read_b64_tr_b16 a[68:69], v13 offset:53760
  ds_read_b64_tr_b16 a[70:71], v13 offset:54016
  v_mfma_f32_16x16x32_bf16 v[160:163], a[4:7], a[84:87], v[160:163]
  buffer_store_dword v39, v1, s[12:15], s62 offen sc1
  v_mfma_f32_16x16x32_bf16 v[164:167], a[12:15], a[84:87], v[164:167]
  s_waitcnt vmcnt(9)
  ds_read_b128 a[32:35], v8 offset:32768
  v_lshl_add_u32 v2, s51, 6, v2
  v_mfma_f32_16x16x32_bf16 v[164:167], a[8:11], a[80:83], v[164:167]
  s_add_u32 m0, s99, 90112
  ds_read_b128 a[36:39], v9 offset:32768
  s_mov_b32 s62, 22020096
  v_mfma_f32_16x16x32_bf16 v[168:171], a[16:19], a[80:83], v[168:171]
  ds_read_b128 a[40:43], v8 offset:34816
  v_mfma_f32_16x16x32_bf16 v[168:171], a[20:23], a[84:87], v[168:171]
  ds_read_b128 a[44:47], v9 offset:34816
  v_mfma_f32_16x16x32_bf16 v[172:175], a[28:31], a[84:87], v[172:175]
  global_load_lds_dwordx4 v[6:7], off offset:0
  v_mfma_f32_16x16x32_bf16 v[172:175], a[24:27], a[80:83], v[172:175]
  s_waitcnt lgkmcnt(10)
  ds_read_b64_tr_b16 a[72:73], v14 offset:49664
  ds_read_b64_tr_b16 a[74:75], v14 offset:49920
  v_mfma_f32_16x16x32_bf16 v[176:179], a[0:3], a[88:91], v[176:179]
  s_waitcnt lgkmcnt(10)
  ds_read_b64_tr_b16 a[76:77], v14 offset:53760
  ds_read_b64_tr_b16 a[78:79], v14 offset:54016
  v_mfma_f32_16x16x32_bf16 v[176:179], a[4:7], a[92:95], v[176:179]
  s_add_u32 m0, s99, 98240
  buffer_store_dword v39, v1, s[12:15], s62 offen sc1
  v_mfma_f32_16x16x32_bf16 v[180:183], a[12:15], a[92:95], v[180:183]
  s_add_u32 s65, s64, 4096
  ds_read_b128 a[48:51], v8 offset:36864
  s_lshl_b32 s66, s4, 2
  v_mfma_f32_16x16x32_bf16 v[180:183], a[8:11], a[88:91], v[180:183]
  s_add_u32 s66, s66, s3
  ds_read_b128 a[52:55], v9 offset:36864
  s_lshl_b32 s66, s66, 9
  v_mfma_f32_16x16x32_bf16 v[184:187], a[16:19], a[88:91], v[184:187]
  s_add_u32 s66, s66, 65536
  ds_read_b128 a[56:59], v8 offset:38912
  v_lshlrev_b32 v62, 3, v0
  v_mfma_f32_16x16x32_bf16 v[184:187], a[20:23], a[92:95], v[184:187]
  s_mul_i32 s67, s3, 192
  ds_read_b128 a[60:63], v9 offset:38912
  s_add_u32 s67, s67, 139264
  v_mfma_f32_16x16x32_bf16 v[188:191], a[28:31], a[92:95], v[188:191]
  global_load_lds_dwordx4 v[6:7], off offset:64
  v_mfma_f32_16x16x32_bf16 v[188:191], a[24:27], a[88:91], v[188:191]
  s_waitcnt lgkmcnt(14)
  s_add_u32 m0, s99, 106368
  v_min_u32 v61, 48, v0
  v_mfma_f32_16x16x32_bf16 v[192:195], a[0:3], a[64:67], v[192:195]
  s_waitcnt lgkmcnt(12)
  global_load_lds_dwordx4 v[6:7], off offset:128
  v_mfma_f32_16x16x32_bf16 v[192:195], a[4:7], a[68:71], v[192:195]
  s_waitcnt lgkmcnt(0)
  s_barrier
  ds_read_b64_tr_b16 a[80:81], v10 offset:0
  v_mfma_f32_16x16x32_bf16 v[196:199], a[12:15], a[68:71], v[196:199]
  ds_read_b64_tr_b16 a[82:83], v10 offset:256
  v_lshl_add_u64 v[6:7], v[6:7], 0, s[56:57]
  v_mfma_f32_16x16x32_bf16 v[196:199], a[8:11], a[64:67], v[196:199]
  s_xor_b32 m0, s49, 1024
  ds_read_b64_tr_b16 a[84:85], v10 offset:4096
  v_cmp_lt_u32 vcc, 47, v0
  v_mfma_f32_16x16x32_bf16 v[200:203], a[16:19], a[64:67], v[200:203]
  ds_read_b64_tr_b16 a[86:87], v10 offset:4352
  v_lshl_add_u32 v61, v61, 2, s67
  v_mfma_f32_16x16x32_bf16 v[200:203], a[20:23], a[68:71], v[200:203]
  buffer_load_dwordx4 v3, s[8:11], s44 offen lds
  v_mfma_f32_16x16x32_bf16 v[204:207], a[28:31], a[68:71], v[204:207]
  s_xor_b32 m0, s49, 3072
  v_mov_b32 v56, 140032
  s_lshl_b32 s67, s3, 10
  v_mfma_f32_16x16x32_bf16 v[204:207], a[24:27], a[64:67], v[204:207]
  s_waitcnt lgkmcnt(4)
  ds_read_b64_tr_b16 a[88:89], v11 offset:0
  ds_read_b64_tr_b16 a[90:91], v11 offset:256
  v_mfma_f32_16x16x32_bf16 v[208:211], a[0:3], a[72:75], v[208:211]
  s_waitcnt lgkmcnt(6)
  ds_read_b64_tr_b16 a[92:93], v11 offset:4096
  ds_read_b64_tr_b16 a[94:95], v11 offset:4352
  v_mfma_f32_16x16x32_bf16 v[208:211], a[4:7], a[76:79], v[208:211]
  s_add_u32 s67, s67, 140288
  buffer_load_dwordx4 v3, s[8:11], s45 offen lds
  v_mfma_f32_16x16x32_bf16 v[212:215], a[12:15], a[76:79], v[212:215]
  s_xor_b32 m0, s49, 5120
  v_cndmask_b32 v61, v61, v56, vcc
  v_lshl_add_u32 v56, v0, 2, s67
  v_mfma_f32_16x16x32_bf16 v[212:215], a[8:11], a[72:75], v[212:215]
  v_lshrrev_b32 v57, 4, v0
  v_lshl_add_u32 v57, v57, 4, s67
  v_mfma_f32_16x16x32_bf16 v[216:219], a[16:19], a[72:75], v[216:219]
  buffer_load_dwordx4 v3, s[8:11], s46 offen lds
  v_mfma_f32_16x16x32_bf16 v[216:219], a[20:23], a[76:79], v[216:219]
  v_mfma_f32_16x16x32_bf16 v[220:223], a[28:31], a[76:79], v[220:223]
  v_mfma_f32_16x16x32_bf16 v[220:223], a[24:27], a[72:75], v[220:223]
  s_waitcnt lgkmcnt(6)
  ds_read_b64_tr_b16 a[64:65], v12 offset:0
  ds_read_b64_tr_b16 a[66:67], v12 offset:256
  v_mfma_f32_16x16x32_bf16 v[64:67], a[32:35], a[80:83], v[64:67]
  s_waitcnt lgkmcnt(6)
  ds_read_b64_tr_b16 a[68:69], v12 offset:4096
  ds_read_b64_tr_b16 a[70:71], v12 offset:4352
  v_mfma_f32_16x16x32_bf16 v[64:67], a[36:39], a[84:87], v[64:67]
  s_xor_b32 m0, s49, 7168
  v_mfma_f32_16x16x32_bf16 v[68:71], a[44:47], a[84:87], v[68:71]
  buffer_load_dwordx4 v3, s[8:11], s47 offen lds
  v_mfma_f32_16x16x32_bf16 v[68:71], a[40:43], a[80:83], v[68:71]
  v_mfma_f32_16x16x32_bf16 v[72:75], a[48:51], a[80:83], v[72:75]
  v_mfma_f32_16x16x32_bf16 v[72:75], a[52:55], a[84:87], v[72:75]
  v_lshl_add_u32 v3, s51, 6, v3
  v_mfma_f32_16x16x32_bf16 v[76:79], a[60:63], a[84:87], v[76:79]
  s_cmp_eq_u32 s50, 4
  s_cselect_b64 s[56:57], s[54:55], s[52:53]
  s_cselect_b32 s51, -18, 2
  v_mfma_f32_16x16x32_bf16 v[76:79], a[56:59], a[80:83], v[76:79]
  s_waitcnt lgkmcnt(6)
  ds_read_b64_tr_b16 a[72:73], v13 offset:0
  ds_read_b64_tr_b16 a[74:75], v13 offset:256
  v_mfma_f32_16x16x32_bf16 v[80:83], a[32:35], a[88:91], v[80:83]
  s_waitcnt lgkmcnt(6)
  ds_read_b64_tr_b16 a[76:77], v13 offset:4096
  ds_read_b64_tr_b16 a[78:79], v13 offset:4352
  v_mfma_f32_16x16x32_bf16 v[80:83], a[36:39], a[92:95], v[80:83]
  s_add_u32 m0, s98, 114688
  v_mfma_f32_16x16x32_bf16 v[84:87], a[44:47], a[92:95], v[84:87]
  global_load_lds_dwordx4 v[4:5], off offset:0
  v_mfma_f32_16x16x32_bf16 v[84:87], a[40:43], a[88:91], v[84:87]
  s_add_u32 m0, s98, 122816
  v_mfma_f32_16x16x32_bf16 v[88:91], a[48:51], a[88:91], v[88:91]
  global_load_lds_dwordx4 v[4:5], off offset:64
  v_mfma_f32_16x16x32_bf16 v[88:91], a[52:55], a[92:95], v[88:91]
  v_mfma_f32_16x16x32_bf16 v[92:95], a[60:63], a[92:95], v[92:95]
  v_mfma_f32_16x16x32_bf16 v[92:95], a[56:59], a[88:91], v[92:95]
  s_waitcnt lgkmcnt(6)
  ds_read_b64_tr_b16 a[80:81], v14 offset:0
  ds_read_b64_tr_b16 a[82:83], v14 offset:256
  v_mfma_f32_16x16x32_bf16 v[96:99], a[32:35], a[64:67], v[96:99]
  s_waitcnt lgkmcnt(6)
  ds_read_b64_tr_b16 a[84:85], v14 offset:4096
  ds_read_b64_tr_b16 a[86:87], v14 offset:4352
  v_mfma_f32_16x16x32_bf16 v[96:99], a[36:39], a[68:71], v[96:99]
  s_add_u32 m0, s98, 130944
  v_mfma_f32_16x16x32_bf16 v[100:103], a[44:47], a[68:71], v[100:103]
  global_load_lds_dwordx4 v[4:5], off offset:128
  v_mfma_f32_16x16x32_bf16 v[100:103], a[40:43], a[64:67], v[100:103]
  v_mfma_f32_16x16x32_bf16 v[104:107], a[48:51], a[64:67], v[104:107]
  v_lshl_add_u64 v[4:5], v[4:5], 0, s[56:57]
  s_xor_b32 m0, s49, 32768
  v_mfma_f32_16x16x32_bf16 v[104:107], a[52:55], a[68:71], v[104:107]
  v_mfma_f32_16x16x32_bf16 v[108:111], a[60:63], a[68:71], v[108:111]
  buffer_load_dwordx4 v2, s[8:11], s44 offen lds
  v_mfma_f32_16x16x32_bf16 v[108:111], a[56:59], a[64:67], v[108:111]
  s_waitcnt lgkmcnt(6)
  ds_read_b64_tr_b16 a[88:89], v10 offset:512
  ds_read_b64_tr_b16 a[90:91], v10 offset:768
  v_mfma_f32_16x16x32_bf16 v[112:115], a[32:35], a[72:75], v[112:115]
  s_waitcnt lgkmcnt(6)
  ds_read_b64_tr_b16 a[92:93], v10 offset:4608
  ds_read_b64_tr_b16 a[94:95], v10 offset:4864
  v_mfma_f32_16x16x32_bf16 v[112:115], a[36:39], a[76:79], v[112:115]
  v_mfma_f32_16x16x32_bf16 v[116:119], a[44:47], a[76:79], v[116:119]
  s_xor_b32 m0, s49, 34816
  v_mfma_f32_16x16x32_bf16 v[116:119], a[40:43], a[72:75], v[116:119]
  v_mfma_f32_16x16x32_bf16 v[120:123], a[48:51], a[72:75], v[120:123]
  buffer_load_dwordx4 v2, s[8:11], s45 offen lds
  v_mfma_f32_16x16x32_bf16 v[120:123], a[52:55], a[76:79], v[120:123]
  v_mfma_f32_16x16x32_bf16 v[124:127], a[60:63], a[76:79], v[124:127]
  v_mfma_f32_16x16x32_bf16 v[124:127], a[56:59], a[72:75], v[124:127]
  s_waitcnt lgkmcnt(6)
  ds_read_b64_tr_b16 a[64:65], v11 offset:512
  ds_read_b64_tr_b16 a[66:67], v11 offset:768
  v_mfma_f32_16x16x32_bf16 v[128:131], a[32:35], a[80:83], v[128:131]
  s_waitcnt lgkmcnt(6)
  ds_read_b64_tr_b16 a[68:69], v11 offset:4608
  ds_read_b64_tr_b16 a[70:71], v11 offset:4864
  v_mfma_f32_16x16x32_bf16 v[128:131], a[36:39], a[84:87], v[128:131]
  s_xor_b32 m0, s49, 36864
  v_mfma_f32_16x16x32_bf16 v[132:135], a[44:47], a[84:87], v[132:135]
  buffer_load_dwordx4 v2, s[8:11], s46 offen lds
  v_mfma_f32_16x16x32_bf16 v[132:135], a[40:43], a[80:83], v[132:135]
  v_mfma_f32_16x16x32_bf16 v[136:139], a[48:51], a[80:83], v[136:139]
  s_xor_b32 m0, s49, 38912
  v_mfma_f32_16x16x32_bf16 v[136:139], a[52:55], a[84:87], v[136:139]
  v_mfma_f32_16x16x32_bf16 v[140:143], a[60:63], a[84:87], v[140:143]
  buffer_load_dwordx4 v2, s[8:11], s47 offen lds
  v_mfma_f32_16x16x32_bf16 v[140:143], a[56:59], a[80:83], v[140:143]
  s_waitcnt lgkmcnt(6)
  ds_read_b64_tr_b16 a[72:73], v12 offset:512
  ds_read_b64_tr_b16 a[74:75], v12 offset:768
  v_mfma_f32_16x16x32_bf16 v[144:147], a[32:35], a[88:91], v[144:147]
  s_waitcnt lgkmcnt(6)
  ds_read_b64_tr_b16 a[76:77], v12 offset:4608
  ds_read_b64_tr_b16 a[78:79], v12 offset:4864
  v_mfma_f32_16x16x32_bf16 v[144:147], a[36:39], a[92:95], v[144:147]
  v_mfma_f32_16x16x32_bf16 v[148:151], a[44:47], a[92:95], v[148:151]
  v_lshl_add_u32 v2, s51, 6, v2
  s_add_u32 m0, s99, 114688
  v_mfma_f32_16x16x32_bf16 v[148:151], a[40:43], a[88:91], v[148:151]
  v_mfma_f32_16x16x32_bf16 v[152:155], a[48:51], a[88:91], v[152:155]
  global_load_lds_dwordx4 v[6:7], off offset:0
  v_mfma_f32_16x16x32_bf16 v[152:155], a[52:55], a[92:95], v[152:155]
  v_mfma_f32_16x16x32_bf16 v[156:159], a[60:63], a[92:95], v[156:159]
  v_mfma_f32_16x16x32_bf16 v[156:159], a[56:59], a[88:91], v[156:159]
  s_waitcnt lgkmcnt(6)
  ds_read_b64_tr_b16 a[80:81], v13 offset:512
  ds_read_b64_tr_b16 a[82:83], v13 offset:768
  v_mfma_f32_16x16x32_bf16 v[160:163], a[32:35], a[64:67], v[160:163]
  s_waitcnt lgkmcnt(6)
  ds_read_b64_tr_b16 a[84:85], v13 offset:4608
  ds_read_b64_tr_b16 a[86:87], v13 offset:4864
  v_mfma_f32_16x16x32_bf16 v[160:163], a[36:39], a[68:71], v[160:163]
  s_add_u32 m0, s99, 122816
  v_mfma_f32_16x16x32_bf16 v[164:167], a[44:47], a[68:71], v[164:167]
  s_waitcnt vmcnt(8)
  ds_read_b128 a[0:3], v8 offset:0
  v_mfma_f32_16x16x32_bf16 v[164:167], a[40:43], a[64:67], v[164:167]
  ds_read_b128 a[4:7], v9 offset:0
  v_mfma_f32_16x16x32_bf16 v[168:171], a[48:51], a[64:67], v[168:171]
  ds_read_b128 a[8:11], v8 offset:2048
  v_mfma_f32_16x16x32_bf16 v[168:171], a[52:55], a[68:71], v[168:171]
  ds_read_b128 a[12:15], v9 offset:2048
  v_mfma_f32_16x16x32_bf16 v[172:175], a[60:63], a[68:71], v[172:175]
  global_load_lds_dwordx4 v[6:7], off offset:64
  v_mfma_f32_16x16x32_bf16 v[172:175], a[56:59], a[64:67], v[172:175]
  s_waitcnt lgkmcnt(10)
  ds_read_b64_tr_b16 a[88:89], v14 offset:512
  ds_read_b64_tr_b16 a[90:91], v14 offset:768
  v_mfma_f32_16x16x32_bf16 v[176:179], a[32:35], a[72:75], v[176:179]
  s_waitcnt lgkmcnt(10)
  ds_read_b64_tr_b16 a[92:93], v14 offset:4608
  ds_read_b64_tr_b16 a[94:95], v14 offset:4864
  v_mfma_f32_16x16x32_bf16 v[176:179], a[36:39], a[76:79], v[176:179]
  s_add_u32 m0, s99, 130944
  v_mfma_f32_16x16x32_bf16 v[180:183], a[44:47], a[76:79], v[180:183]
  ds_read_b128 a[16:19], v8 offset:4096
  v_mfma_f32_16x16x32_bf16 v[180:183], a[40:43], a[72:75], v[180:183]
  ds_read_b128 a[20:23], v9 offset:4096
  v_mfma_f32_16x16x32_bf16 v[184:187], a[48:51], a[72:75], v[184:187]
  ds_read_b128 a[24:27], v8 offset:6144
  v_mfma_f32_16x16x32_bf16 v[184:187], a[52:55], a[76:79], v[184:187]
  ds_read_b128 a[28:31], v9 offset:6144
  v_mfma_f32_16x16x32_bf16 v[188:191], a[60:63], a[76:79], v[188:191]
  global_load_lds_dwordx4 v[6:7], off offset:128
  v_mfma_f32_16x16x32_bf16 v[188:191], a[56:59], a[72:75], v[188:191]
  s_waitcnt lgkmcnt(14)
  v_lshl_add_u64 v[6:7], v[6:7], 0, s[56:57]
  s_xor_b32 m0, s49, 33792
  v_mfma_f32_16x16x32_bf16 v[192:195], a[32:35], a[80:83], v[192:195]
  s_waitcnt lgkmcnt(12)
  buffer_load_dwordx4 v3, s[8:11], s44 offen lds
  v_mfma_f32_16x16x32_bf16 v[192:195], a[36:39], a[84:87], v[192:195]
  s_waitcnt lgkmcnt(0)
  s_barrier
  ds_read_b64_tr_b16 a[64:65], v10 offset:24576
  v_mfma_f32_16x16x32_bf16 v[196:199], a[44:47], a[84:87], v[196:199]
  s_xor_b32 m0, s49, 35840
  ds_read_b64_tr_b16 a[66:67], v10 offset:24832
  v_mfma_f32_16x16x32_bf16 v[196:199], a[40:43], a[80:83], v[196:199]
  ds_read_b64_tr_b16 a[68:69], v10 offset:28672
  v_mfma_f32_16x16x32_bf16 v[200:203], a[48:51], a[80:83], v[200:203]
  ds_read_b64_tr_b16 a[70:71], v10 offset:28928
  v_mfma_f32_16x16x32_bf16 v[200:203], a[52:55], a[84:87], v[200:203]
  buffer_load_dwordx4 v3, s[8:11], s45 offen lds
  v_mfma_f32_16x16x32_bf16 v[204:207], a[60:63], a[84:87], v[204:207]
  s_xor_b32 m0, s49, 37888
  v_mfma_f32_16x16x32_bf16 v[204:207], a[56:59], a[80:83], v[204:207]
  s_waitcnt lgkmcnt(4)
  ds_read_b64_tr_b16 a[72:73], v11 offset:24576
  ds_read_b64_tr_b16 a[74:75], v11 offset:24832
  v_mfma_f32_16x16x32_bf16 v[208:211], a[32:35], a[88:91], v[208:211]
  s_waitcnt lgkmcnt(6)
  ds_read_b64_tr_b16 a[76:77], v11 offset:28672
  ds_read_b64_tr_b16 a[78:79], v11 offset:28928
  v_mfma_f32_16x16x32_bf16 v[208:211], a[36:39], a[92:95], v[208:211]
  buffer_load_dwordx4 v3, s[8:11], s46 offen lds
  v_mfma_f32_16x16x32_bf16 v[212:215], a[44:47], a[92:95], v[212:215]
  s_xor_b32 m0, s49, 39936
  v_mfma_f32_16x16x32_bf16 v[212:215], a[40:43], a[88:91], v[212:215]
  buffer_load_dwordx4 v3, s[8:11], s47 offen lds
  v_mfma_f32_16x16x32_bf16 v[216:219], a[48:51], a[88:91], v[216:219]
  v_mfma_f32_16x16x32_bf16 v[216:219], a[52:55], a[92:95], v[216:219]
  v_mfma_f32_16x16x32_bf16 v[220:223], a[60:63], a[92:95], v[220:223]
  v_mfma_f32_16x16x32_bf16 v[220:223], a[56:59], a[88:91], v[220:223]
  s_waitcnt lgkmcnt(6)
  ds_read_b64_tr_b16 a[80:81], v12 offset:24576
  ds_read_b64_tr_b16 a[82:83], v12 offset:24832
  v_mfma_f32_16x16x32_bf16 v[64:67], a[0:3], a[64:67], v[64:67]
  s_waitcnt lgkmcnt(6)
  ds_read_b64_tr_b16 a[84:85], v12 offset:28672
  ds_read_b64_tr_b16 a[86:87], v12 offset:28928
  v_mfma_f32_16x16x32_bf16 v[64:67], a[4:7], a[68:71], v[64:67]
  buffer_load_dwordx4 v[40:43], v38, s[12:15], s64 offen sc1
  v_mfma_f32_16x16x32_bf16 v[68:71], a[12:15], a[68:71], v[68:71]
  buffer_load_dwordx4 v[44:47], v38, s[12:15], s65 offen sc1
  v_mfma_f32_16x16x32_bf16 v[68:71], a[8:11], a[64:67], v[68:71]
  buffer_load_dwordx2 v[48:49], v62, s[12:15], s66 offen sc1
  v_mfma_f32_16x16x32_bf16 v[72:75], a[16:19], a[64:67], v[72:75]
  v_lshl_add_u32 v3, s51, 6, v3
  v_mfma_f32_16x16x32_bf16 v[72:75], a[20:23], a[68:71], v[72:75]
  s_cmp_eq_u32 s50, 3
  s_cselect_b64 s[56:57], s[54:55], s[52:53]
  s_cselect_b32 s51, -18, 2
  v_mfma_f32_16x16x32_bf16 v[76:79], a[28:31], a[68:71], v[76:79]
  s_add_u32 m0, s98, 65536
  v_mfma_f32_16x16x32_bf16 v[76:79], a[24:27], a[64:67], v[76:79]
  s_waitcnt lgkmcnt(6)
  ds_read_b64_tr_b16 a[88:89], v13 offset:24576
  ds_read_b64_tr_b16 a[90:91], v13 offset:24832
  v_mfma_f32_16x16x32_bf16 v[80:83], a[0:3], a[72:75], v[80:83]
  s_waitcnt lgkmcnt(6)
  ds_read_b64_tr_b16 a[92:93], v13 offset:28672
  ds_read_b64_tr_b16 a[94:95], v13 offset:28928
  v_mfma_f32_16x16x32_bf16 v[80:83], a[4:7], a[76:79], v[80:83]
  global_load_lds_dwordx4 v[4:5], off offset:0
  v_mfma_f32_16x16x32_bf16 v[84:87], a[12:15], a[76:79], v[84:87]
  s_add_u32 m0, s98, 73664
  v_mfma_f32_16x16x32_bf16 v[84:87], a[8:11], a[72:75], v[84:87]
  global_load_lds_dwordx4 v[4:5], off offset:64
  v_mfma_f32_16x16x32_bf16 v[88:91], a[16:19], a[72:75], v[88:91]
  s_add_u32 m0, s98, 81792
  v_mfma_f32_16x16x32_bf16 v[88:91], a[20:23], a[76:79], v[88:91]
  global_load_lds_dwordx4 v[4:5], off offset:128
  v_mfma_f32_16x16x32_bf16 v[92:95], a[28:31], a[76:79], v[92:95]
  v_mfma_f32_16x16x32_bf16 v[92:95], a[24:27], a[72:75], v[92:95]
  s_waitcnt lgkmcnt(6)
  ds_read_b64_tr_b16 a[64:65], v14 offset:24576
  ds_read_b64_tr_b16 a[66:67], v14 offset:24832
  v_mfma_f32_16x16x32_bf16 v[96:99], a[0:3], a[80:83], v[96:99]
  s_waitcnt lgkmcnt(6)
  ds_read_b64_tr_b16 a[68:69], v14 offset:28672
  ds_read_b64_tr_b16 a[70:71], v14 offset:28928
  v_mfma_f32_16x16x32_bf16 v[96:99], a[4:7], a[84:87], v[96:99]
  v_lshl_add_u64 v[4:5], v[4:5], 0, s[56:57]
  s_xor_b32 m0, s49, 0
  v_mfma_f32_16x16x32_bf16 v[100:103], a[12:15], a[84:87], v[100:103]
  buffer_load_dwordx4 v2, s[8:11], s44 offen lds
  v_mfma_f32_16x16x32_bf16 v[100:103], a[8:11], a[80:83], v[100:103]
  v_mfma_f32_16x16x32_bf16 v[104:107], a[16:19], a[80:83], v[104:107]
  s_xor_b32 m0, s49, 2048
  v_mfma_f32_16x16x32_bf16 v[104:107], a[20:23], a[84:87], v[104:107]
  v_mfma_f32_16x16x32_bf16 v[108:111], a[28:31], a[84:87], v[108:111]
  buffer_load_dwordx4 v2, s[8:11], s45 offen lds
  v_mfma_f32_16x16x32_bf16 v[108:111], a[24:27], a[80:83], v[108:111]
  s_waitcnt lgkmcnt(6)
  ds_read_b64_tr_b16 a[72:73], v10 offset:25088
  ds_read_b64_tr_b16 a[74:75], v10 offset:25344
  v_mfma_f32_16x16x32_bf16 v[112:115], a[0:3], a[88:91], v[112:115]
  s_waitcnt lgkmcnt(6)
  ds_read_b64_tr_b16 a[76:77], v10 offset:29184
  ds_read_b64_tr_b16 a[78:79], v10 offset:29440
  v_mfma_f32_16x16x32_bf16 v[112:115], a[4:7], a[92:95], v[112:115]
  s_xor_b32 m0, s49, 4096
  v_mfma_f32_16x16x32_bf16 v[116:119], a[12:15], a[92:95], v[116:119]
  v_mfma_f32_16x16x32_bf16 v[116:119], a[8:11], a[88:91], v[116:119]
  buffer_load_dwordx4 v2, s[8:11], s46 offen lds
  v_mfma_f32_16x16x32_bf16 v[120:123], a[16:19], a[88:91], v[120:123]
  v_mfma_f32_16x16x32_bf16 v[120:123], a[20:23], a[92:95], v[120:123]
  v_mfma_f32_16x16x32_bf16 v[124:127], a[28:31], a[92:95], v[124:127]
  v_mfma_f32_16x16x32_bf16 v[124:127], a[24:27], a[88:91], v[124:127]
  s_waitcnt lgkmcnt(6)
  ds_read_b64_tr_b16 a[80:81], v11 offset:25088
  ds_read_b64_tr_b16 a[82:83], v11 offset:25344
  v_mfma_f32_16x16x32_bf16 v[128:131], a[0:3], a[64:67], v[128:131]
  s_waitcnt lgkmcnt(6)
  ds_read_b64_tr_b16 a[84:85], v11 offset:29184
  ds_read_b64_tr_b16 a[86:87], v11 offset:29440
  v_mfma_f32_16x16x32_bf16 v[128:131], a[4:7], a[68:71], v[128:131]
  s_xor_b32 m0, s49, 6144
  v_mfma_f32_16x16x32_bf16 v[132:135], a[12:15], a[68:71], v[132:135]
  buffer_load_dwordx4 v2, s[8:11], s47 offen lds
  v_mfma_f32_16x16x32_bf16 v[132:135], a[8:11], a[64:67], v[132:135]
  v_mfma_f32_16x16x32_bf16 v[136:139], a[16:19], a[64:67], v[136:139]
  v_lshl_add_u32 v2, s51, 6, v2
  s_add_u32 m0, s99, 65536
  v_mfma_f32_16x16x32_bf16 v[136:139], a[20:23], a[68:71], v[136:139]
  v_mfma_f32_16x16x32_bf16 v[140:143], a[28:31], a[68:71], v[140:143]
  global_load_lds_dwordx4 v[6:7], off offset:0
  v_mfma_f32_16x16x32_bf16 v[140:143], a[24:27], a[64:67], v[140:143]
  s_waitcnt lgkmcnt(6)
  ds_read_b64_tr_b16 a[88:89], v12 offset:25088
  ds_read_b64_tr_b16 a[90:91], v12 offset:25344
  v_mfma_f32_16x16x32_bf16 v[144:147], a[0:3], a[72:75], v[144:147]
  s_waitcnt lgkmcnt(6)
  ds_read_b64_tr_b16 a[92:93], v12 offset:29184
  ds_read_b64_tr_b16 a[94:95], v12 offset:29440
  v_mfma_f32_16x16x32_bf16 v[144:147], a[4:7], a[76:79], v[144:147]
  s_add_u32 m0, s99, 73664
  v_mfma_f32_16x16x32_bf16 v[148:151], a[12:15], a[76:79], v[148:151]
  v_mfma_f32_16x16x32_bf16 v[148:151], a[8:11], a[72:75], v[148:151]
  global_load_lds_dwordx4 v[6:7], off offset:64
  v_mfma_f32_16x16x32_bf16 v[152:155], a[16:19], a[72:75], v[152:155]
  v_mfma_f32_16x16x32_bf16 v[152:155], a[20:23], a[76:79], v[152:155]
  v_mfma_f32_16x16x32_bf16 v[156:159], a[28:31], a[76:79], v[156:159]
  s_add_u32 m0, s99, 81792
  v_mfma_f32_16x16x32_bf16 v[156:159], a[24:27], a[72:75], v[156:159]
  s_waitcnt lgkmcnt(6)
  ds_read_b64_tr_b16 a[64:65], v13 offset:25088
  ds_read_b64_tr_b16 a[66:67], v13 offset:25344
  v_mfma_f32_16x16x32_bf16 v[160:163], a[0:3], a[80:83], v[160:163]
  s_waitcnt lgkmcnt(6)
  ds_read_b64_tr_b16 a[68:69], v13 offset:29184
  ds_read_b64_tr_b16 a[70:71], v13 offset:29440
  v_mfma_f32_16x16x32_bf16 v[160:163], a[4:7], a[84:87], v[160:163]
  global_load_lds_dwordx4 v[6:7], off offset:128
  v_mfma_f32_16x16x32_bf16 v[164:167], a[12:15], a[84:87], v[164:167]
  s_waitcnt vmcnt(13)
  ds_read_b128 a[32:35], v8 offset:32768
  v_mfma_f32_16x16x32_bf16 v[164:167], a[8:11], a[80:83], v[164:167]
  ds_read_b128 a[36:39], v9 offset:32768
  v_mfma_f32_16x16x32_bf16 v[168:171], a[16:19], a[80:83], v[168:171]
  ds_read_b128 a[40:43], v8 offset:34816
  v_lshl_add_u64 v[6:7], v[6:7], 0, s[56:57]
  v_mfma_f32_16x16x32_bf16 v[168:171], a[20:23], a[84:87], v[168:171]
  s_xor_b32 m0, s49, 1024
  ds_read_b128 a[44:47], v9 offset:34816
  v_mfma_f32_16x16x32_bf16 v[172:175], a[28:31], a[84:87], v[172:175]
  buffer_load_dwordx4 v3, s[8:11], s44 offen lds
  v_mfma_f32_16x16x32_bf16 v[172:175], a[24:27], a[80:83], v[172:175]
  s_waitcnt lgkmcnt(10)
  ds_read_b64_tr_b16 a[72:73], v14 offset:25088
  ds_read_b64_tr_b16 a[74:75], v14 offset:25344
  v_mfma_f32_16x16x32_bf16 v[176:179], a[0:3], a[88:91], v[176:179]
  s_waitcnt lgkmcnt(10)
  ds_read_b64_tr_b16 a[76:77], v14 offset:29184
  ds_read_b64_tr_b16 a[78:79], v14 offset:29440
  v_mfma_f32_16x16x32_bf16 v[176:179], a[4:7], a[92:95], v[176:179]
  s_xor_b32 m0, s49, 3072
  v_mfma_f32_16x16x32_bf16 v[180:183], a[12:15], a[92:95], v[180:183]
  ds_read_b128 a[48:51], v8 offset:36864
  v_mfma_f32_16x16x32_bf16 v[180:183], a[8:11], a[88:91], v[180:183]
  ds_read_b128 a[52:55], v9 offset:36864
  v_mfma_f32_16x16x32_bf16 v[184:187], a[16:19], a[88:91], v[184:187]
  ds_read_b128 a[56:59], v8 offset:38912
  v_mfma_f32_16x16x32_bf16 v[184:187], a[20:23], a[92:95], v[184:187]
  ds_read_b128 a[60:63], v9 offset:38912
  v_mfma_f32_16x16x32_bf16 v[188:191], a[28:31], a[92:95], v[188:191]
  buffer_load_dwordx4 v3, s[8:11], s45 offen lds
  v_mfma_f32_16x16x32_bf16 v[188:191], a[24:27], a[88:91], v[188:191]
  s_waitcnt lgkmcnt(14)
  s_xor_b32 m0, s49, 5120
  v_mfma_f32_16x16x32_bf16 v[192:195], a[0:3], a[64:67], v[192:195]
  s_waitcnt lgkmcnt(12)
  buffer_load_dwordx4 v3, s[8:11], s46 offen lds
  v_mfma_f32_16x16x32_bf16 v[192:195], a[4:7], a[68:71], v[192:195]
  s_waitcnt lgkmcnt(0)
  s_barrier
  ds_read_b64_tr_b16 a[80:81], v10 offset:49152
  v_mfma_f32_16x16x32_bf16 v[196:199], a[12:15], a[68:71], v[196:199]
  s_waitcnt vmcnt(13)
  ds_read_b64_tr_b16 a[82:83], v10 offset:49408
  v_xor_b32 v39, s61, v43
  v_mfma_f32_16x16x32_bf16 v[196:199], a[8:11], a[64:67], v[196:199]
  ds_read_b64_tr_b16 a[84:85], v10 offset:53248
  v_bitop3_b32 v39, v47, s61, v39 bitop3:0xbe
  v_mfma_f32_16x16x32_bf16 v[200:203], a[16:19], a[64:67], v[200:203]
  s_xor_b32 m0, s49, 7168
  ds_read_b64_tr_b16 a[86:87], v10 offset:53504
  v_bitop3_b32 v39, v49, s61, v39 bitop3:0xbe
  v_mfma_f32_16x16x32_bf16 v[200:203], a[20:23], a[68:71], v[200:203]
L_hop_kv1:
  s_cbranch_execz L_retkv1
  v_cmp_ne_u32 vcc, 0, v39
  v_mfma_f32_16x16x32_bf16 v[204:207], a[28:31], a[68:71], v[204:207]
  buffer_load_dwordx4 v3, s[8:11], s47 offen lds
  v_mfma_f32_16x16x32_bf16 v[204:207], a[24:27], a[64:67], v[204:207]
  s_waitcnt lgkmcnt(4)
  ds_read_b64_tr_b16 a[88:89], v11 offset:49152
  ds_read_b64_tr_b16 a[90:91], v11 offset:49408
  v_mfma_f32_16x16x32_bf16 v[208:211], a[0:3], a[72:75], v[208:211]
  s_waitcnt lgkmcnt(6)
  ds_read_b64_tr_b16 a[92:93], v11 offset:53248
  ds_read_b64_tr_b16 a[94:95], v11 offset:53504
  v_mfma_f32_16x16x32_bf16 v[208:211], a[4:7], a[76:79], v[208:211]
  s_cbranch_vccnz L_slow_41
L_back_42:
  v_lshl_add_u32 v3, s51, 6, v3
  v_add_f32 v40, v40, v44
  v_mfma_f32_16x16x32_bf16 v[212:215], a[12:15], a[76:79], v[212:215]
  s_cmp_eq_u32 s50, 2
  s_cselect_b64 s[56:57], s[54:55], s[52:53]
  s_cselect_b32 s51, -18, 2
  v_mfma_f32_16x16x32_bf16 v[212:215], a[8:11], a[72:75], v[212:215]
  s_add_u32 m0, s98, 90112
  v_add_f32 v42, v42, v46
  v_add_f32 v41, v41, v45
  v_mfma_f32_16x16x32_bf16 v[216:219], a[16:19], a[72:75], v[216:219]
  global_load_lds_dwordx4 v[4:5], off offset:0
  v_mfma_f32_16x16x32_bf16 v[216:219], a[20:23], a[76:79], v[216:219]
  v_lshlrev_b32 v49, 16, v48
  v_and_b32 v48, 0xffff0000, v48
  v_mfma_f32_16x16x32_bf16 v[220:223], a[28:31], a[76:79], v[220:223]
  s_add_u32 m0, s98, 98240
  v_permlane32_swap_b32 v40, v42
  v_permlane32_swap_b32 v41, v43
  v_mfma_f32_16x16x32_bf16 v[220:223], a[24:27], a[72:75], v[220:223]
  s_waitcnt lgkmcnt(6)
  ds_read_b64_tr_b16 a[64:65], v12 offset:49152
  ds_read_b64_tr_b16 a[66:67], v12 offset:49408
  v_mfma_f32_16x16x32_bf16 v[64:67], a[32:35], a[80:83], v[64:67]
  s_waitcnt lgkmcnt(6)
  ds_read_b64_tr_b16 a[68:69], v12 offset:53248
  ds_read_b64_tr_b16 a[70:71], v12 offset:53504
  v_mfma_f32_16x16x32_bf16 v[64:67], a[36:39], a[84:87], v[64:67]
  global_load_lds_dwordx4 v[4:5], off offset:64
  v_mfma_f32_16x16x32_bf16 v[68:71], a[44:47], a[84:87], v[68:71]
  v_rcp_f32 v50, v49
  v_mfma_f32_16x16x32_bf16 v[68:71], a[40:43], a[80:83], v[68:71]
  v_add_f32 v40, v40, v42
  v_add_f32 v41, v41, v43
  v_mfma_f32_16x16x32_bf16 v[72:75], a[48:51], a[80:83], v[72:75]
  s_add_u32 m0, s98, 106368
  v_mov_b32 v51, v50
  v_mul_f32 v50, 0x3fb8aa3b, v50
  v_mfma_f32_16x16x32_bf16 v[72:75], a[52:55], a[84:87], v[72:75]
  v_permlane16_swap_b32 v40, v41
  v_mfma_f32_16x16x32_bf16 v[76:79], a[60:63], a[84:87], v[76:79]
  global_load_lds_dwordx4 v[4:5], off offset:128
  v_mfma_f32_16x16x32_bf16 v[76:79], a[56:59], a[80:83], v[76:79]
  s_waitcnt lgkmcnt(6)
  ds_read_b64_tr_b16 a[72:73], v13 offset:49152
  ds_read_b64_tr_b16 a[74:75], v13 offset:49408
  v_mfma_f32_16x16x32_bf16 v[80:83], a[32:35], a[88:91], v[80:83]
  s_waitcnt lgkmcnt(6)
  ds_read_b64_tr_b16 a[76:77], v13 offset:53248
  ds_read_b64_tr_b16 a[78:79], v13 offset:53504
  v_mfma_f32_16x16x32_bf16 v[80:83], a[36:39], a[92:95], v[80:83]
  v_lshl_add_u64 v[4:5], v[4:5], 0, s[56:57]
  s_xor_b32 m0, s49, 32768
  v_mfma_f32_16x16x32_bf16 v[84:87], a[44:47], a[92:95], v[84:87]
  v_add_f32 v40, v40, v41
  v_mfma_f32_16x16x32_bf16 v[84:87], a[40:43], a[88:91], v[84:87]
  buffer_load_dwordx4 v2, s[8:11], s44 offen lds
  v_mfma_f32_16x16x32_bf16 v[88:91], a[48:51], a[88:91], v[88:91]
  ds_write_b32 v61, v40
  v_mfma_f32_16x16x32_bf16 v[88:91], a[52:55], a[92:95], v[88:91]
  ds_write_b32 v56, v48
  v_mfma_f32_16x16x32_bf16 v[92:95], a[60:63], a[92:95], v[92:95]
  s_xor_b32 m0, s49, 34816
  ds_write_b32 v56, v50 offset:256
  v_mfma_f32_16x16x32_bf16 v[92:95], a[56:59], a[88:91], v[92:95]
  s_waitcnt lgkmcnt(9)
  ds_read_b64_tr_b16 a[80:81], v14 offset:49152
  ds_read_b64_tr_b16 a[82:83], v14 offset:49408
  v_mfma_f32_16x16x32_bf16 v[96:99], a[32:35], a[64:67], v[96:99]
  s_waitcnt lgkmcnt(9)
  ds_read_b64_tr_b16 a[84:85], v14 offset:53248
  ds_read_b64_tr_b16 a[86:87], v14 offset:53504
  v_mfma_f32_16x16x32_bf16 v[96:99], a[36:39], a[68:71], v[96:99]
  buffer_load_dwordx4 v2, s[8:11], s45 offen lds
  v_mfma_f32_16x16x32_bf16 v[100:103], a[44:47], a[68:71], v[100:103]
  ds_write_b32 v56, v51 offset:512
  v_mfma_f32_16x16x32_bf16 v[100:103], a[40:43], a[64:67], v[100:103]
  s_xor_b32 m0, s49, 36864
  ds_read_b128 v[224:227], v57 offset:0
  ds_read_b128 v[240:243], v57 offset:512
  v_mfma_f32_16x16x32_bf16 v[104:107], a[48:51], a[64:67], v[104:107]
  ds_read_b128 v[228:231], v57 offset:64
  v_mfma_f32_16x16x32_bf16 v[104:107], a[52:55], a[68:71], v[104:107]
  buffer_load_dwordx4 v2, s[8:11], s46 offen lds
  v_mfma_f32_16x16x32_bf16 v[108:111], a[60:63], a[68:71], v[108:111]
  ds_read_b128 v[244:247], v57 offset:576
  v_mfma_f32_16x16x32_bf16 v[108:111], a[56:59], a[64:67], v[108:111]
  s_waitcnt lgkmcnt(14)
  ds_read_b64_tr_b16 a[88:89], v10 offset:49664
  ds_read_b64_tr_b16 a[90:91], v10 offset:49920
  v_mfma_f32_16x16x32_bf16 v[112:115], a[32:35], a[72:75], v[112:115]
  s_waitcnt lgkmcnt(14)
  ds_read_b64_tr_b16 a[92:93], v10 offset:53760
  ds_read_b64_tr_b16 a[94:95], v10 offset:54016
  v_mfma_f32_16x16x32_bf16 v[112:115], a[36:39], a[76:79], v[112:115]
  s_xor_b32 m0, s49, 38912
  ds_read_b128 v[232:235], v57 offset:128
  ds_read_b128 v[248:251], v57 offset:640
  v_mfma_f32_16x16x32_bf16 v[116:119], a[44:47], a[76:79], v[116:119]
  ds_read_b128 v[236:239], v57 offset:192
  v_mfma_f32_16x16x32_bf16 v[116:119], a[40:43], a[72:75], v[116:119]
  buffer_load_dwordx4 v2, s[8:11], s47 offen lds
  v_mfma_f32_16x16x32_bf16 v[120:123], a[48:51], a[72:75], v[120:123]
  ds_read_b128 v[252:255], v57 offset:704
  v_mfma_f32_16x16x32_bf16 v[120:123], a[52:55], a[76:79], v[120:123]
  s_waitcnt lgkmcnt(15)
  s_barrier
  ds_read_b32 v28, v36 offset:8192
  v_mfma_f32_16x16x32_bf16 v[124:127], a[60:63], a[76:79], v[124:127]
  v_lshl_add_u32 v2, s51, 6, v2
  s_add_u32 m0, s99, 90112
  v_mfma_f32_16x16x32_bf16 v[124:127], a[56:59], a[72:75], v[124:127]
  s_waitcnt lgkmcnt(15)
  ds_read_b64_tr_b16 a[64:65], v11 offset:49664
  ds_read_b64_tr_b16 a[66:67], v11 offset:49920
  v_mfma_f32_16x16x32_bf16 v[128:131], a[32:35], a[80:83], v[128:131]
  s_waitcnt lgkmcnt(15)
  ds_read_b64_tr_b16 a[68:69], v11 offset:53760
  ds_read_b64_tr_b16 a[70:71], v11 offset:54016
  v_mfma_f32_16x16x32_bf16 v[128:131], a[36:39], a[84:87], v[128:131]
  global_load_lds_dwordx4 v[6:7], off offset:0
  v_mfma_f32_16x16x32_bf16 v[132:135], a[44:47], a[84:87], v[132:135]
  v_mfma_f32_16x16x32_bf16 v[132:135], a[40:43], a[80:83], v[132:135]
  s_add_u32 m0, s99, 98240
  ds_read_b32 v32, v36 offset:8272
  s_waitcnt lgkmcnt(5)
  v_mfma_f32_16x16x32_bf16 v[136:139], a[48:51], a[80:83], v[136:139]
  v_fmac_f32 v64, v224, v28
  v_fmac_f32 v65, v225, v28
  v_mfma_f32_16x16x32_bf16 v[136:139], a[52:55], a[84:87], v[136:139]
  global_load_lds_dwordx4 v[6:7], off offset:64
  v_mfma_f32_16x16x32_bf16 v[140:143], a[60:63], a[84:87], v[140:143]
  v_fmac_f32 v66, v226, v28
  v_fmac_f32 v67, v227, v28
  v_mfma_f32_16x16x32_bf16 v[140:143], a[56:59], a[80:83], v[140:143]
  s_waitcnt lgkmcnt(5)
  ds_read_b64_tr_b16 a[72:73], v12 offset:49664
  ds_read_b64_tr_b16 a[74:75], v12 offset:49920
  v_mfma_f32_16x16x32_bf16 v[144:147], a[32:35], a[88:91], v[144:147]
  s_waitcnt lgkmcnt(7)
  ds_read_b64_tr_b16 a[76:77], v12 offset:53760
  ds_read_b64_tr_b16 a[78:79], v12 offset:54016
  v_mfma_f32_16x16x32_bf16 v[144:147], a[36:39], a[92:95], v[144:147]
  s_add_u32 m0, s99, 106368
  v_fmac_f32 v68, v228, v28
  v_fmac_f32 v69, v229, v28
  v_mfma_f32_16x16x32_bf16 v[148:151], a[44:47], a[92:95], v[148:151]
  v_fmac_f32 v70, v230, v28
  v_fmac_f32 v71, v231, v28
  v_mfma_f32_16x16x32_bf16 v[148:151], a[40:43], a[88:91], v[148:151]
  global_load_lds_dwordx4 v[6:7], off offset:128
  v_mfma_f32_16x16x32_bf16 v[152:155], a[48:51], a[88:91], v[152:155]
  v_fmac_f32 v72, v232, v28
  v_fmac_f32 v73, v233, v28
  v_mfma_f32_16x16x32_bf16 v[152:155], a[52:55], a[92:95], v[152:155]
  v_fmac_f32 v74, v234, v28
  v_fmac_f32 v75, v235, v28
  v_mfma_f32_16x16x32_bf16 v[156:159], a[60:63], a[92:95], v[156:159]
  v_lshl_add_u64 v[6:7], v[6:7], 0, s[56:57]
  s_xor_b32 m0, s49, 33792
  v_mfma_f32_16x16x32_bf16 v[156:159], a[56:59], a[88:91], v[156:159]
  s_waitcnt lgkmcnt(7)
  ds_read_b64_tr_b16 a[80:81], v13 offset:49664
  ds_read_b64_tr_b16 a[82:83], v13 offset:49920
  v_mfma_f32_16x16x32_bf16 v[160:163], a[32:35], a[64:67], v[160:163]
  s_waitcnt lgkmcnt(7)
  ds_read_b64_tr_b16 a[84:85], v13 offset:53760
  ds_read_b64_tr_b16 a[86:87], v13 offset:54016
  v_mfma_f32_16x16x32_bf16 v[160:163], a[36:39], a[68:71], v[160:163]
  buffer_load_dwordx4 v3, s[8:11], s44 offen lds
  v_mfma_f32_16x16x32_bf16 v[164:167], a[44:47], a[68:71], v[164:167]
  s_waitcnt vmcnt(11)
  ds_read_b128 a[0:3], v8 offset:0
  v_fmac_f32 v76, v236, v28
  v_mfma_f32_16x16x32_bf16 v[164:167], a[40:43], a[64:67], v[164:167]
  s_xor_b32 m0, s49, 35840
  ds_read_b128 a[4:7], v9 offset:0
  v_fmac_f32 v77, v237, v28
  v_mfma_f32_16x16x32_bf16 v[168:171], a[48:51], a[64:67], v[168:171]
  ds_read_b128 a[8:11], v8 offset:2048
  v_fmac_f32 v78, v238, v28
  v_mfma_f32_16x16x32_bf16 v[168:171], a[52:55], a[68:71], v[168:171]
  ds_read_b128 a[12:15], v9 offset:2048
  v_fmac_f32 v79, v239, v28
  v_mfma_f32_16x16x32_bf16 v[172:175], a[60:63], a[68:71], v[172:175]
  buffer_load_dwordx4 v3, s[8:11], s45 offen lds
  v_mfma_f32_16x16x32_bf16 v[172:175], a[56:59], a[64:67], v[172:175]
  s_waitcnt lgkmcnt(10)
  ds_read_b64_tr_b16 a[88:89], v14 offset:49664
  ds_read_b64_tr_b16 a[90:91], v14 offset:49920
  v_mfma_f32_16x16x32_bf16 v[176:179], a[32:35], a[72:75], v[176:179]
  s_waitcnt lgkmcnt(10)
  ds_read_b64_tr_b16 a[92:93], v14 offset:53760
  ds_read_b64_tr_b16 a[94:95], v14 offset:54016
  v_mfma_f32_16x16x32_bf16 v[176:179], a[36:39], a[76:79], v[176:179]
  s_xor_b32 m0, s49, 37888
  ds_read_b32 v28, v36 offset:8432
  v_fmac_f32 v80, v224, v32
  v_mfma_f32_16x16x32_bf16 v[180:183], a[44:47], a[76:79], v[180:183]
  ds_read_b128 a[16:19], v8 offset:4096
  v_fmac_f32 v81, v225, v32
  v_mfma_f32_16x16x32_bf16 v[180:183], a[40:43], a[72:75], v[180:183]
  ds_read_b128 a[20:23], v9 offset:4096
  v_fmac_f32 v82, v226, v32
  v_mfma_f32_16x16x32_bf16 v[184:187], a[48:51], a[72:75], v[184:187]
  ds_read_b128 a[24:27], v8 offset:6144
  v_fmac_f32 v83, v227, v32
  v_mfma_f32_16x16x32_bf16 v[184:187], a[52:55], a[76:79], v[184:187]
  ds_read_b128 a[28:31], v9 offset:6144
  v_fmac_f32 v84, v228, v32
  v_mfma_f32_16x16x32_bf16 v[188:191], a[60:63], a[76:79], v[188:191]
  buffer_load_dwordx4 v3, s[8:11], s46 offen lds
  v_mfma_f32_16x16x32_bf16 v[188:191], a[56:59], a[72:75], v[188:191]
  s_waitcnt lgkmcnt(15)
  s_xor_b32 m0, s49, 39936
  v_fmac_f32 v85, v229, v32
  v_mfma_f32_16x16x32_bf16 v[192:195], a[32:35], a[80:83], v[192:195]
  s_waitcnt lgkmcnt(13)
  buffer_load_dwordx4 v3, s[8:11], s47 offen lds
  v_mfma_f32_16x16x32_bf16 v[192:195], a[36:39], a[84:87], v[192:195]
  s_waitcnt lgkmcnt(0)
  s_barrier
  ds_read_b64_tr_b16 a[64:65], v10 offset:0
  v_mfma_f32_16x16x32_bf16 v[196:199], a[44:47], a[84:87], v[196:199]
  ds_read_b64_tr_b16 a[66:67], v10 offset:256
  v_fmac_f32 v86, v230, v32
  v_mfma_f32_16x16x32_bf16 v[196:199], a[40:43], a[80:83], v[196:199]
  ds_read_b64_tr_b16 a[68:69], v10 offset:4096
  v_lshl_add_u32 v3, s51, 6, v3
  v_mfma_f32_16x16x32_bf16 v[200:203], a[48:51], a[80:83], v[200:203]
  s_cmp_eq_u32 s50, 1
  s_cselect_b64 s[56:57], s[54:55], s[52:53]
  s_cselect_b32 s51, -18, 2
  ds_read_b64_tr_b16 a[70:71], v10 offset:4352
  v_mfma_f32_16x16x32_bf16 v[200:203], a[52:55], a[84:87], v[200:203]
  s_add_u32 m0, s98, 114688
  v_fmac_f32 v87, v231, v32
  v_fmac_f32 v88, v232, v32
  v_mfma_f32_16x16x32_bf16 v[204:207], a[60:63], a[84:87], v[204:207]
  global_load_lds_dwordx4 v[4:5], off offset:0
  v_mfma_f32_16x16x32_bf16 v[204:207], a[56:59], a[80:83], v[204:207]
  s_waitcnt lgkmcnt(4)
  ds_read_b64_tr_b16 a[72:73], v11 offset:0
  ds_read_b64_tr_b16 a[74:75], v11 offset:256
  v_mfma_f32_16x16x32_bf16 v[208:211], a[32:35], a[88:91], v[208:211]
  s_waitcnt lgkmcnt(6)
  ds_read_b64_tr_b16 a[76:77], v11 offset:4096
  ds_read_b64_tr_b16 a[78:79], v11 offset:4352
  v_mfma_f32_16x16x32_bf16 v[208:211], a[36:39], a[92:95], v[208:211]
  s_add_u32 m0, s98, 122816
  v_fmac_f32 v89, v233, v32
  v_fmac_f32 v90, v234, v32
  v_mfma_f32_16x16x32_bf16 v[212:215], a[44:47], a[92:95], v[212:215]
  v_fmac_f32 v91, v235, v32
  v_fmac_f32 v92, v236, v32
  v_fmac_f32 v93, v237, v32
  v_fmac_f32 v94, v238, v32
  v_fmac_f32 v95, v239, v32
  v_mfma_f32_16x16x32_bf16 v[212:215], a[40:43], a[88:91], v[212:215]
  global_load_lds_dwordx4 v[4:5], off offset:64
  v_mfma_f32_16x16x32_bf16 v[216:219], a[48:51], a[88:91], v[216:219]
  ds_read_b32 v32, v36 offset:8576
  v_fmac_f32 v112, v224, v28
  v_mfma_f32_16x16x32_bf16 v[216:219], a[52:55], a[92:95], v[216:219]
  v_fmac_f32 v113, v225, v28
  v_fmac_f32 v114, v226, v28
  v_mfma_f32_16x16x32_bf16 v[220:223], a[60:63], a[92:95], v[220:223]
  s_add_u32 m0, s98, 130944
  v_fmac_f32 v115, v227, v28
  v_fmac_f32 v116, v228, v28
  v_mfma_f32_16x16x32_bf16 v[220:223], a[56:59], a[88:91], v[220:223]
  s_waitcnt lgkmcnt(7)
  ds_read_b64_tr_b16 a[80:81], v12 offset:0
  ds_read_b64_tr_b16 a[82:83], v12 offset:256
  v_mfma_f32_16x16x32_bf16 v[64:67], a[0:3], a[64:67], v[64:67]
  s_waitcnt lgkmcnt(7)
  ds_read_b64_tr_b16 a[84:85], v12 offset:4096
  ds_read_b64_tr_b16 a[86:87], v12 offset:4352
  v_mfma_f32_16x16x32_bf16 v[64:67], a[4:7], a[68:71], v[64:67]
  global_load_lds_dwordx4 v[4:5], off offset:128
  v_mfma_f32_16x16x32_bf16 v[68:71], a[12:15], a[68:71], v[68:71]
  v_fmac_f32 v117, v229, v28
  v_fmac_f32 v118, v230, v28
  v_mfma_f32_16x16x32_bf16 v[68:71], a[8:11], a[64:67], v[68:71]
  v_lshl_add_u64 v[4:5], v[4:5], 0, s[56:57]
  s_xor_b32 m0, s49, 0
  v_mfma_f32_16x16x32_bf16 v[72:75], a[16:19], a[64:67], v[72:75]
  v_fmac_f32 v119, v231, v28
  v_fmac_f32 v120, v232, v28
  v_mfma_f32_16x16x32_bf16 v[72:75], a[20:23], a[68:71], v[72:75]
  buffer_load_dwordx4 v2, s[8:11], s44 offen lds
  v_mfma_f32_16x16x32_bf16 v[76:79], a[28:31], a[68:71], v[76:79]
  v_fmac_f32 v121, v233, v28
  v_fmac_f32 v122, v234, v28
  v_mfma_f32_16x16x32_bf16 v[76:79], a[24:27], a[64:67], v[76:79]
  s_waitcnt lgkmcnt(7)
  ds_read_b64_tr_b16 a[88:89], v13 offset:0
  ds_read_b64_tr_b16 a[90:91], v13 offset:256
  v_mfma_f32_16x16x32_bf16 v[80:83], a[0:3], a[72:75], v[80:83]
  s_waitcnt lgkmcnt(7)
  ds_read_b64_tr_b16 a[92:93], v13 offset:4096
  ds_read_b64_tr_b16 a[94:95], v13 offset:4352
  v_mfma_f32_16x16x32_bf16 v[80:83], a[4:7], a[76:79], v[80:83]
  s_xor_b32 m0, s49, 2048
  v_fmac_f32 v123, v235, v28
  v_fmac_f32 v124, v236, v28
  v_mfma_f32_16x16x32_bf16 v[84:87], a[12:15], a[76:79], v[84:87]
  buffer_load_dwordx4 v2, s[8:11], s45 offen lds
  v_mfma_f32_16x16x32_bf16 v[84:87], a[8:11], a[72:75], v[84:87]
  v_fmac_f32 v125, v237, v28
  v_fmac_f32 v126, v238, v28
  v_mfma_f32_16x16x32_bf16 v[88:91], a[16:19], a[72:75], v[88:91]
  v_fmac_f32 v127, v239, v28
  v_mfma_f32_16x16x32_bf16 v[88:91], a[20:23], a[76:79], v[88:91]
  v_mfma_f32_16x16x32_bf16 v[92:95], a[28:31], a[76:79], v[92:95]
  s_xor_b32 m0, s49, 4096
  v_mfma_f32_16x16x32_bf16 v[92:95], a[24:27], a[72:75], v[92:95]
  s_waitcnt lgkmcnt(6)
  ds_read_b64_tr_b16 a[64:65], v14 offset:0
  ds_read_b64_tr_b16 a[66:67], v14 offset:256
  v_mfma_f32_16x16x32_bf16 v[96:99], a[0:3], a[80:83], v[96:99]
  s_waitcnt lgkmcnt(6)
  ds_read_b64_tr_b16 a[68:69], v14 offset:4096
  ds_read_b64_tr_b16 a[70:71], v14 offset:4352
  v_mfma_f32_16x16x32_bf16 v[96:99], a[4:7], a[84:87], v[96:99]
  buffer_load_dwordx4 v2, s[8:11], s46 offen lds
  v_mfma_f32_16x16x32_bf16 v[100:103], a[12:15], a[84:87], v[100:103]
  ds_read_b32 v28, v36 offset:8816
  v_fmac_f32 v144, v224, v32
  v_mfma_f32_16x16x32_bf16 v[100:103], a[8:11], a[80:83], v[100:103]
  s_xor_b32 m0, s49, 6144
  v_fmac_f32 v145, v225, v32
  v_fmac_f32 v146, v226, v32
  v_mfma_f32_16x16x32_bf16 v[104:107], a[16:19], a[80:83], v[104:107]
  v_fmac_f32 v147, v227, v32
  v_fmac_f32 v148, v228, v32
  v_mfma_f32_16x16x32_bf16 v[104:107], a[20:23], a[84:87], v[104:107]
  buffer_load_dwordx4 v2, s[8:11], s47 offen lds
  v_mfma_f32_16x16x32_bf16 v[108:111], a[28:31], a[84:87], v[108:111]
  v_fmac_f32 v149, v229, v32
  v_fmac_f32 v150, v230, v32
  v_mfma_f32_16x16x32_bf16 v[108:111], a[24:27], a[80:83], v[108:111]
  s_waitcnt lgkmcnt(7)
  ds_read_b64_tr_b16 a[72:73], v10 offset:512
  ds_read_b64_tr_b16 a[74:75], v10 offset:768
  v_mfma_f32_16x16x32_bf16 v[112:115], a[0:3], a[88:91], v[112:115]
  s_waitcnt lgkmcnt(7)
  ds_read_b64_tr_b16 a[76:77], v10 offset:4608
  ds_read_b64_tr_b16 a[78:79], v10 offset:4864
  v_mfma_f32_16x16x32_bf16 v[112:115], a[4:7], a[92:95], v[112:115]
  v_lshl_add_u32 v2, s51, 6, v2
  s_add_u32 m0, s99, 114688
  v_mfma_f32_16x16x32_bf16 v[116:119], a[12:15], a[92:95], v[116:119]
  global_load_lds_dwordx4 v[6:7], off offset:0
  v_mfma_f32_16x16x32_bf16 v[116:119], a[8:11], a[88:91], v[116:119]
  v_fmac_f32 v151, v231, v32
  v_fmac_f32 v152, v232, v32
  v_mfma_f32_16x16x32_bf16 v[120:123], a[16:19], a[88:91], v[120:123]
  v_fmac_f32 v153, v233, v32
  v_fmac_f32 v154, v234, v32
  v_mfma_f32_16x16x32_bf16 v[120:123], a[20:23], a[92:95], v[120:123]
  v_fmac_f32 v155, v235, v32
  v_fmac_f32 v156, v236, v32
  v_mfma_f32_16x16x32_bf16 v[124:127], a[28:31], a[92:95], v[124:127]
  s_add_u32 m0, s99, 122816
  v_fmac_f32 v157, v237, v32
  v_fmac_f32 v158, v238, v32
  v_mfma_f32_16x16x32_bf16 v[124:127], a[24:27], a[88:91], v[124:127]
  s_waitcnt lgkmcnt(7)
  ds_read_b64_tr_b16 a[80:81], v11 offset:512
  ds_read_b64_tr_b16 a[82:83], v11 offset:768
  v_mfma_f32_16x16x32_bf16 v[128:131], a[0:3], a[64:67], v[128:131]
  s_waitcnt lgkmcnt(7)
  ds_read_b64_tr_b16 a[84:85], v11 offset:4608
  ds_read_b64_tr_b16 a[86:87], v11 offset:4864
  v_mfma_f32_16x16x32_bf16 v[128:131], a[4:7], a[68:71], v[128:131]
  global_load_lds_dwordx4 v[6:7], off offset:64
  v_mfma_f32_16x16x32_bf16 v[132:135], a[12:15], a[68:71], v[132:135]
  v_fmac_f32 v159, v239, v32
  v_lshrrev_b32 v38, 3, v0
  v_mfma_f32_16x16x32_bf16 v[132:135], a[8:11], a[64:67], v[132:135]
  s_add_u32 m0, s99, 130944
  ds_read_b32 v32, v36 offset:8352
  v_bfe_u32 v39, v0, 2, 1
  v_mfma_f32_16x16x32_bf16 v[136:139], a[16:19], a[64:67], v[136:139]
  s_waitcnt lgkmcnt(9)
  v_mad_u32_u24 v38, v38, 32, v39
  v_add_lshl_u32 v38, v38, 30, 7
  v_mfma_f32_16x16x32_bf16 v[136:139], a[20:23], a[68:71], v[136:139]
  global_load_lds_dwordx4 v[6:7], off offset:128
  v_mfma_f32_16x16x32_bf16 v[140:143], a[28:31], a[68:71], v[140:143]
  s_mov_b32 s62, 22020096
  buffer_load_dword v39, v38, s[12:15], s62 offen sc1
  v_mfma_f32_16x16x32_bf16 v[140:143], a[24:27], a[64:67], v[140:143]
  s_waitcnt lgkmcnt(7)
  ds_read_b64_tr_b16 a[88:89], v12 offset:512
  ds_read_b64_tr_b16 a[90:91], v12 offset:768
  v_mfma_f32_16x16x32_bf16 v[144:147], a[0:3], a[72:75], v[144:147]
  s_waitcnt lgkmcnt(7)
  ds_read_b64_tr_b16 a[92:93], v12 offset:4608
  ds_read_b64_tr_b16 a[94:95], v12 offset:4864
  v_mfma_f32_16x16x32_bf16 v[144:147], a[4:7], a[76:79], v[144:147]
  v_lshl_add_u64 v[6:7], v[6:7], 0, s[56:57]
  s_xor_b32 m0, s49, 1024
  v_mfma_f32_16x16x32_bf16 v[148:151], a[12:15], a[76:79], v[148:151]
  buffer_load_dwordx4 v3, s[8:11], s44 offen lds
  v_mfma_f32_16x16x32_bf16 v[148:151], a[8:11], a[72:75], v[148:151]
  v_fmac_f32 v192, v224, v28
  v_fmac_f32 v193, v225, v28
  v_mfma_f32_16x16x32_bf16 v[152:155], a[16:19], a[72:75], v[152:155]
  v_fmac_f32 v194, v226, v28
  v_fmac_f32 v195, v227, v28
  v_mfma_f32_16x16x32_bf16 v[152:155], a[20:23], a[76:79], v[152:155]
  s_xor_b32 m0, s49, 3072
  v_fmac_f32 v196, v228, v28
  v_fmac_f32 v197, v229, v28
  v_mfma_f32_16x16x32_bf16 v[156:159], a[28:31], a[76:79], v[156:159]
  v_fmac_f32 v198, v230, v28
  v_fmac_f32 v199, v231, v28
  v_mfma_f32_16x16x32_bf16 v[156:159], a[24:27], a[72:75], v[156:159]
  s_waitcnt lgkmcnt(7)
  ds_read_b64_tr_b16 a[64:65], v13 offset:512
  ds_read_b64_tr_b16 a[66:67], v13 offset:768
  v_mfma_f32_16x16x32_bf16 v[160:163], a[0:3], a[80:83], v[160:163]
  s_waitcnt lgkmcnt(7)
  ds_read_b64_tr_b16 a[68:69], v13 offset:4608
  ds_read_b64_tr_b16 a[70:71], v13 offset:4864
  v_mfma_f32_16x16x32_bf16 v[160:163], a[4:7], a[84:87], v[160:163]
  buffer_load_dwordx4 v3, s[8:11], s45 offen lds
  v_mfma_f32_16x16x32_bf16 v[164:167], a[12:15], a[84:87], v[164:167]
  s_waitcnt vmcnt(13)
  ds_read_b128 a[32:35], v8 offset:32768
  v_fmac_f32 v200, v232, v28
  v_mfma_f32_16x16x32_bf16 v[164:167], a[8:11], a[80:83], v[164:167]
  s_xor_b32 m0, s49, 5120
  ds_read_b128 a[36:39], v9 offset:32768
  v_fmac_f32 v201, v233, v28
  v_mfma_f32_16x16x32_bf16 v[168:171], a[16:19], a[80:83], v[168:171]
  ds_read_b128 a[40:43], v8 offset:34816
  v_fmac_f32 v202, v234, v28
  v_mfma_f32_16x16x32_bf16 v[168:171], a[20:23], a[84:87], v[168:171]
  ds_read_b128 a[44:47], v9 offset:34816
  v_fmac_f32 v203, v235, v28
  v_mfma_f32_16x16x32_bf16 v[172:175], a[28:31], a[84:87], v[172:175]
  v_fmac_f32 v204, v236, v28
  v_fmac_f32 v205, v237, v28
  v_fmac_f32 v206, v238, v28
  v_fmac_f32 v207, v239, v28
  v_mfma_f32_16x16x32_bf16 v[172:175], a[24:27], a[80:83], v[172:175]
  s_waitcnt lgkmcnt(10)
  ds_read_b64_tr_b16 a[72:73], v14 offset:512
  ds_read_b64_tr_b16 a[74:75], v14 offset:768
  v_mfma_f32_16x16x32_bf16 v[176:179], a[0:3], a[88:91], v[176:179]
  s_waitcnt lgkmcnt(10)
  ds_read_b64_tr_b16 a[76:77], v14 offset:4608
  ds_read_b64_tr_b16 a[78:79], v14 offset:4864
  v_mfma_f32_16x16x32_bf16 v[176:179], a[4:7], a[92:95], v[176:179]
  buffer_load_dwordx4 v3, s[8:11], s46 offen lds
  v_mfma_f32_16x16x32_bf16 v[180:183], a[12:15], a[92:95], v[180:183]
  s_xor_b32 m0, s49, 7168
  ds_read_b128 a[48:51], v8 offset:36864
  ds_read_b32 v28, v36 offset:8656
  v_mfma_f32_16x16x32_bf16 v[180:183], a[8:11], a[88:91], v[180:183]
  ds_read_b128 a[52:55], v9 offset:36864
  v_fmac_f32 v96, v224, v32
  v_mfma_f32_16x16x32_bf16 v[184:187], a[16:19], a[88:91], v[184:187]
  ds_read_b128 a[56:59], v8 offset:38912
  v_fmac_f32 v97, v225, v32
  v_mfma_f32_16x16x32_bf16 v[184:187], a[20:23], a[92:95], v[184:187]
  ds_read_b128 a[60:63], v9 offset:38912
  v_fmac_f32 v98, v226, v32
  v_mfma_f32_16x16x32_bf16 v[188:191], a[28:31], a[92:95], v[188:191]
  buffer_load_dwordx4 v3, s[8:11], s47 offen lds
  v_mfma_f32_16x16x32_bf16 v[188:191], a[24:27], a[88:91], v[188:191]
  s_waitcnt lgkmcnt(15)
  v_lshl_add_u32 v3, s51, 6, v3
  v_fmac_f32 v99, v227, v32
  v_mfma_f32_16x16x32_bf16 v[192:195], a[0:3], a[64:67], v[192:195]
  s_waitcnt lgkmcnt(13)
  s_add_u32 m0, s98, 65536
  v_fmac_f32 v100, v228, v32
  v_mfma_f32_16x16x32_bf16 v[192:195], a[4:7], a[68:71], v[192:195]
  s_waitcnt lgkmcnt(0)
  s_barrier
  ds_read_b64_tr_b16 a[80:81], v10 offset:24576
  v_mfma_f32_16x16x32_bf16 v[196:199], a[12:15], a[68:71], v[196:199]
  ds_read_b64_tr_b16 a[82:83], v10 offset:24832
  v_fmac_f32 v101, v229, v32
  v_mfma_f32_16x16x32_bf16 v[196:199], a[8:11], a[64:67], v[196:199]
  ds_read_b64_tr_b16 a[84:85], v10 offset:28672
  v_fmac_f32 v102, v230, v32
  v_mfma_f32_16x16x32_bf16 v[200:203], a[16:19], a[64:67], v[200:203]
  ds_read_b64_tr_b16 a[86:87], v10 offset:28928
  v_fmac_f32 v103, v231, v32
  v_mfma_f32_16x16x32_bf16 v[200:203], a[20:23], a[68:71], v[200:203]
  global_load_lds_dwordx4 v[4:5], off offset:0
  v_mfma_f32_16x16x32_bf16 v[204:207], a[28:31], a[68:71], v[204:207]
  s_add_u32 m0, s98, 73664
  v_fmac_f32 v104, v232, v32
  v_fmac_f32 v105, v233, v32
  v_mfma_f32_16x16x32_bf16 v[204:207], a[24:27], a[64:67], v[204:207]
  s_waitcnt lgkmcnt(4)
  ds_read_b64_tr_b16 a[88:89], v11 offset:24576
  ds_read_b64_tr_b16 a[90:91], v11 offset:24832
  v_mfma_f32_16x16x32_bf16 v[208:211], a[0:3], a[72:75], v[208:211]
  s_waitcnt lgkmcnt(6)
  ds_read_b64_tr_b16 a[92:93], v11 offset:28672
  ds_read_b64_tr_b16 a[94:95], v11 offset:28928
  v_mfma_f32_16x16x32_bf16 v[208:211], a[4:7], a[76:79], v[208:211]
  global_load_lds_dwordx4 v[4:5], off offset:64
  v_mfma_f32_16x16x32_bf16 v[212:215], a[12:15], a[76:79], v[212:215]
  s_add_u32 m0, s98, 81792
  v_fmac_f32 v106, v234, v32
  v_fmac_f32 v107, v235, v32
  v_fmac_f32 v108, v236, v32
  v_fmac_f32 v109, v237, v32
  v_fmac_f32 v110, v238, v32
  v_fmac_f32 v111, v239, v32
  v_mfma_f32_16x16x32_bf16 v[212:215], a[8:11], a[72:75], v[212:215]
  ds_read_b32 v32, v36 offset:8736
  v_fmac_f32 v160, v224, v28
  v_mfma_f32_16x16x32_bf16 v[216:219], a[16:19], a[72:75], v[216:219]
  global_load_lds_dwordx4 v[4:5], off offset:128
  v_mfma_f32_16x16x32_bf16 v[216:219], a[20:23], a[76:79], v[216:219]
  v_fmac_f32 v161, v225, v28
  v_fmac_f32 v162, v226, v28
  v_mfma_f32_16x16x32_bf16 v[220:223], a[28:31], a[76:79], v[220:223]
  v_fmac_f32 v163, v227, v28
  v_fmac_f32 v164, v228, v28
  v_mfma_f32_16x16x32_bf16 v[220:223], a[24:27], a[72:75], v[220:223]
  s_waitcnt lgkmcnt(7)
  ds_read_b64_tr_b16 a[64:65], v12 offset:24576
  ds_read_b64_tr_b16 a[66:67], v12 offset:24832
  v_mfma_f32_16x16x32_bf16 v[64:67], a[32:35], a[80:83], v[64:67]
  s_waitcnt lgkmcnt(7)
  ds_read_b64_tr_b16 a[68:69], v12 offset:28672
  ds_read_b64_tr_b16 a[70:71], v12 offset:28928
  v_mfma_f32_16x16x32_bf16 v[64:67], a[36:39], a[84:87], v[64:67]
  s_xor_b32 m0, s49, 32768
  v_fmac_f32 v165, v229, v28
  v_fmac_f32 v166, v230, v28
  v_mfma_f32_16x16x32_bf16 v[68:71], a[44:47], a[84:87], v[68:71]
  buffer_load_dwordx4 v2, s[8:11], s44 offen lds
  v_mfma_f32_16x16x32_bf16 v[68:71], a[40:43], a[80:83], v[68:71]
  v_fmac_f32 v167, v231, v28
  v_fmac_f32 v168, v232, v28
  v_mfma_f32_16x16x32_bf16 v[72:75], a[48:51], a[80:83], v[72:75]
  v_fmac_f32 v169, v233, v28
  v_fmac_f32 v170, v234, v28
  v_mfma_f32_16x16x32_bf16 v[72:75], a[52:55], a[84:87], v[72:75]
  s_xor_b32 m0, s49, 34816
  v_fmac_f32 v171, v235, v28
  v_fmac_f32 v172, v236, v28
  v_mfma_f32_16x16x32_bf16 v[76:79], a[60:63], a[84:87], v[76:79]
  v_fmac_f32 v173, v237, v28
  v_fmac_f32 v174, v238, v28
  v_mfma_f32_16x16x32_bf16 v[76:79], a[56:59], a[80:83], v[76:79]
  s_waitcnt lgkmcnt(7)
  ds_read_b64_tr_b16 a[72:73], v13 offset:24576
  ds_read_b64_tr_b16 a[74:75], v13 offset:24832
  v_mfma_f32_16x16x32_bf16 v[80:83], a[32:35], a[88:91], v[80:83]
  s_waitcnt lgkmcnt(7)
  ds_read_b64_tr_b16 a[76:77], v13 offset:28672
  ds_read_b64_tr_b16 a[78:79], v13 offset:28928
  v_mfma_f32_16x16x32_bf16 v[80:83], a[36:39], a[92:95], v[80:83]
  buffer_load_dwordx4 v2, s[8:11], s45 offen lds
  v_mfma_f32_16x16x32_bf16 v[84:87], a[44:47], a[92:95], v[84:87]
  s_xor_b32 m0, s49, 36864
  v_fmac_f32 v175, v239, v28
  v_mfma_f32_16x16x32_bf16 v[84:87], a[40:43], a[88:91], v[84:87]
  v_mfma_f32_16x16x32_bf16 v[88:91], a[48:51], a[88:91], v[88:91]
  buffer_load_dwordx4 v2, s[8:11], s46 offen lds
  v_mfma_f32_16x16x32_bf16 v[88:91], a[52:55], a[92:95], v[88:91]
  v_mfma_f32_16x16x32_bf16 v[92:95], a[60:63], a[92:95], v[92:95]
  v_mfma_f32_16x16x32_bf16 v[92:95], a[56:59], a[88:91], v[92:95]
  s_waitcnt lgkmcnt(6)
  ds_read_b64_tr_b16 a[80:81], v14 offset:24576
  ds_read_b64_tr_b16 a[82:83], v14 offset:24832
  v_mfma_f32_16x16x32_bf16 v[96:99], a[32:35], a[64:67], v[96:99]
  s_waitcnt lgkmcnt(6)
  ds_read_b64_tr_b16 a[84:85], v14 offset:28672
  ds_read_b64_tr_b16 a[86:87], v14 offset:28928
  v_mfma_f32_16x16x32_bf16 v[96:99], a[36:39], a[68:71], v[96:99]
  s_xor_b32 m0, s49, 38912
  ds_read_b32 v28, v37 offset:8640
  v_fmac_f32 v176, v224, v32
  v_mfma_f32_16x16x32_bf16 v[100:103], a[44:47], a[68:71], v[100:103]
  buffer_load_dwordx4 v2, s[8:11], s47 offen lds
  v_mfma_f32_16x16x32_bf16 v[100:103], a[40:43], a[64:67], v[100:103]
  v_fmac_f32 v177, v225, v32
  v_fmac_f32 v178, v226, v32
  v_mfma_f32_16x16x32_bf16 v[104:107], a[48:51], a[64:67], v[104:107]
L_hop_kv2:
  s_cbranch_execz L_retkv1
  v_fmac_f32 v179, v227, v32
  v_fmac_f32 v180, v228, v32
  v_mfma_f32_16x16x32_bf16 v[104:107], a[52:55], a[68:71], v[104:107]
  s_add_u32 m0, s99, 65536
  v_fmac_f32 v181, v229, v32
  v_fmac_f32 v182, v230, v32
  v_mfma_f32_16x16x32_bf16 v[108:111], a[60:63], a[68:71], v[108:111]
  s_waitcnt vmcnt(11)
  v_cmp_ne_u32 vcc, s61, v39
  v_fmac_f32 v183, v231, v32
  v_mfma_f32_16x16x32_bf16 v[108:111], a[56:59], a[64:67], v[108:111]
  s_waitcnt lgkmcnt(7)
  ds_read_b64_tr_b16 a[88:89], v10 offset:25088
  ds_read_b64_tr_b16 a[90:91], v10 offset:25344
  v_mfma_f32_16x16x32_bf16 v[112:115], a[32:35], a[72:75], v[112:115]
  s_waitcnt lgkmcnt(7)
  ds_read_b64_tr_b16 a[92:93], v10 offset:29184
  ds_read_b64_tr_b16 a[94:95], v10 offset:29440
  v_mfma_f32_16x16x32_bf16 v[112:115], a[36:39], a[76:79], v[112:115]
  s_cbranch_vccnz L_slow_43
L_back_44:
  global_load_lds_dwordx4 v[6:7], off offset:0
  v_mfma_f32_16x16x32_bf16 v[116:119], a[44:47], a[76:79], v[116:119]
  s_add_u32 m0, s99, 73664
  v_fmac_f32 v184, v232, v32
  v_fmac_f32 v185, v233, v32
  v_mfma_f32_16x16x32_bf16 v[116:119], a[40:43], a[72:75], v[116:119]
  s_add_u32 s23, s83, 0
  v_fmac_f32 v186, v234, v32
  v_fmac_f32 v187, v235, v32
  v_mfma_f32_16x16x32_bf16 v[120:123], a[48:51], a[72:75], v[120:123]
  global_load_lds_dwordx4 v[6:7], off offset:64
  v_mfma_f32_16x16x32_bf16 v[120:123], a[52:55], a[76:79], v[120:123]
  buffer_load_dwordx4 a[96:99], v59, s[12:15], s23 offen offset:0 sc1
  v_mfma_f32_16x16x32_bf16 v[124:127], a[60:63], a[76:79], v[124:127]
  v_fmac_f32 v188, v236, v32
  v_fmac_f32 v189, v237, v32
  v_mfma_f32_16x16x32_bf16 v[124:127], a[56:59], a[72:75], v[124:127]
  s_waitcnt lgkmcnt(7)
  ds_read_b64_tr_b16 a[64:65], v11 offset:25088
  ds_read_b64_tr_b16 a[66:67], v11 offset:25344
  v_mfma_f32_16x16x32_bf16 v[128:131], a[32:35], a[80:83], v[128:131]
  s_waitcnt lgkmcnt(7)
  ds_read_b64_tr_b16 a[68:69], v11 offset:29184
  ds_read_b64_tr_b16 a[70:71], v11 offset:29440
  v_mfma_f32_16x16x32_bf16 v[128:131], a[36:39], a[84:87], v[128:131]
  s_add_u32 m0, s99, 81792
  v_fmac_f32 v190, v238, v32
  v_fmac_f32 v191, v239, v32
  v_mfma_f32_16x16x32_bf16 v[132:135], a[44:47], a[84:87], v[132:135]
  global_load_lds_dwordx4 v[6:7], off offset:128
  v_mfma_f32_16x16x32_bf16 v[132:135], a[40:43], a[80:83], v[132:135]
  ds_read_b32 v32, v37 offset:8256
  s_waitcnt lgkmcnt(9)
  v_mfma_f32_16x16x32_bf16 v[136:139], a[48:51], a[80:83], v[136:139]
  s_xor_b32 m0, s49, 33792
  v_fmac_f32 v208, v224, v28
  v_fmac_f32 v209, v225, v28
  v_mfma_f32_16x16x32_bf16 v[136:139], a[52:55], a[84:87], v[136:139]
  v_fmac_f32 v210, v226, v28
  v_fmac_f32 v211, v227, v28
  v_mfma_f32_16x16x32_bf16 v[140:143], a[60:63], a[84:87], v[140:143]
  buffer_load_dwordx4 v3, s[8:11], s44 offen lds
  v_mfma_f32_16x16x32_bf16 v[140:143], a[56:59], a[80:83], v[140:143]
  s_waitcnt lgkmcnt(7)
  ds_read_b64_tr_b16 a[72:73], v12 offset:25088
  ds_read_b64_tr_b16 a[74:75], v12 offset:25344
  v_mfma_f32_16x16x32_bf16 v[144:147], a[32:35], a[88:91], v[144:147]
  s_waitcnt lgkmcnt(7)
  ds_read_b64_tr_b16 a[76:77], v12 offset:29184
  ds_read_b64_tr_b16 a[78:79], v12 offset:29440
  v_mfma_f32_16x16x32_bf16 v[144:147], a[36:39], a[92:95], v[144:147]
  v_fmac_f32 v212, v228, v28
  v_fmac_f32 v213, v229, v28
  v_mfma_f32_16x16x32_bf16 v[148:151], a[44:47], a[92:95], v[148:151]
  s_xor_b32 m0, s49, 35840
  v_fmac_f32 v214, v230, v28
  v_fmac_f32 v215, v231, v28
  v_mfma_f32_16x16x32_bf16 v[148:151], a[40:43], a[88:91], v[148:151]
  buffer_load_dwordx4 a[100:103], v59, s[12:15], s23 offen offset:1024 sc1
  v_mfma_f32_16x16x32_bf16 v[152:155], a[48:51], a[88:91], v[152:155]
  buffer_load_dwordx4 v3, s[8:11], s45 offen lds
  v_mfma_f32_16x16x32_bf16 v[152:155], a[52:55], a[92:95], v[152:155]
  v_fmac_f32 v216, v232, v28
  v_fmac_f32 v217, v233, v28
  v_mfma_f32_16x16x32_bf16 v[156:159], a[60:63], a[92:95], v[156:159]
  v_fmac_f32 v218, v234, v28
  v_fmac_f32 v219, v235, v28
  v_mfma_f32_16x16x32_bf16 v[156:159], a[56:59], a[88:91], v[156:159]
  s_waitcnt lgkmcnt(7)
  ds_read_b64_tr_b16 a[80:81], v13 offset:25088
  ds_read_b64_tr_b16 a[82:83], v13 offset:25344
  v_mfma_f32_16x16x32_bf16 v[160:163], a[32:35], a[64:67], v[160:163]
  s_waitcnt lgkmcnt(7)
  ds_read_b64_tr_b16 a[84:85], v13 offset:29184
  ds_read_b64_tr_b16 a[86:87], v13 offset:29440
  v_mfma_f32_16x16x32_bf16 v[160:163], a[36:39], a[68:71], v[160:163]
  s_xor_b32 m0, s49, 37888
  v_fmac_f32 v220, v236, v28
  v_fmac_f32 v221, v237, v28
  v_mfma_f32_16x16x32_bf16 v[164:167], a[44:47], a[68:71], v[164:167]
  s_waitcnt vmcnt(14)
  ds_read_b128 a[0:3], v8 offset:0
  v_fmac_f32 v222, v238, v28
  v_mfma_f32_16x16x32_bf16 v[164:167], a[40:43], a[64:67], v[164:167]
  ds_read_b128 a[4:7], v9 offset:0
  v_fmac_f32 v223, v239, v28
  v_mfma_f32_16x16x32_bf16 v[168:171], a[48:51], a[64:67], v[168:171]
  ds_read_b128 a[8:11], v8 offset:2048
  v_mfma_f32_16x16x32_bf16 v[168:171], a[52:55], a[68:71], v[168:171]
  ds_read_b128 a[12:15], v9 offset:2048
  v_mfma_f32_16x16x32_bf16 v[172:175], a[60:63], a[68:71], v[172:175]
  buffer_load_dwordx4 v3, s[8:11], s46 offen lds
  v_mfma_f32_16x16x32_bf16 v[172:175], a[56:59], a[64:67], v[172:175]
  s_waitcnt lgkmcnt(10)
  ds_read_b64_tr_b16 a[88:89], v14 offset:25088
  ds_read_b64_tr_b16 a[90:91], v14 offset:25344
  v_mfma_f32_16x16x32_bf16 v[176:179], a[32:35], a[72:75], v[176:179]
  s_waitcnt lgkmcnt(10)
  ds_read_b64_tr_b16 a[92:93], v14 offset:29184
  ds_read_b64_tr_b16 a[94:95], v14 offset:29440
  v_mfma_f32_16x16x32_bf16 v[176:179], a[36:39], a[76:79], v[176:179]
  s_xor_b32 m0, s49, 39936
  v_fmac_f32 v128, v224, v32
  v_fmac_f32 v129, v225, v32
  v_mfma_f32_16x16x32_bf16 v[180:183], a[44:47], a[76:79], v[180:183]
  ds_read_b128 a[16:19], v8 offset:4096
  v_fmac_f32 v130, v226, v32
  v_mfma_f32_16x16x32_bf16 v[180:183], a[40:43], a[72:75], v[180:183]
  ds_read_b128 a[20:23], v9 offset:4096
  v_fmac_f32 v131, v227, v32
  v_mfma_f32_16x16x32_bf16 v[184:187], a[48:51], a[72:75], v[184:187]
  ds_read_b128 a[24:27], v8 offset:6144
  v_fmac_f32 v132, v228, v32
  v_mfma_f32_16x16x32_bf16 v[184:187], a[52:55], a[76:79], v[184:187]
  ds_read_b128 a[28:31], v9 offset:6144
  v_fmac_f32 v133, v229, v32
  v_mfma_f32_16x16x32_bf16 v[188:191], a[60:63], a[76:79], v[188:191]
  buffer_load_dwordx4 v3, s[8:11], s47 offen lds
  v_mfma_f32_16x16x32_bf16 v[188:191], a[56:59], a[72:75], v[188:191]
  s_waitcnt lgkmcnt(14)
  buffer_load_dwordx4 a[104:107], v59, s[12:15], s23 offen offset:2048 sc1
  v_mfma_f32_16x16x32_bf16 v[192:195], a[32:35], a[80:83], v[192:195]
  s_waitcnt lgkmcnt(12)
  buffer_load_dwordx4 a[108:111], v59, s[12:15], s23 offen offset:3072 sc1
  v_mfma_f32_16x16x32_bf16 v[192:195], a[36:39], a[84:87], v[192:195]
  s_waitcnt lgkmcnt(0)
  s_barrier
  ds_read_b64_tr_b16 a[64:65], v10 offset:49152
  v_mfma_f32_16x16x32_bf16 v[196:199], a[44:47], a[84:87], v[196:199]
  ds_read_b64_tr_b16 a[66:67], v10 offset:49408
  v_fmac_f32 v134, v230, v32
  v_mfma_f32_16x16x32_bf16 v[196:199], a[40:43], a[80:83], v[196:199]
  ds_read_b64_tr_b16 a[68:69], v10 offset:53248
  v_fmac_f32 v135, v231, v32
  v_mfma_f32_16x16x32_bf16 v[200:203], a[48:51], a[80:83], v[200:203]
  ds_read_b64_tr_b16 a[70:71], v10 offset:53504
  v_fmac_f32 v136, v232, v32
  v_mfma_f32_16x16x32_bf16 v[200:203], a[52:55], a[84:87], v[200:203]
  buffer_load_dwordx4 a[112:115], v60, s[12:15], s23 offen offset:0 sc1
  v_mfma_f32_16x16x32_bf16 v[204:207], a[60:63], a[84:87], v[204:207]
  v_fmac_f32 v137, v233, v32
  v_fmac_f32 v138, v234, v32
  v_mfma_f32_16x16x32_bf16 v[204:207], a[56:59], a[80:83], v[204:207]
  s_waitcnt lgkmcnt(4)
  ds_read_b64_tr_b16 a[72:73], v11 offset:49152
  ds_read_b64_tr_b16 a[74:75], v11 offset:49408
  v_mfma_f32_16x16x32_bf16 v[208:211], a[32:35], a[88:91], v[208:211]
  s_waitcnt lgkmcnt(6)
  ds_read_b64_tr_b16 a[76:77], v11 offset:53248
  ds_read_b64_tr_b16 a[78:79], v11 offset:53504
  v_mfma_f32_16x16x32_bf16 v[208:211], a[36:39], a[92:95], v[208:211]
  s_add_u32 s23, s83, 163840
  buffer_load_dwordx4 a[116:119], v59, s[12:15], s23 offen offset:0 sc1
  v_mfma_f32_16x16x32_bf16 v[212:215], a[44:47], a[92:95], v[212:215]
  v_fmac_f32 v139, v235, v32
  v_fmac_f32 v140, v236, v32
  v_fmac_f32 v141, v237, v32
  v_fmac_f32 v142, v238, v32
  v_fmac_f32 v143, v239, v32
  v_mfma_f32_16x16x32_bf16 v[212:215], a[40:43], a[88:91], v[212:215]
  ds_read_b128 v[224:227], v57 offset:256
  v_mfma_f32_16x16x32_bf16 v[216:219], a[48:51], a[88:91], v[216:219]
  buffer_load_dwordx4 a[120:123], v59, s[12:15], s23 offen offset:1024 sc1
  v_mfma_f32_16x16x32_bf16 v[216:219], a[52:55], a[92:95], v[216:219]
  ds_read_b128 v[228:231], v57 offset:320
  v_mfma_f32_16x16x32_bf16 v[220:223], a[60:63], a[92:95], v[220:223]
  ds_read_b128 v[232:235], v57 offset:384
  v_mfma_f32_16x16x32_bf16 v[220:223], a[56:59], a[88:91], v[220:223]
  s_waitcnt lgkmcnt(9)
  ds_read_b64_tr_b16 a[80:81], v12 offset:49152
  ds_read_b64_tr_b16 a[82:83], v12 offset:49408
  v_mfma_f32_16x16x32_bf16 v[64:67], a[0:3], a[64:67], v[64:67]
  s_waitcnt lgkmcnt(9)
  ds_read_b64_tr_b16 a[84:85], v12 offset:53248
  ds_read_b64_tr_b16 a[86:87], v12 offset:53504
  v_mfma_f32_16x16x32_bf16 v[64:67], a[4:7], a[68:71], v[64:67]
  buffer_load_dwordx4 a[124:127], v59, s[12:15], s23 offen offset:2048 sc1
  v_mfma_f32_16x16x32_bf16 v[68:71], a[12:15], a[68:71], v[68:71]
  s_waitcnt vmcnt(6)
  ds_read_b128 a[32:35], v8 offset:32768
  ds_read_b128 v[236:239], v57 offset:448
  v_mfma_f32_16x16x32_bf16 v[68:71], a[8:11], a[64:67], v[68:71]
  ds_read_b128 a[36:39], v9 offset:32768
  v_mfma_f32_16x16x32_bf16 v[72:75], a[16:19], a[64:67], v[72:75]
  ds_read_b128 a[40:43], v8 offset:34816
  v_mfma_f32_16x16x32_bf16 v[72:75], a[20:23], a[68:71], v[72:75]
  ds_read_b128 a[44:47], v9 offset:34816
  v_mfma_f32_16x16x32_bf16 v[76:79], a[28:31], a[68:71], v[76:79]
  buffer_load_dwordx4 a[128:131], v59, s[12:15], s23 offen offset:3072 sc1
  v_mfma_f32_16x16x32_bf16 v[76:79], a[24:27], a[64:67], v[76:79]
  s_waitcnt lgkmcnt(14)
  ds_read_b64_tr_b16 a[88:89], v13 offset:49152
  ds_read_b64_tr_b16 a[90:91], v13 offset:49408
  v_mfma_f32_16x16x32_bf16 v[80:83], a[0:3], a[72:75], v[80:83]
  s_waitcnt lgkmcnt(14)
  ds_read_b64_tr_b16 a[92:93], v13 offset:53248
  ds_read_b64_tr_b16 a[94:95], v13 offset:53504
  v_mfma_f32_16x16x32_bf16 v[80:83], a[4:7], a[76:79], v[80:83]
  v_mfma_f32_16x16x32_bf16 v[84:87], a[12:15], a[76:79], v[84:87]
  s_waitcnt lgkmcnt(7)
  ds_read_b128 a[48:51], v8 offset:36864
  s_mov_b32 s68, 0x358637bd
  v_mfma_f32_16x16x32_bf16 v[84:87], a[8:11], a[72:75], v[84:87]
  s_mov_b32 s69, 0x358637bd
  ds_read_b128 a[52:55], v9 offset:36864
  v_mov_b32 v52, 0x3f803f80
  v_mfma_f32_16x16x32_bf16 v[88:91], a[16:19], a[72:75], v[88:91]
  ds_read_b128 a[56:59], v8 offset:38912
  v_mov_b32 v53, 0x3f803f80
  v_mfma_f32_16x16x32_bf16 v[88:91], a[20:23], a[76:79], v[88:91]
  ds_read_b128 a[60:63], v9 offset:38912
  v_mov_b32 v54, 0x3f803f80
  v_mfma_f32_16x16x32_bf16 v[92:95], a[28:31], a[76:79], v[92:95]
  buffer_load_dwordx4 a[132:135], v60, s[12:15], s23 offen offset:0 sc1
  v_mfma_f32_16x16x32_bf16 v[92:95], a[24:27], a[72:75], v[92:95]
  s_add_u32 s23, s83, 327680
  buffer_load_dwordx4 a[136:139], v59, s[12:15], s23 offen offset:0 sc1
  v_mfma_f32_16x16x32_bf16 v[96:99], a[0:3], a[80:83], v[96:99]
  v_mov_b32 v55, 0x3f803f80
  v_mfma_f32_16x16x32_bf16 v[96:99], a[4:7], a[84:87], v[96:99]
  s_waitcnt lgkmcnt(0)
  s_barrier
  ds_read_b64_tr_b16 a[64:65], v10 offset:0
  v_mfma_f32_16x16x32_bf16 v[100:103], a[12:15], a[84:87], v[100:103]
  ds_read_b64_tr_b16 a[66:67], v10 offset:256
  v_mfma_f32_16x16x32_bf16 v[100:103], a[8:11], a[80:83], v[100:103]
  ds_read_b64_tr_b16 a[68:69], v10 offset:4096
  v_mfma_f32_16x16x32_bf16 v[104:107], a[16:19], a[80:83], v[104:107]
  ds_read_b64_tr_b16 a[70:71], v10 offset:4352
  v_mfma_f32_16x16x32_bf16 v[104:107], a[20:23], a[84:87], v[104:107]
  buffer_load_dwordx4 a[140:143], v59, s[12:15], s23 offen offset:1024 sc1
  v_mfma_f32_16x16x32_bf16 v[108:111], a[28:31], a[84:87], v[108:111]
  v_mfma_f32_16x16x32_bf16 v[108:111], a[24:27], a[80:83], v[108:111]
  s_waitcnt lgkmcnt(4)
  ds_read_b64_tr_b16 a[72:73], v14 offset:49152
  ds_read_b64_tr_b16 a[74:75], v14 offset:49408
  v_mfma_f32_16x16x32_bf16 v[112:115], a[0:3], a[88:91], v[112:115]
  s_waitcnt lgkmcnt(6)
  ds_read_b64_tr_b16 a[76:77], v14 offset:53248
  ds_read_b64_tr_b16 a[78:79], v14 offset:53504
  v_mfma_f32_16x16x32_bf16 v[112:115], a[4:7], a[92:95], v[112:115]
  buffer_load_dwordx4 a[144:147], v59, s[12:15], s23 offen offset:2048 sc1
  v_mfma_f32_16x16x32_bf16 v[116:119], a[12:15], a[92:95], v[116:119]
  v_mfma_f32_16x16x32_bf16 v[116:119], a[8:11], a[88:91], v[116:119]
  v_mfma_f32_16x16x32_bf16 v[120:123], a[16:19], a[88:91], v[120:123]
  v_mfma_f32_16x16x32_bf16 v[120:123], a[20:23], a[92:95], v[120:123]
  buffer_load_dwordx4 a[148:151], v59, s[12:15], s23 offen offset:3072 sc1
  v_mfma_f32_16x16x32_bf16 v[124:127], a[28:31], a[92:95], v[124:127]
  v_mfma_f32_16x16x32_bf16 v[124:127], a[24:27], a[88:91], v[124:127]
  s_waitcnt lgkmcnt(6)
  ds_read_b64_tr_b16 a[80:81], v11 offset:0
  ds_read_b64_tr_b16 a[82:83], v11 offset:256
  v_mfma_f32_16x16x32_bf16 v[64:67], a[32:35], a[64:67], v[64:67]
  s_waitcnt lgkmcnt(6)
  ds_read_b64_tr_b16 a[84:85], v11 offset:4096
  ds_read_b64_tr_b16 a[86:87], v11 offset:4352
  v_mfma_f32_16x16x32_bf16 v[64:67], a[36:39], a[68:71], v[64:67]
  v_mfma_f32_16x16x32_bf16 v[68:71], a[44:47], a[68:71], v[68:71]
  buffer_load_dwordx4 a[152:155], v60, s[12:15], s23 offen offset:0 sc1
  v_mfma_f32_16x16x32_bf16 v[68:71], a[40:43], a[64:67], v[68:71]
  v_mfma_f32_16x16x32_bf16 v[72:75], a[48:51], a[64:67], v[72:75]
  v_mfma_f32_16x16x32_bf16 v[72:75], a[52:55], a[68:71], v[72:75]
  s_add_u32 s23, s83, 491520
  v_mfma_f32_16x16x32_bf16 v[76:79], a[60:63], a[68:71], v[76:79]
  buffer_load_dwordx4 a[156:159], v59, s[12:15], s23 offen offset:0 sc1
  v_mfma_f32_16x16x32_bf16 v[76:79], a[56:59], a[64:67], v[76:79]
  s_waitcnt lgkmcnt(6)
  ds_read_b64_tr_b16 a[88:89], v10 offset:49664
  ds_read_b64_tr_b16 a[90:91], v10 offset:49920
  v_mfma_f32_16x16x32_bf16 v[128:131], a[0:3], a[72:75], v[128:131]
  s_waitcnt lgkmcnt(6)
  ds_read_b64_tr_b16 a[92:93], v10 offset:53760
  ds_read_b64_tr_b16 a[94:95], v10 offset:54016
  v_mfma_f32_16x16x32_bf16 v[128:131], a[4:7], a[76:79], v[128:131]
  v_mfma_f32_16x16x32_bf16 v[132:135], a[12:15], a[76:79], v[132:135]
  v_mul_f32 v40, v224, v64
  v_mul_f32 v41, v225, v65
  v_mfma_f32_16x16x32_bf16 v[132:135], a[8:11], a[72:75], v[132:135]
  buffer_load_dwordx4 a[160:163], v59, s[12:15], s23 offen offset:1024 sc1
  v_mfma_f32_16x16x32_bf16 v[136:139], a[16:19], a[72:75], v[136:139]
  v_mul_f32 v42, v226, v66
  v_mul_f32 v43, v227, v67
  v_mfma_f32_16x16x32_bf16 v[136:139], a[20:23], a[76:79], v[136:139]
  v_exp_f32 v40, v40 clamp
  v_mfma_f32_16x16x32_bf16 v[140:143], a[28:31], a[76:79], v[140:143]
  v_exp_f32 v41, v41 clamp
  v_mfma_f32_16x16x32_bf16 v[140:143], a[24:27], a[72:75], v[140:143]
  s_waitcnt lgkmcnt(6)
  ds_read_b64_tr_b16 a[64:65], v12 offset:0
  ds_read_b64_tr_b16 a[66:67], v12 offset:256
  v_mfma_f32_16x16x32_bf16 v[80:83], a[32:35], a[80:83], v[80:83]
  s_waitcnt lgkmcnt(6)
  ds_read_b64_tr_b16 a[68:69], v12 offset:4096
  ds_read_b64_tr_b16 a[70:71], v12 offset:4352
  v_mfma_f32_16x16x32_bf16 v[80:83], a[36:39], a[84:87], v[80:83]
  buffer_load_dwordx4 a[164:167], v59, s[12:15], s23 offen offset:2048 sc1
  v_mfma_f32_16x16x32_bf16 v[84:87], a[44:47], a[84:87], v[84:87]
  v_exp_f32 v42, v42 clamp
  v_mfma_f32_16x16x32_bf16 v[84:87], a[40:43], a[80:83], v[84:87]
  v_exp_f32 v43, v43 clamp
  v_mfma_f32_16x16x32_bf16 v[88:91], a[48:51], a[80:83], v[88:91]
  buffer_load_dwordx4 a[168:171], v59, s[12:15], s23 offen offset:3072 sc1
  v_mfma_f32_16x16x32_bf16 v[88:91], a[52:55], a[84:87], v[88:91]
  v_fma_f32 v64, v64, v240, s68
  v_fma_f32 v65, v65, v241, s68
  v_mfma_f32_16x16x32_bf16 v[92:95], a[60:63], a[84:87], v[92:95]
  v_fma_f32 v66, v66, v242, s68
  v_fma_f32 v67, v67, v243, s68
  v_mfma_f32_16x16x32_bf16 v[92:95], a[56:59], a[80:83], v[92:95]
  s_waitcnt lgkmcnt(6)
  ds_read_b64_tr_b16 a[72:73], v11 offset:49664
  ds_read_b64_tr_b16 a[74:75], v11 offset:49920
  v_mfma_f32_16x16x32_bf16 v[144:147], a[0:3], a[88:91], v[144:147]
  s_waitcnt lgkmcnt(6)
  ds_read_b64_tr_b16 a[76:77], v11 offset:53760
  ds_read_b64_tr_b16 a[78:79], v11 offset:54016
  v_mfma_f32_16x16x32_bf16 v[144:147], a[4:7], a[92:95], v[144:147]
  buffer_load_dwordx4 a[172:175], v60, s[12:15], s23 offen offset:0 sc1
  v_mfma_f32_16x16x32_bf16 v[148:151], a[12:15], a[92:95], v[148:151]
  v_max_f32 v64, s68, v64
  v_max_f32 v65, s68, v65
  v_mfma_f32_16x16x32_bf16 v[148:151], a[8:11], a[88:91], v[148:151]
  v_max_f32 v66, s68, v66
  v_max_f32 v67, s68, v67
  v_mfma_f32_16x16x32_bf16 v[152:155], a[16:19], a[88:91], v[152:155]
  v_add_f32 v64, v64, v40
  v_add_f32 v65, v65, v41
  v_mfma_f32_16x16x32_bf16 v[152:155], a[20:23], a[92:95], v[152:155]
  s_add_u32 s23, s83, 655360
  v_add_f32 v66, v66, v42
  v_add_f32 v67, v67, v43
  v_mfma_f32_16x16x32_bf16 v[156:159], a[28:31], a[92:95], v[156:159]
  buffer_load_dwordx4 a[176:179], v59, s[12:15], s23 offen offset:0 sc1
  v_mfma_f32_16x16x32_bf16 v[156:159], a[24:27], a[88:91], v[156:159]
  s_waitcnt lgkmcnt(6)
  ds_read_b64_tr_b16 a[80:81], v13 offset:0
  ds_read_b64_tr_b16 a[82:83], v13 offset:256
  v_mfma_f32_16x16x32_bf16 v[96:99], a[32:35], a[64:67], v[96:99]
  s_waitcnt lgkmcnt(6)
  ds_read_b64_tr_b16 a[84:85], v13 offset:4096
  ds_read_b64_tr_b16 a[86:87], v13 offset:4352
  v_mfma_f32_16x16x32_bf16 v[96:99], a[36:39], a[68:71], v[96:99]
  v_cvt_pk_bf16_f32 v64, v64, v65
  v_cvt_pk_bf16_f32 v65, v66, v67
  v_mfma_f32_16x16x32_bf16 v[100:103], a[44:47], a[68:71], v[100:103]
  buffer_load_dwordx4 a[180:183], v59, s[12:15], s23 offen offset:1024 sc1
  v_mfma_f32_16x16x32_bf16 v[100:103], a[40:43], a[64:67], v[100:103]
  v_mul_f32 v44, v228, v68
  v_mul_f32 v45, v229, v69
  v_mfma_f32_16x16x32_bf16 v[104:107], a[48:51], a[64:67], v[104:107]
  v_mul_f32 v46, v230, v70
  v_mul_f32 v47, v231, v71
  v_mfma_f32_16x16x32_bf16 v[104:107], a[52:55], a[68:71], v[104:107]
  v_exp_f32 v44, v44 clamp
  v_mfma_f32_16x16x32_bf16 v[108:111], a[60:63], a[68:71], v[108:111]
  v_exp_f32 v45, v45 clamp
  v_mfma_f32_16x16x32_bf16 v[108:111], a[56:59], a[64:67], v[108:111]
  s_waitcnt lgkmcnt(6)
  ds_read_b64_tr_b16 a[88:89], v12 offset:49664
  ds_read_b64_tr_b16 a[90:91], v12 offset:49920
  v_mfma_f32_16x16x32_bf16 v[160:163], a[0:3], a[72:75], v[160:163]
  s_waitcnt lgkmcnt(6)
  ds_read_b64_tr_b16 a[92:93], v12 offset:53760
  ds_read_b64_tr_b16 a[94:95], v12 offset:54016
  v_mfma_f32_16x16x32_bf16 v[160:163], a[4:7], a[76:79], v[160:163]
  buffer_load_dwordx4 a[184:187], v59, s[12:15], s23 offen offset:2048 sc1
  v_mfma_f32_16x16x32_bf16 v[164:167], a[12:15], a[76:79], v[164:167]
  v_exp_f32 v46, v46 clamp
  v_mfma_f32_16x16x32_bf16 v[164:167], a[8:11], a[72:75], v[164:167]
  v_exp_f32 v47, v47 clamp
  v_mfma_f32_16x16x32_bf16 v[168:171], a[16:19], a[72:75], v[168:171]
  buffer_load_dwordx4 a[188:191], v59, s[12:15], s23 offen offset:3072 sc1
  v_mfma_f32_16x16x32_bf16 v[168:171], a[20:23], a[76:79], v[168:171]
  v_fma_f32 v68, v68, v244, s68
  v_fma_f32 v69, v69, v245, s68
  v_mfma_f32_16x16x32_bf16 v[172:175], a[28:31], a[76:79], v[172:175]
  v_fma_f32 v70, v70, v246, s68
  v_fma_f32 v71, v71, v247, s68
  v_mfma_f32_16x16x32_bf16 v[172:175], a[24:27], a[72:75], v[172:175]
  s_waitcnt lgkmcnt(6)
  ds_read_b64_tr_b16 a[64:65], v14 offset:0
  ds_read_b64_tr_b16 a[66:67], v14 offset:256
  v_mfma_f32_16x16x32_bf16 v[112:115], a[32:35], a[80:83], v[112:115]
  s_waitcnt lgkmcnt(6)
  ds_read_b64_tr_b16 a[68:69], v14 offset:4096
  ds_read_b64_tr_b16 a[70:71], v14 offset:4352
  v_mfma_f32_16x16x32_bf16 v[112:115], a[36:39], a[84:87], v[112:115]
  buffer_load_dwordx4 a[192:195], v60, s[12:15], s23 offen offset:0 sc1
  v_mfma_f32_16x16x32_bf16 v[116:119], a[44:47], a[84:87], v[116:119]
  v_max_f32 v68, s68, v68
  v_max_f32 v69, s68, v69
  v_mfma_f32_16x16x32_bf16 v[116:119], a[40:43], a[80:83], v[116:119]
  v_max_f32 v70, s68, v70
  v_max_f32 v71, s68, v71
  v_mfma_f32_16x16x32_bf16 v[120:123], a[48:51], a[80:83], v[120:123]
  s_add_u32 s23, s83, 819200
  v_add_f32 v68, v68, v44
  v_add_f32 v69, v69, v45
  v_mfma_f32_16x16x32_bf16 v[120:123], a[52:55], a[84:87], v[120:123]
  buffer_load_dwordx4 a[196:199], v59, s[12:15], s23 offen offset:0 sc1
  v_mfma_f32_16x16x32_bf16 v[124:127], a[60:63], a[84:87], v[124:127]
  v_add_f32 v70, v70, v46
  v_add_f32 v71, v71, v47
  v_mfma_f32_16x16x32_bf16 v[124:127], a[56:59], a[80:83], v[124:127]
  s_waitcnt lgkmcnt(6)
  ds_read_b64_tr_b16 a[72:73], v13 offset:49664
  ds_read_b64_tr_b16 a[74:75], v13 offset:49920
  v_mfma_f32_16x16x32_bf16 v[176:179], a[0:3], a[88:91], v[176:179]
  s_waitcnt lgkmcnt(6)
  ds_read_b64_tr_b16 a[76:77], v13 offset:53760
  ds_read_b64_tr_b16 a[78:79], v13 offset:54016
  v_mfma_f32_16x16x32_bf16 v[176:179], a[4:7], a[92:95], v[176:179]
  v_cvt_pk_bf16_f32 v66, v68, v69
  v_cvt_pk_bf16_f32 v67, v70, v71
  v_mfma_f32_16x16x32_bf16 v[180:183], a[12:15], a[92:95], v[180:183]
  buffer_load_dwordx4 a[200:203], v59, s[12:15], s23 offen offset:1024 sc1
  v_mfma_f32_16x16x32_bf16 v[180:183], a[8:11], a[88:91], v[180:183]
  v_mul_f32 v40, v232, v72
  v_mul_f32 v41, v233, v73
  v_mfma_f32_16x16x32_bf16 v[184:187], a[16:19], a[88:91], v[184:187]
  v_mul_f32 v42, v234, v74
  v_mul_f32 v43, v235, v75
  v_mfma_f32_16x16x32_bf16 v[184:187], a[20:23], a[92:95], v[184:187]
  v_exp_f32 v40, v40 clamp
  v_mfma_f32_16x16x32_bf16 v[188:191], a[28:31], a[92:95], v[188:191]
  buffer_load_dwordx4 a[204:207], v59, s[12:15], s23 offen offset:2048 sc1
  v_mfma_f32_16x16x32_bf16 v[188:191], a[24:27], a[88:91], v[188:191]
  s_waitcnt lgkmcnt(6)
  ds_read_b64_tr_b16 a[80:81], v10 offset:512
  ds_read_b64_tr_b16 a[82:83], v10 offset:768
  v_mfma_f32_16x16x32_bf16 v[128:131], a[32:35], a[64:67], v[128:131]
  s_waitcnt lgkmcnt(6)
  ds_read_b64_tr_b16 a[84:85], v10 offset:4608
  ds_read_b64_tr_b16 a[86:87], v10 offset:4864
  v_mfma_f32_16x16x32_bf16 v[128:131], a[36:39], a[68:71], v[128:131]
  v_exp_f32 v41, v41 clamp
  v_mfma_f32_16x16x32_bf16 v[132:135], a[44:47], a[68:71], v[132:135]
  v_exp_f32 v42, v42 clamp
  v_mfma_f32_16x16x32_bf16 v[132:135], a[40:43], a[64:67], v[132:135]
  buffer_load_dwordx4 a[208:211], v59, s[12:15], s23 offen offset:3072 sc1
  v_mfma_f32_16x16x32_bf16 v[136:139], a[48:51], a[64:67], v[136:139]
  v_exp_f32 v43, v43 clamp
  v_mfma_f32_16x16x32_bf16 v[136:139], a[52:55], a[68:71], v[136:139]
  v_fma_f32 v72, v72, v248, s68
  v_fma_f32 v73, v73, v249, s68
  v_mfma_f32_16x16x32_bf16 v[140:143], a[60:63], a[68:71], v[140:143]
  v_fma_f32 v74, v74, v250, s68
  v_fma_f32 v75, v75, v251, s68
  v_mfma_f32_16x16x32_bf16 v[140:143], a[56:59], a[64:67], v[140:143]
  s_waitcnt lgkmcnt(6)
  ds_read_b64_tr_b16 a[88:89], v14 offset:49664
  ds_read_b64_tr_b16 a[90:91], v14 offset:49920
  v_mfma_f32_16x16x32_bf16 v[192:195], a[0:3], a[72:75], v[192:195]
  s_waitcnt lgkmcnt(6)
  ds_read_b64_tr_b16 a[92:93], v14 offset:53760
  ds_read_b64_tr_b16 a[94:95], v14 offset:54016
  v_mfma_f32_16x16x32_bf16 v[192:195], a[4:7], a[76:79], v[192:195]
  buffer_load_dwordx4 a[212:215], v60, s[12:15], s23 offen offset:0 sc1
  v_mfma_f32_16x16x32_bf16 v[196:199], a[12:15], a[76:79], v[196:199]
  v_max_f32 v72, s68, v72
  v_max_f32 v73, s68, v73
  v_mfma_f32_16x16x32_bf16 v[196:199], a[8:11], a[72:75], v[196:199]
  s_add_u32 s23, s83, 983040
  v_max_f32 v74, s68, v74
  v_max_f32 v75, s68, v75
  v_mfma_f32_16x16x32_bf16 v[200:203], a[16:19], a[72:75], v[200:203]
  buffer_load_dwordx4 a[216:219], v59, s[12:15], s23 offen offset:0 sc1
  v_mfma_f32_16x16x32_bf16 v[200:203], a[20:23], a[76:79], v[200:203]
  v_add_f32 v72, v72, v40
  v_add_f32 v73, v73, v41
  v_mfma_f32_16x16x32_bf16 v[204:207], a[28:31], a[76:79], v[204:207]
  v_add_f32 v74, v74, v42
  v_add_f32 v75, v75, v43
  v_mfma_f32_16x16x32_bf16 v[204:207], a[24:27], a[72:75], v[204:207]
  s_waitcnt lgkmcnt(6)
  ds_read_b64_tr_b16 a[64:65], v11 offset:512
  ds_read_b64_tr_b16 a[66:67], v11 offset:768
  v_mfma_f32_16x16x32_bf16 v[144:147], a[32:35], a[80:83], v[144:147]
  s_waitcnt lgkmcnt(6)
  ds_read_b64_tr_b16 a[68:69], v11 offset:4608
  ds_read_b64_tr_b16 a[70:71], v11 offset:4864
  v_mfma_f32_16x16x32_bf16 v[144:147], a[36:39], a[84:87], v[144:147]
  buffer_load_dwordx4 a[220:223], v59, s[12:15], s23 offen offset:1024 sc1
  v_mfma_f32_16x16x32_bf16 v[148:151], a[44:47], a[84:87], v[148:151]
  s_mov_b32 s62, 24117248
  buffer_load_dword v39, v38, s[12:15], s62 offen sc1
  v_mfma_f32_16x16x32_bf16 v[148:151], a[40:43], a[80:83], v[148:151]
  v_cvt_pk_bf16_f32 v72, v72, v73
  v_cvt_pk_bf16_f32 v73, v74, v75
  v_mfma_f32_16x16x32_bf16 v[152:155], a[48:51], a[80:83], v[152:155]
  v_mul_f32 v44, v236, v76
  v_mul_f32 v45, v237, v77
  v_mfma_f32_16x16x32_bf16 v[152:155], a[52:55], a[84:87], v[152:155]
  v_mul_f32 v46, v238, v78
  v_mul_f32 v47, v239, v79
  v_mfma_f32_16x16x32_bf16 v[156:159], a[60:63], a[84:87], v[156:159]
  buffer_load_dwordx4 a[224:227], v59, s[12:15], s23 offen offset:2048 sc1
  v_mfma_f32_16x16x32_bf16 v[156:159], a[56:59], a[80:83], v[156:159]
  s_waitcnt lgkmcnt(6)
  ds_read_b64_tr_b16 a[72:73], v12 offset:512
  ds_read_b64_tr_b16 a[74:75], v12 offset:768
  v_mfma_f32_16x16x32_bf16 v[208:211], a[0:3], a[88:91], v[208:211]
  s_waitcnt lgkmcnt(6)
  ds_read_b64_tr_b16 a[76:77], v12 offset:4608
  ds_read_b64_tr_b16 a[78:79], v12 offset:4864
  v_mfma_f32_16x16x32_bf16 v[208:211], a[4:7], a[92:95], v[208:211]
  v_exp_f32 v44, v44 clamp
  v_mfma_f32_16x16x32_bf16 v[212:215], a[12:15], a[92:95], v[212:215]
  buffer_load_dwordx4 a[228:231], v59, s[12:15], s23 offen offset:3072 sc1
  v_mfma_f32_16x16x32_bf16 v[212:215], a[8:11], a[88:91], v[212:215]
  v_exp_f32 v45, v45 clamp
  v_mfma_f32_16x16x32_bf16 v[216:219], a[16:19], a[88:91], v[216:219]
  v_exp_f32 v46, v46 clamp
  v_mfma_f32_16x16x32_bf16 v[216:219], a[20:23], a[92:95], v[216:219]
  v_exp_f32 v47, v47 clamp
  v_mfma_f32_16x16x32_bf16 v[220:223], a[28:31], a[92:95], v[220:223]
  v_fma_f32 v76, v76, v252, s68
  v_fma_f32 v77, v77, v253, s68
  v_mfma_f32_16x16x32_bf16 v[220:223], a[24:27], a[88:91], v[220:223]
  s_waitcnt lgkmcnt(6)
  ds_read_b64_tr_b16 a[80:81], v13 offset:512
  ds_read_b64_tr_b16 a[82:83], v13 offset:768
  v_mfma_f32_16x16x32_bf16 v[160:163], a[32:35], a[64:67], v[160:163]
  s_waitcnt lgkmcnt(6)
  ds_read_b64_tr_b16 a[84:85], v13 offset:4608
  ds_read_b64_tr_b16 a[86:87], v13 offset:4864
  v_mfma_f32_16x16x32_bf16 v[160:163], a[36:39], a[68:71], v[160:163]
  buffer_load_dwordx4 a[232:235], v60, s[12:15], s23 offen offset:0 sc1
  v_mfma_f32_16x16x32_bf16 v[164:167], a[44:47], a[68:71], v[164:167]
  v_fma_f32 v78, v78, v254, s68
  v_fma_f32 v79, v79, v255, s68
  v_mfma_f32_16x16x32_bf16 v[164:167], a[40:43], a[64:67], v[164:167]
  s_add_u32 s23, s83, 1146880
  v_max_f32 v76, s68, v76
  v_max_f32 v77, s68, v77
  v_mfma_f32_16x16x32_bf16 v[168:171], a[48:51], a[64:67], v[168:171]
  buffer_load_dwordx4 a[236:239], v59, s[12:15], s23 offen offset:0 sc1
  v_mfma_f32_16x16x32_bf16 v[168:171], a[52:55], a[68:71], v[168:171]
  v_max_f32 v78, s68, v78
  v_max_f32 v79, s68, v79
  v_mfma_f32_16x16x32_bf16 v[172:175], a[60:63], a[68:71], v[172:175]
  v_add_f32 v76, v76, v44
  v_add_f32 v77, v77, v45
  v_mfma_f32_16x16x32_bf16 v[172:175], a[56:59], a[64:67], v[172:175]
  s_waitcnt lgkmcnt(6)
  ds_read_b64_tr_b16 a[88:89], v14 offset:512
  ds_read_b64_tr_b16 a[90:91], v14 offset:768
  v_mfma_f32_16x16x32_bf16 v[176:179], a[32:35], a[72:75], v[176:179]
  s_waitcnt lgkmcnt(6)
  ds_read_b64_tr_b16 a[92:93], v14 offset:4608
  ds_read_b64_tr_b16 a[94:95], v14 offset:4864
  v_mfma_f32_16x16x32_bf16 v[176:179], a[36:39], a[76:79], v[176:179]
  buffer_load_dwordx4 a[240:243], v59, s[12:15], s23 offen offset:1024 sc1
  v_mfma_f32_16x16x32_bf16 v[180:183], a[44:47], a[76:79], v[180:183]
  v_add_f32 v78, v78, v46
  v_add_f32 v79, v79, v47
  v_mfma_f32_16x16x32_bf16 v[180:183], a[40:43], a[72:75], v[180:183]
  v_cvt_pk_bf16_f32 v74, v76, v77
  v_cvt_pk_bf16_f32 v75, v78, v79
  v_mfma_f32_16x16x32_bf16 v[184:187], a[48:51], a[72:75], v[184:187]
  v_mul_f32 v40, v224, v80
  v_mul_f32 v41, v225, v81
  v_mfma_f32_16x16x32_bf16 v[184:187], a[52:55], a[76:79], v[184:187]
  buffer_load_dwordx4 a[244:247], v59, s[12:15], s23 offen offset:2048 sc1
  v_mfma_f32_16x16x32_bf16 v[188:191], a[60:63], a[76:79], v[188:191]
  v_mul_f32 v42, v226, v82
  v_mul_f32 v43, v227, v83
  v_mfma_f32_16x16x32_bf16 v[188:191], a[56:59], a[72:75], v[188:191]
  s_waitcnt lgkmcnt(6)
  v_exp_f32 v40, v40 clamp
  v_mfma_f32_16x16x32_bf16 v[192:195], a[32:35], a[80:83], v[192:195]
  s_waitcnt lgkmcnt(4)
  v_exp_f32 v41, v41 clamp
  v_mfma_f32_16x16x32_bf16 v[192:195], a[36:39], a[84:87], v[192:195]
L_hop_kv3:
  s_cbranch_execz L_retkv1
  v_exp_f32 v42, v42 clamp
  v_mfma_f32_16x16x32_bf16 v[196:199], a[44:47], a[84:87], v[196:199]
  buffer_load_dwordx4 a[248:251], v59, s[12:15], s23 offen offset:3072 sc1
  v_mfma_f32_16x16x32_bf16 v[196:199], a[40:43], a[80:83], v[196:199]
  v_exp_f32 v43, v43 clamp
  v_mfma_f32_16x16x32_bf16 v[200:203], a[48:51], a[80:83], v[200:203]
  v_fma_f32 v80, v80, v240, s68
  v_fma_f32 v81, v81, v241, s68
  v_mfma_f32_16x16x32_bf16 v[200:203], a[52:55], a[84:87], v[200:203]
  v_fma_f32 v82, v82, v242, s68
  v_fma_f32 v83, v83, v243, s68
  v_mfma_f32_16x16x32_bf16 v[204:207], a[60:63], a[84:87], v[204:207]
  buffer_load_dwordx4 a[252:255], v60, s[12:15], s23 offen offset:0 sc1
  v_mfma_f32_16x16x32_bf16 v[204:207], a[56:59], a[80:83], v[204:207]
  s_waitcnt lgkmcnt(2)
  v_max_f32 v80, s68, v80
  v_max_f32 v81, s68, v81
  v_mfma_f32_16x16x32_bf16 v[208:211], a[32:35], a[88:91], v[208:211]
  s_waitcnt lgkmcnt(0)
  v_max_f32 v82, s68, v82
  v_max_f32 v83, s68, v83
  v_mfma_f32_16x16x32_bf16 v[208:211], a[36:39], a[92:95], v[208:211]
  v_add_f32 v80, v80, v40
  v_add_f32 v81, v81, v41
  v_mfma_f32_16x16x32_bf16 v[212:215], a[44:47], a[92:95], v[212:215]
  s_waitcnt vmcnt(8)
  v_cmp_ne_u32 vcc, s61, v39
  v_add_f32 v82, v82, v42
  v_mfma_f32_16x16x32_bf16 v[212:215], a[40:43], a[88:91], v[212:215]
  v_add_f32 v83, v83, v43
  v_cvt_pk_bf16_f32 v80, v80, v81
  v_mfma_f32_16x16x32_bf16 v[216:219], a[48:51], a[88:91], v[216:219]
  s_cbranch_vccnz L_slow_45
L_back_46:
  v_cvt_pk_bf16_f32 v81, v82, v83
  v_mul_f32 v44, v228, v84
  v_mfma_f32_16x16x32_bf16 v[216:219], a[52:55], a[92:95], v[216:219]
  v_mul_f32 v45, v229, v85
  v_mul_f32 v46, v230, v86
  v_mfma_f32_16x16x32_bf16 v[220:223], a[60:63], a[92:95], v[220:223]
  v_mul_f32 v47, v231, v87
  v_mfma_f32_16x16x32_bf16 v[220:223], a[56:59], a[88:91], v[220:223]
  v_exp_f32 v44, v44 clamp
  s_nop 7
  v_exp_f32 v45, v45 clamp
  v_exp_f32 v46, v46 clamp
  v_exp_f32 v47, v47 clamp
  v_fma_f32 v84, v84, v244, s68
  v_fma_f32 v85, v85, v245, s68
  v_fma_f32 v86, v86, v246, s68
  v_fma_f32 v87, v87, v247, s68
  v_max_f32 v84, s68, v84
  v_max_f32 v85, s68, v85
  v_max_f32 v86, s68, v86
  v_max_f32 v87, s68, v87
  v_add_f32 v84, v84, v44
  v_add_f32 v85, v85, v45
  v_add_f32 v86, v86, v46
  v_add_f32 v87, v87, v47
  v_cvt_pk_bf16_f32 v82, v84, v85
  v_cvt_pk_bf16_f32 v83, v86, v87
  v_pk_mul_f32 v[40:41], v[88:89], v[232:233]
  v_pk_mul_f32 v[42:43], v[90:91], v[234:235]
  v_exp_f32 v40, v40 clamp
  v_exp_f32 v41, v41 clamp
  v_exp_f32 v42, v42 clamp
  v_exp_f32 v43, v43 clamp
  v_pk_fma_f32 v[88:89], v[88:89], v[248:249], s[68:69]
  v_pk_fma_f32 v[90:91], v[90:91], v[250:251], s[68:69]
  v_max_f32 v88, s68, v88
  v_max_f32 v89, s68, v89
  v_max_f32 v90, s68, v90
  v_max_f32 v91, s68, v91
  v_pk_add_f32 v[88:89], v[88:89], v[40:41]
  v_pk_add_f32 v[90:91], v[90:91], v[42:43]
  v_cvt_pk_bf16_f32 v88, v88, v89
  v_cvt_pk_bf16_f32 v89, v90, v91
  s_add_u32 s23, s83, 1310720
  s_add_u32 m0, s48, 0
  s_nop 0
  buffer_load_dwordx4 v59, s[12:15], s23 offen offset:0 sc1 lds
  v_pk_mul_f32 v[44:45], v[92:93], v[236:237]
  v_pk_mul_f32 v[46:47], v[94:95], v[238:239]
  v_exp_f32 v44, v44 clamp
  v_exp_f32 v45, v45 clamp
  v_exp_f32 v46, v46 clamp
  v_exp_f32 v47, v47 clamp
  v_pk_fma_f32 v[92:93], v[92:93], v[252:253], s[68:69]
  v_pk_fma_f32 v[94:95], v[94:95], v[254:255], s[68:69]
  v_max_f32 v92, s68, v92
  v_max_f32 v93, s68, v93
  v_max_f32 v94, s68, v94
  v_max_f32 v95, s68, v95
  v_pk_add_f32 v[92:93], v[92:93], v[44:45]
  v_pk_add_f32 v[94:95], v[94:95], v[46:47]
  v_cvt_pk_bf16_f32 v90, v92, v93
  v_cvt_pk_bf16_f32 v91, v94, v95
  s_add_u32 m0, s48, 0
  s_nop 0
  buffer_load_dwordx4 v59, s[12:15], s23 offen offset:1024 sc1 lds
  v_pk_mul_f32 v[40:41], v[96:97], v[224:225]
  v_pk_mul_f32 v[42:43], v[98:99], v[226:227]
  v_exp_f32 v40, v40 clamp
  v_exp_f32 v41, v41 clamp
  v_exp_f32 v42, v42 clamp
  v_exp_f32 v43, v43 clamp
  v_pk_fma_f32 v[96:97], v[96:97], v[240:241], s[68:69]
  v_pk_fma_f32 v[98:99], v[98:99], v[242:243], s[68:69]
  v_max_f32 v96, s68, v96
  v_max_f32 v97, s68, v97
  v_max_f32 v98, s68, v98
  v_max_f32 v99, s68, v99
  v_pk_add_f32 v[96:97], v[96:97], v[40:41]
  v_pk_add_f32 v[98:99], v[98:99], v[42:43]
  v_cvt_pk_bf16_f32 v96, v96, v97
  v_cvt_pk_bf16_f32 v97, v98, v99
  s_add_u32 m0, s48, 0
  s_nop 0
  buffer_load_dwordx4 v59, s[12:15], s23 offen offset:2048 sc1 lds
  v_pk_mul_f32 v[44:45], v[100:101], v[228:229]
  v_pk_mul_f32 v[46:47], v[102:103], v[230:231]
  v_exp_f32 v44, v44 clamp
  v_exp_f32 v45, v45 clamp
  v_exp_f32 v46, v46 clamp
  v_exp_f32 v47, v47 clamp
  v_pk_fma_f32 v[100:101], v[100:101], v[244:245], s[68:69]
  v_pk_fma_f32 v[102:103], v[102:103], v[246:247], s[68:69]
  v_max_f32 v100, s68, v100
  v_max_f32 v101, s68, v101
  v_max_f32 v102, s68, v102
  v_max_f32 v103, s68, v103
  v_pk_add_f32 v[100:101], v[100:101], v[44:45]
  v_pk_add_f32 v[102:103], v[102:103], v[46:47]
  v_cvt_pk_bf16_f32 v98, v100, v101
  v_cvt_pk_bf16_f32 v99, v102, v103
  s_add_u32 m0, s48, 0
  s_nop 0
  buffer_load_dwordx4 v59, s[12:15], s23 offen offset:3072 sc1 lds
  v_pk_mul_f32 v[40:41], v[104:105], v[232:233]
  v_pk_mul_f32 v[42:43], v[106:107], v[234:235]
  v_exp_f32 v40, v40 clamp
  v_exp_f32 v41, v41 clamp
  v_exp_f32 v42, v42 clamp
  v_exp_f32 v43, v43 clamp
  v_pk_fma_f32 v[104:105], v[104:105], v[248:249], s[68:69]
  v_pk_fma_f32 v[106:107], v[106:107], v[250:251], s[68:69]
  v_max_f32 v104, s68, v104
  v_max_f32 v105, s68, v105
  v_max_f32 v106, s68, v106
  v_max_f32 v107, s68, v107
  v_pk_add_f32 v[104:105], v[104:105], v[40:41]
  v_pk_add_f32 v[106:107], v[106:107], v[42:43]
  v_cvt_pk_bf16_f32 v104, v104, v105
  v_cvt_pk_bf16_f32 v105, v106, v107
  s_add_u32 m0, s48, 4096
  s_nop 0
  buffer_load_dwordx4 v60, s[12:15], s23 offen offset:0 sc1 lds
  v_pk_mul_f32 v[44:45], v[108:109], v[236:237]
  v_pk_mul_f32 v[46:47], v[110:111], v[238:239]
  v_exp_f32 v44, v44 clamp
  v_exp_f32 v45, v45 clamp
  v_exp_f32 v46, v46 clamp
  v_exp_f32 v47, v47 clamp
  v_pk_fma_f32 v[108:109], v[108:109], v[252:253], s[68:69]
  v_pk_fma_f32 v[110:111], v[110:111], v[254:255], s[68:69]
  v_max_f32 v108, s68, v108
  v_max_f32 v109, s68, v109
  v_max_f32 v110, s68, v110
  v_max_f32 v111, s68, v111
  v_pk_add_f32 v[108:109], v[108:109], v[44:45]
  v_pk_add_f32 v[110:111], v[110:111], v[46:47]
  v_cvt_pk_bf16_f32 v106, v108, v109
  v_cvt_pk_bf16_f32 v107, v110, v111
  s_add_u32 s23, s83, 1474560
  s_add_u32 m0, s48, 5120
  s_nop 0
  buffer_load_dwordx4 v59, s[12:15], s23 offen offset:0 sc1 lds
  v_pk_mul_f32 v[40:41], v[112:113], v[224:225]
  v_pk_mul_f32 v[42:43], v[114:115], v[226:227]
  v_exp_f32 v40, v40 clamp
  v_exp_f32 v41, v41 clamp
  v_exp_f32 v42, v42 clamp
  v_exp_f32 v43, v43 clamp
  v_pk_fma_f32 v[112:113], v[112:113], v[240:241], s[68:69]
  v_pk_fma_f32 v[114:115], v[114:115], v[242:243], s[68:69]
  v_max_f32 v112, s68, v112
  v_max_f32 v113, s68, v113
  v_max_f32 v114, s68, v114
  v_max_f32 v115, s68, v115
  v_pk_add_f32 v[112:113], v[112:113], v[40:41]
  v_pk_add_f32 v[114:115], v[114:115], v[42:43]
  v_cvt_pk_bf16_f32 v112, v112, v113
  v_cvt_pk_bf16_f32 v113, v114, v115
  s_add_u32 m0, s48, 5120
  s_nop 0
  buffer_load_dwordx4 v59, s[12:15], s23 offen offset:1024 sc1 lds
  v_pk_mul_f32 v[44:45], v[116:117], v[228:229]
  v_pk_mul_f32 v[46:47], v[118:119], v[230:231]
  v_exp_f32 v44, v44 clamp
  v_exp_f32 v45, v45 clamp
  v_exp_f32 v46, v46 clamp
  v_exp_f32 v47, v47 clamp
  v_pk_fma_f32 v[116:117], v[116:117], v[244:245], s[68:69]
  v_pk_fma_f32 v[118:119], v[118:119], v[246:247], s[68:69]
  v_max_f32 v116, s68, v116
  v_max_f32 v117, s68, v117
  v_max_f32 v118, s68, v118
  v_max_f32 v119, s68, v119
  v_pk_add_f32 v[116:117], v[116:117], v[44:45]
  v_pk_add_f32 v[118:119], v[118:119], v[46:47]
  v_cvt_pk_bf16_f32 v114, v116, v117
  v_cvt_pk_bf16_f32 v115, v118, v119
  s_add_u32 m0, s48, 5120
  s_nop 0
  buffer_load_dwordx4 v59, s[12:15], s23 offen offset:2048 sc1 lds
  v_pk_mul_f32 v[40:41], v[120:121], v[232:233]
  v_pk_mul_f32 v[42:43], v[122:123], v[234:235]
  v_exp_f32 v40, v40 clamp
  v_exp_f32 v41, v41 clamp
  v_exp_f32 v42, v42 clamp
  v_exp_f32 v43, v43 clamp
  v_pk_fma_f32 v[120:121], v[120:121], v[248:249], s[68:69]
  v_pk_fma_f32 v[122:123], v[122:123], v[250:251], s[68:69]
  v_max_f32 v120, s68, v120
  v_max_f32 v121, s68, v121
  v_max_f32 v122, s68, v122
  v_max_f32 v123, s68, v123
  v_pk_add_f32 v[120:121], v[120:121], v[40:41]
  v_pk_add_f32 v[122:123], v[122:123], v[42:43]
  v_cvt_pk_bf16_f32 v120, v120, v121
  v_cvt_pk_bf16_f32 v121, v122, v123
  s_add_u32 m0, s48, 29696
  s_nop 0
  buffer_load_dwordx4 v59, s[12:15], s23 offen offset:3072 sc1 lds
  v_pk_mul_f32 v[44:45], v[124:125], v[236:237]
  v_pk_mul_f32 v[46:47], v[126:127], v[238:239]
  v_exp_f32 v44, v44 clamp
  v_exp_f32 v45, v45 clamp
  v_exp_f32 v46, v46 clamp
  v_exp_f32 v47, v47 clamp
  v_pk_fma_f32 v[124:125], v[124:125], v[252:253], s[68:69]
  v_pk_fma_f32 v[126:127], v[126:127], v[254:255], s[68:69]
  v_max_f32 v124, s68, v124
  v_max_f32 v125, s68, v125
  v_max_f32 v126, s68, v126
  v_max_f32 v127, s68, v127
  v_pk_add_f32 v[124:125], v[124:125], v[44:45]
  v_pk_add_f32 v[126:127], v[126:127], v[46:47]
  v_cvt_pk_bf16_f32 v122, v124, v125
  v_cvt_pk_bf16_f32 v123, v126, v127
  s_add_u32 m0, s48, 33792
  s_nop 0
  buffer_load_dwordx4 v60, s[12:15], s23 offen offset:0 sc1 lds
  v_pk_mul_f32 v[40:41], v[128:129], v[224:225]
  v_pk_mul_f32 v[42:43], v[130:131], v[226:227]
  v_exp_f32 v40, v40 clamp
  v_exp_f32 v41, v41 clamp
  v_exp_f32 v42, v42 clamp
  v_exp_f32 v43, v43 clamp
  v_pk_fma_f32 v[128:129], v[128:129], v[240:241], s[68:69]
  v_pk_fma_f32 v[130:131], v[130:131], v[242:243], s[68:69]
  v_max_f32 v128, s68, v128
  v_max_f32 v129, s68, v129
  v_max_f32 v130, s68, v130
  v_max_f32 v131, s68, v131
  v_pk_add_f32 v[128:129], v[128:129], v[40:41]
  v_pk_add_f32 v[130:131], v[130:131], v[42:43]
  v_cvt_pk_bf16_f32 v128, v128, v129
  v_cvt_pk_bf16_f32 v129, v130, v131
  s_add_u32 s23, s83, 1638400
  s_add_u32 m0, s48, 34816
  s_nop 0
  buffer_load_dwordx4 v59, s[12:15], s23 offen offset:0 sc1 lds
  v_pk_mul_f32 v[44:45], v[132:133], v[228:229]
  v_pk_mul_f32 v[46:47], v[134:135], v[230:231]
  v_exp_f32 v44, v44 clamp
  v_exp_f32 v45, v45 clamp
  v_exp_f32 v46, v46 clamp
  v_exp_f32 v47, v47 clamp
  v_pk_fma_f32 v[132:133], v[132:133], v[244:245], s[68:69]
  v_pk_fma_f32 v[134:135], v[134:135], v[246:247], s[68:69]
  v_max_f32 v132, s68, v132
  v_max_f32 v133, s68, v133
  v_max_f32 v134, s68, v134
  v_max_f32 v135, s68, v135
  v_pk_add_f32 v[132:133], v[132:133], v[44:45]
  v_pk_add_f32 v[134:135], v[134:135], v[46:47]
  v_cvt_pk_bf16_f32 v130, v132, v133
  v_cvt_pk_bf16_f32 v131, v134, v135
  s_add_u32 m0, s48, 34816
  s_nop 0
  buffer_load_dwordx4 v59, s[12:15], s23 offen offset:1024 sc1 lds
  v_pk_mul_f32 v[40:41], v[136:137], v[232:233]
  v_pk_mul_f32 v[42:43], v[138:139], v[234:235]
  v_exp_f32 v40, v40 clamp
  v_exp_f32 v41, v41 clamp
  v_exp_f32 v42, v42 clamp
  v_exp_f32 v43, v43 clamp
  v_pk_fma_f32 v[136:137], v[136:137], v[248:249], s[68:69]
  v_pk_fma_f32 v[138:139], v[138:139], v[250:251], s[68:69]
  v_max_f32 v136, s68, v136
  v_max_f32 v137, s68, v137
  v_max_f32 v138, s68, v138
  v_max_f32 v139, s68, v139
  v_pk_add_f32 v[136:137], v[136:137], v[40:41]
  v_pk_add_f32 v[138:139], v[138:139], v[42:43]
  v_cvt_pk_bf16_f32 v136, v136, v137
  v_cvt_pk_bf16_f32 v137, v138, v139
  s_add_u32 m0, s48, 34816
  s_nop 0
  buffer_load_dwordx4 v59, s[12:15], s23 offen offset:2048 sc1 lds
  v_pk_mul_f32 v[44:45], v[140:141], v[236:237]
  v_pk_mul_f32 v[46:47], v[142:143], v[238:239]
  v_exp_f32 v44, v44 clamp
  v_exp_f32 v45, v45 clamp
  v_exp_f32 v46, v46 clamp
  v_exp_f32 v47, v47 clamp
  v_pk_fma_f32 v[140:141], v[140:141], v[252:253], s[68:69]
  v_pk_fma_f32 v[142:143], v[142:143], v[254:255], s[68:69]
  v_max_f32 v140, s68, v140
  v_max_f32 v141, s68, v141
  v_max_f32 v142, s68, v142
  v_max_f32 v143, s68, v143
  v_pk_add_f32 v[140:141], v[140:141], v[44:45]
  v_pk_add_f32 v[142:143], v[142:143], v[46:47]
  v_cvt_pk_bf16_f32 v138, v140, v141
  v_cvt_pk_bf16_f32 v139, v142, v143
  s_add_u32 m0, s48, 34816
  s_nop 0
  buffer_load_dwordx4 v59, s[12:15], s23 offen offset:3072 sc1 lds
  v_pk_mul_f32 v[144:145], v[144:145], v[240:241]
  v_pk_mul_f32 v[146:147], v[146:147], v[242:243]
  v_cvt_pk_bf16_f32 v144, v144, v145
  v_cvt_pk_bf16_f32 v145, v146, v147
  v_pk_mul_f32 v[148:149], v[148:149], v[244:245]
  v_pk_mul_f32 v[150:151], v[150:151], v[246:247]
  v_cvt_pk_bf16_f32 v146, v148, v149
  v_cvt_pk_bf16_f32 v147, v150, v151
  v_pk_mul_f32 v[152:153], v[152:153], v[248:249]
  v_pk_mul_f32 v[154:155], v[154:155], v[250:251]
  v_cvt_pk_bf16_f32 v152, v152, v153
  v_cvt_pk_bf16_f32 v153, v154, v155
  v_pk_mul_f32 v[156:157], v[156:157], v[252:253]
  v_pk_mul_f32 v[158:159], v[158:159], v[254:255]
  v_cvt_pk_bf16_f32 v154, v156, v157
  v_cvt_pk_bf16_f32 v155, v158, v159
  s_add_u32 m0, s48, 38912
  s_nop 0
  buffer_load_dwordx4 v60, s[12:15], s23 offen offset:0 sc1 lds
  v_pk_mul_f32 v[160:161], v[160:161], v[240:241]
  v_pk_mul_f32 v[162:163], v[162:163], v[242:243]
  v_cvt_pk_bf16_f32 v160, v160, v161
  v_cvt_pk_bf16_f32 v161, v162, v163
  v_pk_mul_f32 v[164:165], v[164:165], v[244:245]
  v_pk_mul_f32 v[166:167], v[166:167], v[246:247]
  v_cvt_pk_bf16_f32 v162, v164, v165
  v_cvt_pk_bf16_f32 v163, v166, v167
  v_pk_mul_f32 v[168:169], v[168:169], v[248:249]
  v_pk_mul_f32 v[170:171], v[170:171], v[250:251]
  v_cvt_pk_bf16_f32 v168, v168, v169
  v_cvt_pk_bf16_f32 v169, v170, v171
  v_pk_mul_f32 v[172:173], v[172:173], v[252:253]
  v_pk_mul_f32 v[174:175], v[174:175], v[254:255]
  v_cvt_pk_bf16_f32 v170, v172, v173
  v_cvt_pk_bf16_f32 v171, v174, v175
  s_mov_b32 s62, 26214400
  buffer_load_dword v39, v38, s[12:15], s62 offen sc1
  s_add_u32 s23, s83, 1802240
  buffer_load_dwordx4 a[0:3], v59, s[12:15], s23 offen offset:0 sc1
  v_pk_mul_f32 v[176:177], v[176:177], v[240:241]
  v_pk_mul_f32 v[178:179], v[178:179], v[242:243]
  v_cvt_pk_bf16_f32 v176, v176, v177
  v_cvt_pk_bf16_f32 v177, v178, v179
  v_pk_mul_f32 v[180:181], v[180:181], v[244:245]
  v_pk_mul_f32 v[182:183], v[182:183], v[246:247]
  v_cvt_pk_bf16_f32 v178, v180, v181
  v_cvt_pk_bf16_f32 v179, v182, v183
  v_pk_mul_f32 v[184:185], v[184:185], v[248:249]
  v_pk_mul_f32 v[186:187], v[186:187], v[250:251]
  v_cvt_pk_bf16_f32 v184, v184, v185
  v_cvt_pk_bf16_f32 v185, v186, v187
  v_pk_mul_f32 v[188:189], v[188:189], v[252:253]
  v_pk_mul_f32 v[190:191], v[190:191], v[254:255]
  v_cvt_pk_bf16_f32 v186, v188, v189
  v_cvt_pk_bf16_f32 v187, v190, v191
  buffer_load_dwordx4 a[4:7], v59, s[12:15], s23 offen offset:1024 sc1
  v_pk_mul_f32 v[192:193], v[192:193], v[240:241]
  v_pk_mul_f32 v[194:195], v[194:195], v[242:243]
  v_cvt_pk_bf16_f32 v192, v192, v193
  v_cvt_pk_bf16_f32 v193, v194, v195
  v_pk_mul_f32 v[196:197], v[196:197], v[244:245]
  v_pk_mul_f32 v[198:199], v[198:199], v[246:247]
  v_cvt_pk_bf16_f32 v194, v196, v197
  v_cvt_pk_bf16_f32 v195, v198, v199
  v_pk_mul_f32 v[200:201], v[200:201], v[248:249]
  v_pk_mul_f32 v[202:203], v[202:203], v[250:251]
  v_cvt_pk_bf16_f32 v200, v200, v201
  v_cvt_pk_bf16_f32 v201, v202, v203
  v_pk_mul_f32 v[204:205], v[204:205], v[252:253]
  v_pk_mul_f32 v[206:207], v[206:207], v[254:255]
  v_cvt_pk_bf16_f32 v202, v204, v205
  v_cvt_pk_bf16_f32 v203, v206, v207
  buffer_load_dwordx4 a[8:11], v59, s[12:15], s23 offen offset:2048 sc1
  v_pk_mul_f32 v[208:209], v[208:209], v[240:241]
  v_pk_mul_f32 v[210:211], v[210:211], v[242:243]
  v_cvt_pk_bf16_f32 v208, v208, v209
  v_cvt_pk_bf16_f32 v209, v210, v211
  v_pk_mul_f32 v[212:213], v[212:213], v[244:245]
  v_pk_mul_f32 v[214:215], v[214:215], v[246:247]
  v_cvt_pk_bf16_f32 v210, v212, v213
  v_cvt_pk_bf16_f32 v211, v214, v215
  v_pk_mul_f32 v[216:217], v[216:217], v[248:249]
  v_pk_mul_f32 v[218:219], v[218:219], v[250:251]
  v_cvt_pk_bf16_f32 v216, v216, v217
  v_cvt_pk_bf16_f32 v217, v218, v219
  v_pk_mul_f32 v[220:221], v[220:221], v[252:253]
  v_pk_mul_f32 v[222:223], v[222:223], v[254:255]
  v_cvt_pk_bf16_f32 v218, v220, v221
  v_cvt_pk_bf16_f32 v219, v222, v223
  buffer_load_dwordx4 a[12:15], v59, s[12:15], s23 offen offset:3072 sc1
  s_nop 0
  v_mfma_f32_16x16x32_bf16 v[100:103], v[128:131], v[144:147], 0
  s_mov_b32 s84, 0xffff0000
  s_mov_b32 s85, 0x0
  v_mfma_f32_16x16x32_bf16 v[100:103], v[136:139], v[152:155], v[100:103]
  s_mov_b32 s86, 0x0
  s_mov_b32 s87, 0xffff
  v_mfma_f32_16x16x32_bf16 v[108:111], v[128:131], v[160:163], 0
  s_mov_b32 s88, 0x0
  s_mov_b32 s89, 0xffff0000
  v_mfma_f32_16x16x32_bf16 v[108:111], v[136:139], v[168:171], v[108:111]
  s_mov_b32 s90, 0xf000f0
  s_mov_b32 s91, 0xf000f0
  v_mfma_f32_16x16x32_bf16 v[116:119], v[128:131], v[176:179], 0
  s_mov_b32 s92, 0xf000f00
  s_mov_b32 s93, 0xf000f00
  v_mfma_f32_16x16x32_bf16 v[116:119], v[136:139], v[184:187], v[116:119]
  s_mov_b32 s94, 0xf000f000
  s_mov_b32 s95, 0xf000f000
  v_mfma_f32_16x16x32_bf16 v[124:127], v[128:131], v[192:195], 0
  s_mov_b32 s66, 0x00f0000f
  s_mov_b32 s67, 0xf0000f00
  v_mfma_f32_16x16x32_bf16 v[124:127], v[136:139], v[200:203], v[124:127]
  s_lshl_b32 s64, s3, 10
  s_add_u32 s64, s64, 65536
  v_add_u32 v20, s64, v59
  v_mfma_f32_16x16x32_bf16 v[132:135], v[64:67], v[208:211], 0
  s_add_u32 s64, s48, 65536
  s_barrier
  v_add_u32 v21, s64, v59
  v_mfma_f32_16x16x32_bf16 v[132:135], v[72:75], v[216:219], v[132:135]
  buffer_load_dwordx4 a[16:19], v60, s[12:15], s23 offen offset:0 sc1
  v_mfma_f32_16x16x32_bf16 v[140:143], v[80:83], v[208:211], 0
  v_mfma_f32_16x16x32_bf16 v[140:143], v[88:91], v[216:219], v[140:143]
  v_cndmask_b32 v100, v100, v108, s[84:85]
  v_cndmask_b32 v101, v101, v109, s[84:85]
  v_mfma_f32_16x16x32_bf16 v[148:151], v[96:99], v[208:211], 0
  v_cndmask_b32 v102, v102, v110, s[84:85]
  v_cndmask_b32 v103, v103, v111, s[84:85]
  v_mfma_f32_16x16x32_bf16 v[148:151], v[104:107], v[216:219], v[148:151]
  v_cndmask_b32 v100, v100, v116, s[86:87]
  v_cndmask_b32 v101, v101, v117, s[86:87]
  v_mfma_f32_16x16x32_bf16 v[156:159], v[112:115], v[208:211], 0
  v_cndmask_b32 v102, v102, v118, s[86:87]
  v_cndmask_b32 v103, v103, v119, s[86:87]
  v_mfma_f32_16x16x32_bf16 v[156:159], v[120:123], v[216:219], v[156:159]
  v_cndmask_b32 v100, v100, v124, s[88:89]
  v_cndmask_b32 v101, v101, v125, s[88:89]
  v_mfma_f32_16x16x32_bf16 v[164:167], v[64:67], v[52:55], 0
  v_cndmask_b32 v102, v102, v126, s[88:89]
  v_cndmask_b32 v103, v103, v127, s[88:89]
  v_mfma_f32_16x16x32_bf16 v[164:167], v[72:75], v[52:55], v[164:167]
  ds_write_b128 v20, v[100:103] offset:16384
  v_mfma_f32_16x16x32_bf16 v[172:175], v[80:83], v[52:55], 0
  s_waitcnt vmcnt(5)
  v_cmp_ne_u32 vcc, s61, v39
  s_nop 1
  s_cbranch_vccnz L_slow_47
L_back_48:
  s_add_u32 s23, s83, 1966080
  buffer_load_dwordx4 a[20:23], v59, s[12:15], s23 offen offset:0 sc1
  v_mfma_f32_16x16x32_bf16 v[172:175], v[88:91], v[52:55], v[172:175]
  v_cndmask_b32 v132, v132, v140, s[90:91]
  v_cndmask_b32 v133, v133, v141, s[90:91]
  v_mfma_f32_16x16x32_bf16 v[180:183], v[96:99], v[52:55], 0
  v_cndmask_b32 v134, v134, v142, s[90:91]
  v_cndmask_b32 v135, v135, v143, s[90:91]
  v_mfma_f32_16x16x32_bf16 v[180:183], v[104:107], v[52:55], v[180:183]
  v_cndmask_b32 v132, v132, v148, s[92:93]
  v_cndmask_b32 v133, v133, v149, s[92:93]
  v_mfma_f32_16x16x32_bf16 v[188:191], v[112:115], v[52:55], 0
  v_cndmask_b32 v134, v134, v150, s[92:93]
  v_cndmask_b32 v135, v135, v151, s[92:93]
  v_mfma_f32_16x16x32_bf16 v[188:191], v[120:123], v[52:55], v[188:191]
  v_cndmask_b32 v132, v132, v156, s[94:95]
  v_cndmask_b32 v133, v133, v157, s[94:95]
  v_mfma_f32_16x16x32_bf16 v[196:199], v[128:131], v[208:211], 0
  v_cndmask_b32 v134, v134, v158, s[94:95]
  v_cndmask_b32 v135, v135, v159, s[94:95]
  v_mfma_f32_16x16x32_bf16 v[196:199], v[136:139], v[216:219], v[196:199]
  ds_write_b128 v20, v[132:135] offset:20480
  v_mfma_f32_16x16x32_bf16 v[204:207], v[128:131], v[52:55], 0
  v_mfma_f32_16x16x32_bf16 v[204:207], v[136:139], v[52:55], v[204:207]
  v_cndmask_b32 v164, v164, v172, s[90:91]
  v_cndmask_b32 v165, v165, v173, s[90:91]
  v_mfma_f32_16x16x32_bf16 v[68:71], v[64:67], v[144:147], 0
  v_cndmask_b32 v166, v166, v174, s[90:91]
  v_cndmask_b32 v167, v167, v175, s[90:91]
  v_mfma_f32_16x16x32_bf16 v[68:71], v[72:75], v[152:155], v[68:71]
  v_cndmask_b32 v164, v164, v180, s[92:93]
  v_cndmask_b32 v165, v165, v181, s[92:93]
  v_mfma_f32_16x16x32_bf16 v[76:79], v[80:83], v[160:163], 0
  v_cndmask_b32 v166, v166, v182, s[92:93]
  v_cndmask_b32 v167, v167, v183, s[92:93]
  v_mfma_f32_16x16x32_bf16 v[76:79], v[88:91], v[168:171], v[76:79]
  v_cndmask_b32 v164, v164, v188, s[94:95]
  v_cndmask_b32 v165, v165, v189, s[94:95]
  v_mfma_f32_16x16x32_bf16 v[84:87], v[96:99], v[176:179], 0
  v_cndmask_b32 v166, v166, v190, s[94:95]
  v_cndmask_b32 v167, v167, v191, s[94:95]
  v_mfma_f32_16x16x32_bf16 v[84:87], v[104:107], v[184:187], v[84:87]
  ds_write_b128 v20, v[164:167] offset:24576
  v_mfma_f32_16x16x32_bf16 v[92:95], v[112:115], v[192:195], 0
  v_mfma_f32_16x16x32_bf16 v[92:95], v[120:123], v[200:203], v[92:95]
  v_cndmask_b32 v196, v204, v196, s[66:67]
  v_cndmask_b32 v197, v205, v197, s[66:67]
  v_cndmask_b32 v198, v206, v198, s[66:67]
  v_cndmask_b32 v199, v207, v199, s[66:67]
  ds_write_b128 v20, v[196:199] offset:28672
  s_nop 1
  ds_write_b128 v20, v[68:71] offset:0
  ds_write_b128 v20, v[76:79] offset:4096
  ds_write_b128 v20, v[84:87] offset:8192
  ds_write_b128 v20, v[92:95] offset:12288
  buffer_load_dwordx4 a[24:27], v59, s[12:15], s23 offen offset:1024 sc1
  s_waitcnt lgkmcnt(0)
  s_barrier
  ds_read_b128 v[64:67], v21 offset:0
  ds_read_b128 v[68:71], v21 offset:1024
  ds_read_b128 v[72:75], v21 offset:2048
  ds_read_b128 v[76:79], v21 offset:3072
  ds_read_b128 v[80:83], v21 offset:4096
  ds_read_b128 v[84:87], v21 offset:5120
  ds_read_b128 v[88:91], v21 offset:6144
  ds_read_b128 v[92:95], v21 offset:7168
  s_lshl_b32 s65, s5, 16
  s_add_u32 s65, s65, 524288
  s_lshl_b32 s64, s3, 4
  s_add_u32 s64, s64, s4
  s_lshl_b32 s64, s64, 10
  s_add_u32 s64, s64, s65
  s_and_b32 s66, s61, 0xff
  v_mov_b32 v22, s66
  s_movk_i32 s66, 0xff00
  s_waitcnt lgkmcnt(4)
  v_pk_add_f32 v[64:65], v[64:65], v[68:69]
  v_pk_add_f32 v[72:73], v[72:73], v[76:77]
  v_pk_add_f32 v[66:67], v[66:67], v[70:71]
  v_pk_add_f32 v[74:75], v[74:75], v[78:79]
  v_pk_add_f32 v[64:65], v[64:65], v[72:73]
  v_pk_add_f32 v[66:67], v[66:67], v[74:75]
  v_and_or_b32 v64, v64, s66, v22
  v_and_or_b32 v65, v65, s66, v22
  v_and_or_b32 v66, v66, s66, v22
  v_and_or_b32 v67, v67, s66, v22
  buffer_store_dwordx4 v[64:67], v59, s[12:15], s64 offen sc1
  s_add_u32 s64, s64, 8192
  s_waitcnt lgkmcnt(0)
  v_pk_add_f32 v[80:81], v[80:81], v[84:85]
  v_pk_add_f32 v[88:89], v[88:89], v[92:93]
  v_pk_add_f32 v[82:83], v[82:83], v[86:87]
  v_pk_add_f32 v[90:91], v[90:91], v[94:95]
  v_pk_add_f32 v[80:81], v[80:81], v[88:89]
  v_pk_add_f32 v[82:83], v[82:83], v[90:91]
  v_and_or_b32 v80, v80, s66, v22
  v_and_or_b32 v81, v81, s66, v22
  v_and_or_b32 v82, v82, s66, v22
  v_and_or_b32 v83, v83, s66, v22
  buffer_store_dwordx4 v[80:83], v59, s[12:15], s64 offen sc1
  s_add_u32 s64, s64, 8192
L_hop_kv4:
  s_cbranch_execz L_retkv2
  s_barrier
  s_mov_b32 s62, 19922944
  v_mov_b32 v39, s61
  buffer_store_dword v39, v1, s[12:15], s62 offen sc1
  s_lshl_b32 s64, s4, 13
  s_add_u32 s64, s64, s65
  s_lshl_b32 s67, s3, 8
  s_add_u32 s64, s64, s67
  s_add_u32 s65, s64, 4096
  v_lshrrev_b32 v23, 4, v0
  v_and_b32 v24, 15, v0
  v_lshlrev_b32 v24, 4, v24
  v_lshl_add_u32 v25, v23, 10, v24
  v_lshl_add_u32 v26, v23, 2, v24
  s_lshl_b32 s66, s5, 3
  s_add_u32 s66, s66, s4
  s_lshl_b32 s66, s66, 10
  s_add_u32 s66, s66, s67
  s_add_u32 s66, s66, 458752
  s_and_b32 s67, s61, 0xffff
  v_mov_b32 v27, s67
  s_mov_b32 s67, 0xffff0000
  buffer_load_dwordx4 a[28:31], v59, s[12:15], s23 offen offset:2048 sc1
  buffer_load_dwordx4 a[32:35], v59, s[12:15], s23 offen offset:3072 sc1
  buffer_load_dwordx4 a[36:39], v60, s[12:15], s23 offen offset:0 sc1
  s_and_b32 s23, s3, 2
  s_mul_i32 s23, s23, 40960
  s_sub_u32 s23, s83, s23
  s_add_u32 s23, s23, 2129920
  buffer_load_dwordx4 a[40:43], v59, s[12:15], s23 offen offset:0 sc1
  buffer_load_dwordx4 a[44:47], v59, s[12:15], s23 offen offset:1024 sc1
  buffer_load_dwordx4 a[48:51], v59, s[12:15], s23 offen offset:2048 sc1
  buffer_load_dwordx4 a[52:55], v59, s[12:15], s23 offen offset:3072 sc1
  buffer_load_dwordx4 a[56:59], v60, s[12:15], s23 offen offset:0 sc1
  s_add_u32 s23, s83, 2211840
  buffer_load_dwordx4 a[60:63], v59, s[12:15], s23 offen offset:0 sc1
  buffer_load_dwordx4 a[64:67], v59, s[12:15], s23 offen offset:1024 sc1
  buffer_load_dwordx4 a[68:71], v59, s[12:15], s23 offen offset:2048 sc1
  buffer_load_dwordx4 a[72:75], v59, s[12:15], s23 offen offset:3072 sc1
  buffer_load_dwordx4 a[76:79], v60, s[12:15], s23 offen offset:0 sc1
  s_add_u32 s23, s83, 2375680
  buffer_load_dwordx4 v[176:179], v59, s[12:15], s23 offen offset:0 sc1
  buffer_load_dwordx4 v[180:183], v59, s[12:15], s23 offen offset:1024 sc1
  buffer_load_dwordx4 v[184:187], v59, s[12:15], s23 offen offset:2048 sc1
  buffer_load_dwordx4 v[188:191], v59, s[12:15], s23 offen offset:3072 sc1
  buffer_load_dwordx4 v[192:195], v60, s[12:15], s23 offen offset:0 sc1
  v_lshlrev_b32 v2, 3, v0
  v_add_u32 v2, 98304, v2
  v_lshrrev_b32 v12, 4, v0
  v_and_b32 v13, 15, v0
  v_lshrrev_b32 v14, 2, v13
  v_and_b32 v13, 3, v13
  v_lshlrev_b32 v15, 7, v12
  v_add_u32 v15, 98304, v15
  v_lshl_add_u32 v14, v14, 3, v15
  v_add_u32 v16, 2560, v14
  v_add_u32 v17, 3072, v15
  v_cmp_eq_u32 vcc, 0, v13
  v_mov_b32 v18, 106496
  v_mov_b32 v56, 0
  v_cndmask_b32 v7, v17, v16, vcc
  v_mov_b32 v57, 0
  v_add_u32 v19, 2048, v2
  ds_write_b64 v18, v[56:57]
  ds_write_b64 v18, v[56:57] offset:4096
  v_add_u32 v16, 3584, v14
  v_add_u32 v17, 3616, v15
  v_cmp_eq_u32 s[68:69], 0, v12
  v_cndmask_b32 v16, v17, v16, vcc
  s_nop 0
  v_cndmask_b32 v3, v18, v19, s[68:69]
  v_cndmask_b32 v8, v18, v16, s[68:69]
  v_add_u32 v16, 3616, v14
  v_add_u32 v17, 3648, v15
  v_cmp_eq_u32 s[68:69], 1, v12
  v_cndmask_b32 v16, v17, v16, vcc
  s_nop 0
  v_cndmask_b32 v4, v18, v19, s[68:69]
  v_cndmask_b32 v9, v18, v16, s[68:69]
  v_add_u32 v16, 3648, v14
  v_add_u32 v17, 3680, v15
  v_cmp_eq_u32 s[68:69], 2, v12
  v_cndmask_b32 v16, v17, v16, vcc
  s_nop 0
  v_cndmask_b32 v5, v18, v19, s[68:69]
  v_cndmask_b32 v10, v18, v16, s[68:69]
  v_add_u32 v16, 3680, v14
  v_add_u32 v17, 3584, v15
  v_cmp_eq_u32 s[68:69], 3, v12
  v_cndmask_b32 v16, v17, v16, vcc
  s_nop 0
  v_cndmask_b32 v6, v18, v19, s[68:69]
  v_cndmask_b32 v11, v18, v16, s[68:69]
  s_mov_b32 s76, 28311552
  v_mov_b32 v29, v38
  v_lshrrev_b32 v38, 3, v0
  v_mad_u32_u24 v38, v38, 32, s7
  v_lshlrev_b32 v38, 7, v38
  buffer_load_dwordx4 v[96:99], v25, s[12:15], s64 offen sc1
  buffer_load_dwordx4 v[100:103], v25, s[12:15], s65 offen sc1
  buffer_load_dword v30, v29, s[12:15], s76 offen sc1
  s_waitcnt vmcnt(0)
  v_xor_b32 v28, v96, v22
  v_bitop3_b32 v28, v97, v22, v28 bitop3:0xbe
  v_bitop3_b32 v28, v98, v22, v28 bitop3:0xbe
  v_bitop3_b32 v28, v99, v22, v28 bitop3:0xbe
  v_bitop3_b32 v28, v100, v22, v28 bitop3:0xbe
  v_bitop3_b32 v28, v101, v22, v28 bitop3:0xbe
  v_bitop3_b32 v28, v102, v22, v28 bitop3:0xbe
  v_bitop3_b32 v28, v103, v22, v28 bitop3:0xbe
  v_and_b32 v28, 0xff, v28
  v_cmp_ne_u32 vcc, 0, v28
  s_nop 1
  s_cbranch_vccnz L_slow_49
L_back_50:
  v_xor_b32 v96, v96, v22
  v_xor_b32 v97, v97, v22
  v_xor_b32 v98, v98, v22
  v_xor_b32 v99, v99, v22
  v_xor_b32 v100, v100, v22
  v_xor_b32 v101, v101, v22
  v_xor_b32 v102, v102, v22
  v_xor_b32 v103, v103, v22
  v_pk_add_f32 v[96:97], v[96:97], v[100:101]
  v_pk_add_f32 v[98:99], v[98:99], v[102:103]
  s_nop 1
  v_permlane32_swap_b32 v96, v98
  v_permlane32_swap_b32 v97, v99
  v_add_f32 v96, v96, v98
  v_add_f32 v97, v97, v99
  s_nop 1
  v_permlane16_swap_b32 v96, v97
  v_add_f32 v96, v96, v97
  v_cvt_pk_bf16_f32 v96, v96, v96
  v_and_or_b32 v96, v96, s67, v27
  buffer_store_dword v96, v26, s[12:15], s66 offen sc1
  s_barrier
  s_mov_b32 s62, 22020096
  v_mov_b32 v39, s61
  buffer_store_dword v39, v1, s[12:15], s62 offen sc1
  v_cmp_ne_u32 vcc, s61, v30
  v_mov_b32 v38, v29
  s_nop 0
  s_cbranch_vccnz L_slow_51
L_back_52:
  s_lshr_b32 s70, s5, 1
  s_and_b32 s72, s5, 1
  s_mul_i32 s66, s4, 32
  s_add_u32 s66, s66, s70
  s_add_u32 s66, s66, 26
  s_lshl_b32 s66, s66, 7
  v_mov_b32 v38, s66
  s_mov_b32 s62, 24117248
  buffer_load_dword v39, v38, s[12:15], s62 offen sc1
  s_add_u32 s23, s83, 2539520
  buffer_load_dwordx4 v[196:199], v59, s[12:15], s23 offen offset:0 sc1
  buffer_load_dwordx4 v[200:203], v59, s[12:15], s23 offen offset:1024 sc1
  buffer_load_dwordx4 v[204:207], v59, s[12:15], s23 offen offset:2048 sc1
  buffer_load_dwordx4 v[208:211], v59, s[12:15], s23 offen offset:3072 sc1
  buffer_load_dwordx4 v[212:215], v60, s[12:15], s23 offen offset:0 sc1
  s_add_u32 s23, s83, 2703360
  buffer_load_dwordx4 v[216:219], v59, s[12:15], s23 offen offset:0 sc1
  buffer_load_dwordx4 v[220:223], v59, s[12:15], s23 offen offset:1024 sc1
  buffer_load_dwordx4 v[224:227], v59, s[12:15], s23 offen offset:2048 sc1
  buffer_load_dwordx4 v[228:231], v59, s[12:15], s23 offen offset:3072 sc1
  buffer_load_dwordx4 v[232:235], v60, s[12:15], s23 offen offset:0 sc1
  s_add_u32 s23, s83, 2867200
  buffer_load_dwordx4 v[236:239], v59, s[12:15], s23 offen offset:0 sc1
  buffer_load_dwordx4 v[240:243], v59, s[12:15], s23 offen offset:1024 sc1
  buffer_load_dwordx4 v[244:247], v59, s[12:15], s23 offen offset:2048 sc1
  buffer_load_dwordx4 v[248:251], v59, s[12:15], s23 offen offset:3072 sc1
  buffer_load_dwordx4 v[252:255], v60, s[12:15], s23 offen offset:0 sc1
  s_branch L_touch4
L_kvback:
  s_lshl_b32 s75, s72, 3
  s_add_u32 s65, s75, s70
  s_lshl_b32 s66, s4, 2
  s_add_u32 s66, s66, s3
  s_mul_i32 s66, s66, 20
  s_add_u32 s66, s66, s65
  s_lshl_b32 s66, s66, 12
  s_add_u32 s66, s66, 15204352
  s_add_u32 s67, s66, 16384
  s_add_u32 s65, s70, 16
  s_lshl_b32 s68, s4, 2
  s_add_u32 s68, s68, s3
  s_mul_i32 s68, s68, 20
  s_add_u32 s68, s68, s65
  s_lshl_b32 s68, s68, 12
  s_add_u32 s68, s68, 15204352
  s_add_u32 s68, s68, s75
  s_lshl_b32 s64, s5, 2
  s_add_u32 s64, s64, s3
  s_lshl_b32 s64, s64, 11
  s_add_u32 s64, s64, 458752
  s_waitcnt vmcnt(15)
  v_cmp_ne_u32 vcc, s61, v39
  s_nop 1
  s_cbranch_vccnz L_slow_53
L_back_54:
  buffer_load_dwordx2 v[64:65], v59, s[12:15], s68 offen offset:2048 sc1
  buffer_load_dwordx4 v[66:69], v59, s[12:15], s66 offen offset:2048 sc1
  buffer_load_dwordx4 v[72:75], v59, s[12:15], s67 offen offset:2048 sc1
  buffer_load_dwordx2 v[78:79], v59, s[12:15], s68 offen offset:3072 sc1
  buffer_load_dwordx4 v[80:83], v59, s[12:15], s66 offen offset:3072 sc1
  buffer_load_dwordx4 v[86:89], v59, s[12:15], s67 offen offset:3072 sc1
  v_lshrrev_b32 v38, 3, v0
  v_mad_u32_u24 v38, v38, 32, s7
  v_lshlrev_b32 v38, 7, v38
  s_lshl_b32 s73, s4, 2
  s_add_u32 s73, s73, s3
  s_lshl_b32 s73, s73, 4
  s_add_u32 s73, s73, s70
  s_mul_i32 s73, s73, 19456
  s_add_u32 s73, s73, 5412864
  s_lshl_b32 s75, s72, 9
  s_add_u32 s75, s75, s73
  s_sub_u32 s75, s75, 94208
  s_add_u32 s76, s75, 77824
  s_lshl_b32 s74, s72, 11
  s_add_u32 s73, s73, s74
  s_mul_i32 s66, s3, 1024
  v_add_u32 v36, s66, v2
  s_mov_b32 s66, 0x07060302
  s_add_u32 s77, s82, 4096
  s_add_u32 s78, s82, 8192
  s_xor_b32 s65, s3, 3
  s_mul_i32 s65, s65, 77824
  v_add_u32 v30, s65, v59
  s_sub_u32 s73, s73, s65
  s_add_u32 s74, s73, 77824
  s_mov_b32 s65, 26214400
  s_lshr_b32 s71, s80, 2
  s_mul_i32 s71, s71, 32
  v_lshrrev_b32 v28, 1, v0
  v_min_u32 v28, 17, v28
  s_and_b32 s62, s80, 0
  s_lshl_b32 s62, s62, 9
  s_add_u32 s62, s62, s71
  v_add_lshl_u32 v28, v28, s62, 7
  buffer_load_dword v29, v28, s[12:15], s65 offen sc1
  buffer_load_dwordx4 v[40:43], v59, s[12:15], s64 offen offset:0 sc1
  buffer_load_dwordx4 v[44:47], v59, s[12:15], s64 offen offset:1024 sc1
  s_waitcnt vmcnt(0)
  v_xor_b32 v37, s61, v40
  v_bitop3_b32 v37, v41, s61, v37 bitop3:0xbe
  v_bitop3_b32 v37, v42, s61, v37 bitop3:0xbe
  v_bitop3_b32 v37, v43, s61, v37 bitop3:0xbe
  v_bitop3_b32 v37, v44, s61, v37 bitop3:0xbe
  v_bitop3_b32 v37, v45, s61, v37 bitop3:0xbe
  v_bitop3_b32 v37, v46, s61, v37 bitop3:0xbe
  v_bitop3_b32 v37, v47, s61, v37 bitop3:0xbe
  v_and_b32 v37, 0xffff, v37
  v_cmp_ne_u32 vcc, 0, v37
  s_nop 1
  s_cbranch_vccnz L_slow_55
L_back_56:
  v_cmp_ne_u32 vcc, s61, v29
  v_mov_b32 v38, v28
  v_perm_b32 v40, v41, v40, s66
  v_perm_b32 v41, v43, v42, s66
  v_perm_b32 v44, v45, v44, s66
  v_perm_b32 v45, v47, v46, s66
  ds_write_b64 v36, v[40:41] offset:0
  ds_write_b64 v36, v[44:45] offset:512
  v_mov_b32 v70, v64
  v_mov_b32 v71, v65
  v_mov_b32 v76, v64
  v_mov_b32 v77, v65
  v_mov_b32 v84, v78
  v_mov_b32 v85, v79
  v_mov_b32 v90, v78
  v_mov_b32 v91, v79
  s_cbranch_vccnz L_slow_57
L_back_58:
  v_mov_b32 v28, 0
  v_mov_b32 v29, 0x358637bd
  s_add_u32 s79, s82, 12288
  s_bitcmp1_b32 s3, 0
  s_cselect_b32 s65, 1, -1
  s_mul_i32 s65, s65, 77824
  s_add_u32 s65, s65, s82
  buffer_load_dwordx4 a[80:83], v30, s[12:15], s82 offen offset:0 sc1
  buffer_load_dwordx4 a[84:87], v30, s[12:15], s82 offen offset:1024 sc1
  buffer_load_dwordx4 a[88:91], v30, s[12:15], s82 offen offset:2048 sc1
  buffer_load_dwordx4 a[92:95], v30, s[12:15], s82 offen offset:3072 sc1
  buffer_load_dwordx4 v[32:35], v30, s[12:15], s77 offen offset:0 sc1
  s_waitcnt lgkmcnt(0)
  s_barrier
  ds_read_b64 v[122:123], v7 offset:0
  ds_read_b64 v[120:121], v8 offset:0
  ds_read_b64 v[118:119], v2 offset:0
  ds_read_b64 v[116:117], v3 offset:0
  ds_read_b64 v[128:129], v7 offset:32
  ds_read_b64 v[130:131], v9 offset:0
  ds_read_b64 v[124:125], v2 offset:512
  ds_read_b64 v[126:127], v4 offset:0
  ds_read_b64 v[138:139], v7 offset:64
  ds_read_b64 v[136:137], v10 offset:0
  ds_read_b64 v[134:135], v2 offset:1024
  ds_read_b64 v[132:133], v5 offset:0
  buffer_load_dwordx4 v[36:39], v30, s[12:15], s77 offen offset:1024 sc1
  buffer_load_dwordx4 v[40:43], v30, s[12:15], s77 offen offset:2048 sc1
  buffer_load_dwordx4 v[44:47], v30, s[12:15], s77 offen offset:3072 sc1
  buffer_load_dwordx4 v[48:51], v30, s[12:15], s78 offen offset:0 sc1
  buffer_load_dwordx4 v[52:55], v30, s[12:15], s78 offen offset:1024 sc1
  buffer_load_dwordx4 v[56:59], v30, s[12:15], s78 offen offset:2048 sc1
  buffer_load_dwordx4 v[60:63], v30, s[12:15], s78 offen offset:3072 sc1
  s_waitcnt lgkmcnt(8)
  v_mfma_f32_16x16x32_bf16 v[16:19], v[120:123], v[64:67], v[28:31]
  v_mfma_f32_16x16x32_bf16 v[12:15], v[116:119], v[64:67], 0
  v_mfma_f32_16x16x32_bf16 v[24:27], v[120:123], v[78:81], v[28:31]
  v_mfma_f32_16x16x32_bf16 v[20:23], v[116:119], v[78:81], 0
  s_nop 3
  s_waitcnt lgkmcnt(4)
  v_mfma_f32_16x16x32_bf16 v[144:147], v[128:131], v[68:71], v[28:31]
  v_rcp_f32 v17, v17
  v_mfma_f32_16x16x32_bf16 v[140:143], v[124:127], v[68:71], 0
  ds_read_b64 v[120:121], v7 offset:96
  ds_read_b64 v[122:123], v11 offset:0
  ds_read_b64 v[116:117], v2 offset:1536
  ds_read_b64 v[118:119], v6 offset:0
  v_mul_f32 v148, v16, v17
  v_mul_f32 v12, v12, v17
  v_mul_f32 v13, v13, v17
  v_mul_f32 v14, v14, v17
  v_mul_f32 v15, v15, v17
  v_cvt_pk_bf16_f32 v66, v12, v13
  v_cvt_pk_bf16_f32 v67, v14, v15
  v_mfma_f32_16x16x32_bf16 v[16:19], v[128:131], v[82:85], v[28:31]
  v_rcp_f32 v25, v25
  v_mfma_f32_16x16x32_bf16 v[12:15], v[124:127], v[82:85], 0
  v_mul_f32 v152, v24, v25
  v_mul_f32 v20, v20, v25
  v_mul_f32 v21, v21, v25
  v_mul_f32 v22, v22, v25
  v_mul_f32 v23, v23, v25
  v_cvt_pk_bf16_f32 v80, v20, v21
  v_cvt_pk_bf16_f32 v81, v22, v23
  s_waitcnt lgkmcnt(4)
  v_mfma_f32_16x16x32_bf16 v[24:27], v[136:139], v[70:73], v[28:31]
  v_rcp_f32 v145, v145
  v_mfma_f32_16x16x32_bf16 v[20:23], v[132:135], v[70:73], 0
  v_mul_f32 v144, v144, v145
  v_mul_f32 v140, v140, v145
  v_mul_f32 v141, v141, v145
  v_mul_f32 v142, v142, v145
  v_mul_f32 v143, v143, v145
  v_cvt_pk_bf16_f32 v148, v148, v144
  v_cvt_pk_bf16_f32 v68, v140, v141
  v_cvt_pk_bf16_f32 v69, v142, v143
  v_mfma_f32_16x16x32_bf16 v[144:147], v[136:139], v[84:87], v[28:31]
  buffer_store_dwordx4 v[66:69], v30, s[12:15], s73 offen offset:0 sc1
  v_rcp_f32 v17, v17
  v_mfma_f32_16x16x32_bf16 v[140:143], v[132:135], v[84:87], 0
  v_mul_f32 v16, v16, v17
  v_mul_f32 v12, v12, v17
  v_mul_f32 v13, v13, v17
  v_mul_f32 v14, v14, v17
  v_mul_f32 v15, v15, v17
  v_cvt_pk_bf16_f32 v152, v152, v16
  v_cvt_pk_bf16_f32 v82, v12, v13
  v_cvt_pk_bf16_f32 v83, v14, v15
  s_waitcnt lgkmcnt(0)
  v_mfma_f32_16x16x32_bf16 v[16:19], v[120:123], v[74:77], v[28:31]
  buffer_store_dwordx4 v[80:83], v30, s[12:15], s74 offen offset:0 sc1
  v_rcp_f32 v25, v25
  v_mfma_f32_16x16x32_bf16 v[12:15], v[116:119], v[74:77], 0
  v_mul_f32 v149, v24, v25
  v_mul_f32 v20, v20, v25
  v_mul_f32 v21, v21, v25
  v_mul_f32 v22, v22, v25
  v_mul_f32 v23, v23, v25
  v_cvt_pk_bf16_f32 v72, v20, v21
  v_cvt_pk_bf16_f32 v73, v22, v23
  v_mfma_f32_16x16x32_bf16 v[24:27], v[120:123], v[88:91], v[28:31]
  v_rcp_f32 v145, v145
  v_mfma_f32_16x16x32_bf16 v[20:23], v[116:119], v[88:91], 0
  v_mul_f32 v153, v144, v145
  v_mul_f32 v140, v140, v145
  v_mul_f32 v141, v141, v145
  v_mul_f32 v142, v142, v145
  v_mul_f32 v143, v143, v145
  v_cvt_pk_bf16_f32 v86, v140, v141
  v_cvt_pk_bf16_f32 v87, v142, v143
  s_nop 0
  v_rcp_f32 v17, v17
  s_nop 0
  v_mul_f32 v16, v16, v17
  v_mul_f32 v12, v12, v17
  v_mul_f32 v13, v13, v17
  v_mul_f32 v14, v14, v17
  v_mul_f32 v15, v15, v17
  v_cvt_pk_bf16_f32 v149, v149, v16
  v_cvt_pk_bf16_f32 v74, v12, v13
  v_cvt_pk_bf16_f32 v75, v14, v15
  s_nop 0
  buffer_store_dwordx4 v[72:75], v30, s[12:15], s73 offen offset:1024 sc1
  v_rcp_f32 v25, v25
  s_nop 0
  v_mul_f32 v24, v24, v25
  v_mul_f32 v20, v20, v25
  v_mul_f32 v21, v21, v25
  v_mul_f32 v22, v22, v25
  v_mul_f32 v23, v23, v25
  v_cvt_pk_bf16_f32 v153, v153, v24
  v_cvt_pk_bf16_f32 v88, v20, v21
  v_cvt_pk_bf16_f32 v89, v22, v23
  buffer_store_dwordx4 v[86:89], v30, s[12:15], s74 offen offset:1024 sc1
  buffer_store_dwordx2 v[148:149], v2, s[12:15], s75 offen offset:0 sc1
  buffer_store_dwordx2 v[152:153], v2, s[12:15], s76 offen offset:0 sc1
  s_waitcnt vmcnt(6)
  s_branch L_p2c
L_slow_41:
  s_mov_b32 s59, 131072
  s_branch L_first_60
L_spin_59:
  s_sleep 2
L_first_60:
  buffer_load_dwordx4 v[40:43], v38, s[12:15], s64 offen sc1
  buffer_load_dwordx4 v[44:47], v38, s[12:15], s65 offen sc1
  buffer_load_dwordx2 v[48:49], v62, s[12:15], s66 offen sc1
  s_waitcnt vmcnt(0)
  v_xor_b32 v39, s61, v43
  v_bitop3_b32 v39, v47, s61, v39 bitop3:0xbe
  v_bitop3_b32 v39, v49, s61, v39 bitop3:0xbe
  v_cmp_ne_u32 vcc, 0, v39
  s_sub_u32 s59, s59, 1
  s_cbranch_scc1 L_back_42
  s_cbranch_vccnz L_spin_59
  s_branch L_back_42
L_slow_43:
  s_mov_b32 s59, 131072
  s_branch L_first_62
L_spin_61:
  s_sleep 2
L_first_62:
  s_mov_b32 s62, 22020096
  buffer_load_dword v39, v38, s[12:15], s62 offen sc1
  s_waitcnt vmcnt(0)
  v_cmp_ne_u32 vcc, s61, v39
  s_sub_u32 s59, s59, 1
  s_cbranch_scc1 L_back_44
  s_cbranch_vccnz L_spin_61
  s_branch L_back_44
L_slow_45:
  s_mov_b32 s59, 131072
  s_branch L_first_64
L_spin_63:
  s_sleep 2
L_first_64:
  s_mov_b32 s62, 24117248
  buffer_load_dword v39, v38, s[12:15], s62 offen sc1
  s_waitcnt vmcnt(0)
  v_cmp_ne_u32 vcc, s61, v39
  s_sub_u32 s59, s59, 1
  s_cbranch_scc1 L_back_46
  s_cbranch_vccnz L_spin_63
  s_branch L_back_46
L_slow_47:
  s_mov_b32 s59, 131072
  s_branch L_first_66
L_spin_65:
  s_sleep 2
L_first_66:
  s_mov_b32 s62, 26214400
  buffer_load_dword v39, v38, s[12:15], s62 offen sc1
  s_waitcnt vmcnt(0)
  v_cmp_ne_u32 vcc, s61, v39
  s_sub_u32 s59, s59, 1
  s_cbranch_scc1 L_back_48
  s_cbranch_vccnz L_spin_65
  s_branch L_back_48
L_slow_49:
  s_mov_b32 s79, 64
  s_branch L_first_68
L_spin_67:
  s_sleep 2
L_first_68:
  s_mov_b32 s59, 131072
  s_branch L_first_71
L_spin_69:
  s_sleep 2
L_first_71:
  s_mov_b32 s62, 19922944
  buffer_load_dword v39, v38, s[12:15], s62 offen sc1
  s_waitcnt vmcnt(0)
  v_cmp_ne_u32 vcc, s61, v39
  s_sub_u32 s59, s59, 1
  s_cbranch_scc1 L_spun_70
  s_cbranch_vccnz L_spin_69
L_spun_70:
  buffer_load_dwordx4 v[96:99], v25, s[12:15], s64 offen sc1
  buffer_load_dwordx4 v[100:103], v25, s[12:15], s65 offen sc1
  buffer_load_dword v30, v29, s[12:15], s76 offen sc1
  s_waitcnt vmcnt(0)
  v_xor_b32 v28, v96, v22
  v_bitop3_b32 v28, v97, v22, v28 bitop3:0xbe
  v_bitop3_b32 v28, v98, v22, v28 bitop3:0xbe
  v_bitop3_b32 v28, v99, v22, v28 bitop3:0xbe
  v_bitop3_b32 v28, v100, v22, v28 bitop3:0xbe
  v_bitop3_b32 v28, v101, v22, v28 bitop3:0xbe
  v_bitop3_b32 v28, v102, v22, v28 bitop3:0xbe
  v_bitop3_b32 v28, v103, v22, v28 bitop3:0xbe
  v_and_b32 v28, 0xff, v28
  v_cmp_ne_u32 vcc, 0, v28
  s_sub_u32 s79, s79, 1
  s_cbranch_scc1 L_back_50
  s_cbranch_vccnz L_spin_67
  s_branch L_back_50
L_slow_51:
  s_mov_b32 s59, 131072
  s_branch L_first_73
L_spin_72:
  s_sleep 2
L_first_73:
  s_mov_b32 s62, 28311552
  buffer_load_dword v39, v38, s[12:15], s62 offen sc1
  s_waitcnt vmcnt(0)
  v_cmp_ne_u32 vcc, s61, v39
  s_sub_u32 s59, s59, 1
  s_cbranch_scc1 L_back_52
  s_cbranch_vccnz L_spin_72
  s_branch L_back_52
L_slow_53:
  s_mov_b32 s59, 131072
  s_branch L_first_75
L_spin_74:
  s_sleep 2
L_first_75:
  s_mov_b32 s62, 24117248
  buffer_load_dword v39, v38, s[12:15], s62 offen sc1
  s_waitcnt vmcnt(0)
  v_cmp_ne_u32 vcc, s61, v39
  s_sub_u32 s59, s59, 1
  s_cbranch_scc1 L_back_54
  s_cbranch_vccnz L_spin_74
  s_branch L_back_54
L_slow_55:
  s_mov_b32 s79, 64
  s_branch L_first_77
L_spin_76:
  s_sleep 2
L_first_77:
  s_mov_b32 s59, 131072
  s_branch L_first_80
L_spin_78:
  s_sleep 2
L_first_80:
  s_mov_b32 s62, 22020096
  buffer_load_dword v39, v38, s[12:15], s62 offen sc1
  s_waitcnt vmcnt(0)
  v_cmp_ne_u32 vcc, s61, v39
  s_sub_u32 s59, s59, 1
  s_cbranch_scc1 L_spun_79
  s_cbranch_vccnz L_spin_78
L_spun_79:
  buffer_load_dword v29, v28, s[12:15], s65 offen sc1
  buffer_load_dwordx4 v[40:43], v59, s[12:15], s64 offen offset:0 sc1
  buffer_load_dwordx4 v[44:47], v59, s[12:15], s64 offen offset:1024 sc1
  s_waitcnt vmcnt(0)
  v_xor_b32 v37, s61, v40
  v_bitop3_b32 v37, v41, s61, v37 bitop3:0xbe
  v_bitop3_b32 v37, v42, s61, v37 bitop3:0xbe
  v_bitop3_b32 v37, v43, s61, v37 bitop3:0xbe
  v_bitop3_b32 v37, v44, s61, v37 bitop3:0xbe
  v_bitop3_b32 v37, v45, s61, v37 bitop3:0xbe
  v_bitop3_b32 v37, v46, s61, v37 bitop3:0xbe
  v_bitop3_b32 v37, v47, s61, v37 bitop3:0xbe
  v_and_b32 v37, 0xffff, v37
  v_cmp_ne_u32 vcc, 0, v37
  s_sub_u32 s79, s79, 1
  s_cbranch_scc1 L_back_56
  s_cbranch_vccnz L_spin_76
  s_branch L_back_56
L_slow_57:
  s_mov_b32 s59, 131072
  s_branch L_first_82
L_spin_81:
  s_sleep 2
L_first_82:
  s_mov_b32 s62, 26214400
  buffer_load_dword v39, v38, s[12:15], s62 offen sc1
  s_waitcnt vmcnt(0)
  v_cmp_ne_u32 vcc, s61, v39
  s_sub_u32 s59, s59, 1
  s_cbranch_scc1 L_back_58
  s_cbranch_vccnz L_spin_81
  s_branch L_back_58
  .p2align 12
L_q:
  s_mov_b32 s64, 0
  v_lshl_add_u32 v23, v22, 3, s64
  v_add_u32 v23, 0, v23
  v_lshrrev_b32 v24, 6, v23
  v_and_b32 v25, 63, v23
  v_xor_b32 v25, v25, v21
  v_lshl_add_u32 v24, v24, 13, v20
  v_add_u32 v10, v24, v25
  v_lshl_add_u32 v23, v22, 3, s64
  v_add_u32 v23, 40, v23
  v_lshrrev_b32 v24, 6, v23
  v_and_b32 v25, 63, v23
  v_xor_b32 v25, v25, v21
  v_lshl_add_u32 v24, v24, 13, v20
  v_add_u32 v11, v24, v25
  v_lshl_add_u32 v23, v22, 3, s64
  v_add_u32 v23, 80, v23
  v_lshrrev_b32 v24, 6, v23
  v_and_b32 v25, 63, v23
  v_xor_b32 v25, v25, v21
  v_lshl_add_u32 v24, v24, 13, v20
  v_add_u32 v12, v24, v25
  v_lshl_add_u32 v23, v22, 3, s64
  v_add_u32 v23, 120, v23
  v_lshrrev_b32 v24, 6, v23
  v_and_b32 v25, 63, v23
  v_xor_b32 v25, v25, v21
  v_lshl_add_u32 v24, v24, 13, v20
  v_add_u32 v13, v24, v25
  v_mul_u32_u24 v23, 40, v22
  v_add_u32 v23, s64, v23
  v_add_u32 v23, 32, v23
  v_lshrrev_b32 v24, 6, v23
  v_and_b32 v25, 63, v23
  v_xor_b32 v25, v25, v21
  v_lshl_add_u32 v24, v24, 13, v20
  v_add_u32 v14, v24, v25
  s_mov_b32 s64, 32
  v_lshl_add_u32 v23, v22, 3, s64
  v_add_u32 v23, 0, v23
  v_lshrrev_b32 v24, 6, v23
  v_and_b32 v25, 63, v23
  v_xor_b32 v25, v25, v21
  v_lshl_add_u32 v24, v24, 13, v20
  v_add_u32 v15, v24, v25
  v_add_u32 v15, 512, v15
  v_lshl_add_u32 v23, v22, 3, s64
  v_add_u32 v23, 40, v23
  v_lshrrev_b32 v24, 6, v23
  v_and_b32 v25, 63, v23
  v_xor_b32 v25, v25, v21
  v_lshl_add_u32 v24, v24, 13, v20
  v_add_u32 v16, v24, v25
  v_add_u32 v16, 512, v16
  v_lshl_add_u32 v23, v22, 3, s64
  v_add_u32 v23, 80, v23
  v_lshrrev_b32 v24, 6, v23
  v_and_b32 v25, 63, v23
  v_xor_b32 v25, v25, v21
  v_lshl_add_u32 v24, v24, 13, v20
  v_add_u32 v17, v24, v25
  v_add_u32 v17, 512, v17
  v_lshl_add_u32 v23, v22, 3, s64
  v_add_u32 v23, 120, v23
  v_lshrrev_b32 v24, 6, v23
  v_and_b32 v25, 63, v23
  v_xor_b32 v25, v25, v21
  v_lshl_add_u32 v24, v24, 13, v20
  v_add_u32 v18, v24, v25
  v_add_u32 v18, 512, v18
  v_mul_u32_u24 v23, 40, v22
  v_add_u32 v23, s64, v23
  v_add_u32 v23, 32, v23
  v_lshrrev_b32 v24, 6, v23
  v_and_b32 v25, 63, v23
  v_xor_b32 v25, v25, v21
  v_lshl_add_u32 v24, v24, 13, v20
  v_add_u32 v19, v24, v25
  v_add_u32 v19, 512, v19
  v_lshrrev_b32 v23, 4, v0
  v_mul_u32_u24 v24, 80, v23
  v_lshlrev_b32 v23, 4, v23
  v_add_u32 v36, 0x20000, v23
  v_add_u32 v37, 0x20000, v24
  s_cmp_eq_u32 s50, 8
  s_cselect_b64 s[56:57], s[54:55], s[52:53]
  s_cselect_b32 s51, -18, 2
  s_add_u32 m0, s98, 90112
  s_nop 0
  global_load_lds_dwordx4 v[4:5], off offset:0
  s_add_u32 m0, s98, 98240
  s_nop 0
  global_load_lds_dwordx4 v[4:5], off offset:64
  s_add_u32 m0, s98, 106368
  s_nop 0
  global_load_lds_dwordx4 v[4:5], off offset:128
  v_lshl_add_u64 v[4:5], v[4:5], 0, s[56:57]
  s_xor_b32 m0, s49, 32768
  s_nop 0
  buffer_load_dwordx4 v2, s[8:11], s44 offen lds
  s_xor_b32 m0, s49, 34816
  s_nop 0
  buffer_load_dwordx4 v2, s[8:11], s45 offen lds
  s_xor_b32 m0, s49, 36864
  s_nop 0
  buffer_load_dwordx4 v2, s[8:11], s46 offen lds
  s_xor_b32 m0, s49, 38912
  s_nop 0
  buffer_load_dwordx4 v2, s[8:11], s47 offen lds
  s_waitcnt vmcnt(7)
  s_barrier
  ds_read_b64_tr_b16 a[64:65], v10 offset:0
  ds_read_b64_tr_b16 a[66:67], v10 offset:256
  ds_read_b64_tr_b16 a[68:69], v10 offset:4096
  ds_read_b64_tr_b16 a[70:71], v10 offset:4352
  ds_read_b128 a[0:3], v8 offset:0
  ds_read_b128 a[4:7], v9 offset:0
  ds_read_b128 a[8:11], v8 offset:2048
  ds_read_b128 a[12:15], v9 offset:2048
  ds_read_b128 a[16:19], v8 offset:4096
  ds_read_b128 a[20:23], v9 offset:4096
  ds_read_b128 a[24:27], v8 offset:6144
  ds_read_b128 a[28:31], v9 offset:6144
  ds_read_b64_tr_b16 a[72:73], v11 offset:0
  ds_read_b64_tr_b16 a[74:75], v11 offset:256
  ds_read_b64_tr_b16 a[76:77], v11 offset:4096
  ds_read_b64_tr_b16 a[78:79], v11 offset:4352
  s_waitcnt lgkmcnt(4)
  v_mfma_f32_16x16x32_bf16 v[64:67], a[64:67], a[0:3], 0
  ds_read_b64_tr_b16 a[80:81], v12 offset:0
  ds_read_b64_tr_b16 a[82:83], v12 offset:256
  v_mfma_f32_16x16x32_bf16 v[64:67], a[68:71], a[4:7], v[64:67]
  s_waitcnt lgkmcnt(6)
  ds_read_b64_tr_b16 a[84:85], v12 offset:4096
  ds_read_b64_tr_b16 a[86:87], v12 offset:4352
  v_mfma_f32_16x16x32_bf16 v[68:71], a[68:71], a[12:15], 0
  ds_read_b64_tr_b16 a[96:97], v56 offset:0
  ds_read_b64_tr_b16 a[98:99], v56 offset:256
  ds_read_b64_tr_b16 a[100:101], v56 offset:4096
  ds_read_b64_tr_b16 a[102:103], v56 offset:4352
  v_mfma_f32_16x16x32_bf16 v[68:71], a[64:67], a[8:11], v[68:71]
  v_lshl_add_u32 v2, s51, 6, v2
  s_add_u32 m0, s99, 90112
  v_mfma_f32_16x16x32_bf16 v[72:75], a[64:67], a[16:19], 0
  v_mfma_f32_16x16x32_bf16 v[72:75], a[68:71], a[20:23], v[72:75]
  global_load_lds_dwordx4 v[6:7], off offset:0
  v_mfma_f32_16x16x32_bf16 v[76:79], a[68:71], a[28:31], 0
  v_mfma_f32_16x16x32_bf16 v[76:79], a[64:67], a[24:27], v[76:79]
  s_waitcnt lgkmcnt(8)
  ds_read_b64_tr_b16 a[88:89], v13 offset:0
  ds_read_b64_tr_b16 a[90:91], v13 offset:256
  ds_read_b64_tr_b16 a[92:93], v13 offset:4096
  ds_read_b64_tr_b16 a[94:95], v13 offset:4352
  v_mfma_f32_16x16x32_bf16 v[80:83], a[72:75], a[0:3], 0
  s_add_u32 m0, s99, 98240
  v_mfma_f32_16x16x32_bf16 v[80:83], a[76:79], a[4:7], v[80:83]
  v_mfma_f32_16x16x32_bf16 v[84:87], a[76:79], a[12:15], 0
  ds_read_b64_tr_b16 a[104:105], v57 offset:0
  ds_read_b64_tr_b16 a[106:107], v57 offset:256
  ds_read_b64_tr_b16 a[108:109], v57 offset:4096
  ds_read_b64_tr_b16 a[110:111], v57 offset:4352
  v_mfma_f32_16x16x32_bf16 v[84:87], a[72:75], a[8:11], v[84:87]
  global_load_lds_dwordx4 v[6:7], off offset:64
  v_mfma_f32_16x16x32_bf16 v[88:91], a[72:75], a[16:19], 0
  v_mfma_f32_16x16x32_bf16 v[88:91], a[76:79], a[20:23], v[88:91]
  s_add_u32 m0, s99, 106368
  v_mfma_f32_16x16x32_bf16 v[92:95], a[76:79], a[28:31], 0
  v_mfma_f32_16x16x32_bf16 v[92:95], a[72:75], a[24:27], v[92:95]
  s_waitcnt lgkmcnt(12)
  ds_read_b64_tr_b16 a[64:65], v15 offset:0
  ds_read_b64_tr_b16 a[66:67], v15 offset:256
  ds_read_b64_tr_b16 a[68:69], v15 offset:4096
  ds_read_b64_tr_b16 a[70:71], v15 offset:4352
  v_mfma_f32_16x16x32_bf16 v[96:99], a[80:83], a[0:3], 0
  global_load_lds_dwordx4 v[6:7], off offset:128
  v_mfma_f32_16x16x32_bf16 v[96:99], a[84:87], a[4:7], v[96:99]
  v_mfma_f32_16x16x32_bf16 v[100:103], a[84:87], a[12:15], 0
  ds_read_b64_tr_b16 a[112:113], v58 offset:0
  ds_read_b64_tr_b16 a[114:115], v58 offset:256
  ds_read_b64_tr_b16 a[116:117], v58 offset:4096
  ds_read_b64_tr_b16 a[118:119], v58 offset:4352
  v_mfma_f32_16x16x32_bf16 v[100:103], a[80:83], a[8:11], v[100:103]
  v_lshl_add_u64 v[6:7], v[6:7], 0, s[56:57]
  s_xor_b32 m0, s49, 33792
  v_mfma_f32_16x16x32_bf16 v[104:107], a[80:83], a[16:19], 0
  v_mfma_f32_16x16x32_bf16 v[104:107], a[84:87], a[20:23], v[104:107]
  buffer_load_dwordx4 v3, s[8:11], s44 offen lds
  v_mfma_f32_16x16x32_bf16 v[108:111], a[84:87], a[28:31], 0
  v_mfma_f32_16x16x32_bf16 v[108:111], a[80:83], a[24:27], v[108:111]
  s_waitcnt lgkmcnt(12)
  ds_read_b64_tr_b16 a[72:73], v16 offset:0
  ds_read_b64_tr_b16 a[74:75], v16 offset:256
  ds_read_b64_tr_b16 a[76:77], v16 offset:4096
  ds_read_b64_tr_b16 a[78:79], v16 offset:4352
  v_mfma_f32_16x16x32_bf16 v[112:115], a[88:91], a[0:3], 0
  s_xor_b32 m0, s49, 35840
  v_mfma_f32_16x16x32_bf16 v[112:115], a[92:95], a[4:7], v[112:115]
  v_mfma_f32_16x16x32_bf16 v[116:119], a[92:95], a[12:15], 0
  buffer_load_dwordx4 v3, s[8:11], s45 offen lds
  v_mfma_f32_16x16x32_bf16 v[116:119], a[88:91], a[8:11], v[116:119]
  v_mfma_f32_16x16x32_bf16 v[120:123], a[88:91], a[16:19], 0
  v_mfma_f32_16x16x32_bf16 v[120:123], a[92:95], a[20:23], v[120:123]
  s_xor_b32 m0, s49, 37888
  v_mfma_f32_16x16x32_bf16 v[124:127], a[92:95], a[28:31], 0
  v_mfma_f32_16x16x32_bf16 v[124:127], a[88:91], a[24:27], v[124:127]
  s_waitcnt lgkmcnt(4)
  buffer_load_dwordx4 v3, s[8:11], s46 offen lds
  v_mfma_f32_16x16x32_bf16 v[40:43], v[52:55], a[96:99], 0
  v_mfma_f32_16x16x32_bf16 v[40:43], v[52:55], a[100:103], v[40:43]
  v_mfma_f32_16x16x32_bf16 v[44:47], v[52:55], a[104:107], 0
  v_mfma_f32_16x16x32_bf16 v[44:47], v[52:55], a[108:111], v[44:47]
  s_xor_b32 m0, s49, 39936
  v_mfma_f32_16x16x32_bf16 v[48:51], v[52:55], a[112:115], 0
  v_mfma_f32_16x16x32_bf16 v[48:51], v[52:55], a[116:119], v[48:51]
  ds_read_b64_tr_b16 a[80:81], v17 offset:0
  ds_read_b64_tr_b16 a[82:83], v17 offset:256
  ds_read_b64_tr_b16 a[84:85], v17 offset:4096
  ds_read_b64_tr_b16 a[86:87], v17 offset:4352
  v_mfma_f32_16x16x32_bf16 v[128:131], a[64:67], a[0:3], 0
  buffer_load_dwordx4 v3, s[8:11], s47 offen lds
  v_mfma_f32_16x16x32_bf16 v[128:131], a[68:71], a[4:7], v[128:131]
  v_mov_b32 v52, s21
  v_mov_b32 v53, s21
  v_mfma_f32_16x16x32_bf16 v[132:135], a[68:71], a[12:15], 0
  v_lshl_add_u32 v3, s51, 6, v3
  v_mov_b32 v54, s21
  v_mfma_f32_16x16x32_bf16 v[132:135], a[64:67], a[8:11], v[132:135]
  s_cmp_eq_u32 s50, 7
  s_cselect_b64 s[56:57], s[54:55], s[52:53]
  s_cselect_b32 s51, -18, 2
  v_mfma_f32_16x16x32_bf16 v[136:139], a[64:67], a[16:19], 0
  s_add_u32 m0, s98, 114688
  v_mov_b32 v55, s21
  v_lshrrev_b32 v61, 4, v0
  v_mfma_f32_16x16x32_bf16 v[136:139], a[68:71], a[20:23], v[136:139]
  global_load_lds_dwordx4 v[4:5], off offset:0
  v_mfma_f32_16x16x32_bf16 v[140:143], a[68:71], a[28:31], 0
  v_and_b32 v62, 15, v0
  v_lshlrev_b32 v62, 4, v62
  v_mfma_f32_16x16x32_bf16 v[140:143], a[64:67], a[24:27], v[140:143]
  s_waitcnt lgkmcnt(4)
  ds_read_b64_tr_b16 a[88:89], v18 offset:0
  ds_read_b64_tr_b16 a[90:91], v18 offset:256
  ds_read_b64_tr_b16 a[92:93], v18 offset:4096
  ds_read_b64_tr_b16 a[94:95], v18 offset:4352
  v_mfma_f32_16x16x32_bf16 v[144:147], a[72:75], a[0:3], 0
  s_add_u32 m0, s98, 122816
  v_lshl_add_u32 v38, v61, 10, v62
  v_lshl_add_u32 v61, v61, 28, v62
  v_mfma_f32_16x16x32_bf16 v[144:147], a[76:79], a[4:7], v[144:147]
  s_lshl_b32 s64, s7, 13
  global_load_lds_dwordx4 v[4:5], off offset:64
  v_mfma_f32_16x16x32_bf16 v[148:151], a[76:79], a[12:15], 0
  s_lshl_b32 s66, s3, 8
  s_add_u32 s64, s64, s66
  s_add_u32 s64, s64, 98304
  v_mfma_f32_16x16x32_bf16 v[148:151], a[72:75], a[8:11], v[148:151]
  s_lshl_b32 s65, s4, 10
  s_add_u32 s65, s65, s64
  v_mfma_f32_16x16x32_bf16 v[152:155], a[72:75], a[16:19], 0
  s_add_u32 m0, s98, 130944
  v_mfma_f32_16x16x32_bf16 v[152:155], a[76:79], a[20:23], v[152:155]
  v_mfma_f32_16x16x32_bf16 v[156:159], a[76:79], a[28:31], 0
  global_load_lds_dwordx4 v[4:5], off offset:128
  v_mfma_f32_16x16x32_bf16 v[156:159], a[72:75], a[24:27], v[156:159]
  s_waitcnt lgkmcnt(4)
  ds_read_b64_tr_b16 a[64:65], v14 offset:0
  ds_read_b64_tr_b16 a[66:67], v14 offset:256
  ds_read_b64_tr_b16 a[68:69], v14 offset:4096
  ds_read_b64_tr_b16 a[70:71], v14 offset:4352
  v_mfma_f32_16x16x32_bf16 v[160:163], a[80:83], a[0:3], 0
  v_mfma_f32_16x16x32_bf16 v[160:163], a[84:87], a[4:7], v[160:163]
  v_mfma_f32_16x16x32_bf16 v[164:167], a[84:87], a[12:15], 0
  s_waitcnt lgkmcnt(0)
  s_and_b32 s61, s62, -8
  s_add_u32 s61, s61, 8
  s_mov_b64 exec, 0
  s_cmp_eq_u32 s3, 0
  s_cbranch_scc1 L_hop_q0
  s_cmp_eq_u32 s3, 1
  s_cbranch_scc1 L_hop_q1
  s_cmp_eq_u32 s3, 2
  s_cbranch_scc1 L_hop_q2
  s_cmp_eq_u32 s3, 3
  s_cbranch_scc1 L_hop_q3
L_retq1:
  s_mov_b64 exec, -1
  s_mov_b64 exec, 0
  s_cmp_eq_u32 s3, 0
  s_cbranch_scc1 L_hop_q4
  s_cmp_eq_u32 s3, 1
  s_cbranch_scc1 L_retq2
  s_cmp_eq_u32 s3, 2
  s_cbranch_scc1 L_retq2
  s_cmp_eq_u32 s3, 3
  s_cbranch_scc1 L_retq2
L_retq2:
  s_mov_b64 exec, -1
  s_waitcnt vmcnt(3)
  ds_read_b128 a[32:35], v8 offset:32768
  ds_read_b128 a[36:39], v9 offset:32768
  ds_read_b128 a[40:43], v8 offset:34816
  ds_read_b128 a[44:47], v9 offset:34816
  v_mfma_f32_16x16x32_bf16 v[164:167], a[80:83], a[8:11], v[164:167]
  v_lshl_add_u64 v[4:5], v[4:5], 0, s[56:57]
  s_xor_b32 m0, s49, 0
  v_mfma_f32_16x16x32_bf16 v[168:171], a[80:83], a[16:19], 0
  buffer_load_dwordx4 v2, s[8:11], s44 offen lds
  v_mfma_f32_16x16x32_bf16 v[168:171], a[84:87], a[20:23], v[168:171]
  v_mfma_f32_16x16x32_bf16 v[172:175], a[84:87], a[28:31], 0
  v_mfma_f32_16x16x32_bf16 v[172:175], a[80:83], a[24:27], v[172:175]
  s_xor_b32 m0, s49, 2048
  ds_read_b64_tr_b16 a[72:73], v19 offset:0
  ds_read_b64_tr_b16 a[74:75], v19 offset:256
  ds_read_b64_tr_b16 a[76:77], v19 offset:4096
  ds_read_b64_tr_b16 a[78:79], v19 offset:4352
  v_mfma_f32_16x16x32_bf16 v[176:179], a[88:91], a[0:3], 0
  v_mfma_f32_16x16x32_bf16 v[176:179], a[92:95], a[4:7], v[176:179]
  buffer_load_dwordx4 v2, s[8:11], s45 offen lds
  v_mfma_f32_16x16x32_bf16 v[180:183], a[92:95], a[12:15], 0
  ds_read_b128 a[48:51], v8 offset:36864
  ds_read_b128 a[52:55], v9 offset:36864
  ds_read_b128 a[56:59], v8 offset:38912
  ds_read_b128 a[60:63], v9 offset:38912
  v_mfma_f32_16x16x32_bf16 v[180:183], a[88:91], a[8:11], v[180:183]
  v_mfma_f32_16x16x32_bf16 v[184:187], a[88:91], a[16:19], 0
  s_xor_b32 m0, s49, 4096
  v_mfma_f32_16x16x32_bf16 v[184:187], a[92:95], a[20:23], v[184:187]
  v_mfma_f32_16x16x32_bf16 v[188:191], a[92:95], a[28:31], 0
  buffer_load_dwordx4 v2, s[8:11], s46 offen lds
  v_mfma_f32_16x16x32_bf16 v[188:191], a[88:91], a[24:27], v[188:191]
  v_mfma_f32_16x16x32_bf16 v[192:195], a[64:67], a[0:3], 0
  v_mfma_f32_16x16x32_bf16 v[192:195], a[68:71], a[4:7], v[192:195]
  s_waitcnt lgkmcnt(0)
  s_barrier
  ds_read_b64_tr_b16 a[80:81], v10 offset:24576
  v_mfma_f32_16x16x32_bf16 v[196:199], a[68:71], a[12:15], 0
  s_xor_b32 m0, s49, 6144
  ds_read_b64_tr_b16 a[82:83], v10 offset:24832
  v_mfma_f32_16x16x32_bf16 v[196:199], a[64:67], a[8:11], v[196:199]
  ds_read_b64_tr_b16 a[84:85], v10 offset:28672
  v_mfma_f32_16x16x32_bf16 v[200:203], a[64:67], a[16:19], 0
  ds_read_b64_tr_b16 a[86:87], v10 offset:28928
  v_mfma_f32_16x16x32_bf16 v[200:203], a[68:71], a[20:23], v[200:203]
  buffer_load_dwordx4 v2, s[8:11], s47 offen lds
  v_mfma_f32_16x16x32_bf16 v[204:207], a[68:71], a[28:31], 0
  v_mfma_f32_16x16x32_bf16 v[204:207], a[64:67], a[24:27], v[204:207]
  ds_read_b64_tr_b16 a[88:89], v11 offset:24576
  ds_read_b64_tr_b16 a[90:91], v11 offset:24832
  ds_read_b64_tr_b16 a[92:93], v11 offset:28672
  ds_read_b64_tr_b16 a[94:95], v11 offset:28928
  v_mfma_f32_16x16x32_bf16 v[208:211], a[72:75], a[0:3], 0
  v_lshl_add_u32 v2, s51, 6, v2
  s_add_u32 m0, s99, 114688
  v_mfma_f32_16x16x32_bf16 v[208:211], a[76:79], a[4:7], v[208:211]
  global_load_lds_dwordx4 v[6:7], off offset:0
  v_mfma_f32_16x16x32_bf16 v[212:215], a[76:79], a[12:15], 0
  v_mfma_f32_16x16x32_bf16 v[212:215], a[72:75], a[8:11], v[212:215]
  v_mfma_f32_16x16x32_bf16 v[216:219], a[72:75], a[16:19], 0
  s_add_u32 m0, s99, 122816
  v_mfma_f32_16x16x32_bf16 v[216:219], a[76:79], a[20:23], v[216:219]
  v_mfma_f32_16x16x32_bf16 v[220:223], a[76:79], a[28:31], 0
  global_load_lds_dwordx4 v[6:7], off offset:64
  v_mfma_f32_16x16x32_bf16 v[220:223], a[72:75], a[24:27], v[220:223]
  s_waitcnt lgkmcnt(4)
  ds_read_b64_tr_b16 a[64:65], v12 offset:24576
  ds_read_b64_tr_b16 a[66:67], v12 offset:24832
  ds_read_b64_tr_b16 a[68:69], v12 offset:28672
  ds_read_b64_tr_b16 a[70:71], v12 offset:28928
  v_mfma_f32_16x16x32_bf16 v[64:67], a[80:83], a[32:35], v[64:67]
  v_mfma_f32_16x16x32_bf16 v[64:67], a[84:87], a[36:39], v[64:67]
  v_mfma_f32_16x16x32_bf16 v[68:71], a[84:87], a[44:47], v[68:71]
  s_add_u32 m0, s99, 130944
  ds_read_b64_tr_b16 a[96:97], v56 offset:24576
  ds_read_b64_tr_b16 a[98:99], v56 offset:24832
  ds_read_b64_tr_b16 a[100:101], v56 offset:28672
  ds_read_b64_tr_b16 a[102:103], v56 offset:28928
  v_mfma_f32_16x16x32_bf16 v[68:71], a[80:83], a[40:43], v[68:71]
  v_mfma_f32_16x16x32_bf16 v[72:75], a[80:83], a[48:51], v[72:75]
  global_load_lds_dwordx4 v[6:7], off offset:128
  v_mfma_f32_16x16x32_bf16 v[72:75], a[84:87], a[52:55], v[72:75]
  v_mfma_f32_16x16x32_bf16 v[76:79], a[84:87], a[60:63], v[76:79]
  v_mfma_f32_16x16x32_bf16 v[76:79], a[80:83], a[56:59], v[76:79]
  s_waitcnt lgkmcnt(8)
  ds_read_b64_tr_b16 a[72:73], v13 offset:24576
  ds_read_b64_tr_b16 a[74:75], v13 offset:24832
  ds_read_b64_tr_b16 a[76:77], v13 offset:28672
  ds_read_b64_tr_b16 a[78:79], v13 offset:28928
  v_mfma_f32_16x16x32_bf16 v[80:83], a[88:91], a[32:35], v[80:83]
  v_lshl_add_u64 v[6:7], v[6:7], 0, s[56:57]
  s_xor_b32 m0, s49, 1024
  v_mfma_f32_16x16x32_bf16 v[80:83], a[92:95], a[36:39], v[80:83]
  buffer_load_dwordx4 v3, s[8:11], s44 offen lds
  v_mfma_f32_16x16x32_bf16 v[84:87], a[92:95], a[44:47], v[84:87]
  ds_read_b64_tr_b16 a[104:105], v57 offset:24576
  ds_read_b64_tr_b16 a[106:107], v57 offset:24832
  ds_read_b64_tr_b16 a[108:109], v57 offset:28672
  ds_read_b64_tr_b16 a[110:111], v57 offset:28928
  v_mfma_f32_16x16x32_bf16 v[84:87], a[88:91], a[40:43], v[84:87]
  v_mfma_f32_16x16x32_bf16 v[88:91], a[88:91], a[48:51], v[88:91]
  s_xor_b32 m0, s49, 3072
  v_mfma_f32_16x16x32_bf16 v[88:91], a[92:95], a[52:55], v[88:91]
  v_mfma_f32_16x16x32_bf16 v[92:95], a[92:95], a[60:63], v[92:95]
  buffer_load_dwordx4 v3, s[8:11], s45 offen lds
  v_mfma_f32_16x16x32_bf16 v[92:95], a[88:91], a[56:59], v[92:95]
  s_waitcnt lgkmcnt(12)
  ds_read_b64_tr_b16 a[80:81], v15 offset:24576
  ds_read_b64_tr_b16 a[82:83], v15 offset:24832
  ds_read_b64_tr_b16 a[84:85], v15 offset:28672
  ds_read_b64_tr_b16 a[86:87], v15 offset:28928
  v_mfma_f32_16x16x32_bf16 v[96:99], a[64:67], a[32:35], v[96:99]
  v_mfma_f32_16x16x32_bf16 v[96:99], a[68:71], a[36:39], v[96:99]
  s_xor_b32 m0, s49, 5120
  v_mfma_f32_16x16x32_bf16 v[100:103], a[68:71], a[44:47], v[100:103]
  ds_read_b64_tr_b16 a[112:113], v58 offset:24576
  ds_read_b64_tr_b16 a[114:115], v58 offset:24832
  ds_read_b64_tr_b16 a[116:117], v58 offset:28672
  ds_read_b64_tr_b16 a[118:119], v58 offset:28928
  v_mfma_f32_16x16x32_bf16 v[100:103], a[64:67], a[40:43], v[100:103]
  buffer_load_dwordx4 v3, s[8:11], s46 offen lds
  v_mfma_f32_16x16x32_bf16 v[104:107], a[64:67], a[48:51], v[104:107]
  v_mfma_f32_16x16x32_bf16 v[104:107], a[68:71], a[52:55], v[104:107]
  v_mfma_f32_16x16x32_bf16 v[108:111], a[68:71], a[60:63], v[108:111]
  v_mfma_f32_16x16x32_bf16 v[108:111], a[64:67], a[56:59], v[108:111]
  s_waitcnt lgkmcnt(12)
  ds_read_b64_tr_b16 a[88:89], v16 offset:24576
  ds_read_b64_tr_b16 a[90:91], v16 offset:24832
  ds_read_b64_tr_b16 a[92:93], v16 offset:28672
  ds_read_b64_tr_b16 a[94:95], v16 offset:28928
  v_mfma_f32_16x16x32_bf16 v[112:115], a[72:75], a[32:35], v[112:115]
  s_xor_b32 m0, s49, 7168
  v_mfma_f32_16x16x32_bf16 v[112:115], a[76:79], a[36:39], v[112:115]
  buffer_load_dwordx4 v3, s[8:11], s47 offen lds
  v_mfma_f32_16x16x32_bf16 v[116:119], a[76:79], a[44:47], v[116:119]
  v_mfma_f32_16x16x32_bf16 v[116:119], a[72:75], a[40:43], v[116:119]
  v_mfma_f32_16x16x32_bf16 v[120:123], a[72:75], a[48:51], v[120:123]
  v_lshl_add_u32 v3, s51, 6, v3
  v_mfma_f32_16x16x32_bf16 v[120:123], a[76:79], a[52:55], v[120:123]
  s_cmp_eq_u32 s50, 6
  s_cselect_b64 s[56:57], s[54:55], s[52:53]
  s_cselect_b32 s51, -18, 2
  v_mfma_f32_16x16x32_bf16 v[124:127], a[76:79], a[60:63], v[124:127]
  s_add_u32 m0, s98, 65536
  v_mfma_f32_16x16x32_bf16 v[124:127], a[72:75], a[56:59], v[124:127]
  s_waitcnt lgkmcnt(4)
  global_load_lds_dwordx4 v[4:5], off offset:0
  v_mfma_f32_16x16x32_bf16 v[40:43], v[52:55], a[96:99], v[40:43]
  v_mfma_f32_16x16x32_bf16 v[40:43], v[52:55], a[100:103], v[40:43]
  s_add_u32 m0, s98, 73664
  v_mfma_f32_16x16x32_bf16 v[44:47], v[52:55], a[104:107], v[44:47]
  v_mfma_f32_16x16x32_bf16 v[44:47], v[52:55], a[108:111], v[44:47]
  global_load_lds_dwordx4 v[4:5], off offset:64
  v_mfma_f32_16x16x32_bf16 v[48:51], v[52:55], a[112:115], v[48:51]
  v_mfma_f32_16x16x32_bf16 v[48:51], v[52:55], a[116:119], v[48:51]
  ds_read_b64_tr_b16 a[64:65], v17 offset:24576
  ds_read_b64_tr_b16 a[66:67], v17 offset:24832
  ds_read_b64_tr_b16 a[68:69], v17 offset:28672
  ds_read_b64_tr_b16 a[70:71], v17 offset:28928
  v_mfma_f32_16x16x32_bf16 v[128:131], a[80:83], a[32:35], v[128:131]
  v_mov_b32 v52, s22
  v_mov_b32 v53, s22
  v_mfma_f32_16x16x32_bf16 v[128:131], a[84:87], a[36:39], v[128:131]
  s_add_u32 m0, s98, 81792
  v_mov_b32 v54, s22
  v_mov_b32 v55, s22
  v_mfma_f32_16x16x32_bf16 v[132:135], a[84:87], a[44:47], v[132:135]
  v_mfma_f32_16x16x32_bf16 v[132:135], a[80:83], a[40:43], v[132:135]
  global_load_lds_dwordx4 v[4:5], off offset:128
  v_mfma_f32_16x16x32_bf16 v[136:139], a[80:83], a[48:51], v[136:139]
  v_mfma_f32_16x16x32_bf16 v[136:139], a[84:87], a[52:55], v[136:139]
  v_mfma_f32_16x16x32_bf16 v[140:143], a[84:87], a[60:63], v[140:143]
  v_lshl_add_u64 v[4:5], v[4:5], 0, s[56:57]
  s_xor_b32 m0, s49, 32768
  v_mfma_f32_16x16x32_bf16 v[140:143], a[80:83], a[56:59], v[140:143]
  s_waitcnt lgkmcnt(4)
  ds_read_b64_tr_b16 a[72:73], v18 offset:24576
  ds_read_b64_tr_b16 a[74:75], v18 offset:24832
  ds_read_b64_tr_b16 a[76:77], v18 offset:28672
  ds_read_b64_tr_b16 a[78:79], v18 offset:28928
  v_mfma_f32_16x16x32_bf16 v[144:147], a[88:91], a[32:35], v[144:147]
  buffer_load_dwordx4 v2, s[8:11], s44 offen lds
  v_mfma_f32_16x16x32_bf16 v[144:147], a[92:95], a[36:39], v[144:147]
  v_mfma_f32_16x16x32_bf16 v[148:151], a[92:95], a[44:47], v[148:151]
  v_mfma_f32_16x16x32_bf16 v[148:151], a[88:91], a[40:43], v[148:151]
  s_xor_b32 m0, s49, 34816
  v_mfma_f32_16x16x32_bf16 v[152:155], a[88:91], a[48:51], v[152:155]
  v_mfma_f32_16x16x32_bf16 v[152:155], a[92:95], a[52:55], v[152:155]
  buffer_load_dwordx4 v2, s[8:11], s45 offen lds
  v_mfma_f32_16x16x32_bf16 v[156:159], a[92:95], a[60:63], v[156:159]
  v_mfma_f32_16x16x32_bf16 v[156:159], a[88:91], a[56:59], v[156:159]
  s_waitcnt lgkmcnt(4)
  ds_read_b64_tr_b16 a[80:81], v14 offset:24576
  ds_read_b64_tr_b16 a[82:83], v14 offset:24832
  ds_read_b64_tr_b16 a[84:85], v14 offset:28672
  ds_read_b64_tr_b16 a[86:87], v14 offset:28928
  v_mfma_f32_16x16x32_bf16 v[160:163], a[64:67], a[32:35], v[160:163]
  v_mfma_f32_16x16x32_bf16 v[160:163], a[68:71], a[36:39], v[160:163]
  s_xor_b32 m0, s49, 36864
  v_mfma_f32_16x16x32_bf16 v[164:167], a[68:71], a[44:47], v[164:167]
  s_waitcnt vmcnt(5)
  ds_read_b128 a[0:3], v8 offset:0
  ds_read_b128 a[4:7], v9 offset:0
  ds_read_b128 a[8:11], v8 offset:2048
  ds_read_b128 a[12:15], v9 offset:2048
  v_mfma_f32_16x16x32_bf16 v[164:167], a[64:67], a[40:43], v[164:167]
  buffer_load_dwordx4 v2, s[8:11], s46 offen lds
  v_mfma_f32_16x16x32_bf16 v[168:171], a[64:67], a[48:51], v[168:171]
  v_mfma_f32_16x16x32_bf16 v[168:171], a[68:71], a[52:55], v[168:171]
  v_mfma_f32_16x16x32_bf16 v[172:175], a[68:71], a[60:63], v[172:175]
  s_xor_b32 m0, s49, 38912
  v_mfma_f32_16x16x32_bf16 v[172:175], a[64:67], a[56:59], v[172:175]
  s_waitcnt lgkmcnt(8)
  ds_read_b64_tr_b16 a[88:89], v19 offset:24576
  ds_read_b64_tr_b16 a[90:91], v19 offset:24832
  ds_read_b64_tr_b16 a[92:93], v19 offset:28672
  ds_read_b64_tr_b16 a[94:95], v19 offset:28928
  v_mfma_f32_16x16x32_bf16 v[176:179], a[72:75], a[32:35], v[176:179]
  buffer_load_dwordx4 v2, s[8:11], s47 offen lds
  v_mfma_f32_16x16x32_bf16 v[176:179], a[76:79], a[36:39], v[176:179]
  v_mfma_f32_16x16x32_bf16 v[180:183], a[76:79], a[44:47], v[180:183]
  ds_read_b128 a[16:19], v8 offset:4096
  ds_read_b128 a[20:23], v9 offset:4096
  ds_read_b128 a[24:27], v8 offset:6144
  ds_read_b128 a[28:31], v9 offset:6144
  v_mfma_f32_16x16x32_bf16 v[180:183], a[72:75], a[40:43], v[180:183]
  v_lshl_add_u32 v2, s51, 6, v2
  s_add_u32 m0, s99, 65536
  v_mfma_f32_16x16x32_bf16 v[184:187], a[72:75], a[48:51], v[184:187]
  v_mfma_f32_16x16x32_bf16 v[184:187], a[76:79], a[52:55], v[184:187]
  global_load_lds_dwordx4 v[6:7], off offset:0
  v_mfma_f32_16x16x32_bf16 v[188:191], a[76:79], a[60:63], v[188:191]
  v_mfma_f32_16x16x32_bf16 v[188:191], a[72:75], a[56:59], v[188:191]
  s_waitcnt lgkmcnt(14)
  v_mfma_f32_16x16x32_bf16 v[192:195], a[80:83], a[32:35], v[192:195]
  s_waitcnt lgkmcnt(12)
  v_mfma_f32_16x16x32_bf16 v[192:195], a[84:87], a[36:39], v[192:195]
  s_waitcnt lgkmcnt(0)
  s_barrier
  ds_read_b64_tr_b16 a[64:65], v10 offset:49152
  v_mfma_f32_16x16x32_bf16 v[196:199], a[84:87], a[44:47], v[196:199]
  s_add_u32 m0, s99, 73664
  ds_read_b64_tr_b16 a[66:67], v10 offset:49408
  v_mfma_f32_16x16x32_bf16 v[196:199], a[80:83], a[40:43], v[196:199]
  ds_read_b64_tr_b16 a[68:69], v10 offset:53248
  v_mfma_f32_16x16x32_bf16 v[200:203], a[80:83], a[48:51], v[200:203]
  ds_read_b64_tr_b16 a[70:71], v10 offset:53504
  v_mfma_f32_16x16x32_bf16 v[200:203], a[84:87], a[52:55], v[200:203]
  global_load_lds_dwordx4 v[6:7], off offset:64
  v_mfma_f32_16x16x32_bf16 v[204:207], a[84:87], a[60:63], v[204:207]
  s_add_u32 m0, s99, 81792
  v_mfma_f32_16x16x32_bf16 v[204:207], a[80:83], a[56:59], v[204:207]
  ds_read_b64_tr_b16 a[72:73], v11 offset:49152
  ds_read_b64_tr_b16 a[74:75], v11 offset:49408
  ds_read_b64_tr_b16 a[76:77], v11 offset:53248
  ds_read_b64_tr_b16 a[78:79], v11 offset:53504
  v_mfma_f32_16x16x32_bf16 v[208:211], a[88:91], a[32:35], v[208:211]
  global_load_lds_dwordx4 v[6:7], off offset:128
  v_mfma_f32_16x16x32_bf16 v[208:211], a[92:95], a[36:39], v[208:211]
  v_mfma_f32_16x16x32_bf16 v[212:215], a[92:95], a[44:47], v[212:215]
  v_mfma_f32_16x16x32_bf16 v[212:215], a[88:91], a[40:43], v[212:215]
  v_lshl_add_u64 v[6:7], v[6:7], 0, s[56:57]
  s_xor_b32 m0, s49, 33792
  v_mfma_f32_16x16x32_bf16 v[216:219], a[88:91], a[48:51], v[216:219]
  v_mfma_f32_16x16x32_bf16 v[216:219], a[92:95], a[52:55], v[216:219]
  buffer_load_dwordx4 v3, s[8:11], s44 offen lds
  v_mfma_f32_16x16x32_bf16 v[220:223], a[92:95], a[60:63], v[220:223]
  v_mfma_f32_16x16x32_bf16 v[220:223], a[88:91], a[56:59], v[220:223]
  s_waitcnt lgkmcnt(6)
  ds_read_b64_tr_b16 a[80:81], v12 offset:49152
  ds_read_b64_tr_b16 a[82:83], v12 offset:49408
  v_mfma_f32_16x16x32_bf16 v[64:67], a[64:67], a[0:3], v[64:67]
  s_waitcnt lgkmcnt(6)
  ds_read_b64_tr_b16 a[84:85], v12 offset:53248
  ds_read_b64_tr_b16 a[86:87], v12 offset:53504
  v_mfma_f32_16x16x32_bf16 v[64:67], a[68:71], a[4:7], v[64:67]
  s_xor_b32 m0, s49, 35840
  v_mfma_f32_16x16x32_bf16 v[68:71], a[68:71], a[12:15], v[68:71]
  ds_read_b64_tr_b16 a[96:97], v56 offset:49152
  v_mfma_f32_16x16x32_bf16 v[68:71], a[64:67], a[8:11], v[68:71]
  ds_read_b64_tr_b16 a[98:99], v56 offset:49408
  v_mfma_f32_16x16x32_bf16 v[72:75], a[64:67], a[16:19], v[72:75]
  ds_read_b64_tr_b16 a[100:101], v56 offset:53248
  v_mfma_f32_16x16x32_bf16 v[72:75], a[68:71], a[20:23], v[72:75]
L_hop_q0:
  s_cbranch_execz L_retq1
  ds_read_b64_tr_b16 a[102:103], v56 offset:53504
  v_mfma_f32_16x16x32_bf16 v[76:79], a[68:71], a[28:31], v[76:79]
  buffer_load_dwordx4 v3, s[8:11], s45 offen lds
  v_mfma_f32_16x16x32_bf16 v[76:79], a[64:67], a[24:27], v[76:79]
  s_waitcnt lgkmcnt(10)
  ds_read_b64_tr_b16 a[88:89], v13 offset:49152
  ds_read_b64_tr_b16 a[90:91], v13 offset:49408
  v_mfma_f32_16x16x32_bf16 v[80:83], a[72:75], a[0:3], v[80:83]
  s_waitcnt lgkmcnt(10)
  ds_read_b64_tr_b16 a[92:93], v13 offset:53248
  ds_read_b64_tr_b16 a[94:95], v13 offset:53504
  v_mfma_f32_16x16x32_bf16 v[80:83], a[76:79], a[4:7], v[80:83]
  s_xor_b32 m0, s49, 37888
  v_mfma_f32_16x16x32_bf16 v[84:87], a[76:79], a[12:15], v[84:87]
  ds_read_b64_tr_b16 a[104:105], v57 offset:49152
  v_mfma_f32_16x16x32_bf16 v[84:87], a[72:75], a[8:11], v[84:87]
  ds_read_b64_tr_b16 a[106:107], v57 offset:49408
  v_mfma_f32_16x16x32_bf16 v[88:91], a[72:75], a[16:19], v[88:91]
  ds_read_b64_tr_b16 a[108:109], v57 offset:53248
  v_mfma_f32_16x16x32_bf16 v[88:91], a[76:79], a[20:23], v[88:91]
  ds_read_b64_tr_b16 a[110:111], v57 offset:53504
  v_mfma_f32_16x16x32_bf16 v[92:95], a[76:79], a[28:31], v[92:95]
  buffer_load_dwordx4 v3, s[8:11], s46 offen lds
  v_mfma_f32_16x16x32_bf16 v[92:95], a[72:75], a[24:27], v[92:95]
  s_waitcnt lgkmcnt(14)
  ds_read_b64_tr_b16 a[64:65], v15 offset:49152
  ds_read_b64_tr_b16 a[66:67], v15 offset:49408
  v_mfma_f32_16x16x32_bf16 v[96:99], a[80:83], a[0:3], v[96:99]
  s_waitcnt lgkmcnt(14)
  ds_read_b64_tr_b16 a[68:69], v15 offset:53248
  ds_read_b64_tr_b16 a[70:71], v15 offset:53504
  v_mfma_f32_16x16x32_bf16 v[96:99], a[84:87], a[4:7], v[96:99]
  s_xor_b32 m0, s49, 39936
  v_mfma_f32_16x16x32_bf16 v[100:103], a[84:87], a[12:15], v[100:103]
  ds_read_b64_tr_b16 a[112:113], v58 offset:49152
  v_mfma_f32_16x16x32_bf16 v[100:103], a[80:83], a[8:11], v[100:103]
  ds_read_b64_tr_b16 a[114:115], v58 offset:49408
  v_mfma_f32_16x16x32_bf16 v[104:107], a[80:83], a[16:19], v[104:107]
  ds_read_b64_tr_b16 a[116:117], v58 offset:53248
  v_mfma_f32_16x16x32_bf16 v[104:107], a[84:87], a[20:23], v[104:107]
  ds_read_b64_tr_b16 a[118:119], v58 offset:53504
  v_mfma_f32_16x16x32_bf16 v[108:111], a[84:87], a[28:31], v[108:111]
  buffer_load_dwordx4 v3, s[8:11], s47 offen lds
  v_mfma_f32_16x16x32_bf16 v[108:111], a[80:83], a[24:27], v[108:111]
  s_waitcnt lgkmcnt(14)
  ds_read_b64_tr_b16 a[72:73], v16 offset:49152
  ds_read_b64_tr_b16 a[74:75], v16 offset:49408
  v_mfma_f32_16x16x32_bf16 v[112:115], a[88:91], a[0:3], v[112:115]
  s_waitcnt lgkmcnt(14)
  ds_read_b64_tr_b16 a[76:77], v16 offset:53248
  ds_read_b64_tr_b16 a[78:79], v16 offset:53504
  v_mfma_f32_16x16x32_bf16 v[112:115], a[92:95], a[4:7], v[112:115]
  v_lshl_add_u32 v3, s51, 6, v3
  v_mfma_f32_16x16x32_bf16 v[116:119], a[92:95], a[12:15], v[116:119]
  s_cmp_eq_u32 s50, 5
  s_cselect_b64 s[56:57], s[54:55], s[52:53]
  s_cselect_b32 s51, -18, 2
  v_mfma_f32_16x16x32_bf16 v[116:119], a[88:91], a[8:11], v[116:119]
  s_add_u32 m0, s98, 90112
  v_mfma_f32_16x16x32_bf16 v[120:123], a[88:91], a[16:19], v[120:123]
  global_load_lds_dwordx4 v[4:5], off offset:0
  v_mfma_f32_16x16x32_bf16 v[120:123], a[92:95], a[20:23], v[120:123]
  s_add_u32 m0, s98, 98240
  v_mfma_f32_16x16x32_bf16 v[124:127], a[92:95], a[28:31], v[124:127]
  global_load_lds_dwordx4 v[4:5], off offset:64
  v_mfma_f32_16x16x32_bf16 v[124:127], a[88:91], a[24:27], v[124:127]
  s_waitcnt lgkmcnt(4)
  s_add_u32 m0, s98, 106368
  v_mfma_f32_16x16x32_bf16 v[40:43], v[52:55], a[96:99], v[40:43]
  global_load_lds_dwordx4 v[4:5], off offset:128
  v_mfma_f32_16x16x32_bf16 v[40:43], v[52:55], a[100:103], v[40:43]
  v_lshl_add_u64 v[4:5], v[4:5], 0, s[56:57]
  s_xor_b32 m0, s49, 0
  v_mfma_f32_16x16x32_bf16 v[44:47], v[52:55], a[104:107], v[44:47]
  buffer_load_dwordx4 v2, s[8:11], s44 offen lds
  v_mfma_f32_16x16x32_bf16 v[44:47], v[52:55], a[108:111], v[44:47]
  v_mfma_f32_16x16x32_bf16 v[48:51], v[52:55], a[112:115], v[48:51]
  v_mfma_f32_16x16x32_bf16 v[48:51], v[52:55], a[116:119], v[48:51]
  s_waitcnt lgkmcnt(4)
  ds_read_b64_tr_b16 a[80:81], v17 offset:49152
  ds_read_b64_tr_b16 a[82:83], v17 offset:49408
  v_mfma_f32_16x16x32_bf16 v[128:131], a[64:67], a[0:3], v[128:131]
  s_waitcnt lgkmcnt(6)
  ds_read_b64_tr_b16 a[84:85], v17 offset:53248
  ds_read_b64_tr_b16 a[86:87], v17 offset:53504
  v_mfma_f32_16x16x32_bf16 v[128:131], a[68:71], a[4:7], v[128:131]
  s_xor_b32 m0, s49, 2048
  v_mfma_f32_16x16x32_bf16 v[132:135], a[68:71], a[12:15], v[132:135]
  buffer_load_dwordx4 v2, s[8:11], s45 offen lds
  v_mfma_f32_16x16x32_bf16 v[132:135], a[64:67], a[8:11], v[132:135]
  v_mfma_f32_16x16x32_bf16 v[136:139], a[64:67], a[16:19], v[136:139]
  v_mfma_f32_16x16x32_bf16 v[136:139], a[68:71], a[20:23], v[136:139]
  s_xor_b32 m0, s49, 4096
  v_mfma_f32_16x16x32_bf16 v[140:143], a[68:71], a[28:31], v[140:143]
  v_mfma_f32_16x16x32_bf16 v[140:143], a[64:67], a[24:27], v[140:143]
  s_waitcnt lgkmcnt(6)
  ds_read_b64_tr_b16 a[88:89], v18 offset:49152
  ds_read_b64_tr_b16 a[90:91], v18 offset:49408
  v_mfma_f32_16x16x32_bf16 v[144:147], a[72:75], a[0:3], v[144:147]
  s_waitcnt lgkmcnt(6)
  ds_read_b64_tr_b16 a[92:93], v18 offset:53248
  ds_read_b64_tr_b16 a[94:95], v18 offset:53504
  v_mfma_f32_16x16x32_bf16 v[144:147], a[76:79], a[4:7], v[144:147]
  buffer_load_dwordx4 v2, s[8:11], s46 offen lds
  v_mfma_f32_16x16x32_bf16 v[148:151], a[76:79], a[12:15], v[148:151]
  s_xor_b32 m0, s49, 6144
  v_mov_b32 v41, v44
  v_mov_b32 v42, v48
  v_mfma_f32_16x16x32_bf16 v[148:151], a[72:75], a[8:11], v[148:151]
  v_mov_b32 v43, s61
  v_mfma_f32_16x16x32_bf16 v[152:155], a[72:75], a[16:19], v[152:155]
  buffer_load_dwordx4 v2, s[8:11], s47 offen lds
  v_mfma_f32_16x16x32_bf16 v[152:155], a[76:79], a[20:23], v[152:155]
  buffer_store_dwordx4 v[40:43], v61, s[12:15], s65 offen sc1
  v_mfma_f32_16x16x32_bf16 v[156:159], a[76:79], a[28:31], v[156:159]
  v_not_b32 v39, v43
  s_add_u32 s65, s64, 4096
  v_mfma_f32_16x16x32_bf16 v[156:159], a[72:75], a[24:27], v[156:159]
  s_waitcnt lgkmcnt(6)
  ds_read_b64_tr_b16 a[64:65], v14 offset:49152
  ds_read_b64_tr_b16 a[66:67], v14 offset:49408
  v_mfma_f32_16x16x32_bf16 v[160:163], a[80:83], a[0:3], v[160:163]
  s_waitcnt lgkmcnt(6)
  ds_read_b64_tr_b16 a[68:69], v14 offset:53248
  ds_read_b64_tr_b16 a[70:71], v14 offset:53504
  v_mfma_f32_16x16x32_bf16 v[160:163], a[84:87], a[4:7], v[160:163]
  s_lshl_b32 s66, s4, 2
  v_lshl_add_u32 v2, s51, 6, v2
  s_add_u32 m0, s99, 90112
  v_mfma_f32_16x16x32_bf16 v[164:167], a[84:87], a[12:15], v[164:167]
  s_waitcnt vmcnt(8)
  ds_read_b128 a[32:35], v8 offset:32768
  s_add_u32 s66, s66, s3
  v_mfma_f32_16x16x32_bf16 v[164:167], a[80:83], a[8:11], v[164:167]
  s_lshl_b32 s66, s66, 9
  ds_read_b128 a[36:39], v9 offset:32768
  s_add_u32 s66, s66, 65536
  v_mfma_f32_16x16x32_bf16 v[168:171], a[80:83], a[16:19], v[168:171]
  ds_read_b128 a[40:43], v8 offset:34816
  v_lshlrev_b32 v62, 3, v0
  v_mfma_f32_16x16x32_bf16 v[168:171], a[84:87], a[20:23], v[168:171]
  s_mul_i32 s67, s3, 192
  ds_read_b128 a[44:47], v9 offset:34816
  s_add_u32 s67, s67, 139264
  v_mfma_f32_16x16x32_bf16 v[172:175], a[84:87], a[28:31], v[172:175]
  global_load_lds_dwordx4 v[6:7], off offset:0
  v_mfma_f32_16x16x32_bf16 v[172:175], a[80:83], a[24:27], v[172:175]
  s_waitcnt lgkmcnt(10)
  ds_read_b64_tr_b16 a[72:73], v19 offset:49152
  ds_read_b64_tr_b16 a[74:75], v19 offset:49408
  v_mfma_f32_16x16x32_bf16 v[176:179], a[88:91], a[0:3], v[176:179]
  s_waitcnt lgkmcnt(10)
  ds_read_b64_tr_b16 a[76:77], v19 offset:53248
  ds_read_b64_tr_b16 a[78:79], v19 offset:53504
  v_mfma_f32_16x16x32_bf16 v[176:179], a[92:95], a[4:7], v[176:179]
  s_add_u32 m0, s99, 98240
  v_min_u32 v61, 48, v0
  v_cmp_lt_u32 vcc, 47, v0
  v_mfma_f32_16x16x32_bf16 v[180:183], a[92:95], a[12:15], v[180:183]
  ds_read_b128 a[48:51], v8 offset:36864
  v_lshl_add_u32 v61, v61, 2, s67
  v_mfma_f32_16x16x32_bf16 v[180:183], a[88:91], a[8:11], v[180:183]
  ds_read_b128 a[52:55], v9 offset:36864
  v_mov_b32 v56, 140032
  v_mfma_f32_16x16x32_bf16 v[184:187], a[88:91], a[16:19], v[184:187]
  s_lshl_b32 s67, s3, 10
  ds_read_b128 a[56:59], v8 offset:38912
  s_add_u32 s67, s67, 140288
  v_mfma_f32_16x16x32_bf16 v[184:187], a[92:95], a[20:23], v[184:187]
  ds_read_b128 a[60:63], v9 offset:38912
  v_cndmask_b32 v61, v61, v56, vcc
  v_mfma_f32_16x16x32_bf16 v[188:191], a[92:95], a[28:31], v[188:191]
  global_load_lds_dwordx4 v[6:7], off offset:64
  v_mfma_f32_16x16x32_bf16 v[188:191], a[88:91], a[24:27], v[188:191]
  s_waitcnt lgkmcnt(14)
  s_add_u32 m0, s99, 106368
  v_lshl_add_u32 v56, v0, 2, s67
  v_mfma_f32_16x16x32_bf16 v[192:195], a[64:67], a[0:3], v[192:195]
  s_waitcnt lgkmcnt(12)
  global_load_lds_dwordx4 v[6:7], off offset:128
  v_mfma_f32_16x16x32_bf16 v[192:195], a[68:71], a[4:7], v[192:195]
  s_waitcnt lgkmcnt(0)
  s_barrier
  ds_read_b64_tr_b16 a[80:81], v10 offset:0
  v_mfma_f32_16x16x32_bf16 v[196:199], a[68:71], a[12:15], v[196:199]
  ds_read_b64_tr_b16 a[82:83], v10 offset:256
  v_lshl_add_u64 v[6:7], v[6:7], 0, s[56:57]
  v_mfma_f32_16x16x32_bf16 v[196:199], a[64:67], a[8:11], v[196:199]
  s_xor_b32 m0, s49, 1024
  ds_read_b64_tr_b16 a[84:85], v10 offset:4096
  v_and_b32 v57, 15, v0
  v_mfma_f32_16x16x32_bf16 v[200:203], a[64:67], a[16:19], v[200:203]
  ds_read_b64_tr_b16 a[86:87], v10 offset:4352
  v_lshl_add_u32 v57, v57, 2, s67
  v_mfma_f32_16x16x32_bf16 v[200:203], a[68:71], a[20:23], v[200:203]
  buffer_load_dwordx4 v3, s[8:11], s44 offen lds
  v_mfma_f32_16x16x32_bf16 v[204:207], a[68:71], a[28:31], v[204:207]
  s_xor_b32 m0, s49, 3072
  v_mfma_f32_16x16x32_bf16 v[204:207], a[64:67], a[24:27], v[204:207]
  s_waitcnt lgkmcnt(4)
  ds_read_b64_tr_b16 a[88:89], v11 offset:0
  ds_read_b64_tr_b16 a[90:91], v11 offset:256
  v_mfma_f32_16x16x32_bf16 v[208:211], a[72:75], a[0:3], v[208:211]
  s_waitcnt lgkmcnt(6)
  ds_read_b64_tr_b16 a[92:93], v11 offset:4096
  ds_read_b64_tr_b16 a[94:95], v11 offset:4352
  v_mfma_f32_16x16x32_bf16 v[208:211], a[76:79], a[4:7], v[208:211]
  buffer_load_dwordx4 v3, s[8:11], s45 offen lds
  v_mfma_f32_16x16x32_bf16 v[212:215], a[76:79], a[12:15], v[212:215]
  s_xor_b32 m0, s49, 5120
  v_mfma_f32_16x16x32_bf16 v[212:215], a[72:75], a[8:11], v[212:215]
  v_mfma_f32_16x16x32_bf16 v[216:219], a[72:75], a[16:19], v[216:219]
  buffer_load_dwordx4 v3, s[8:11], s46 offen lds
  v_mfma_f32_16x16x32_bf16 v[216:219], a[76:79], a[20:23], v[216:219]
  v_mfma_f32_16x16x32_bf16 v[220:223], a[76:79], a[28:31], v[220:223]
  v_mfma_f32_16x16x32_bf16 v[220:223], a[72:75], a[24:27], v[220:223]
  s_waitcnt lgkmcnt(6)
  ds_read_b64_tr_b16 a[64:65], v12 offset:0
  ds_read_b64_tr_b16 a[66:67], v12 offset:256
  v_mfma_f32_16x16x32_bf16 v[64:67], a[80:83], a[32:35], v[64:67]
  s_waitcnt lgkmcnt(6)
  ds_read_b64_tr_b16 a[68:69], v12 offset:4096
  ds_read_b64_tr_b16 a[70:71], v12 offset:4352
  v_mfma_f32_16x16x32_bf16 v[64:67], a[84:87], a[36:39], v[64:67]
  s_xor_b32 m0, s49, 7168
  v_mfma_f32_16x16x32_bf16 v[68:71], a[84:87], a[44:47], v[68:71]
  buffer_load_dwordx4 v3, s[8:11], s47 offen lds
  v_mfma_f32_16x16x32_bf16 v[68:71], a[80:83], a[40:43], v[68:71]
  v_mfma_f32_16x16x32_bf16 v[72:75], a[80:83], a[48:51], v[72:75]
  v_mfma_f32_16x16x32_bf16 v[72:75], a[84:87], a[52:55], v[72:75]
  v_lshl_add_u32 v3, s51, 6, v3
  v_mfma_f32_16x16x32_bf16 v[76:79], a[84:87], a[60:63], v[76:79]
  s_cmp_eq_u32 s50, 4
  s_cselect_b64 s[56:57], s[54:55], s[52:53]
  s_cselect_b32 s51, -18, 2
  v_mfma_f32_16x16x32_bf16 v[76:79], a[80:83], a[56:59], v[76:79]
  s_waitcnt lgkmcnt(6)
  ds_read_b64_tr_b16 a[72:73], v13 offset:0
  ds_read_b64_tr_b16 a[74:75], v13 offset:256
  v_mfma_f32_16x16x32_bf16 v[80:83], a[88:91], a[32:35], v[80:83]
  s_waitcnt lgkmcnt(6)
  ds_read_b64_tr_b16 a[76:77], v13 offset:4096
  ds_read_b64_tr_b16 a[78:79], v13 offset:4352
  v_mfma_f32_16x16x32_bf16 v[80:83], a[92:95], a[36:39], v[80:83]
  s_add_u32 m0, s98, 114688
  v_mfma_f32_16x16x32_bf16 v[84:87], a[92:95], a[44:47], v[84:87]
  global_load_lds_dwordx4 v[4:5], off offset:0
  v_mfma_f32_16x16x32_bf16 v[84:87], a[88:91], a[40:43], v[84:87]
  s_add_u32 m0, s98, 122816
  v_mfma_f32_16x16x32_bf16 v[88:91], a[88:91], a[48:51], v[88:91]
  global_load_lds_dwordx4 v[4:5], off offset:64
  v_mfma_f32_16x16x32_bf16 v[88:91], a[92:95], a[52:55], v[88:91]
  v_mfma_f32_16x16x32_bf16 v[92:95], a[92:95], a[60:63], v[92:95]
  v_mfma_f32_16x16x32_bf16 v[92:95], a[88:91], a[56:59], v[92:95]
  s_waitcnt lgkmcnt(6)
  ds_read_b64_tr_b16 a[80:81], v15 offset:0
  ds_read_b64_tr_b16 a[82:83], v15 offset:256
  v_mfma_f32_16x16x32_bf16 v[96:99], a[64:67], a[32:35], v[96:99]
  s_waitcnt lgkmcnt(6)
  ds_read_b64_tr_b16 a[84:85], v15 offset:4096
  ds_read_b64_tr_b16 a[86:87], v15 offset:4352
  v_mfma_f32_16x16x32_bf16 v[96:99], a[68:71], a[36:39], v[96:99]
  s_add_u32 m0, s98, 130944
  v_mfma_f32_16x16x32_bf16 v[100:103], a[68:71], a[44:47], v[100:103]
  global_load_lds_dwordx4 v[4:5], off offset:128
  v_mfma_f32_16x16x32_bf16 v[100:103], a[64:67], a[40:43], v[100:103]
  v_mfma_f32_16x16x32_bf16 v[104:107], a[64:67], a[48:51], v[104:107]
  v_lshl_add_u64 v[4:5], v[4:5], 0, s[56:57]
  s_xor_b32 m0, s49, 32768
  v_mfma_f32_16x16x32_bf16 v[104:107], a[68:71], a[52:55], v[104:107]
  v_mfma_f32_16x16x32_bf16 v[108:111], a[68:71], a[60:63], v[108:111]
  buffer_load_dwordx4 v2, s[8:11], s44 offen lds
  v_mfma_f32_16x16x32_bf16 v[108:111], a[64:67], a[56:59], v[108:111]
  s_waitcnt lgkmcnt(6)
  ds_read_b64_tr_b16 a[88:89], v16 offset:0
  ds_read_b64_tr_b16 a[90:91], v16 offset:256
  v_mfma_f32_16x16x32_bf16 v[112:115], a[72:75], a[32:35], v[112:115]
  s_waitcnt lgkmcnt(6)
  ds_read_b64_tr_b16 a[92:93], v16 offset:4096
  ds_read_b64_tr_b16 a[94:95], v16 offset:4352
  v_mfma_f32_16x16x32_bf16 v[112:115], a[76:79], a[36:39], v[112:115]
  v_mfma_f32_16x16x32_bf16 v[116:119], a[76:79], a[44:47], v[116:119]
  s_xor_b32 m0, s49, 34816
  v_mfma_f32_16x16x32_bf16 v[116:119], a[72:75], a[40:43], v[116:119]
  v_mfma_f32_16x16x32_bf16 v[120:123], a[72:75], a[48:51], v[120:123]
  buffer_load_dwordx4 v2, s[8:11], s45 offen lds
  v_mfma_f32_16x16x32_bf16 v[120:123], a[76:79], a[52:55], v[120:123]
  v_mfma_f32_16x16x32_bf16 v[124:127], a[76:79], a[60:63], v[124:127]
  v_mfma_f32_16x16x32_bf16 v[124:127], a[72:75], a[56:59], v[124:127]
  s_waitcnt lgkmcnt(6)
  ds_read_b64_tr_b16 a[64:65], v17 offset:0
  ds_read_b64_tr_b16 a[66:67], v17 offset:256
  v_mfma_f32_16x16x32_bf16 v[128:131], a[80:83], a[32:35], v[128:131]
  s_waitcnt lgkmcnt(6)
  ds_read_b64_tr_b16 a[68:69], v17 offset:4096
  ds_read_b64_tr_b16 a[70:71], v17 offset:4352
  v_mfma_f32_16x16x32_bf16 v[128:131], a[84:87], a[36:39], v[128:131]
  s_xor_b32 m0, s49, 36864
  v_mfma_f32_16x16x32_bf16 v[132:135], a[84:87], a[44:47], v[132:135]
  buffer_load_dwordx4 v2, s[8:11], s46 offen lds
  v_mfma_f32_16x16x32_bf16 v[132:135], a[80:83], a[40:43], v[132:135]
  v_mfma_f32_16x16x32_bf16 v[136:139], a[80:83], a[48:51], v[136:139]
  s_xor_b32 m0, s49, 38912
  v_mfma_f32_16x16x32_bf16 v[136:139], a[84:87], a[52:55], v[136:139]
  v_mfma_f32_16x16x32_bf16 v[140:143], a[84:87], a[60:63], v[140:143]
  buffer_load_dwordx4 v2, s[8:11], s47 offen lds
  v_mfma_f32_16x16x32_bf16 v[140:143], a[80:83], a[56:59], v[140:143]
  s_waitcnt lgkmcnt(6)
  ds_read_b64_tr_b16 a[72:73], v18 offset:0
  ds_read_b64_tr_b16 a[74:75], v18 offset:256
  v_mfma_f32_16x16x32_bf16 v[144:147], a[88:91], a[32:35], v[144:147]
  s_waitcnt lgkmcnt(6)
  ds_read_b64_tr_b16 a[76:77], v18 offset:4096
  ds_read_b64_tr_b16 a[78:79], v18 offset:4352
  v_mfma_f32_16x16x32_bf16 v[144:147], a[92:95], a[36:39], v[144:147]
  v_mfma_f32_16x16x32_bf16 v[148:151], a[92:95], a[44:47], v[148:151]
  v_lshl_add_u32 v2, s51, 6, v2
  s_add_u32 m0, s99, 114688
  v_mfma_f32_16x16x32_bf16 v[148:151], a[88:91], a[40:43], v[148:151]
  v_mfma_f32_16x16x32_bf16 v[152:155], a[88:91], a[48:51], v[152:155]
  global_load_lds_dwordx4 v[6:7], off offset:0
  v_mfma_f32_16x16x32_bf16 v[152:155], a[92:95], a[52:55], v[152:155]
  v_mfma_f32_16x16x32_bf16 v[156:159], a[92:95], a[60:63], v[156:159]
  v_mfma_f32_16x16x32_bf16 v[156:159], a[88:91], a[56:59], v[156:159]
  s_waitcnt lgkmcnt(6)
  ds_read_b64_tr_b16 a[80:81], v14 offset:0
  ds_read_b64_tr_b16 a[82:83], v14 offset:256
  v_mfma_f32_16x16x32_bf16 v[160:163], a[64:67], a[32:35], v[160:163]
  s_waitcnt lgkmcnt(6)
  ds_read_b64_tr_b16 a[84:85], v14 offset:4096
  ds_read_b64_tr_b16 a[86:87], v14 offset:4352
  v_mfma_f32_16x16x32_bf16 v[160:163], a[68:71], a[36:39], v[160:163]
  s_add_u32 m0, s99, 122816
  v_mfma_f32_16x16x32_bf16 v[164:167], a[68:71], a[44:47], v[164:167]
  s_waitcnt vmcnt(8)
  ds_read_b128 a[0:3], v8 offset:0
  v_mfma_f32_16x16x32_bf16 v[164:167], a[64:67], a[40:43], v[164:167]
  ds_read_b128 a[4:7], v9 offset:0
  v_mfma_f32_16x16x32_bf16 v[168:171], a[64:67], a[48:51], v[168:171]
  ds_read_b128 a[8:11], v8 offset:2048
  v_mfma_f32_16x16x32_bf16 v[168:171], a[68:71], a[52:55], v[168:171]
  ds_read_b128 a[12:15], v9 offset:2048
  v_mfma_f32_16x16x32_bf16 v[172:175], a[68:71], a[60:63], v[172:175]
  global_load_lds_dwordx4 v[6:7], off offset:64
  v_mfma_f32_16x16x32_bf16 v[172:175], a[64:67], a[56:59], v[172:175]
  s_waitcnt lgkmcnt(10)
  ds_read_b64_tr_b16 a[88:89], v19 offset:0
  ds_read_b64_tr_b16 a[90:91], v19 offset:256
  v_mfma_f32_16x16x32_bf16 v[176:179], a[72:75], a[32:35], v[176:179]
  s_waitcnt lgkmcnt(10)
  ds_read_b64_tr_b16 a[92:93], v19 offset:4096
  ds_read_b64_tr_b16 a[94:95], v19 offset:4352
  v_mfma_f32_16x16x32_bf16 v[176:179], a[76:79], a[36:39], v[176:179]
  s_add_u32 m0, s99, 130944
  v_mfma_f32_16x16x32_bf16 v[180:183], a[76:79], a[44:47], v[180:183]
  ds_read_b128 a[16:19], v8 offset:4096
  v_mfma_f32_16x16x32_bf16 v[180:183], a[72:75], a[40:43], v[180:183]
  ds_read_b128 a[20:23], v9 offset:4096
  v_mfma_f32_16x16x32_bf16 v[184:187], a[72:75], a[48:51], v[184:187]
  ds_read_b128 a[24:27], v8 offset:6144
  v_mfma_f32_16x16x32_bf16 v[184:187], a[76:79], a[52:55], v[184:187]
  ds_read_b128 a[28:31], v9 offset:6144
  v_mfma_f32_16x16x32_bf16 v[188:191], a[76:79], a[60:63], v[188:191]
  global_load_lds_dwordx4 v[6:7], off offset:128
  v_mfma_f32_16x16x32_bf16 v[188:191], a[72:75], a[56:59], v[188:191]
  s_waitcnt lgkmcnt(14)
  v_lshl_add_u64 v[6:7], v[6:7], 0, s[56:57]
  s_xor_b32 m0, s49, 33792
  v_mfma_f32_16x16x32_bf16 v[192:195], a[80:83], a[32:35], v[192:195]
  s_waitcnt lgkmcnt(12)
  buffer_load_dwordx4 v3, s[8:11], s44 offen lds
  v_mfma_f32_16x16x32_bf16 v[192:195], a[84:87], a[36:39], v[192:195]
  s_waitcnt lgkmcnt(0)
  s_barrier
  ds_read_b64_tr_b16 a[64:65], v10 offset:24576
  v_mfma_f32_16x16x32_bf16 v[196:199], a[84:87], a[44:47], v[196:199]
  s_xor_b32 m0, s49, 35840
  ds_read_b64_tr_b16 a[66:67], v10 offset:24832
  v_mfma_f32_16x16x32_bf16 v[196:199], a[80:83], a[40:43], v[196:199]
  ds_read_b64_tr_b16 a[68:69], v10 offset:28672
  v_mfma_f32_16x16x32_bf16 v[200:203], a[80:83], a[48:51], v[200:203]
  ds_read_b64_tr_b16 a[70:71], v10 offset:28928
  v_mfma_f32_16x16x32_bf16 v[200:203], a[84:87], a[52:55], v[200:203]
  buffer_load_dwordx4 v3, s[8:11], s45 offen lds
  v_mfma_f32_16x16x32_bf16 v[204:207], a[84:87], a[60:63], v[204:207]
  s_xor_b32 m0, s49, 37888
  v_mfma_f32_16x16x32_bf16 v[204:207], a[80:83], a[56:59], v[204:207]
  s_waitcnt lgkmcnt(4)
  ds_read_b64_tr_b16 a[72:73], v11 offset:24576
  ds_read_b64_tr_b16 a[74:75], v11 offset:24832
  v_mfma_f32_16x16x32_bf16 v[208:211], a[88:91], a[32:35], v[208:211]
  s_waitcnt lgkmcnt(6)
  ds_read_b64_tr_b16 a[76:77], v11 offset:28672
  ds_read_b64_tr_b16 a[78:79], v11 offset:28928
  v_mfma_f32_16x16x32_bf16 v[208:211], a[92:95], a[36:39], v[208:211]
  buffer_load_dwordx4 v3, s[8:11], s46 offen lds
  v_mfma_f32_16x16x32_bf16 v[212:215], a[92:95], a[44:47], v[212:215]
  s_xor_b32 m0, s49, 39936
  v_mfma_f32_16x16x32_bf16 v[212:215], a[88:91], a[40:43], v[212:215]
  buffer_load_dwordx4 v3, s[8:11], s47 offen lds
  v_mfma_f32_16x16x32_bf16 v[216:219], a[88:91], a[48:51], v[216:219]
  v_mfma_f32_16x16x32_bf16 v[216:219], a[92:95], a[52:55], v[216:219]
  v_mfma_f32_16x16x32_bf16 v[220:223], a[92:95], a[60:63], v[220:223]
  v_mfma_f32_16x16x32_bf16 v[220:223], a[88:91], a[56:59], v[220:223]
  s_waitcnt lgkmcnt(6)
  ds_read_b64_tr_b16 a[80:81], v12 offset:24576
  ds_read_b64_tr_b16 a[82:83], v12 offset:24832
  v_mfma_f32_16x16x32_bf16 v[64:67], a[64:67], a[0:3], v[64:67]
  s_waitcnt lgkmcnt(6)
  ds_read_b64_tr_b16 a[84:85], v12 offset:28672
  ds_read_b64_tr_b16 a[86:87], v12 offset:28928
  v_mfma_f32_16x16x32_bf16 v[64:67], a[68:71], a[4:7], v[64:67]
  buffer_load_dwordx4 v[40:43], v38, s[12:15], s64 offen sc1
  v_mfma_f32_16x16x32_bf16 v[68:71], a[68:71], a[12:15], v[68:71]
  buffer_load_dwordx4 v[44:47], v38, s[12:15], s65 offen sc1
  v_mfma_f32_16x16x32_bf16 v[68:71], a[64:67], a[8:11], v[68:71]
  buffer_load_dwordx2 v[48:49], v62, s[12:15], s66 offen sc1
  v_mfma_f32_16x16x32_bf16 v[72:75], a[64:67], a[16:19], v[72:75]
  v_lshl_add_u32 v3, s51, 6, v3
  v_mfma_f32_16x16x32_bf16 v[72:75], a[68:71], a[20:23], v[72:75]
  s_cmp_eq_u32 s50, 3
  s_cselect_b64 s[56:57], s[54:55], s[52:53]
  s_cselect_b32 s51, -18, 2
  v_mfma_f32_16x16x32_bf16 v[76:79], a[68:71], a[28:31], v[76:79]
  s_add_u32 m0, s98, 65536
  v_mfma_f32_16x16x32_bf16 v[76:79], a[64:67], a[24:27], v[76:79]
  s_waitcnt lgkmcnt(6)
  ds_read_b64_tr_b16 a[88:89], v13 offset:24576
  ds_read_b64_tr_b16 a[90:91], v13 offset:24832
  v_mfma_f32_16x16x32_bf16 v[80:83], a[72:75], a[0:3], v[80:83]
  s_waitcnt lgkmcnt(6)
  ds_read_b64_tr_b16 a[92:93], v13 offset:28672
  ds_read_b64_tr_b16 a[94:95], v13 offset:28928
  v_mfma_f32_16x16x32_bf16 v[80:83], a[76:79], a[4:7], v[80:83]
  global_load_lds_dwordx4 v[4:5], off offset:0
  v_mfma_f32_16x16x32_bf16 v[84:87], a[76:79], a[12:15], v[84:87]
  s_add_u32 m0, s98, 73664
  v_mfma_f32_16x16x32_bf16 v[84:87], a[72:75], a[8:11], v[84:87]
  global_load_lds_dwordx4 v[4:5], off offset:64
  v_mfma_f32_16x16x32_bf16 v[88:91], a[72:75], a[16:19], v[88:91]
  s_add_u32 m0, s98, 81792
  v_mfma_f32_16x16x32_bf16 v[88:91], a[76:79], a[20:23], v[88:91]
  global_load_lds_dwordx4 v[4:5], off offset:128
  v_mfma_f32_16x16x32_bf16 v[92:95], a[76:79], a[28:31], v[92:95]
  v_mfma_f32_16x16x32_bf16 v[92:95], a[72:75], a[24:27], v[92:95]
  s_waitcnt lgkmcnt(6)
  ds_read_b64_tr_b16 a[64:65], v15 offset:24576
  ds_read_b64_tr_b16 a[66:67], v15 offset:24832
  v_mfma_f32_16x16x32_bf16 v[96:99], a[80:83], a[0:3], v[96:99]
  s_waitcnt lgkmcnt(6)
  ds_read_b64_tr_b16 a[68:69], v15 offset:28672
  ds_read_b64_tr_b16 a[70:71], v15 offset:28928
  v_mfma_f32_16x16x32_bf16 v[96:99], a[84:87], a[4:7], v[96:99]
  v_lshl_add_u64 v[4:5], v[4:5], 0, s[56:57]
  s_xor_b32 m0, s49, 0
  v_mfma_f32_16x16x32_bf16 v[100:103], a[84:87], a[12:15], v[100:103]
  buffer_load_dwordx4 v2, s[8:11], s44 offen lds
  v_mfma_f32_16x16x32_bf16 v[100:103], a[80:83], a[8:11], v[100:103]
  v_mfma_f32_16x16x32_bf16 v[104:107], a[80:83], a[16:19], v[104:107]
  s_xor_b32 m0, s49, 2048
  v_mfma_f32_16x16x32_bf16 v[104:107], a[84:87], a[20:23], v[104:107]
  v_mfma_f32_16x16x32_bf16 v[108:111], a[84:87], a[28:31], v[108:111]
  buffer_load_dwordx4 v2, s[8:11], s45 offen lds
  v_mfma_f32_16x16x32_bf16 v[108:111], a[80:83], a[24:27], v[108:111]
  s_waitcnt lgkmcnt(6)
  ds_read_b64_tr_b16 a[72:73], v16 offset:24576
  ds_read_b64_tr_b16 a[74:75], v16 offset:24832
  v_mfma_f32_16x16x32_bf16 v[112:115], a[88:91], a[0:3], v[112:115]
  s_waitcnt lgkmcnt(6)
  ds_read_b64_tr_b16 a[76:77], v16 offset:28672
  ds_read_b64_tr_b16 a[78:79], v16 offset:28928
  v_mfma_f32_16x16x32_bf16 v[112:115], a[92:95], a[4:7], v[112:115]
  s_xor_b32 m0, s49, 4096
  v_mfma_f32_16x16x32_bf16 v[116:119], a[92:95], a[12:15], v[116:119]
  v_mfma_f32_16x16x32_bf16 v[116:119], a[88:91], a[8:11], v[116:119]
  buffer_load_dwordx4 v2, s[8:11], s46 offen lds
  v_mfma_f32_16x16x32_bf16 v[120:123], a[88:91], a[16:19], v[120:123]
  v_mfma_f32_16x16x32_bf16 v[120:123], a[92:95], a[20:23], v[120:123]
  v_mfma_f32_16x16x32_bf16 v[124:127], a[92:95], a[28:31], v[124:127]
  v_mfma_f32_16x16x32_bf16 v[124:127], a[88:91], a[24:27], v[124:127]
  s_waitcnt lgkmcnt(6)
  ds_read_b64_tr_b16 a[80:81], v17 offset:24576
  ds_read_b64_tr_b16 a[82:83], v17 offset:24832
  v_mfma_f32_16x16x32_bf16 v[128:131], a[64:67], a[0:3], v[128:131]
  s_waitcnt lgkmcnt(6)
  ds_read_b64_tr_b16 a[84:85], v17 offset:28672
  ds_read_b64_tr_b16 a[86:87], v17 offset:28928
  v_mfma_f32_16x16x32_bf16 v[128:131], a[68:71], a[4:7], v[128:131]
  s_xor_b32 m0, s49, 6144
  v_mfma_f32_16x16x32_bf16 v[132:135], a[68:71], a[12:15], v[132:135]
  buffer_load_dwordx4 v2, s[8:11], s47 offen lds
  v_mfma_f32_16x16x32_bf16 v[132:135], a[64:67], a[8:11], v[132:135]
  v_mfma_f32_16x16x32_bf16 v[136:139], a[64:67], a[16:19], v[136:139]
  v_lshl_add_u32 v2, s51, 6, v2
  s_add_u32 m0, s99, 65536
  v_mfma_f32_16x16x32_bf16 v[136:139], a[68:71], a[20:23], v[136:139]
  v_mfma_f32_16x16x32_bf16 v[140:143], a[68:71], a[28:31], v[140:143]
  global_load_lds_dwordx4 v[6:7], off offset:0
  v_mfma_f32_16x16x32_bf16 v[140:143], a[64:67], a[24:27], v[140:143]
  s_waitcnt lgkmcnt(6)
  ds_read_b64_tr_b16 a[88:89], v18 offset:24576
  ds_read_b64_tr_b16 a[90:91], v18 offset:24832
  v_mfma_f32_16x16x32_bf16 v[144:147], a[72:75], a[0:3], v[144:147]
  s_waitcnt lgkmcnt(6)
  ds_read_b64_tr_b16 a[92:93], v18 offset:28672
  ds_read_b64_tr_b16 a[94:95], v18 offset:28928
  v_mfma_f32_16x16x32_bf16 v[144:147], a[76:79], a[4:7], v[144:147]
  s_add_u32 m0, s99, 73664
  v_mfma_f32_16x16x32_bf16 v[148:151], a[76:79], a[12:15], v[148:151]
  v_mfma_f32_16x16x32_bf16 v[148:151], a[72:75], a[8:11], v[148:151]
  global_load_lds_dwordx4 v[6:7], off offset:64
  v_mfma_f32_16x16x32_bf16 v[152:155], a[72:75], a[16:19], v[152:155]
  v_mfma_f32_16x16x32_bf16 v[152:155], a[76:79], a[20:23], v[152:155]
  v_mfma_f32_16x16x32_bf16 v[156:159], a[76:79], a[28:31], v[156:159]
  s_add_u32 m0, s99, 81792
  v_mfma_f32_16x16x32_bf16 v[156:159], a[72:75], a[24:27], v[156:159]
  s_waitcnt lgkmcnt(6)
  ds_read_b64_tr_b16 a[64:65], v14 offset:24576
  ds_read_b64_tr_b16 a[66:67], v14 offset:24832
  v_mfma_f32_16x16x32_bf16 v[160:163], a[80:83], a[0:3], v[160:163]
  s_waitcnt lgkmcnt(6)
  ds_read_b64_tr_b16 a[68:69], v14 offset:28672
  ds_read_b64_tr_b16 a[70:71], v14 offset:28928
  v_mfma_f32_16x16x32_bf16 v[160:163], a[84:87], a[4:7], v[160:163]
  global_load_lds_dwordx4 v[6:7], off offset:128
  v_mfma_f32_16x16x32_bf16 v[164:167], a[84:87], a[12:15], v[164:167]
  s_waitcnt vmcnt(13)
  ds_read_b128 a[32:35], v8 offset:32768
  v_mfma_f32_16x16x32_bf16 v[164:167], a[80:83], a[8:11], v[164:167]
  ds_read_b128 a[36:39], v9 offset:32768
  v_mfma_f32_16x16x32_bf16 v[168:171], a[80:83], a[16:19], v[168:171]
  ds_read_b128 a[40:43], v8 offset:34816
  v_lshl_add_u64 v[6:7], v[6:7], 0, s[56:57]
  v_mfma_f32_16x16x32_bf16 v[168:171], a[84:87], a[20:23], v[168:171]
  s_xor_b32 m0, s49, 1024
  ds_read_b128 a[44:47], v9 offset:34816
  v_mfma_f32_16x16x32_bf16 v[172:175], a[84:87], a[28:31], v[172:175]
  buffer_load_dwordx4 v3, s[8:11], s44 offen lds
  v_mfma_f32_16x16x32_bf16 v[172:175], a[80:83], a[24:27], v[172:175]
  s_waitcnt lgkmcnt(10)
  ds_read_b64_tr_b16 a[72:73], v19 offset:24576
  ds_read_b64_tr_b16 a[74:75], v19 offset:24832
  v_mfma_f32_16x16x32_bf16 v[176:179], a[88:91], a[0:3], v[176:179]
  s_waitcnt lgkmcnt(10)
  ds_read_b64_tr_b16 a[76:77], v19 offset:28672
  ds_read_b64_tr_b16 a[78:79], v19 offset:28928
  v_mfma_f32_16x16x32_bf16 v[176:179], a[92:95], a[4:7], v[176:179]
  s_xor_b32 m0, s49, 3072
  v_mfma_f32_16x16x32_bf16 v[180:183], a[92:95], a[12:15], v[180:183]
  ds_read_b128 a[48:51], v8 offset:36864
  v_mfma_f32_16x16x32_bf16 v[180:183], a[88:91], a[8:11], v[180:183]
  ds_read_b128 a[52:55], v9 offset:36864
  v_mfma_f32_16x16x32_bf16 v[184:187], a[88:91], a[16:19], v[184:187]
L_hop_q1:
  s_cbranch_execz L_retq1
  ds_read_b128 a[56:59], v8 offset:38912
  v_mfma_f32_16x16x32_bf16 v[184:187], a[92:95], a[20:23], v[184:187]
  ds_read_b128 a[60:63], v9 offset:38912
  v_mfma_f32_16x16x32_bf16 v[188:191], a[92:95], a[28:31], v[188:191]
  buffer_load_dwordx4 v3, s[8:11], s45 offen lds
  v_mfma_f32_16x16x32_bf16 v[188:191], a[88:91], a[24:27], v[188:191]
  s_waitcnt lgkmcnt(14)
  s_xor_b32 m0, s49, 5120
  v_mfma_f32_16x16x32_bf16 v[192:195], a[64:67], a[0:3], v[192:195]
  s_waitcnt lgkmcnt(12)
  buffer_load_dwordx4 v3, s[8:11], s46 offen lds
  v_mfma_f32_16x16x32_bf16 v[192:195], a[68:71], a[4:7], v[192:195]
  s_waitcnt lgkmcnt(0)
  s_barrier
  ds_read_b64_tr_b16 a[80:81], v10 offset:49152
  v_mfma_f32_16x16x32_bf16 v[196:199], a[68:71], a[12:15], v[196:199]
  s_waitcnt vmcnt(13)
  ds_read_b64_tr_b16 a[82:83], v10 offset:49408
  v_xor_b32 v39, s61, v43
  v_mfma_f32_16x16x32_bf16 v[196:199], a[64:67], a[8:11], v[196:199]
  ds_read_b64_tr_b16 a[84:85], v10 offset:53248
  v_bitop3_b32 v39, v47, s61, v39 bitop3:0xbe
  v_mfma_f32_16x16x32_bf16 v[200:203], a[64:67], a[16:19], v[200:203]
  s_xor_b32 m0, s49, 7168
  ds_read_b64_tr_b16 a[86:87], v10 offset:53504
  v_bitop3_b32 v39, v49, s61, v39 bitop3:0xbe
  v_mfma_f32_16x16x32_bf16 v[200:203], a[68:71], a[20:23], v[200:203]
  v_cmp_ne_u32 vcc, 0, v39
  v_mfma_f32_16x16x32_bf16 v[204:207], a[68:71], a[28:31], v[204:207]
  buffer_load_dwordx4 v3, s[8:11], s47 offen lds
  v_mfma_f32_16x16x32_bf16 v[204:207], a[64:67], a[24:27], v[204:207]
  s_waitcnt lgkmcnt(4)
  ds_read_b64_tr_b16 a[88:89], v11 offset:49152
  ds_read_b64_tr_b16 a[90:91], v11 offset:49408
  v_mfma_f32_16x16x32_bf16 v[208:211], a[72:75], a[0:3], v[208:211]
  s_waitcnt lgkmcnt(6)
  ds_read_b64_tr_b16 a[92:93], v11 offset:53248
  ds_read_b64_tr_b16 a[94:95], v11 offset:53504
  v_mfma_f32_16x16x32_bf16 v[208:211], a[76:79], a[4:7], v[208:211]
  s_cbranch_vccnz L_slow_83
L_back_84:
  v_lshl_add_u32 v3, s51, 6, v3
  v_add_f32 v40, v40, v44
  v_mfma_f32_16x16x32_bf16 v[212:215], a[76:79], a[12:15], v[212:215]
  s_cmp_eq_u32 s50, 2
  s_cselect_b64 s[56:57], s[54:55], s[52:53]
  s_cselect_b32 s51, -18, 2
  v_mfma_f32_16x16x32_bf16 v[212:215], a[72:75], a[8:11], v[212:215]
  s_add_u32 m0, s98, 90112
  v_add_f32 v42, v42, v46
  v_add_f32 v41, v41, v45
  v_mfma_f32_16x16x32_bf16 v[216:219], a[72:75], a[16:19], v[216:219]
  global_load_lds_dwordx4 v[4:5], off offset:0
  v_mfma_f32_16x16x32_bf16 v[216:219], a[76:79], a[20:23], v[216:219]
  v_lshlrev_b32 v49, 16, v48
  v_and_b32 v48, 0xffff0000, v48
  v_mfma_f32_16x16x32_bf16 v[220:223], a[76:79], a[28:31], v[220:223]
  s_add_u32 m0, s98, 98240
  v_permlane32_swap_b32 v40, v42
  v_permlane32_swap_b32 v41, v43
  v_mfma_f32_16x16x32_bf16 v[220:223], a[72:75], a[24:27], v[220:223]
  s_waitcnt lgkmcnt(6)
  ds_read_b64_tr_b16 a[64:65], v12 offset:49152
  ds_read_b64_tr_b16 a[66:67], v12 offset:49408
  v_mfma_f32_16x16x32_bf16 v[64:67], a[80:83], a[32:35], v[64:67]
  s_waitcnt lgkmcnt(6)
  ds_read_b64_tr_b16 a[68:69], v12 offset:53248
  ds_read_b64_tr_b16 a[70:71], v12 offset:53504
  v_mfma_f32_16x16x32_bf16 v[64:67], a[84:87], a[36:39], v[64:67]
  global_load_lds_dwordx4 v[4:5], off offset:64
  v_mfma_f32_16x16x32_bf16 v[68:71], a[84:87], a[44:47], v[68:71]
  v_rcp_f32 v50, v49
  v_mfma_f32_16x16x32_bf16 v[68:71], a[80:83], a[40:43], v[68:71]
  v_add_f32 v40, v40, v42
  v_add_f32 v41, v41, v43
  v_mfma_f32_16x16x32_bf16 v[72:75], a[80:83], a[48:51], v[72:75]
  s_add_u32 m0, s98, 106368
  v_mov_b32 v51, v50
  v_mul_f32 v50, 0x3fb8aa3b, v50
  v_mfma_f32_16x16x32_bf16 v[72:75], a[84:87], a[52:55], v[72:75]
  v_permlane16_swap_b32 v40, v41
  v_mfma_f32_16x16x32_bf16 v[76:79], a[84:87], a[60:63], v[76:79]
  global_load_lds_dwordx4 v[4:5], off offset:128
  v_mfma_f32_16x16x32_bf16 v[76:79], a[80:83], a[56:59], v[76:79]
  s_waitcnt lgkmcnt(6)
  ds_read_b64_tr_b16 a[72:73], v13 offset:49152
  ds_read_b64_tr_b16 a[74:75], v13 offset:49408
  v_mfma_f32_16x16x32_bf16 v[80:83], a[88:91], a[32:35], v[80:83]
  s_waitcnt lgkmcnt(6)
  ds_read_b64_tr_b16 a[76:77], v13 offset:53248
  ds_read_b64_tr_b16 a[78:79], v13 offset:53504
  v_mfma_f32_16x16x32_bf16 v[80:83], a[92:95], a[36:39], v[80:83]
  v_lshl_add_u64 v[4:5], v[4:5], 0, s[56:57]
  s_xor_b32 m0, s49, 32768
  v_mfma_f32_16x16x32_bf16 v[84:87], a[92:95], a[44:47], v[84:87]
  v_add_f32 v40, v40, v41
  v_mfma_f32_16x16x32_bf16 v[84:87], a[88:91], a[40:43], v[84:87]
  buffer_load_dwordx4 v2, s[8:11], s44 offen lds
  v_mfma_f32_16x16x32_bf16 v[88:91], a[88:91], a[48:51], v[88:91]
  ds_write_b32 v61, v40
  v_mfma_f32_16x16x32_bf16 v[88:91], a[92:95], a[52:55], v[88:91]
  ds_write_b32 v56, v48
  v_mfma_f32_16x16x32_bf16 v[92:95], a[92:95], a[60:63], v[92:95]
  s_xor_b32 m0, s49, 34816
  ds_write_b32 v56, v50 offset:256
  v_mfma_f32_16x16x32_bf16 v[92:95], a[88:91], a[56:59], v[92:95]
  s_waitcnt lgkmcnt(9)
  ds_read_b64_tr_b16 a[80:81], v15 offset:49152
  ds_read_b64_tr_b16 a[82:83], v15 offset:49408
  v_mfma_f32_16x16x32_bf16 v[96:99], a[64:67], a[32:35], v[96:99]
  s_waitcnt lgkmcnt(9)
  ds_read_b64_tr_b16 a[84:85], v15 offset:53248
  ds_read_b64_tr_b16 a[86:87], v15 offset:53504
  v_mfma_f32_16x16x32_bf16 v[96:99], a[68:71], a[36:39], v[96:99]
  buffer_load_dwordx4 v2, s[8:11], s45 offen lds
  v_mfma_f32_16x16x32_bf16 v[100:103], a[68:71], a[44:47], v[100:103]
  ds_write_b32 v56, v51 offset:512
  v_mfma_f32_16x16x32_bf16 v[100:103], a[64:67], a[40:43], v[100:103]
  s_xor_b32 m0, s49, 36864
  ds_read_b32 v52, v57 offset:0
  ds_read2_b32 v[20:21], v57 offset0:64 offset1:128
  v_mfma_f32_16x16x32_bf16 v[104:107], a[64:67], a[48:51], v[104:107]
  ds_read_b32 v53, v57 offset:64
  v_mfma_f32_16x16x32_bf16 v[104:107], a[68:71], a[52:55], v[104:107]
  buffer_load_dwordx4 v2, s[8:11], s46 offen lds
  v_mfma_f32_16x16x32_bf16 v[108:111], a[68:71], a[60:63], v[108:111]
  ds_read2_b32 v[22:23], v57 offset0:80 offset1:144
  v_mfma_f32_16x16x32_bf16 v[108:111], a[64:67], a[56:59], v[108:111]
  s_waitcnt lgkmcnt(14)
  ds_read_b64_tr_b16 a[88:89], v16 offset:49152
  ds_read_b64_tr_b16 a[90:91], v16 offset:49408
  v_mfma_f32_16x16x32_bf16 v[112:115], a[72:75], a[32:35], v[112:115]
  s_waitcnt lgkmcnt(14)
  ds_read_b64_tr_b16 a[92:93], v16 offset:53248
  ds_read_b64_tr_b16 a[94:95], v16 offset:53504
  v_mfma_f32_16x16x32_bf16 v[112:115], a[76:79], a[36:39], v[112:115]
  s_xor_b32 m0, s49, 38912
  ds_read_b32 v54, v57 offset:128
  ds_read2_b32 v[24:25], v57 offset0:96 offset1:160
  v_mfma_f32_16x16x32_bf16 v[116:119], a[76:79], a[44:47], v[116:119]
  ds_read_b32 v55, v57 offset:192
  v_mfma_f32_16x16x32_bf16 v[116:119], a[72:75], a[40:43], v[116:119]
  buffer_load_dwordx4 v2, s[8:11], s47 offen lds
  v_mfma_f32_16x16x32_bf16 v[120:123], a[72:75], a[48:51], v[120:123]
  ds_read2_b32 v[26:27], v57 offset0:112 offset1:176
  v_mfma_f32_16x16x32_bf16 v[120:123], a[76:79], a[52:55], v[120:123]
  s_waitcnt lgkmcnt(15)
  s_barrier
  ds_read_b128 v[28:31], v36 offset:8192
  v_mfma_f32_16x16x32_bf16 v[124:127], a[76:79], a[60:63], v[124:127]
  v_lshl_add_u32 v2, s51, 6, v2
  s_add_u32 m0, s99, 90112
  v_mfma_f32_16x16x32_bf16 v[124:127], a[72:75], a[56:59], v[124:127]
  s_waitcnt lgkmcnt(15)
  ds_read_b64_tr_b16 a[64:65], v17 offset:49152
  ds_read_b64_tr_b16 a[66:67], v17 offset:49408
  v_mfma_f32_16x16x32_bf16 v[128:131], a[80:83], a[32:35], v[128:131]
  s_waitcnt lgkmcnt(15)
  ds_read_b64_tr_b16 a[68:69], v17 offset:53248
  ds_read_b64_tr_b16 a[70:71], v17 offset:53504
  v_mfma_f32_16x16x32_bf16 v[128:131], a[84:87], a[36:39], v[128:131]
  global_load_lds_dwordx4 v[6:7], off offset:0
  v_mfma_f32_16x16x32_bf16 v[132:135], a[84:87], a[44:47], v[132:135]
  v_mfma_f32_16x16x32_bf16 v[132:135], a[80:83], a[40:43], v[132:135]
  s_add_u32 m0, s99, 98240
  ds_read_b128 v[32:35], v36 offset:8272
  s_waitcnt lgkmcnt(5)
  v_mfma_f32_16x16x32_bf16 v[136:139], a[80:83], a[48:51], v[136:139]
  v_fmac_f32 v64, v52, v28
  v_fmac_f32 v65, v52, v29
  v_mfma_f32_16x16x32_bf16 v[136:139], a[84:87], a[52:55], v[136:139]
  global_load_lds_dwordx4 v[6:7], off offset:64
  v_mfma_f32_16x16x32_bf16 v[140:143], a[84:87], a[60:63], v[140:143]
  v_fmac_f32 v66, v52, v30
  v_fmac_f32 v67, v52, v31
  v_mfma_f32_16x16x32_bf16 v[140:143], a[80:83], a[56:59], v[140:143]
  s_waitcnt lgkmcnt(5)
  ds_read_b64_tr_b16 a[72:73], v18 offset:49152
  ds_read_b64_tr_b16 a[74:75], v18 offset:49408
  v_mfma_f32_16x16x32_bf16 v[144:147], a[88:91], a[32:35], v[144:147]
  s_waitcnt lgkmcnt(7)
  ds_read_b64_tr_b16 a[76:77], v18 offset:53248
  ds_read_b64_tr_b16 a[78:79], v18 offset:53504
  v_mfma_f32_16x16x32_bf16 v[144:147], a[92:95], a[36:39], v[144:147]
  s_add_u32 m0, s99, 106368
  v_fmac_f32 v68, v53, v28
  v_fmac_f32 v69, v53, v29
  v_mfma_f32_16x16x32_bf16 v[148:151], a[92:95], a[44:47], v[148:151]
  v_fmac_f32 v70, v53, v30
  v_fmac_f32 v71, v53, v31
  v_mfma_f32_16x16x32_bf16 v[148:151], a[88:91], a[40:43], v[148:151]
  global_load_lds_dwordx4 v[6:7], off offset:128
  v_mfma_f32_16x16x32_bf16 v[152:155], a[88:91], a[48:51], v[152:155]
  v_fmac_f32 v72, v54, v28
  v_fmac_f32 v73, v54, v29
  v_mfma_f32_16x16x32_bf16 v[152:155], a[92:95], a[52:55], v[152:155]
  v_fmac_f32 v74, v54, v30
  v_fmac_f32 v75, v54, v31
  v_mfma_f32_16x16x32_bf16 v[156:159], a[92:95], a[60:63], v[156:159]
  v_lshl_add_u64 v[6:7], v[6:7], 0, s[56:57]
  s_xor_b32 m0, s49, 33792
  v_mfma_f32_16x16x32_bf16 v[156:159], a[88:91], a[56:59], v[156:159]
  s_waitcnt lgkmcnt(7)
  ds_read_b64_tr_b16 a[80:81], v14 offset:49152
  ds_read_b64_tr_b16 a[82:83], v14 offset:49408
  v_mfma_f32_16x16x32_bf16 v[160:163], a[64:67], a[32:35], v[160:163]
  s_waitcnt lgkmcnt(7)
  ds_read_b64_tr_b16 a[84:85], v14 offset:53248
  ds_read_b64_tr_b16 a[86:87], v14 offset:53504
  v_mfma_f32_16x16x32_bf16 v[160:163], a[68:71], a[36:39], v[160:163]
  buffer_load_dwordx4 v3, s[8:11], s44 offen lds
  v_mfma_f32_16x16x32_bf16 v[164:167], a[68:71], a[44:47], v[164:167]
  s_waitcnt vmcnt(11)
  ds_read_b128 a[0:3], v8 offset:0
  v_fmac_f32 v76, v55, v28
  v_mfma_f32_16x16x32_bf16 v[164:167], a[64:67], a[40:43], v[164:167]
  s_xor_b32 m0, s49, 35840
  ds_read_b128 a[4:7], v9 offset:0
  v_fmac_f32 v77, v55, v29
  v_mfma_f32_16x16x32_bf16 v[168:171], a[64:67], a[48:51], v[168:171]
  ds_read_b128 a[8:11], v8 offset:2048
  v_fmac_f32 v78, v55, v30
  v_mfma_f32_16x16x32_bf16 v[168:171], a[68:71], a[52:55], v[168:171]
  ds_read_b128 a[12:15], v9 offset:2048
  v_fmac_f32 v79, v55, v31
  v_mfma_f32_16x16x32_bf16 v[172:175], a[68:71], a[60:63], v[172:175]
  buffer_load_dwordx4 v3, s[8:11], s45 offen lds
  v_mfma_f32_16x16x32_bf16 v[172:175], a[64:67], a[56:59], v[172:175]
  s_waitcnt lgkmcnt(10)
  ds_read_b64_tr_b16 a[88:89], v19 offset:49152
  ds_read_b64_tr_b16 a[90:91], v19 offset:49408
  v_mfma_f32_16x16x32_bf16 v[176:179], a[72:75], a[32:35], v[176:179]
  s_waitcnt lgkmcnt(10)
  ds_read_b64_tr_b16 a[92:93], v19 offset:53248
  ds_read_b64_tr_b16 a[94:95], v19 offset:53504
  v_mfma_f32_16x16x32_bf16 v[176:179], a[76:79], a[36:39], v[176:179]
  s_xor_b32 m0, s49, 37888
  ds_read_b128 v[28:31], v36 offset:8432
  v_fmac_f32 v80, v52, v32
  v_mfma_f32_16x16x32_bf16 v[180:183], a[76:79], a[44:47], v[180:183]
  ds_read_b128 a[16:19], v8 offset:4096
  v_fmac_f32 v81, v52, v33
  v_mfma_f32_16x16x32_bf16 v[180:183], a[72:75], a[40:43], v[180:183]
  ds_read_b128 a[20:23], v9 offset:4096
  v_fmac_f32 v82, v52, v34
  v_mfma_f32_16x16x32_bf16 v[184:187], a[72:75], a[48:51], v[184:187]
  ds_read_b128 a[24:27], v8 offset:6144
  v_fmac_f32 v83, v52, v35
  v_mfma_f32_16x16x32_bf16 v[184:187], a[76:79], a[52:55], v[184:187]
  ds_read_b128 a[28:31], v9 offset:6144
  v_fmac_f32 v84, v53, v32
  v_mfma_f32_16x16x32_bf16 v[188:191], a[76:79], a[60:63], v[188:191]
  buffer_load_dwordx4 v3, s[8:11], s46 offen lds
  v_mfma_f32_16x16x32_bf16 v[188:191], a[72:75], a[56:59], v[188:191]
  s_waitcnt lgkmcnt(15)
  s_xor_b32 m0, s49, 39936
  v_fmac_f32 v85, v53, v33
  v_mfma_f32_16x16x32_bf16 v[192:195], a[80:83], a[32:35], v[192:195]
  s_waitcnt lgkmcnt(13)
  buffer_load_dwordx4 v3, s[8:11], s47 offen lds
  v_mfma_f32_16x16x32_bf16 v[192:195], a[84:87], a[36:39], v[192:195]
  s_waitcnt lgkmcnt(0)
  s_barrier
  ds_read_b64_tr_b16 a[64:65], v10 offset:0
  v_mfma_f32_16x16x32_bf16 v[196:199], a[84:87], a[44:47], v[196:199]
  ds_read_b64_tr_b16 a[66:67], v10 offset:256
  v_fmac_f32 v86, v53, v34
  v_mfma_f32_16x16x32_bf16 v[196:199], a[80:83], a[40:43], v[196:199]
  ds_read_b64_tr_b16 a[68:69], v10 offset:4096
  v_lshl_add_u32 v3, s51, 6, v3
  v_mfma_f32_16x16x32_bf16 v[200:203], a[80:83], a[48:51], v[200:203]
  s_cmp_eq_u32 s50, 1
  s_cselect_b64 s[56:57], s[54:55], s[52:53]
  s_cselect_b32 s51, -18, 2
  ds_read_b64_tr_b16 a[70:71], v10 offset:4352
  v_mfma_f32_16x16x32_bf16 v[200:203], a[84:87], a[52:55], v[200:203]
  s_add_u32 m0, s98, 114688
  v_fmac_f32 v87, v53, v35
  v_fmac_f32 v88, v54, v32
  v_mfma_f32_16x16x32_bf16 v[204:207], a[84:87], a[60:63], v[204:207]
  global_load_lds_dwordx4 v[4:5], off offset:0
  v_mfma_f32_16x16x32_bf16 v[204:207], a[80:83], a[56:59], v[204:207]
  s_waitcnt lgkmcnt(4)
  ds_read_b64_tr_b16 a[72:73], v11 offset:0
  ds_read_b64_tr_b16 a[74:75], v11 offset:256
  v_mfma_f32_16x16x32_bf16 v[208:211], a[88:91], a[32:35], v[208:211]
  s_waitcnt lgkmcnt(6)
  ds_read_b64_tr_b16 a[76:77], v11 offset:4096
  ds_read_b64_tr_b16 a[78:79], v11 offset:4352
  v_mfma_f32_16x16x32_bf16 v[208:211], a[92:95], a[36:39], v[208:211]
  s_add_u32 m0, s98, 122816
  v_fmac_f32 v89, v54, v33
  v_fmac_f32 v90, v54, v34
  v_mfma_f32_16x16x32_bf16 v[212:215], a[92:95], a[44:47], v[212:215]
  v_fmac_f32 v91, v54, v35
  v_fmac_f32 v92, v55, v32
  v_fmac_f32 v93, v55, v33
  v_fmac_f32 v94, v55, v34
  v_fmac_f32 v95, v55, v35
  v_mfma_f32_16x16x32_bf16 v[212:215], a[88:91], a[40:43], v[212:215]
  global_load_lds_dwordx4 v[4:5], off offset:64
  v_mfma_f32_16x16x32_bf16 v[216:219], a[88:91], a[48:51], v[216:219]
  ds_read_b128 v[32:35], v36 offset:8720
  v_fmac_f32 v112, v52, v28
  v_mfma_f32_16x16x32_bf16 v[216:219], a[92:95], a[52:55], v[216:219]
  v_fmac_f32 v113, v52, v29
  v_fmac_f32 v114, v52, v30
  v_mfma_f32_16x16x32_bf16 v[220:223], a[92:95], a[60:63], v[220:223]
  s_add_u32 m0, s98, 130944
  v_fmac_f32 v115, v52, v31
  v_fmac_f32 v116, v53, v28
  v_mfma_f32_16x16x32_bf16 v[220:223], a[88:91], a[56:59], v[220:223]
  s_waitcnt lgkmcnt(7)
  ds_read_b64_tr_b16 a[80:81], v12 offset:0
  ds_read_b64_tr_b16 a[82:83], v12 offset:256
  v_mfma_f32_16x16x32_bf16 v[64:67], a[64:67], a[0:3], v[64:67]
  s_waitcnt lgkmcnt(7)
  ds_read_b64_tr_b16 a[84:85], v12 offset:4096
  ds_read_b64_tr_b16 a[86:87], v12 offset:4352
  v_mfma_f32_16x16x32_bf16 v[64:67], a[68:71], a[4:7], v[64:67]
  global_load_lds_dwordx4 v[4:5], off offset:128
  v_mfma_f32_16x16x32_bf16 v[68:71], a[68:71], a[12:15], v[68:71]
  v_fmac_f32 v117, v53, v29
  v_fmac_f32 v118, v53, v30
  v_mfma_f32_16x16x32_bf16 v[68:71], a[64:67], a[8:11], v[68:71]
  v_lshl_add_u64 v[4:5], v[4:5], 0, s[56:57]
  s_xor_b32 m0, s49, 0
  v_mfma_f32_16x16x32_bf16 v[72:75], a[64:67], a[16:19], v[72:75]
  v_fmac_f32 v119, v53, v31
  v_fmac_f32 v120, v54, v28
  v_mfma_f32_16x16x32_bf16 v[72:75], a[68:71], a[20:23], v[72:75]
  buffer_load_dwordx4 v2, s[8:11], s44 offen lds
  v_mfma_f32_16x16x32_bf16 v[76:79], a[68:71], a[28:31], v[76:79]
  v_fmac_f32 v121, v54, v29
  v_fmac_f32 v122, v54, v30
  v_mfma_f32_16x16x32_bf16 v[76:79], a[64:67], a[24:27], v[76:79]
  s_waitcnt lgkmcnt(7)
  ds_read_b64_tr_b16 a[88:89], v13 offset:0
  ds_read_b64_tr_b16 a[90:91], v13 offset:256
  v_mfma_f32_16x16x32_bf16 v[80:83], a[72:75], a[0:3], v[80:83]
  s_waitcnt lgkmcnt(7)
  ds_read_b64_tr_b16 a[92:93], v13 offset:4096
  ds_read_b64_tr_b16 a[94:95], v13 offset:4352
  v_mfma_f32_16x16x32_bf16 v[80:83], a[76:79], a[4:7], v[80:83]
  s_xor_b32 m0, s49, 2048
  v_fmac_f32 v123, v54, v31
  v_fmac_f32 v124, v55, v28
  v_mfma_f32_16x16x32_bf16 v[84:87], a[76:79], a[12:15], v[84:87]
  buffer_load_dwordx4 v2, s[8:11], s45 offen lds
  v_mfma_f32_16x16x32_bf16 v[84:87], a[72:75], a[8:11], v[84:87]
  v_fmac_f32 v125, v55, v29
  v_fmac_f32 v126, v55, v30
  v_mfma_f32_16x16x32_bf16 v[88:91], a[72:75], a[16:19], v[88:91]
  v_fmac_f32 v127, v55, v31
  v_mfma_f32_16x16x32_bf16 v[88:91], a[76:79], a[20:23], v[88:91]
  v_mfma_f32_16x16x32_bf16 v[92:95], a[76:79], a[28:31], v[92:95]
  s_xor_b32 m0, s49, 4096
  v_mfma_f32_16x16x32_bf16 v[92:95], a[72:75], a[24:27], v[92:95]
  s_waitcnt lgkmcnt(6)
  ds_read_b64_tr_b16 a[64:65], v15 offset:0
  ds_read_b64_tr_b16 a[66:67], v15 offset:256
  v_mfma_f32_16x16x32_bf16 v[96:99], a[80:83], a[0:3], v[96:99]
  s_waitcnt lgkmcnt(6)
  ds_read_b64_tr_b16 a[68:69], v15 offset:4096
  ds_read_b64_tr_b16 a[70:71], v15 offset:4352
  v_mfma_f32_16x16x32_bf16 v[96:99], a[84:87], a[4:7], v[96:99]
  buffer_load_dwordx4 v2, s[8:11], s46 offen lds
  v_mfma_f32_16x16x32_bf16 v[100:103], a[84:87], a[12:15], v[100:103]
  ds_read_b128 v[28:31], v37 offset:8256
  v_fmac_f32 v144, v52, v32
  v_mfma_f32_16x16x32_bf16 v[100:103], a[80:83], a[8:11], v[100:103]
  s_xor_b32 m0, s49, 6144
  v_fmac_f32 v145, v52, v33
  v_fmac_f32 v146, v52, v34
  v_mfma_f32_16x16x32_bf16 v[104:107], a[80:83], a[16:19], v[104:107]
  v_fmac_f32 v147, v52, v35
  v_fmac_f32 v148, v53, v32
  v_mfma_f32_16x16x32_bf16 v[104:107], a[84:87], a[20:23], v[104:107]
  buffer_load_dwordx4 v2, s[8:11], s47 offen lds
  v_mfma_f32_16x16x32_bf16 v[108:111], a[84:87], a[28:31], v[108:111]
  v_fmac_f32 v149, v53, v33
  v_fmac_f32 v150, v53, v34
  v_mfma_f32_16x16x32_bf16 v[108:111], a[80:83], a[24:27], v[108:111]
  s_waitcnt lgkmcnt(7)
  ds_read_b64_tr_b16 a[72:73], v16 offset:0
  ds_read_b64_tr_b16 a[74:75], v16 offset:256
  v_mfma_f32_16x16x32_bf16 v[112:115], a[88:91], a[0:3], v[112:115]
  s_waitcnt lgkmcnt(7)
  ds_read_b64_tr_b16 a[76:77], v16 offset:4096
  ds_read_b64_tr_b16 a[78:79], v16 offset:4352
  v_mfma_f32_16x16x32_bf16 v[112:115], a[92:95], a[4:7], v[112:115]
  v_lshl_add_u32 v2, s51, 6, v2
  s_add_u32 m0, s99, 114688
  v_mfma_f32_16x16x32_bf16 v[116:119], a[92:95], a[12:15], v[116:119]
  global_load_lds_dwordx4 v[6:7], off offset:0
  v_mfma_f32_16x16x32_bf16 v[116:119], a[88:91], a[8:11], v[116:119]
  v_fmac_f32 v151, v53, v35
  v_fmac_f32 v152, v54, v32
  v_mfma_f32_16x16x32_bf16 v[120:123], a[88:91], a[16:19], v[120:123]
  v_fmac_f32 v153, v54, v33
  v_fmac_f32 v154, v54, v34
  v_mfma_f32_16x16x32_bf16 v[120:123], a[92:95], a[20:23], v[120:123]
  v_fmac_f32 v155, v54, v35
  v_fmac_f32 v156, v55, v32
  v_mfma_f32_16x16x32_bf16 v[124:127], a[92:95], a[28:31], v[124:127]
  s_add_u32 m0, s99, 122816
  v_fmac_f32 v157, v55, v33
  v_fmac_f32 v158, v55, v34
  v_mfma_f32_16x16x32_bf16 v[124:127], a[88:91], a[24:27], v[124:127]
  s_waitcnt lgkmcnt(7)
  ds_read_b64_tr_b16 a[80:81], v17 offset:0
  ds_read_b64_tr_b16 a[82:83], v17 offset:256
  v_mfma_f32_16x16x32_bf16 v[128:131], a[64:67], a[0:3], v[128:131]
  s_waitcnt lgkmcnt(7)
  ds_read_b64_tr_b16 a[84:85], v17 offset:4096
  ds_read_b64_tr_b16 a[86:87], v17 offset:4352
  v_mfma_f32_16x16x32_bf16 v[128:131], a[68:71], a[4:7], v[128:131]
  global_load_lds_dwordx4 v[6:7], off offset:64
  v_mfma_f32_16x16x32_bf16 v[132:135], a[68:71], a[12:15], v[132:135]
  v_fmac_f32 v159, v55, v35
  v_lshrrev_b32 v38, 3, v0
  v_mfma_f32_16x16x32_bf16 v[132:135], a[64:67], a[8:11], v[132:135]
  s_add_u32 m0, s99, 130944
  ds_read_b128 v[32:35], v36 offset:8352
  v_bfe_u32 v39, v0, 2, 1
  v_mfma_f32_16x16x32_bf16 v[136:139], a[64:67], a[16:19], v[136:139]
  s_waitcnt lgkmcnt(9)
  v_mad_u32_u24 v38, v38, 32, v39
  v_add_lshl_u32 v38, v38, 30, 7
  v_mfma_f32_16x16x32_bf16 v[136:139], a[68:71], a[20:23], v[136:139]
  global_load_lds_dwordx4 v[6:7], off offset:128
  v_mfma_f32_16x16x32_bf16 v[140:143], a[68:71], a[28:31], v[140:143]
  s_mov_b32 s62, 22020096
  buffer_load_dword v39, v38, s[12:15], s62 offen sc1
  v_mfma_f32_16x16x32_bf16 v[140:143], a[64:67], a[24:27], v[140:143]
  s_waitcnt lgkmcnt(7)
  ds_read_b64_tr_b16 a[88:89], v18 offset:0
  ds_read_b64_tr_b16 a[90:91], v18 offset:256
  v_mfma_f32_16x16x32_bf16 v[144:147], a[72:75], a[0:3], v[144:147]
  s_waitcnt lgkmcnt(7)
  ds_read_b64_tr_b16 a[92:93], v18 offset:4096
  ds_read_b64_tr_b16 a[94:95], v18 offset:4352
  v_mfma_f32_16x16x32_bf16 v[144:147], a[76:79], a[4:7], v[144:147]
  v_lshl_add_u64 v[6:7], v[6:7], 0, s[56:57]
  s_xor_b32 m0, s49, 1024
  v_mfma_f32_16x16x32_bf16 v[148:151], a[76:79], a[12:15], v[148:151]
  buffer_load_dwordx4 v3, s[8:11], s44 offen lds
  v_mfma_f32_16x16x32_bf16 v[148:151], a[72:75], a[8:11], v[148:151]
  v_fmac_f32 v192, v52, v28
  v_fmac_f32 v193, v52, v29
  v_mfma_f32_16x16x32_bf16 v[152:155], a[72:75], a[16:19], v[152:155]
  v_fmac_f32 v194, v52, v30
  v_fmac_f32 v195, v52, v31
  v_mfma_f32_16x16x32_bf16 v[152:155], a[76:79], a[20:23], v[152:155]
  s_xor_b32 m0, s49, 3072
  v_fmac_f32 v196, v53, v28
  v_fmac_f32 v197, v53, v29
  v_mfma_f32_16x16x32_bf16 v[156:159], a[76:79], a[28:31], v[156:159]
  v_fmac_f32 v198, v53, v30
  v_fmac_f32 v199, v53, v31
  v_mfma_f32_16x16x32_bf16 v[156:159], a[72:75], a[24:27], v[156:159]
  s_waitcnt lgkmcnt(7)
  ds_read_b64_tr_b16 a[64:65], v14 offset:0
  ds_read_b64_tr_b16 a[66:67], v14 offset:256
  v_mfma_f32_16x16x32_bf16 v[160:163], a[80:83], a[0:3], v[160:163]
  s_waitcnt lgkmcnt(7)
  ds_read_b64_tr_b16 a[68:69], v14 offset:4096
  ds_read_b64_tr_b16 a[70:71], v14 offset:4352
  v_mfma_f32_16x16x32_bf16 v[160:163], a[84:87], a[4:7], v[160:163]
  buffer_load_dwordx4 v3, s[8:11], s45 offen lds
  v_mfma_f32_16x16x32_bf16 v[164:167], a[84:87], a[12:15], v[164:167]
  s_waitcnt vmcnt(13)
  ds_read_b128 a[32:35], v8 offset:32768
  v_fmac_f32 v200, v54, v28
  v_mfma_f32_16x16x32_bf16 v[164:167], a[80:83], a[8:11], v[164:167]
  s_xor_b32 m0, s49, 5120
  ds_read_b128 a[36:39], v9 offset:32768
  v_fmac_f32 v201, v54, v29
  v_mfma_f32_16x16x32_bf16 v[168:171], a[80:83], a[16:19], v[168:171]
  ds_read_b128 a[40:43], v8 offset:34816
  v_fmac_f32 v202, v54, v30
  v_mfma_f32_16x16x32_bf16 v[168:171], a[84:87], a[20:23], v[168:171]
  ds_read_b128 a[44:47], v9 offset:34816
  v_fmac_f32 v203, v54, v31
  v_mfma_f32_16x16x32_bf16 v[172:175], a[84:87], a[28:31], v[172:175]
  v_fmac_f32 v204, v55, v28
  v_fmac_f32 v205, v55, v29
  v_fmac_f32 v206, v55, v30
  v_fmac_f32 v207, v55, v31
  v_mfma_f32_16x16x32_bf16 v[172:175], a[80:83], a[24:27], v[172:175]
  s_waitcnt lgkmcnt(10)
  ds_read_b64_tr_b16 a[72:73], v19 offset:0
  ds_read_b64_tr_b16 a[74:75], v19 offset:256
  v_mfma_f32_16x16x32_bf16 v[176:179], a[88:91], a[0:3], v[176:179]
  s_waitcnt lgkmcnt(10)
  ds_read_b64_tr_b16 a[76:77], v19 offset:4096
  ds_read_b64_tr_b16 a[78:79], v19 offset:4352
  v_mfma_f32_16x16x32_bf16 v[176:179], a[92:95], a[4:7], v[176:179]
  buffer_load_dwordx4 v3, s[8:11], s46 offen lds
  v_mfma_f32_16x16x32_bf16 v[180:183], a[92:95], a[12:15], v[180:183]
  s_xor_b32 m0, s49, 7168
  ds_read_b128 a[48:51], v8 offset:36864
  ds_read_b128 v[28:31], v36 offset:8800
  v_mfma_f32_16x16x32_bf16 v[180:183], a[88:91], a[8:11], v[180:183]
  ds_read_b128 a[52:55], v9 offset:36864
  v_fmac_f32 v96, v52, v32
  v_mfma_f32_16x16x32_bf16 v[184:187], a[88:91], a[16:19], v[184:187]
  ds_read_b128 a[56:59], v8 offset:38912
  v_fmac_f32 v97, v52, v33
  v_mfma_f32_16x16x32_bf16 v[184:187], a[92:95], a[20:23], v[184:187]
  ds_read_b128 a[60:63], v9 offset:38912
  v_fmac_f32 v98, v52, v34
  v_mfma_f32_16x16x32_bf16 v[188:191], a[92:95], a[28:31], v[188:191]
  buffer_load_dwordx4 v3, s[8:11], s47 offen lds
  v_mfma_f32_16x16x32_bf16 v[188:191], a[88:91], a[24:27], v[188:191]
  s_waitcnt lgkmcnt(15)
  v_lshl_add_u32 v3, s51, 6, v3
  v_fmac_f32 v99, v52, v35
  v_mfma_f32_16x16x32_bf16 v[192:195], a[64:67], a[0:3], v[192:195]
  s_waitcnt lgkmcnt(13)
  s_add_u32 m0, s98, 65536
  v_fmac_f32 v100, v53, v32
  v_mfma_f32_16x16x32_bf16 v[192:195], a[68:71], a[4:7], v[192:195]
  s_waitcnt lgkmcnt(0)
  s_barrier
  ds_read_b64_tr_b16 a[80:81], v10 offset:24576
  v_mfma_f32_16x16x32_bf16 v[196:199], a[68:71], a[12:15], v[196:199]
  ds_read_b64_tr_b16 a[82:83], v10 offset:24832
  v_fmac_f32 v101, v53, v33
  v_mfma_f32_16x16x32_bf16 v[196:199], a[64:67], a[8:11], v[196:199]
  ds_read_b64_tr_b16 a[84:85], v10 offset:28672
  v_fmac_f32 v102, v53, v34
  v_mfma_f32_16x16x32_bf16 v[200:203], a[64:67], a[16:19], v[200:203]
  ds_read_b64_tr_b16 a[86:87], v10 offset:28928
  v_fmac_f32 v103, v53, v35
  v_mfma_f32_16x16x32_bf16 v[200:203], a[68:71], a[20:23], v[200:203]
  global_load_lds_dwordx4 v[4:5], off offset:0
  v_mfma_f32_16x16x32_bf16 v[204:207], a[68:71], a[28:31], v[204:207]
  s_add_u32 m0, s98, 73664
  v_fmac_f32 v104, v54, v32
  v_fmac_f32 v105, v54, v33
  v_mfma_f32_16x16x32_bf16 v[204:207], a[64:67], a[24:27], v[204:207]
  s_waitcnt lgkmcnt(4)
  ds_read_b64_tr_b16 a[88:89], v11 offset:24576
  ds_read_b64_tr_b16 a[90:91], v11 offset:24832
  v_mfma_f32_16x16x32_bf16 v[208:211], a[72:75], a[0:3], v[208:211]
  s_waitcnt lgkmcnt(6)
  ds_read_b64_tr_b16 a[92:93], v11 offset:28672
  ds_read_b64_tr_b16 a[94:95], v11 offset:28928
  v_mfma_f32_16x16x32_bf16 v[208:211], a[76:79], a[4:7], v[208:211]
  global_load_lds_dwordx4 v[4:5], off offset:64
  v_mfma_f32_16x16x32_bf16 v[212:215], a[76:79], a[12:15], v[212:215]
  s_add_u32 m0, s98, 81792
  v_fmac_f32 v106, v54, v34
  v_fmac_f32 v107, v54, v35
  v_fmac_f32 v108, v55, v32
  v_fmac_f32 v109, v55, v33
  v_fmac_f32 v110, v55, v34
  v_fmac_f32 v111, v55, v35
  v_mfma_f32_16x16x32_bf16 v[212:215], a[72:75], a[8:11], v[212:215]
  ds_read_b128 v[32:35], v36 offset:8880
  v_fmac_f32 v160, v52, v28
  v_mfma_f32_16x16x32_bf16 v[216:219], a[72:75], a[16:19], v[216:219]
  global_load_lds_dwordx4 v[4:5], off offset:128
  v_mfma_f32_16x16x32_bf16 v[216:219], a[76:79], a[20:23], v[216:219]
  v_fmac_f32 v161, v52, v29
  v_fmac_f32 v162, v52, v30
  v_mfma_f32_16x16x32_bf16 v[220:223], a[76:79], a[28:31], v[220:223]
  v_fmac_f32 v163, v52, v31
  v_fmac_f32 v164, v53, v28
  v_mfma_f32_16x16x32_bf16 v[220:223], a[72:75], a[24:27], v[220:223]
  s_waitcnt lgkmcnt(7)
  ds_read_b64_tr_b16 a[64:65], v12 offset:24576
  ds_read_b64_tr_b16 a[66:67], v12 offset:24832
  v_mfma_f32_16x16x32_bf16 v[64:67], a[80:83], a[32:35], v[64:67]
  s_waitcnt lgkmcnt(7)
  ds_read_b64_tr_b16 a[68:69], v12 offset:28672
  ds_read_b64_tr_b16 a[70:71], v12 offset:28928
  v_mfma_f32_16x16x32_bf16 v[64:67], a[84:87], a[36:39], v[64:67]
  s_xor_b32 m0, s49, 32768
  v_fmac_f32 v165, v53, v29
  v_fmac_f32 v166, v53, v30
  v_mfma_f32_16x16x32_bf16 v[68:71], a[84:87], a[44:47], v[68:71]
  buffer_load_dwordx4 v2, s[8:11], s44 offen lds
  v_mfma_f32_16x16x32_bf16 v[68:71], a[80:83], a[40:43], v[68:71]
  v_fmac_f32 v167, v53, v31
  v_fmac_f32 v168, v54, v28
  v_mfma_f32_16x16x32_bf16 v[72:75], a[80:83], a[48:51], v[72:75]
  v_fmac_f32 v169, v54, v29
  v_fmac_f32 v170, v54, v30
  v_mfma_f32_16x16x32_bf16 v[72:75], a[84:87], a[52:55], v[72:75]
  s_xor_b32 m0, s49, 34816
  v_fmac_f32 v171, v54, v31
  v_fmac_f32 v172, v55, v28
  v_mfma_f32_16x16x32_bf16 v[76:79], a[84:87], a[60:63], v[76:79]
  v_fmac_f32 v173, v55, v29
  v_fmac_f32 v174, v55, v30
  v_mfma_f32_16x16x32_bf16 v[76:79], a[80:83], a[56:59], v[76:79]
  s_waitcnt lgkmcnt(7)
  ds_read_b64_tr_b16 a[72:73], v13 offset:24576
  ds_read_b64_tr_b16 a[74:75], v13 offset:24832
  v_mfma_f32_16x16x32_bf16 v[80:83], a[88:91], a[32:35], v[80:83]
  s_waitcnt lgkmcnt(7)
  ds_read_b64_tr_b16 a[76:77], v13 offset:28672
  ds_read_b64_tr_b16 a[78:79], v13 offset:28928
  v_mfma_f32_16x16x32_bf16 v[80:83], a[92:95], a[36:39], v[80:83]
  buffer_load_dwordx4 v2, s[8:11], s45 offen lds
  v_mfma_f32_16x16x32_bf16 v[84:87], a[92:95], a[44:47], v[84:87]
  s_xor_b32 m0, s49, 36864
  v_fmac_f32 v175, v55, v31
  v_mfma_f32_16x16x32_bf16 v[84:87], a[88:91], a[40:43], v[84:87]
L_hop_q2:
  s_cbranch_execz L_retq1
  v_mfma_f32_16x16x32_bf16 v[88:91], a[88:91], a[48:51], v[88:91]
  buffer_load_dwordx4 v2, s[8:11], s46 offen lds
  v_mfma_f32_16x16x32_bf16 v[88:91], a[92:95], a[52:55], v[88:91]
  v_mfma_f32_16x16x32_bf16 v[92:95], a[92:95], a[60:63], v[92:95]
  v_mfma_f32_16x16x32_bf16 v[92:95], a[88:91], a[56:59], v[92:95]
  s_waitcnt lgkmcnt(6)
  ds_read_b64_tr_b16 a[80:81], v15 offset:24576
  ds_read_b64_tr_b16 a[82:83], v15 offset:24832
  v_mfma_f32_16x16x32_bf16 v[96:99], a[64:67], a[32:35], v[96:99]
  s_waitcnt lgkmcnt(6)
  ds_read_b64_tr_b16 a[84:85], v15 offset:28672
  ds_read_b64_tr_b16 a[86:87], v15 offset:28928
  v_mfma_f32_16x16x32_bf16 v[96:99], a[68:71], a[36:39], v[96:99]
  s_xor_b32 m0, s49, 38912
  ds_read_b128 v[28:31], v37 offset:8704
  v_fmac_f32 v176, v52, v32
  v_mfma_f32_16x16x32_bf16 v[100:103], a[68:71], a[44:47], v[100:103]
  buffer_load_dwordx4 v2, s[8:11], s47 offen lds
  v_mfma_f32_16x16x32_bf16 v[100:103], a[64:67], a[40:43], v[100:103]
  v_fmac_f32 v177, v52, v33
  v_fmac_f32 v178, v52, v34
  v_mfma_f32_16x16x32_bf16 v[104:107], a[64:67], a[48:51], v[104:107]
  v_fmac_f32 v179, v52, v35
  v_fmac_f32 v180, v53, v32
  v_mfma_f32_16x16x32_bf16 v[104:107], a[68:71], a[52:55], v[104:107]
  s_add_u32 m0, s99, 65536
  v_fmac_f32 v181, v53, v33
  v_fmac_f32 v182, v53, v34
  v_mfma_f32_16x16x32_bf16 v[108:111], a[68:71], a[60:63], v[108:111]
  s_waitcnt vmcnt(11)
  v_cmp_ne_u32 vcc, s61, v39
  v_fmac_f32 v183, v53, v35
  v_mfma_f32_16x16x32_bf16 v[108:111], a[64:67], a[56:59], v[108:111]
  s_waitcnt lgkmcnt(7)
  ds_read_b64_tr_b16 a[88:89], v16 offset:24576
  ds_read_b64_tr_b16 a[90:91], v16 offset:24832
  v_mfma_f32_16x16x32_bf16 v[112:115], a[72:75], a[32:35], v[112:115]
  s_waitcnt lgkmcnt(7)
  ds_read_b64_tr_b16 a[92:93], v16 offset:28672
  ds_read_b64_tr_b16 a[94:95], v16 offset:28928
  v_mfma_f32_16x16x32_bf16 v[112:115], a[76:79], a[36:39], v[112:115]
  s_cbranch_vccnz L_slow_85
L_back_86:
  global_load_lds_dwordx4 v[6:7], off offset:0
  v_mfma_f32_16x16x32_bf16 v[116:119], a[76:79], a[44:47], v[116:119]
  s_add_u32 m0, s99, 73664
  v_fmac_f32 v184, v54, v32
  v_fmac_f32 v185, v54, v33
  v_mfma_f32_16x16x32_bf16 v[116:119], a[72:75], a[40:43], v[116:119]
  s_add_u32 s23, s83, 0
  v_fmac_f32 v186, v54, v34
  v_fmac_f32 v187, v54, v35
  v_mfma_f32_16x16x32_bf16 v[120:123], a[72:75], a[48:51], v[120:123]
  global_load_lds_dwordx4 v[6:7], off offset:64
  v_mfma_f32_16x16x32_bf16 v[120:123], a[76:79], a[52:55], v[120:123]
  buffer_load_dwordx4 a[96:99], v59, s[12:15], s23 offen offset:0 sc1
  v_mfma_f32_16x16x32_bf16 v[124:127], a[76:79], a[60:63], v[124:127]
  v_fmac_f32 v188, v55, v32
  v_fmac_f32 v189, v55, v33
  v_mfma_f32_16x16x32_bf16 v[124:127], a[72:75], a[56:59], v[124:127]
  s_waitcnt lgkmcnt(7)
  ds_read_b64_tr_b16 a[64:65], v17 offset:24576
  ds_read_b64_tr_b16 a[66:67], v17 offset:24832
  v_mfma_f32_16x16x32_bf16 v[128:131], a[80:83], a[32:35], v[128:131]
  s_waitcnt lgkmcnt(7)
  ds_read_b64_tr_b16 a[68:69], v17 offset:28672
  ds_read_b64_tr_b16 a[70:71], v17 offset:28928
  v_mfma_f32_16x16x32_bf16 v[128:131], a[84:87], a[36:39], v[128:131]
  s_add_u32 m0, s99, 81792
  v_fmac_f32 v190, v55, v34
  v_fmac_f32 v191, v55, v35
  v_mfma_f32_16x16x32_bf16 v[132:135], a[84:87], a[44:47], v[132:135]
  global_load_lds_dwordx4 v[6:7], off offset:128
  v_mfma_f32_16x16x32_bf16 v[132:135], a[80:83], a[40:43], v[132:135]
  ds_read_b128 v[32:35], v36 offset:8640
  s_waitcnt lgkmcnt(9)
  v_mfma_f32_16x16x32_bf16 v[136:139], a[80:83], a[48:51], v[136:139]
  s_xor_b32 m0, s49, 33792
  v_fmac_f32 v208, v52, v28
  v_fmac_f32 v209, v52, v29
  v_mfma_f32_16x16x32_bf16 v[136:139], a[84:87], a[52:55], v[136:139]
  v_fmac_f32 v210, v52, v30
  v_fmac_f32 v211, v52, v31
  v_mfma_f32_16x16x32_bf16 v[140:143], a[84:87], a[60:63], v[140:143]
  buffer_load_dwordx4 v3, s[8:11], s44 offen lds
  v_mfma_f32_16x16x32_bf16 v[140:143], a[80:83], a[56:59], v[140:143]
  s_waitcnt lgkmcnt(7)
  ds_read_b64_tr_b16 a[72:73], v18 offset:24576
  ds_read_b64_tr_b16 a[74:75], v18 offset:24832
  v_mfma_f32_16x16x32_bf16 v[144:147], a[88:91], a[32:35], v[144:147]
  s_waitcnt lgkmcnt(7)
  ds_read_b64_tr_b16 a[76:77], v18 offset:28672
  ds_read_b64_tr_b16 a[78:79], v18 offset:28928
  v_mfma_f32_16x16x32_bf16 v[144:147], a[92:95], a[36:39], v[144:147]
  v_fmac_f32 v212, v53, v28
  v_fmac_f32 v213, v53, v29
  v_mfma_f32_16x16x32_bf16 v[148:151], a[92:95], a[44:47], v[148:151]
  s_xor_b32 m0, s49, 35840
  v_fmac_f32 v214, v53, v30
  v_fmac_f32 v215, v53, v31
  v_mfma_f32_16x16x32_bf16 v[148:151], a[88:91], a[40:43], v[148:151]
  buffer_load_dwordx4 a[100:103], v59, s[12:15], s23 offen offset:1024 sc1
  v_mfma_f32_16x16x32_bf16 v[152:155], a[88:91], a[48:51], v[152:155]
  buffer_load_dwordx4 v3, s[8:11], s45 offen lds
  v_mfma_f32_16x16x32_bf16 v[152:155], a[92:95], a[52:55], v[152:155]
  v_fmac_f32 v216, v54, v28
  v_fmac_f32 v217, v54, v29
  v_mfma_f32_16x16x32_bf16 v[156:159], a[92:95], a[60:63], v[156:159]
  v_fmac_f32 v218, v54, v30
  v_fmac_f32 v219, v54, v31
  v_mfma_f32_16x16x32_bf16 v[156:159], a[88:91], a[56:59], v[156:159]
  s_waitcnt lgkmcnt(7)
  ds_read_b64_tr_b16 a[80:81], v14 offset:24576
  ds_read_b64_tr_b16 a[82:83], v14 offset:24832
  v_mfma_f32_16x16x32_bf16 v[160:163], a[64:67], a[32:35], v[160:163]
  s_waitcnt lgkmcnt(7)
  ds_read_b64_tr_b16 a[84:85], v14 offset:28672
  ds_read_b64_tr_b16 a[86:87], v14 offset:28928
  v_mfma_f32_16x16x32_bf16 v[160:163], a[68:71], a[36:39], v[160:163]
  s_xor_b32 m0, s49, 37888
  v_fmac_f32 v220, v55, v28
  v_fmac_f32 v221, v55, v29
  v_mfma_f32_16x16x32_bf16 v[164:167], a[68:71], a[44:47], v[164:167]
  s_waitcnt vmcnt(14)
  ds_read_b128 a[0:3], v8 offset:0
  v_fmac_f32 v222, v55, v30
  v_mfma_f32_16x16x32_bf16 v[164:167], a[64:67], a[40:43], v[164:167]
  ds_read_b128 a[4:7], v9 offset:0
  v_fmac_f32 v223, v55, v31
  v_mfma_f32_16x16x32_bf16 v[168:171], a[64:67], a[48:51], v[168:171]
  ds_read_b128 a[8:11], v8 offset:2048
  v_mfma_f32_16x16x32_bf16 v[168:171], a[68:71], a[52:55], v[168:171]
  ds_read_b128 a[12:15], v9 offset:2048
  v_mfma_f32_16x16x32_bf16 v[172:175], a[68:71], a[60:63], v[172:175]
  buffer_load_dwordx4 v3, s[8:11], s46 offen lds
  v_mfma_f32_16x16x32_bf16 v[172:175], a[64:67], a[56:59], v[172:175]
  s_waitcnt lgkmcnt(10)
  ds_read_b64_tr_b16 a[88:89], v19 offset:24576
  ds_read_b64_tr_b16 a[90:91], v19 offset:24832
  v_mfma_f32_16x16x32_bf16 v[176:179], a[72:75], a[32:35], v[176:179]
  s_waitcnt lgkmcnt(10)
  ds_read_b64_tr_b16 a[92:93], v19 offset:28672
  ds_read_b64_tr_b16 a[94:95], v19 offset:28928
  v_mfma_f32_16x16x32_bf16 v[176:179], a[76:79], a[36:39], v[176:179]
  s_xor_b32 m0, s49, 39936
  v_fmac_f32 v128, v52, v32
  v_fmac_f32 v129, v52, v33
  v_mfma_f32_16x16x32_bf16 v[180:183], a[76:79], a[44:47], v[180:183]
  ds_read_b128 a[16:19], v8 offset:4096
  v_fmac_f32 v130, v52, v34
  v_mfma_f32_16x16x32_bf16 v[180:183], a[72:75], a[40:43], v[180:183]
  ds_read_b128 a[20:23], v9 offset:4096
  v_fmac_f32 v131, v52, v35
  v_mfma_f32_16x16x32_bf16 v[184:187], a[72:75], a[48:51], v[184:187]
  ds_read_b128 a[24:27], v8 offset:6144
  v_fmac_f32 v132, v53, v32
  v_mfma_f32_16x16x32_bf16 v[184:187], a[76:79], a[52:55], v[184:187]
  ds_read_b128 a[28:31], v9 offset:6144
  v_fmac_f32 v133, v53, v33
  v_mfma_f32_16x16x32_bf16 v[188:191], a[76:79], a[60:63], v[188:191]
  buffer_load_dwordx4 v3, s[8:11], s47 offen lds
  v_mfma_f32_16x16x32_bf16 v[188:191], a[72:75], a[56:59], v[188:191]
  s_waitcnt lgkmcnt(14)
  buffer_load_dwordx4 a[104:107], v59, s[12:15], s23 offen offset:2048 sc1
  v_mfma_f32_16x16x32_bf16 v[192:195], a[80:83], a[32:35], v[192:195]
  s_waitcnt lgkmcnt(12)
  buffer_load_dwordx4 a[108:111], v59, s[12:15], s23 offen offset:3072 sc1
  v_mfma_f32_16x16x32_bf16 v[192:195], a[84:87], a[36:39], v[192:195]
  s_waitcnt lgkmcnt(0)
  s_barrier
  ds_read_b64_tr_b16 a[64:65], v10 offset:49152
  v_mfma_f32_16x16x32_bf16 v[196:199], a[84:87], a[44:47], v[196:199]
  ds_read_b64_tr_b16 a[66:67], v10 offset:49408
  v_fmac_f32 v134, v53, v34
  v_mfma_f32_16x16x32_bf16 v[196:199], a[80:83], a[40:43], v[196:199]
  ds_read_b64_tr_b16 a[68:69], v10 offset:53248
  v_fmac_f32 v135, v53, v35
  v_mfma_f32_16x16x32_bf16 v[200:203], a[80:83], a[48:51], v[200:203]
  ds_read_b64_tr_b16 a[70:71], v10 offset:53504
  v_fmac_f32 v136, v54, v32
  v_mfma_f32_16x16x32_bf16 v[200:203], a[84:87], a[52:55], v[200:203]
  buffer_load_dwordx4 a[112:115], v60, s[12:15], s23 offen offset:0 sc1
  v_mfma_f32_16x16x32_bf16 v[204:207], a[84:87], a[60:63], v[204:207]
  v_fmac_f32 v137, v54, v33
  v_fmac_f32 v138, v54, v34
  v_mfma_f32_16x16x32_bf16 v[204:207], a[80:83], a[56:59], v[204:207]
  s_waitcnt lgkmcnt(4)
  ds_read_b64_tr_b16 a[72:73], v11 offset:49152
  ds_read_b64_tr_b16 a[74:75], v11 offset:49408
  v_mfma_f32_16x16x32_bf16 v[208:211], a[88:91], a[32:35], v[208:211]
  s_waitcnt lgkmcnt(6)
  ds_read_b64_tr_b16 a[76:77], v11 offset:53248
  ds_read_b64_tr_b16 a[78:79], v11 offset:53504
  v_mfma_f32_16x16x32_bf16 v[208:211], a[92:95], a[36:39], v[208:211]
  s_add_u32 s23, s83, 163840
  buffer_load_dwordx4 a[116:119], v59, s[12:15], s23 offen offset:0 sc1
  v_mfma_f32_16x16x32_bf16 v[212:215], a[92:95], a[44:47], v[212:215]
  v_fmac_f32 v139, v54, v35
  v_fmac_f32 v140, v55, v32
  v_fmac_f32 v141, v55, v33
  v_fmac_f32 v142, v55, v34
  v_fmac_f32 v143, v55, v35
  v_mfma_f32_16x16x32_bf16 v[212:215], a[88:91], a[40:43], v[212:215]
  s_mov_b32 s68, 0x358637bd
  s_mov_b32 s69, 0x358637bd
  s_lshl_b32 s64, s4, 2
  v_mfma_f32_16x16x32_bf16 v[216:219], a[88:91], a[48:51], v[216:219]
  s_add_u32 s64, s64, s3
  buffer_load_dwordx4 a[120:123], v59, s[12:15], s23 offen offset:1024 sc1
  v_mfma_f32_16x16x32_bf16 v[216:219], a[92:95], a[52:55], v[216:219]
  s_mul_i32 s64, s64, 20
  s_add_u32 s64, s64, s5
  s_lshl_b32 s64, s64, 12
  v_mfma_f32_16x16x32_bf16 v[220:223], a[92:95], a[60:63], v[220:223]
  s_add_u32 s64, s64, 15204352
  v_mfma_f32_16x16x32_bf16 v[220:223], a[88:91], a[56:59], v[220:223]
  s_waitcnt lgkmcnt(6)
  ds_read_b64_tr_b16 a[80:81], v12 offset:49152
  ds_read_b64_tr_b16 a[82:83], v12 offset:49408
  v_mfma_f32_16x16x32_bf16 v[64:67], a[64:67], a[0:3], v[64:67]
  s_waitcnt lgkmcnt(6)
  ds_read_b64_tr_b16 a[84:85], v12 offset:53248
  ds_read_b64_tr_b16 a[86:87], v12 offset:53504
  v_mfma_f32_16x16x32_bf16 v[64:67], a[68:71], a[4:7], v[64:67]
  buffer_load_dwordx4 a[124:127], v59, s[12:15], s23 offen offset:2048 sc1
  v_mfma_f32_16x16x32_bf16 v[68:71], a[68:71], a[12:15], v[68:71]
  s_waitcnt vmcnt(6)
  ds_read_b128 a[32:35], v8 offset:32768
  v_mfma_f32_16x16x32_bf16 v[68:71], a[64:67], a[8:11], v[68:71]
  ds_read_b128 a[36:39], v9 offset:32768
  v_mfma_f32_16x16x32_bf16 v[72:75], a[64:67], a[16:19], v[72:75]
  ds_read_b128 a[40:43], v8 offset:34816
  v_mfma_f32_16x16x32_bf16 v[72:75], a[68:71], a[20:23], v[72:75]
  ds_read_b128 a[44:47], v9 offset:34816
  v_mfma_f32_16x16x32_bf16 v[76:79], a[68:71], a[28:31], v[76:79]
  buffer_load_dwordx4 a[128:131], v59, s[12:15], s23 offen offset:3072 sc1
  v_mfma_f32_16x16x32_bf16 v[76:79], a[64:67], a[24:27], v[76:79]
  s_waitcnt lgkmcnt(10)
  ds_read_b64_tr_b16 a[88:89], v13 offset:49152
  ds_read_b64_tr_b16 a[90:91], v13 offset:49408
  v_mfma_f32_16x16x32_bf16 v[80:83], a[72:75], a[0:3], v[80:83]
  s_waitcnt lgkmcnt(10)
  ds_read_b64_tr_b16 a[92:93], v13 offset:53248
  ds_read_b64_tr_b16 a[94:95], v13 offset:53504
  v_mfma_f32_16x16x32_bf16 v[80:83], a[76:79], a[4:7], v[80:83]
  v_mfma_f32_16x16x32_bf16 v[84:87], a[76:79], a[12:15], v[84:87]
  ds_read_b128 a[48:51], v8 offset:36864
  v_mfma_f32_16x16x32_bf16 v[84:87], a[72:75], a[8:11], v[84:87]
  ds_read_b128 a[52:55], v9 offset:36864
  v_mfma_f32_16x16x32_bf16 v[88:91], a[72:75], a[16:19], v[88:91]
  ds_read_b128 a[56:59], v8 offset:38912
  v_mfma_f32_16x16x32_bf16 v[88:91], a[76:79], a[20:23], v[88:91]
  ds_read_b128 a[60:63], v9 offset:38912
  v_mfma_f32_16x16x32_bf16 v[92:95], a[76:79], a[28:31], v[92:95]
  buffer_load_dwordx4 a[132:135], v60, s[12:15], s23 offen offset:0 sc1
  v_mfma_f32_16x16x32_bf16 v[92:95], a[72:75], a[24:27], v[92:95]
  s_waitcnt lgkmcnt(14)
  s_add_u32 s23, s83, 327680
  v_mfma_f32_16x16x32_bf16 v[96:99], a[80:83], a[0:3], v[96:99]
  s_waitcnt lgkmcnt(12)
  buffer_load_dwordx4 a[136:139], v59, s[12:15], s23 offen offset:0 sc1
  v_mfma_f32_16x16x32_bf16 v[96:99], a[84:87], a[4:7], v[96:99]
  s_waitcnt lgkmcnt(0)
  s_barrier
  ds_read_b64_tr_b16 a[64:65], v10 offset:0
  v_mfma_f32_16x16x32_bf16 v[100:103], a[84:87], a[12:15], v[100:103]
  ds_read_b64_tr_b16 a[66:67], v10 offset:256
  v_mfma_f32_16x16x32_bf16 v[100:103], a[80:83], a[8:11], v[100:103]
  ds_read_b64_tr_b16 a[68:69], v10 offset:4096
  v_mfma_f32_16x16x32_bf16 v[104:107], a[80:83], a[16:19], v[104:107]
  ds_read_b64_tr_b16 a[70:71], v10 offset:4352
  v_mfma_f32_16x16x32_bf16 v[104:107], a[84:87], a[20:23], v[104:107]
  buffer_load_dwordx4 a[140:143], v59, s[12:15], s23 offen offset:1024 sc1
  v_mfma_f32_16x16x32_bf16 v[108:111], a[84:87], a[28:31], v[108:111]
  v_mfma_f32_16x16x32_bf16 v[108:111], a[80:83], a[24:27], v[108:111]
  s_waitcnt lgkmcnt(4)
  ds_read_b64_tr_b16 a[72:73], v15 offset:49152
  ds_read_b64_tr_b16 a[74:75], v15 offset:49408
  v_mfma_f32_16x16x32_bf16 v[112:115], a[88:91], a[0:3], v[112:115]
  s_waitcnt lgkmcnt(6)
  ds_read_b64_tr_b16 a[76:77], v15 offset:53248
  ds_read_b64_tr_b16 a[78:79], v15 offset:53504
  v_mfma_f32_16x16x32_bf16 v[112:115], a[92:95], a[4:7], v[112:115]
  buffer_load_dwordx4 a[144:147], v59, s[12:15], s23 offen offset:2048 sc1
  v_mfma_f32_16x16x32_bf16 v[116:119], a[92:95], a[12:15], v[116:119]
  v_mfma_f32_16x16x32_bf16 v[116:119], a[88:91], a[8:11], v[116:119]
  v_mfma_f32_16x16x32_bf16 v[120:123], a[88:91], a[16:19], v[120:123]
  v_mfma_f32_16x16x32_bf16 v[120:123], a[92:95], a[20:23], v[120:123]
  buffer_load_dwordx4 a[148:151], v59, s[12:15], s23 offen offset:3072 sc1
  v_mfma_f32_16x16x32_bf16 v[124:127], a[92:95], a[28:31], v[124:127]
  v_mfma_f32_16x16x32_bf16 v[124:127], a[88:91], a[24:27], v[124:127]
  s_waitcnt lgkmcnt(6)
  ds_read_b64_tr_b16 a[80:81], v11 offset:0
  ds_read_b64_tr_b16 a[82:83], v11 offset:256
  v_mfma_f32_16x16x32_bf16 v[64:67], a[64:67], a[32:35], v[64:67]
  s_waitcnt lgkmcnt(6)
  ds_read_b64_tr_b16 a[84:85], v11 offset:4096
  ds_read_b64_tr_b16 a[86:87], v11 offset:4352
  v_mfma_f32_16x16x32_bf16 v[64:67], a[68:71], a[36:39], v[64:67]
  v_mfma_f32_16x16x32_bf16 v[68:71], a[68:71], a[44:47], v[68:71]
  buffer_load_dwordx4 a[152:155], v60, s[12:15], s23 offen offset:0 sc1
  v_mfma_f32_16x16x32_bf16 v[68:71], a[64:67], a[40:43], v[68:71]
  v_mfma_f32_16x16x32_bf16 v[72:75], a[64:67], a[48:51], v[72:75]
  v_mfma_f32_16x16x32_bf16 v[72:75], a[68:71], a[52:55], v[72:75]
  s_add_u32 s23, s83, 491520
  v_mfma_f32_16x16x32_bf16 v[76:79], a[68:71], a[60:63], v[76:79]
  buffer_load_dwordx4 a[156:159], v59, s[12:15], s23 offen offset:0 sc1
  v_mfma_f32_16x16x32_bf16 v[76:79], a[64:67], a[56:59], v[76:79]
  s_waitcnt lgkmcnt(6)
  ds_read_b64_tr_b16 a[88:89], v16 offset:49152
  ds_read_b64_tr_b16 a[90:91], v16 offset:49408
  v_mfma_f32_16x16x32_bf16 v[128:131], a[72:75], a[0:3], v[128:131]
  s_waitcnt lgkmcnt(6)
  ds_read_b64_tr_b16 a[92:93], v16 offset:53248
  ds_read_b64_tr_b16 a[94:95], v16 offset:53504
  v_mfma_f32_16x16x32_bf16 v[128:131], a[76:79], a[4:7], v[128:131]
  v_mfma_f32_16x16x32_bf16 v[132:135], a[76:79], a[12:15], v[132:135]
  v_mul_f32 v40, v20, v64
  v_mul_f32 v41, v20, v65
  v_mfma_f32_16x16x32_bf16 v[132:135], a[72:75], a[8:11], v[132:135]
  buffer_load_dwordx4 a[160:163], v59, s[12:15], s23 offen offset:1024 sc1
  v_mfma_f32_16x16x32_bf16 v[136:139], a[72:75], a[16:19], v[136:139]
  v_mul_f32 v42, v20, v66
  v_mul_f32 v43, v20, v67
  v_mfma_f32_16x16x32_bf16 v[136:139], a[76:79], a[20:23], v[136:139]
  v_exp_f32 v40, v40 clamp
  v_mfma_f32_16x16x32_bf16 v[140:143], a[76:79], a[28:31], v[140:143]
  v_exp_f32 v41, v41 clamp
  v_mfma_f32_16x16x32_bf16 v[140:143], a[72:75], a[24:27], v[140:143]
  s_waitcnt lgkmcnt(6)
  ds_read_b64_tr_b16 a[64:65], v12 offset:0
  ds_read_b64_tr_b16 a[66:67], v12 offset:256
  v_mfma_f32_16x16x32_bf16 v[80:83], a[80:83], a[32:35], v[80:83]
  s_waitcnt lgkmcnt(6)
  ds_read_b64_tr_b16 a[68:69], v12 offset:4096
  ds_read_b64_tr_b16 a[70:71], v12 offset:4352
  v_mfma_f32_16x16x32_bf16 v[80:83], a[84:87], a[36:39], v[80:83]
  buffer_load_dwordx4 a[164:167], v59, s[12:15], s23 offen offset:2048 sc1
  v_mfma_f32_16x16x32_bf16 v[84:87], a[84:87], a[44:47], v[84:87]
  v_exp_f32 v42, v42 clamp
  v_mfma_f32_16x16x32_bf16 v[84:87], a[80:83], a[40:43], v[84:87]
  v_exp_f32 v43, v43 clamp
  v_mfma_f32_16x16x32_bf16 v[88:91], a[80:83], a[48:51], v[88:91]
  buffer_load_dwordx4 a[168:171], v59, s[12:15], s23 offen offset:3072 sc1
  v_mfma_f32_16x16x32_bf16 v[88:91], a[84:87], a[52:55], v[88:91]
  v_fma_f32 v64, v64, v21, s68
  v_fma_f32 v65, v65, v21, s68
  v_mfma_f32_16x16x32_bf16 v[92:95], a[84:87], a[60:63], v[92:95]
  v_fma_f32 v66, v66, v21, s68
  v_fma_f32 v67, v67, v21, s68
  v_mfma_f32_16x16x32_bf16 v[92:95], a[80:83], a[56:59], v[92:95]
  s_waitcnt lgkmcnt(6)
  ds_read_b64_tr_b16 a[72:73], v17 offset:49152
  ds_read_b64_tr_b16 a[74:75], v17 offset:49408
  v_mfma_f32_16x16x32_bf16 v[144:147], a[88:91], a[0:3], v[144:147]
  s_waitcnt lgkmcnt(6)
  ds_read_b64_tr_b16 a[76:77], v17 offset:53248
  ds_read_b64_tr_b16 a[78:79], v17 offset:53504
  v_mfma_f32_16x16x32_bf16 v[144:147], a[92:95], a[4:7], v[144:147]
  buffer_load_dwordx4 a[172:175], v60, s[12:15], s23 offen offset:0 sc1
  v_mfma_f32_16x16x32_bf16 v[148:151], a[92:95], a[12:15], v[148:151]
  v_max_f32 v64, s68, v64
  v_max_f32 v65, s68, v65
  v_mfma_f32_16x16x32_bf16 v[148:151], a[88:91], a[8:11], v[148:151]
  v_max_f32 v66, s68, v66
  v_max_f32 v67, s68, v67
  v_mfma_f32_16x16x32_bf16 v[152:155], a[88:91], a[16:19], v[152:155]
  v_add_f32 v64, v64, v40
  v_add_f32 v65, v65, v41
  v_mfma_f32_16x16x32_bf16 v[152:155], a[92:95], a[20:23], v[152:155]
  s_add_u32 s23, s83, 655360
  v_add_f32 v66, v66, v42
  v_add_f32 v67, v67, v43
  v_mfma_f32_16x16x32_bf16 v[156:159], a[92:95], a[28:31], v[156:159]
  buffer_load_dwordx4 a[176:179], v59, s[12:15], s23 offen offset:0 sc1
  v_mfma_f32_16x16x32_bf16 v[156:159], a[88:91], a[24:27], v[156:159]
  s_waitcnt lgkmcnt(6)
  ds_read_b64_tr_b16 a[80:81], v13 offset:0
  ds_read_b64_tr_b16 a[82:83], v13 offset:256
  v_mfma_f32_16x16x32_bf16 v[96:99], a[64:67], a[32:35], v[96:99]
  s_waitcnt lgkmcnt(6)
  ds_read_b64_tr_b16 a[84:85], v13 offset:4096
  ds_read_b64_tr_b16 a[86:87], v13 offset:4352
  v_mfma_f32_16x16x32_bf16 v[96:99], a[68:71], a[36:39], v[96:99]
  v_cvt_pk_bf16_f32 v64, v64, v65
  v_cvt_pk_bf16_f32 v65, v66, v67
  v_mfma_f32_16x16x32_bf16 v[100:103], a[68:71], a[44:47], v[100:103]
  buffer_load_dwordx4 a[180:183], v59, s[12:15], s23 offen offset:1024 sc1
  v_mfma_f32_16x16x32_bf16 v[100:103], a[64:67], a[40:43], v[100:103]
  v_mul_f32 v44, v22, v68
  v_mul_f32 v45, v22, v69
  v_mfma_f32_16x16x32_bf16 v[104:107], a[64:67], a[48:51], v[104:107]
  v_mul_f32 v46, v22, v70
  v_mul_f32 v47, v22, v71
  v_mfma_f32_16x16x32_bf16 v[104:107], a[68:71], a[52:55], v[104:107]
  v_exp_f32 v44, v44 clamp
  v_mfma_f32_16x16x32_bf16 v[108:111], a[68:71], a[60:63], v[108:111]
  v_exp_f32 v45, v45 clamp
  v_mfma_f32_16x16x32_bf16 v[108:111], a[64:67], a[56:59], v[108:111]
  s_waitcnt lgkmcnt(6)
  ds_read_b64_tr_b16 a[88:89], v18 offset:49152
  ds_read_b64_tr_b16 a[90:91], v18 offset:49408
  v_mfma_f32_16x16x32_bf16 v[160:163], a[72:75], a[0:3], v[160:163]
  s_waitcnt lgkmcnt(6)
  ds_read_b64_tr_b16 a[92:93], v18 offset:53248
  ds_read_b64_tr_b16 a[94:95], v18 offset:53504
  v_mfma_f32_16x16x32_bf16 v[160:163], a[76:79], a[4:7], v[160:163]
  buffer_load_dwordx4 a[184:187], v59, s[12:15], s23 offen offset:2048 sc1
  v_mfma_f32_16x16x32_bf16 v[164:167], a[76:79], a[12:15], v[164:167]
  v_exp_f32 v46, v46 clamp
  v_mfma_f32_16x16x32_bf16 v[164:167], a[72:75], a[8:11], v[164:167]
  v_exp_f32 v47, v47 clamp
  v_mfma_f32_16x16x32_bf16 v[168:171], a[72:75], a[16:19], v[168:171]
  buffer_load_dwordx4 a[188:191], v59, s[12:15], s23 offen offset:3072 sc1
  v_mfma_f32_16x16x32_bf16 v[168:171], a[76:79], a[20:23], v[168:171]
  v_fma_f32 v68, v68, v23, s68
  v_fma_f32 v69, v69, v23, s68
  v_mfma_f32_16x16x32_bf16 v[172:175], a[76:79], a[28:31], v[172:175]
  v_fma_f32 v70, v70, v23, s68
  v_fma_f32 v71, v71, v23, s68
  v_mfma_f32_16x16x32_bf16 v[172:175], a[72:75], a[24:27], v[172:175]
  s_waitcnt lgkmcnt(6)
  ds_read_b64_tr_b16 a[64:65], v15 offset:0
  ds_read_b64_tr_b16 a[66:67], v15 offset:256
  v_mfma_f32_16x16x32_bf16 v[112:115], a[80:83], a[32:35], v[112:115]
  s_waitcnt lgkmcnt(6)
  ds_read_b64_tr_b16 a[68:69], v15 offset:4096
  ds_read_b64_tr_b16 a[70:71], v15 offset:4352
  v_mfma_f32_16x16x32_bf16 v[112:115], a[84:87], a[36:39], v[112:115]
  buffer_load_dwordx4 a[192:195], v60, s[12:15], s23 offen offset:0 sc1
  v_mfma_f32_16x16x32_bf16 v[116:119], a[84:87], a[44:47], v[116:119]
  v_max_f32 v68, s68, v68
  v_max_f32 v69, s68, v69
  v_mfma_f32_16x16x32_bf16 v[116:119], a[80:83], a[40:43], v[116:119]
  v_max_f32 v70, s68, v70
  v_max_f32 v71, s68, v71
  v_mfma_f32_16x16x32_bf16 v[120:123], a[80:83], a[48:51], v[120:123]
  s_add_u32 s23, s83, 819200
  v_add_f32 v68, v68, v44
  v_add_f32 v69, v69, v45
  v_mfma_f32_16x16x32_bf16 v[120:123], a[84:87], a[52:55], v[120:123]
  buffer_load_dwordx4 a[196:199], v59, s[12:15], s23 offen offset:0 sc1
  v_mfma_f32_16x16x32_bf16 v[124:127], a[84:87], a[60:63], v[124:127]
  v_add_f32 v70, v70, v46
  v_add_f32 v71, v71, v47
  v_mfma_f32_16x16x32_bf16 v[124:127], a[80:83], a[56:59], v[124:127]
  s_waitcnt lgkmcnt(6)
  ds_read_b64_tr_b16 a[72:73], v14 offset:49152
  ds_read_b64_tr_b16 a[74:75], v14 offset:49408
  v_mfma_f32_16x16x32_bf16 v[176:179], a[88:91], a[0:3], v[176:179]
  s_waitcnt lgkmcnt(6)
  ds_read_b64_tr_b16 a[76:77], v14 offset:53248
  ds_read_b64_tr_b16 a[78:79], v14 offset:53504
  v_mfma_f32_16x16x32_bf16 v[176:179], a[92:95], a[4:7], v[176:179]
  v_cvt_pk_bf16_f32 v68, v68, v69
  v_cvt_pk_bf16_f32 v69, v70, v71
  v_mfma_f32_16x16x32_bf16 v[180:183], a[92:95], a[12:15], v[180:183]
  buffer_load_dwordx4 a[200:203], v59, s[12:15], s23 offen offset:1024 sc1
  v_mfma_f32_16x16x32_bf16 v[180:183], a[88:91], a[8:11], v[180:183]
  v_mul_f32 v40, v24, v72
  v_mul_f32 v41, v24, v73
  v_mfma_f32_16x16x32_bf16 v[184:187], a[88:91], a[16:19], v[184:187]
  v_mul_f32 v42, v24, v74
  v_mul_f32 v43, v24, v75
  v_mfma_f32_16x16x32_bf16 v[184:187], a[92:95], a[20:23], v[184:187]
  v_exp_f32 v40, v40 clamp
  v_mfma_f32_16x16x32_bf16 v[188:191], a[92:95], a[28:31], v[188:191]
  buffer_load_dwordx4 a[204:207], v59, s[12:15], s23 offen offset:2048 sc1
  v_mfma_f32_16x16x32_bf16 v[188:191], a[88:91], a[24:27], v[188:191]
  s_waitcnt lgkmcnt(6)
  ds_read_b64_tr_b16 a[80:81], v16 offset:0
  ds_read_b64_tr_b16 a[82:83], v16 offset:256
  v_mfma_f32_16x16x32_bf16 v[128:131], a[64:67], a[32:35], v[128:131]
  s_waitcnt lgkmcnt(6)
  ds_read_b64_tr_b16 a[84:85], v16 offset:4096
  ds_read_b64_tr_b16 a[86:87], v16 offset:4352
  v_mfma_f32_16x16x32_bf16 v[128:131], a[68:71], a[36:39], v[128:131]
  v_exp_f32 v41, v41 clamp
  v_mfma_f32_16x16x32_bf16 v[132:135], a[68:71], a[44:47], v[132:135]
  v_exp_f32 v42, v42 clamp
  v_mfma_f32_16x16x32_bf16 v[132:135], a[64:67], a[40:43], v[132:135]
  buffer_load_dwordx4 a[208:211], v59, s[12:15], s23 offen offset:3072 sc1
  v_mfma_f32_16x16x32_bf16 v[136:139], a[64:67], a[48:51], v[136:139]
  v_exp_f32 v43, v43 clamp
  v_mfma_f32_16x16x32_bf16 v[136:139], a[68:71], a[52:55], v[136:139]
  v_fma_f32 v72, v72, v25, s68
  v_fma_f32 v73, v73, v25, s68
  v_mfma_f32_16x16x32_bf16 v[140:143], a[68:71], a[60:63], v[140:143]
  v_fma_f32 v74, v74, v25, s68
  v_fma_f32 v75, v75, v25, s68
  v_mfma_f32_16x16x32_bf16 v[140:143], a[64:67], a[56:59], v[140:143]
  s_waitcnt lgkmcnt(6)
  ds_read_b64_tr_b16 a[88:89], v19 offset:49152
  ds_read_b64_tr_b16 a[90:91], v19 offset:49408
  v_mfma_f32_16x16x32_bf16 v[192:195], a[72:75], a[0:3], v[192:195]
  s_waitcnt lgkmcnt(6)
  ds_read_b64_tr_b16 a[92:93], v19 offset:53248
  ds_read_b64_tr_b16 a[94:95], v19 offset:53504
  v_mfma_f32_16x16x32_bf16 v[192:195], a[76:79], a[4:7], v[192:195]
  buffer_load_dwordx4 a[212:215], v60, s[12:15], s23 offen offset:0 sc1
  v_mfma_f32_16x16x32_bf16 v[196:199], a[76:79], a[12:15], v[196:199]
  v_max_f32 v72, s68, v72
  v_max_f32 v73, s68, v73
  v_mfma_f32_16x16x32_bf16 v[196:199], a[72:75], a[8:11], v[196:199]
  s_add_u32 s23, s83, 983040
  v_max_f32 v74, s68, v74
  v_max_f32 v75, s68, v75
  v_mfma_f32_16x16x32_bf16 v[200:203], a[72:75], a[16:19], v[200:203]
  buffer_load_dwordx4 a[216:219], v59, s[12:15], s23 offen offset:0 sc1
  v_mfma_f32_16x16x32_bf16 v[200:203], a[76:79], a[20:23], v[200:203]
  v_add_f32 v72, v72, v40
  v_add_f32 v73, v73, v41
  v_mfma_f32_16x16x32_bf16 v[204:207], a[76:79], a[28:31], v[204:207]
  v_add_f32 v74, v74, v42
  v_add_f32 v75, v75, v43
  v_mfma_f32_16x16x32_bf16 v[204:207], a[72:75], a[24:27], v[204:207]
  s_waitcnt lgkmcnt(6)
  ds_read_b64_tr_b16 a[64:65], v17 offset:0
  ds_read_b64_tr_b16 a[66:67], v17 offset:256
  v_mfma_f32_16x16x32_bf16 v[144:147], a[80:83], a[32:35], v[144:147]
  s_waitcnt lgkmcnt(6)
  ds_read_b64_tr_b16 a[68:69], v17 offset:4096
  ds_read_b64_tr_b16 a[70:71], v17 offset:4352
  v_mfma_f32_16x16x32_bf16 v[144:147], a[84:87], a[36:39], v[144:147]
  buffer_load_dwordx4 a[220:223], v59, s[12:15], s23 offen offset:1024 sc1
  v_mfma_f32_16x16x32_bf16 v[148:151], a[84:87], a[44:47], v[148:151]
  s_mov_b32 s62, 24117248
  buffer_load_dword v39, v38, s[12:15], s62 offen sc1
  v_mfma_f32_16x16x32_bf16 v[148:151], a[80:83], a[40:43], v[148:151]
  v_cvt_pk_bf16_f32 v72, v72, v73
  v_cvt_pk_bf16_f32 v73, v74, v75
  v_mfma_f32_16x16x32_bf16 v[152:155], a[80:83], a[48:51], v[152:155]
  v_mul_f32 v44, v26, v76
  v_mul_f32 v45, v26, v77
  v_mfma_f32_16x16x32_bf16 v[152:155], a[84:87], a[52:55], v[152:155]
  v_mul_f32 v46, v26, v78
  v_mul_f32 v47, v26, v79
  v_mfma_f32_16x16x32_bf16 v[156:159], a[84:87], a[60:63], v[156:159]
  buffer_load_dwordx4 a[224:227], v59, s[12:15], s23 offen offset:2048 sc1
  v_mfma_f32_16x16x32_bf16 v[156:159], a[80:83], a[56:59], v[156:159]
  s_waitcnt lgkmcnt(6)
  ds_read_b64_tr_b16 a[72:73], v18 offset:0
  ds_read_b64_tr_b16 a[74:75], v18 offset:256
  v_mfma_f32_16x16x32_bf16 v[208:211], a[88:91], a[0:3], v[208:211]
  s_waitcnt lgkmcnt(6)
  ds_read_b64_tr_b16 a[76:77], v18 offset:4096
  ds_read_b64_tr_b16 a[78:79], v18 offset:4352
  v_mfma_f32_16x16x32_bf16 v[208:211], a[92:95], a[4:7], v[208:211]
  v_exp_f32 v44, v44 clamp
  v_mfma_f32_16x16x32_bf16 v[212:215], a[92:95], a[12:15], v[212:215]
  buffer_load_dwordx4 a[228:231], v59, s[12:15], s23 offen offset:3072 sc1
  v_mfma_f32_16x16x32_bf16 v[212:215], a[88:91], a[8:11], v[212:215]
  v_exp_f32 v45, v45 clamp
  v_mfma_f32_16x16x32_bf16 v[216:219], a[88:91], a[16:19], v[216:219]
  v_exp_f32 v46, v46 clamp
  v_mfma_f32_16x16x32_bf16 v[216:219], a[92:95], a[20:23], v[216:219]
  v_exp_f32 v47, v47 clamp
  v_mfma_f32_16x16x32_bf16 v[220:223], a[92:95], a[28:31], v[220:223]
  v_fma_f32 v76, v76, v27, s68
  v_fma_f32 v77, v77, v27, s68
  v_mfma_f32_16x16x32_bf16 v[220:223], a[88:91], a[24:27], v[220:223]
  s_waitcnt lgkmcnt(6)
  ds_read_b64_tr_b16 a[80:81], v14 offset:0
  ds_read_b64_tr_b16 a[82:83], v14 offset:256
  v_mfma_f32_16x16x32_bf16 v[160:163], a[64:67], a[32:35], v[160:163]
  s_waitcnt lgkmcnt(6)
  ds_read_b64_tr_b16 a[84:85], v14 offset:4096
  ds_read_b64_tr_b16 a[86:87], v14 offset:4352
  v_mfma_f32_16x16x32_bf16 v[160:163], a[68:71], a[36:39], v[160:163]
  buffer_load_dwordx4 a[232:235], v60, s[12:15], s23 offen offset:0 sc1
  v_mfma_f32_16x16x32_bf16 v[164:167], a[68:71], a[44:47], v[164:167]
  v_fma_f32 v78, v78, v27, s68
  v_fma_f32 v79, v79, v27, s68
  v_mfma_f32_16x16x32_bf16 v[164:167], a[64:67], a[40:43], v[164:167]
  s_add_u32 s23, s83, 1146880
  v_max_f32 v76, s68, v76
  v_max_f32 v77, s68, v77
  v_mfma_f32_16x16x32_bf16 v[168:171], a[64:67], a[48:51], v[168:171]
  buffer_load_dwordx4 a[236:239], v59, s[12:15], s23 offen offset:0 sc1
  v_mfma_f32_16x16x32_bf16 v[168:171], a[68:71], a[52:55], v[168:171]
  v_max_f32 v78, s68, v78
  v_max_f32 v79, s68, v79
  v_mfma_f32_16x16x32_bf16 v[172:175], a[68:71], a[60:63], v[172:175]
  v_add_f32 v76, v76, v44
  v_add_f32 v77, v77, v45
  v_mfma_f32_16x16x32_bf16 v[172:175], a[64:67], a[56:59], v[172:175]
  s_waitcnt lgkmcnt(6)
  ds_read_b64_tr_b16 a[88:89], v19 offset:0
  ds_read_b64_tr_b16 a[90:91], v19 offset:256
  v_mfma_f32_16x16x32_bf16 v[176:179], a[72:75], a[32:35], v[176:179]
  s_waitcnt lgkmcnt(6)
  ds_read_b64_tr_b16 a[92:93], v19 offset:4096
  ds_read_b64_tr_b16 a[94:95], v19 offset:4352
  v_mfma_f32_16x16x32_bf16 v[176:179], a[76:79], a[36:39], v[176:179]
L_hop_q3:
  s_cbranch_execz L_retq1
  buffer_load_dwordx4 a[240:243], v59, s[12:15], s23 offen offset:1024 sc1
  v_mfma_f32_16x16x32_bf16 v[180:183], a[76:79], a[44:47], v[180:183]
  v_add_f32 v78, v78, v46
  v_add_f32 v79, v79, v47
  v_mfma_f32_16x16x32_bf16 v[180:183], a[72:75], a[40:43], v[180:183]
  v_cvt_pk_bf16_f32 v76, v76, v77
  v_cvt_pk_bf16_f32 v77, v78, v79
  v_mfma_f32_16x16x32_bf16 v[184:187], a[72:75], a[48:51], v[184:187]
  v_mul_f32 v40, v20, v80
  v_mul_f32 v41, v20, v81
  v_mfma_f32_16x16x32_bf16 v[184:187], a[76:79], a[52:55], v[184:187]
  buffer_load_dwordx4 a[244:247], v59, s[12:15], s23 offen offset:2048 sc1
  v_mfma_f32_16x16x32_bf16 v[188:191], a[76:79], a[60:63], v[188:191]
  v_mul_f32 v42, v20, v82
  v_mul_f32 v43, v20, v83
  v_mfma_f32_16x16x32_bf16 v[188:191], a[72:75], a[56:59], v[188:191]
  s_waitcnt lgkmcnt(6)
  v_exp_f32 v40, v40 clamp
  v_mfma_f32_16x16x32_bf16 v[192:195], a[80:83], a[32:35], v[192:195]
  s_waitcnt lgkmcnt(4)
  v_exp_f32 v41, v41 clamp
  v_mfma_f32_16x16x32_bf16 v[192:195], a[84:87], a[36:39], v[192:195]
  v_exp_f32 v42, v42 clamp
  v_mfma_f32_16x16x32_bf16 v[196:199], a[84:87], a[44:47], v[196:199]
  buffer_load_dwordx4 a[248:251], v59, s[12:15], s23 offen offset:3072 sc1
  v_mfma_f32_16x16x32_bf16 v[196:199], a[80:83], a[40:43], v[196:199]
  v_exp_f32 v43, v43 clamp
  v_mfma_f32_16x16x32_bf16 v[200:203], a[80:83], a[48:51], v[200:203]
  v_fma_f32 v80, v80, v21, s68
  v_fma_f32 v81, v81, v21, s68
  v_mfma_f32_16x16x32_bf16 v[200:203], a[84:87], a[52:55], v[200:203]
  v_fma_f32 v82, v82, v21, s68
  v_fma_f32 v83, v83, v21, s68
  v_mfma_f32_16x16x32_bf16 v[204:207], a[84:87], a[60:63], v[204:207]
  buffer_load_dwordx4 a[252:255], v60, s[12:15], s23 offen offset:0 sc1
  v_mfma_f32_16x16x32_bf16 v[204:207], a[80:83], a[56:59], v[204:207]
  s_waitcnt lgkmcnt(2)
  v_max_f32 v80, s68, v80
  v_max_f32 v81, s68, v81
  v_mfma_f32_16x16x32_bf16 v[208:211], a[88:91], a[32:35], v[208:211]
  s_waitcnt lgkmcnt(0)
  v_max_f32 v82, s68, v82
  v_max_f32 v83, s68, v83
  v_mfma_f32_16x16x32_bf16 v[208:211], a[92:95], a[36:39], v[208:211]
  v_add_f32 v80, v80, v40
  v_add_f32 v81, v81, v41
  v_mfma_f32_16x16x32_bf16 v[212:215], a[92:95], a[44:47], v[212:215]
  s_waitcnt vmcnt(8)
  v_cmp_ne_u32 vcc, s61, v39
  v_add_f32 v82, v82, v42
  v_mfma_f32_16x16x32_bf16 v[212:215], a[88:91], a[40:43], v[212:215]
  v_add_f32 v83, v83, v43
  v_cvt_pk_bf16_f32 v80, v80, v81
  v_mfma_f32_16x16x32_bf16 v[216:219], a[88:91], a[48:51], v[216:219]
  s_cbranch_vccnz L_slow_87
L_back_88:
  v_cvt_pk_bf16_f32 v81, v82, v83
  v_mul_f32 v44, v22, v84
  v_mfma_f32_16x16x32_bf16 v[216:219], a[92:95], a[52:55], v[216:219]
  v_mul_f32 v45, v22, v85
  v_mul_f32 v46, v22, v86
  v_mfma_f32_16x16x32_bf16 v[220:223], a[92:95], a[60:63], v[220:223]
  v_mul_f32 v47, v22, v87
  v_mfma_f32_16x16x32_bf16 v[220:223], a[88:91], a[56:59], v[220:223]
  v_exp_f32 v44, v44 clamp
  s_nop 7
  v_exp_f32 v45, v45 clamp
  v_exp_f32 v46, v46 clamp
  v_exp_f32 v47, v47 clamp
  v_fma_f32 v84, v84, v23, s68
  v_fma_f32 v85, v85, v23, s68
  v_fma_f32 v86, v86, v23, s68
  v_fma_f32 v87, v87, v23, s68
  v_max_f32 v84, s68, v84
  v_max_f32 v85, s68, v85
  v_max_f32 v86, s68, v86
  v_max_f32 v87, s68, v87
  v_add_f32 v84, v84, v44
  v_add_f32 v85, v85, v45
  v_add_f32 v86, v86, v46
  v_add_f32 v87, v87, v47
  v_cvt_pk_bf16_f32 v84, v84, v85
  v_cvt_pk_bf16_f32 v85, v86, v87
  v_pk_mul_f32 v[40:41], v[88:89], v[24:25] op_sel_hi:[1,0]
  v_pk_mul_f32 v[42:43], v[90:91], v[24:25] op_sel_hi:[1,0]
  v_exp_f32 v40, v40 clamp
  v_exp_f32 v41, v41 clamp
  v_exp_f32 v42, v42 clamp
  v_exp_f32 v43, v43 clamp
  v_pk_fma_f32 v[88:89], v[88:89], v[24:25], s[68:69] op_sel:[0,1,0] op_sel_hi:[1,1,1]
  v_pk_fma_f32 v[90:91], v[90:91], v[24:25], s[68:69] op_sel:[0,1,0] op_sel_hi:[1,1,1]
  v_max_f32 v88, s68, v88
  v_max_f32 v89, s68, v89
  v_max_f32 v90, s68, v90
  v_max_f32 v91, s68, v91
  v_pk_add_f32 v[88:89], v[88:89], v[40:41]
  v_pk_add_f32 v[90:91], v[90:91], v[42:43]
  v_cvt_pk_bf16_f32 v74, v88, v89
  v_cvt_pk_bf16_f32 v75, v90, v91
  buffer_store_dwordx4 v[72:75], v59, s[12:15], s64 offen offset:2048 sc1
  v_pk_mul_f32 v[44:45], v[92:93], v[26:27] op_sel_hi:[1,0]
  v_pk_mul_f32 v[46:47], v[94:95], v[26:27] op_sel_hi:[1,0]
  v_exp_f32 v44, v44 clamp
  v_exp_f32 v45, v45 clamp
  v_exp_f32 v46, v46 clamp
  v_exp_f32 v47, v47 clamp
  v_pk_fma_f32 v[92:93], v[92:93], v[26:27], s[68:69] op_sel:[0,1,0] op_sel_hi:[1,1,1]
  v_pk_fma_f32 v[94:95], v[94:95], v[26:27], s[68:69] op_sel:[0,1,0] op_sel_hi:[1,1,1]
  v_max_f32 v92, s68, v92
  v_max_f32 v93, s68, v93
  v_max_f32 v94, s68, v94
  v_max_f32 v95, s68, v95
  v_pk_add_f32 v[92:93], v[92:93], v[44:45]
  v_pk_add_f32 v[94:95], v[94:95], v[46:47]
  v_cvt_pk_bf16_f32 v78, v92, v93
  v_cvt_pk_bf16_f32 v79, v94, v95
  buffer_store_dwordx4 v[76:79], v59, s[12:15], s64 offen offset:3072 sc1
  s_add_u32 s64, s64, 16384
  s_add_u32 s23, s83, 1310720
  s_add_u32 m0, s48, 0
  s_nop 0
  buffer_load_dwordx4 v59, s[12:15], s23 offen offset:0 sc1 lds
  v_pk_mul_f32 v[40:41], v[96:97], v[20:21] op_sel_hi:[1,0]
  v_pk_mul_f32 v[42:43], v[98:99], v[20:21] op_sel_hi:[1,0]
  v_exp_f32 v40, v40 clamp
  v_exp_f32 v41, v41 clamp
  v_exp_f32 v42, v42 clamp
  v_exp_f32 v43, v43 clamp
  v_pk_fma_f32 v[96:97], v[96:97], v[20:21], s[68:69] op_sel:[0,1,0] op_sel_hi:[1,1,1]
  v_pk_fma_f32 v[98:99], v[98:99], v[20:21], s[68:69] op_sel:[0,1,0] op_sel_hi:[1,1,1]
  v_max_f32 v96, s68, v96
  v_max_f32 v97, s68, v97
  v_max_f32 v98, s68, v98
  v_max_f32 v99, s68, v99
  v_pk_add_f32 v[96:97], v[96:97], v[40:41]
  v_pk_add_f32 v[98:99], v[98:99], v[42:43]
  v_cvt_pk_bf16_f32 v96, v96, v97
  v_cvt_pk_bf16_f32 v97, v98, v99
  v_pk_mul_f32 v[44:45], v[100:101], v[22:23] op_sel_hi:[1,0]
  v_pk_mul_f32 v[46:47], v[102:103], v[22:23] op_sel_hi:[1,0]
  v_exp_f32 v44, v44 clamp
  v_exp_f32 v45, v45 clamp
  v_exp_f32 v46, v46 clamp
  v_exp_f32 v47, v47 clamp
  v_pk_fma_f32 v[100:101], v[100:101], v[22:23], s[68:69] op_sel:[0,1,0] op_sel_hi:[1,1,1]
  v_pk_fma_f32 v[102:103], v[102:103], v[22:23], s[68:69] op_sel:[0,1,0] op_sel_hi:[1,1,1]
  v_max_f32 v100, s68, v100
  v_max_f32 v101, s68, v101
  v_max_f32 v102, s68, v102
  v_max_f32 v103, s68, v103
  v_pk_add_f32 v[100:101], v[100:101], v[44:45]
  v_pk_add_f32 v[102:103], v[102:103], v[46:47]
  v_cvt_pk_bf16_f32 v100, v100, v101
  v_cvt_pk_bf16_f32 v101, v102, v103
  s_add_u32 m0, s48, 0
  s_nop 0
  buffer_load_dwordx4 v59, s[12:15], s23 offen offset:1024 sc1 lds
  v_pk_mul_f32 v[40:41], v[104:105], v[24:25] op_sel_hi:[1,0]
  v_pk_mul_f32 v[42:43], v[106:107], v[24:25] op_sel_hi:[1,0]
  v_exp_f32 v40, v40 clamp
  v_exp_f32 v41, v41 clamp
  v_exp_f32 v42, v42 clamp
  v_exp_f32 v43, v43 clamp
  v_pk_fma_f32 v[104:105], v[104:105], v[24:25], s[68:69] op_sel:[0,1,0] op_sel_hi:[1,1,1]
  v_pk_fma_f32 v[106:107], v[106:107], v[24:25], s[68:69] op_sel:[0,1,0] op_sel_hi:[1,1,1]
  v_max_f32 v104, s68, v104
  v_max_f32 v105, s68, v105
  v_max_f32 v106, s68, v106
  v_max_f32 v107, s68, v107
  v_pk_add_f32 v[104:105], v[104:105], v[40:41]
  v_pk_add_f32 v[106:107], v[106:107], v[42:43]
  v_cvt_pk_bf16_f32 v104, v104, v105
  v_cvt_pk_bf16_f32 v105, v106, v107
  v_pk_mul_f32 v[44:45], v[108:109], v[26:27] op_sel_hi:[1,0]
  v_pk_mul_f32 v[46:47], v[110:111], v[26:27] op_sel_hi:[1,0]
  v_exp_f32 v44, v44 clamp
  v_exp_f32 v45, v45 clamp
  v_exp_f32 v46, v46 clamp
  v_exp_f32 v47, v47 clamp
  v_pk_fma_f32 v[108:109], v[108:109], v[26:27], s[68:69] op_sel:[0,1,0] op_sel_hi:[1,1,1]
  v_pk_fma_f32 v[110:111], v[110:111], v[26:27], s[68:69] op_sel:[0,1,0] op_sel_hi:[1,1,1]
  v_max_f32 v108, s68, v108
  v_max_f32 v109, s68, v109
  v_max_f32 v110, s68, v110
  v_max_f32 v111, s68, v111
  v_pk_add_f32 v[108:109], v[108:109], v[44:45]
  v_pk_add_f32 v[110:111], v[110:111], v[46:47]
  v_cvt_pk_bf16_f32 v108, v108, v109
  v_cvt_pk_bf16_f32 v109, v110, v111
  s_add_u32 m0, s48, 0
  s_nop 0
  buffer_load_dwordx4 v59, s[12:15], s23 offen offset:2048 sc1 lds
  v_pk_mul_f32 v[40:41], v[112:113], v[20:21] op_sel_hi:[1,0]
  v_pk_mul_f32 v[42:43], v[114:115], v[20:21] op_sel_hi:[1,0]
  v_exp_f32 v40, v40 clamp
  v_exp_f32 v41, v41 clamp
  v_exp_f32 v42, v42 clamp
  v_exp_f32 v43, v43 clamp
  v_pk_fma_f32 v[112:113], v[112:113], v[20:21], s[68:69] op_sel:[0,1,0] op_sel_hi:[1,1,1]
  v_pk_fma_f32 v[114:115], v[114:115], v[20:21], s[68:69] op_sel:[0,1,0] op_sel_hi:[1,1,1]
  v_max_f32 v112, s68, v112
  v_max_f32 v113, s68, v113
  v_max_f32 v114, s68, v114
  v_max_f32 v115, s68, v115
  v_pk_add_f32 v[112:113], v[112:113], v[40:41]
  v_pk_add_f32 v[114:115], v[114:115], v[42:43]
  v_cvt_pk_bf16_f32 v112, v112, v113
  v_cvt_pk_bf16_f32 v113, v114, v115
  v_pk_mul_f32 v[44:45], v[116:117], v[22:23] op_sel_hi:[1,0]
  v_pk_mul_f32 v[46:47], v[118:119], v[22:23] op_sel_hi:[1,0]
  v_exp_f32 v44, v44 clamp
  v_exp_f32 v45, v45 clamp
  v_exp_f32 v46, v46 clamp
  v_exp_f32 v47, v47 clamp
  v_pk_fma_f32 v[116:117], v[116:117], v[22:23], s[68:69] op_sel:[0,1,0] op_sel_hi:[1,1,1]
  v_pk_fma_f32 v[118:119], v[118:119], v[22:23], s[68:69] op_sel:[0,1,0] op_sel_hi:[1,1,1]
  v_max_f32 v116, s68, v116
  v_max_f32 v117, s68, v117
  v_max_f32 v118, s68, v118
  v_max_f32 v119, s68, v119
  v_pk_add_f32 v[116:117], v[116:117], v[44:45]
  v_pk_add_f32 v[118:119], v[118:119], v[46:47]
  v_cvt_pk_bf16_f32 v116, v116, v117
  v_cvt_pk_bf16_f32 v117, v118, v119
  s_add_u32 m0, s48, 0
  s_nop 0
  buffer_load_dwordx4 v59, s[12:15], s23 offen offset:3072 sc1 lds
  v_pk_mul_f32 v[40:41], v[120:121], v[24:25] op_sel_hi:[1,0]
  v_pk_mul_f32 v[42:43], v[122:123], v[24:25] op_sel_hi:[1,0]
  v_exp_f32 v40, v40 clamp
  v_exp_f32 v41, v41 clamp
  v_exp_f32 v42, v42 clamp
  v_exp_f32 v43, v43 clamp
  v_pk_fma_f32 v[120:121], v[120:121], v[24:25], s[68:69] op_sel:[0,1,0] op_sel_hi:[1,1,1]
  v_pk_fma_f32 v[122:123], v[122:123], v[24:25], s[68:69] op_sel:[0,1,0] op_sel_hi:[1,1,1]
  v_max_f32 v120, s68, v120
  v_max_f32 v121, s68, v121
  v_max_f32 v122, s68, v122
  v_max_f32 v123, s68, v123
  v_pk_add_f32 v[120:121], v[120:121], v[40:41]
  v_pk_add_f32 v[122:123], v[122:123], v[42:43]
  v_cvt_pk_bf16_f32 v106, v120, v121
  v_cvt_pk_bf16_f32 v107, v122, v123
  buffer_store_dwordx4 v[104:107], v59, s[12:15], s64 offen offset:2048 sc1
  v_pk_mul_f32 v[44:45], v[124:125], v[26:27] op_sel_hi:[1,0]
  v_pk_mul_f32 v[46:47], v[126:127], v[26:27] op_sel_hi:[1,0]
  v_exp_f32 v44, v44 clamp
  v_exp_f32 v45, v45 clamp
  v_exp_f32 v46, v46 clamp
  v_exp_f32 v47, v47 clamp
  v_pk_fma_f32 v[124:125], v[124:125], v[26:27], s[68:69] op_sel:[0,1,0] op_sel_hi:[1,1,1]
  v_pk_fma_f32 v[126:127], v[126:127], v[26:27], s[68:69] op_sel:[0,1,0] op_sel_hi:[1,1,1]
  v_max_f32 v124, s68, v124
  v_max_f32 v125, s68, v125
  v_max_f32 v126, s68, v126
  v_max_f32 v127, s68, v127
  v_pk_add_f32 v[124:125], v[124:125], v[44:45]
  v_pk_add_f32 v[126:127], v[126:127], v[46:47]
  v_cvt_pk_bf16_f32 v110, v124, v125
  v_cvt_pk_bf16_f32 v111, v126, v127
  buffer_store_dwordx4 v[108:111], v59, s[12:15], s64 offen offset:3072 sc1
  s_add_u32 s64, s64, 16384
  s_add_u32 m0, s48, 4096
  s_nop 0
  buffer_load_dwordx4 v60, s[12:15], s23 offen offset:0 sc1 lds
  v_pk_mul_f32 v[40:41], v[128:129], v[20:21] op_sel_hi:[1,0]
  v_pk_mul_f32 v[42:43], v[130:131], v[20:21] op_sel_hi:[1,0]
  v_exp_f32 v40, v40 clamp
  v_exp_f32 v41, v41 clamp
  v_exp_f32 v42, v42 clamp
  v_exp_f32 v43, v43 clamp
  v_pk_fma_f32 v[128:129], v[128:129], v[20:21], s[68:69] op_sel:[0,1,0] op_sel_hi:[1,1,1]
  v_pk_fma_f32 v[130:131], v[130:131], v[20:21], s[68:69] op_sel:[0,1,0] op_sel_hi:[1,1,1]
  v_max_f32 v128, s68, v128
  v_max_f32 v129, s68, v129
  v_max_f32 v130, s68, v130
  v_max_f32 v131, s68, v131
  v_pk_add_f32 v[128:129], v[128:129], v[40:41]
  v_pk_add_f32 v[130:131], v[130:131], v[42:43]
  v_cvt_pk_bf16_f32 v128, v128, v129
  v_cvt_pk_bf16_f32 v129, v130, v131
  v_pk_mul_f32 v[44:45], v[132:133], v[22:23] op_sel_hi:[1,0]
  v_pk_mul_f32 v[46:47], v[134:135], v[22:23] op_sel_hi:[1,0]
  v_exp_f32 v44, v44 clamp
  v_exp_f32 v45, v45 clamp
  v_exp_f32 v46, v46 clamp
  v_exp_f32 v47, v47 clamp
  v_pk_fma_f32 v[132:133], v[132:133], v[22:23], s[68:69] op_sel:[0,1,0] op_sel_hi:[1,1,1]
  v_pk_fma_f32 v[134:135], v[134:135], v[22:23], s[68:69] op_sel:[0,1,0] op_sel_hi:[1,1,1]
  v_max_f32 v132, s68, v132
  v_max_f32 v133, s68, v133
  v_max_f32 v134, s68, v134
  v_max_f32 v135, s68, v135
  v_pk_add_f32 v[132:133], v[132:133], v[44:45]
  v_pk_add_f32 v[134:135], v[134:135], v[46:47]
  v_cvt_pk_bf16_f32 v132, v132, v133
  v_cvt_pk_bf16_f32 v133, v134, v135
  v_pk_mul_f32 v[40:41], v[136:137], v[24:25] op_sel_hi:[1,0]
  v_pk_mul_f32 v[42:43], v[138:139], v[24:25] op_sel_hi:[1,0]
  v_exp_f32 v40, v40 clamp
  v_exp_f32 v41, v41 clamp
  v_exp_f32 v42, v42 clamp
  v_exp_f32 v43, v43 clamp
  v_pk_fma_f32 v[136:137], v[136:137], v[24:25], s[68:69] op_sel:[0,1,0] op_sel_hi:[1,1,1]
  v_pk_fma_f32 v[138:139], v[138:139], v[24:25], s[68:69] op_sel:[0,1,0] op_sel_hi:[1,1,1]
  v_max_f32 v136, s68, v136
  v_max_f32 v137, s68, v137
  v_max_f32 v138, s68, v138
  v_max_f32 v139, s68, v139
  v_pk_add_f32 v[136:137], v[136:137], v[40:41]
  v_pk_add_f32 v[138:139], v[138:139], v[42:43]
  v_cvt_pk_bf16_f32 v136, v136, v137
  v_cvt_pk_bf16_f32 v137, v138, v139
  v_pk_mul_f32 v[44:45], v[140:141], v[26:27] op_sel_hi:[1,0]
  v_pk_mul_f32 v[46:47], v[142:143], v[26:27] op_sel_hi:[1,0]
  v_exp_f32 v44, v44 clamp
  v_exp_f32 v45, v45 clamp
  v_exp_f32 v46, v46 clamp
  v_exp_f32 v47, v47 clamp
  v_pk_fma_f32 v[140:141], v[140:141], v[26:27], s[68:69] op_sel:[0,1,0] op_sel_hi:[1,1,1]
  v_pk_fma_f32 v[142:143], v[142:143], v[26:27], s[68:69] op_sel:[0,1,0] op_sel_hi:[1,1,1]
  v_max_f32 v140, s68, v140
  v_max_f32 v141, s68, v141
  v_max_f32 v142, s68, v142
  v_max_f32 v143, s68, v143
  v_pk_add_f32 v[140:141], v[140:141], v[44:45]
  v_pk_add_f32 v[142:143], v[142:143], v[46:47]
  v_cvt_pk_bf16_f32 v140, v140, v141
  v_cvt_pk_bf16_f32 v141, v142, v143
  v_pk_mul_f32 v[40:41], v[144:145], v[20:21] op_sel_hi:[1,0]
  v_pk_mul_f32 v[42:43], v[146:147], v[20:21] op_sel_hi:[1,0]
  v_exp_f32 v40, v40 clamp
  v_exp_f32 v41, v41 clamp
  v_exp_f32 v42, v42 clamp
  v_exp_f32 v43, v43 clamp
  v_pk_fma_f32 v[144:145], v[144:145], v[20:21], s[68:69] op_sel:[0,1,0] op_sel_hi:[1,1,1]
  v_pk_fma_f32 v[146:147], v[146:147], v[20:21], s[68:69] op_sel:[0,1,0] op_sel_hi:[1,1,1]
  v_max_f32 v144, s68, v144
  v_max_f32 v145, s68, v145
  v_max_f32 v146, s68, v146
  v_max_f32 v147, s68, v147
  v_pk_add_f32 v[144:145], v[144:145], v[40:41]
  v_pk_add_f32 v[146:147], v[146:147], v[42:43]
  v_cvt_pk_bf16_f32 v144, v144, v145
  v_cvt_pk_bf16_f32 v145, v146, v147
  v_pk_mul_f32 v[44:45], v[148:149], v[22:23] op_sel_hi:[1,0]
  v_pk_mul_f32 v[46:47], v[150:151], v[22:23] op_sel_hi:[1,0]
  v_exp_f32 v44, v44 clamp
  v_exp_f32 v45, v45 clamp
  v_exp_f32 v46, v46 clamp
  v_exp_f32 v47, v47 clamp
  v_pk_fma_f32 v[148:149], v[148:149], v[22:23], s[68:69] op_sel:[0,1,0] op_sel_hi:[1,1,1]
  v_pk_fma_f32 v[150:151], v[150:151], v[22:23], s[68:69] op_sel:[0,1,0] op_sel_hi:[1,1,1]
  v_max_f32 v148, s68, v148
  v_max_f32 v149, s68, v149
  v_max_f32 v150, s68, v150
  v_max_f32 v151, s68, v151
  v_pk_add_f32 v[148:149], v[148:149], v[44:45]
  v_pk_add_f32 v[150:151], v[150:151], v[46:47]
  v_cvt_pk_bf16_f32 v148, v148, v149
  v_cvt_pk_bf16_f32 v149, v150, v151
  v_pk_mul_f32 v[40:41], v[152:153], v[24:25] op_sel_hi:[1,0]
  v_pk_mul_f32 v[42:43], v[154:155], v[24:25] op_sel_hi:[1,0]
  v_exp_f32 v40, v40 clamp
  v_exp_f32 v41, v41 clamp
  v_exp_f32 v42, v42 clamp
  v_exp_f32 v43, v43 clamp
  v_pk_fma_f32 v[152:153], v[152:153], v[24:25], s[68:69] op_sel:[0,1,0] op_sel_hi:[1,1,1]
  v_pk_fma_f32 v[154:155], v[154:155], v[24:25], s[68:69] op_sel:[0,1,0] op_sel_hi:[1,1,1]
  v_max_f32 v152, s68, v152
  v_max_f32 v153, s68, v153
  v_max_f32 v154, s68, v154
  v_max_f32 v155, s68, v155
  v_pk_add_f32 v[152:153], v[152:153], v[40:41]
  v_pk_add_f32 v[154:155], v[154:155], v[42:43]
  v_cvt_pk_bf16_f32 v138, v152, v153
  v_cvt_pk_bf16_f32 v139, v154, v155
  buffer_store_dwordx4 v[136:139], v59, s[12:15], s64 offen offset:2048 sc1
  v_pk_mul_f32 v[44:45], v[156:157], v[26:27] op_sel_hi:[1,0]
  v_pk_mul_f32 v[46:47], v[158:159], v[26:27] op_sel_hi:[1,0]
  v_exp_f32 v44, v44 clamp
  v_exp_f32 v45, v45 clamp
  v_exp_f32 v46, v46 clamp
  v_exp_f32 v47, v47 clamp
  v_pk_fma_f32 v[156:157], v[156:157], v[26:27], s[68:69] op_sel:[0,1,0] op_sel_hi:[1,1,1]
  v_pk_fma_f32 v[158:159], v[158:159], v[26:27], s[68:69] op_sel:[0,1,0] op_sel_hi:[1,1,1]
  v_max_f32 v156, s68, v156
  v_max_f32 v157, s68, v157
  v_max_f32 v158, s68, v158
  v_max_f32 v159, s68, v159
  v_pk_add_f32 v[156:157], v[156:157], v[44:45]
  v_pk_add_f32 v[158:159], v[158:159], v[46:47]
  v_cvt_pk_bf16_f32 v142, v156, v157
  v_cvt_pk_bf16_f32 v143, v158, v159
  buffer_store_dwordx4 v[140:143], v59, s[12:15], s64 offen offset:3072 sc1
  s_add_u32 s64, s64, 16384
  v_pk_mul_f32 v[40:41], v[160:161], v[20:21] op_sel_hi:[1,0]
  v_pk_mul_f32 v[42:43], v[162:163], v[20:21] op_sel_hi:[1,0]
  v_exp_f32 v40, v40 clamp
  v_exp_f32 v41, v41 clamp
  v_exp_f32 v42, v42 clamp
  v_exp_f32 v43, v43 clamp
  v_pk_fma_f32 v[160:161], v[160:161], v[20:21], s[68:69] op_sel:[0,1,0] op_sel_hi:[1,1,1]
  v_pk_fma_f32 v[162:163], v[162:163], v[20:21], s[68:69] op_sel:[0,1,0] op_sel_hi:[1,1,1]
  v_max_f32 v160, s68, v160
  v_max_f32 v161, s68, v161
  v_max_f32 v162, s68, v162
  v_max_f32 v163, s68, v163
  v_pk_add_f32 v[160:161], v[160:161], v[40:41]
  v_pk_add_f32 v[162:163], v[162:163], v[42:43]
  v_cvt_pk_bf16_f32 v160, v160, v161
  v_cvt_pk_bf16_f32 v161, v162, v163
  v_pk_mul_f32 v[44:45], v[164:165], v[22:23] op_sel_hi:[1,0]
  v_pk_mul_f32 v[46:47], v[166:167], v[22:23] op_sel_hi:[1,0]
  v_exp_f32 v44, v44 clamp
  v_exp_f32 v45, v45 clamp
  v_exp_f32 v46, v46 clamp
  v_exp_f32 v47, v47 clamp
  v_pk_fma_f32 v[164:165], v[164:165], v[22:23], s[68:69] op_sel:[0,1,0] op_sel_hi:[1,1,1]
  v_pk_fma_f32 v[166:167], v[166:167], v[22:23], s[68:69] op_sel:[0,1,0] op_sel_hi:[1,1,1]
  v_max_f32 v164, s68, v164
  v_max_f32 v165, s68, v165
  v_max_f32 v166, s68, v166
  v_max_f32 v167, s68, v167
  v_pk_add_f32 v[164:165], v[164:165], v[44:45]
  v_pk_add_f32 v[166:167], v[166:167], v[46:47]
  v_cvt_pk_bf16_f32 v164, v164, v165
  v_cvt_pk_bf16_f32 v165, v166, v167
  v_pk_mul_f32 v[40:41], v[168:169], v[24:25] op_sel_hi:[1,0]
  v_pk_mul_f32 v[42:43], v[170:171], v[24:25] op_sel_hi:[1,0]
  v_exp_f32 v40, v40 clamp
  v_exp_f32 v41, v41 clamp
  v_exp_f32 v42, v42 clamp
  v_exp_f32 v43, v43 clamp
  v_pk_fma_f32 v[168:169], v[168:169], v[24:25], s[68:69] op_sel:[0,1,0] op_sel_hi:[1,1,1]
  v_pk_fma_f32 v[170:171], v[170:171], v[24:25], s[68:69] op_sel:[0,1,0] op_sel_hi:[1,1,1]
  v_max_f32 v168, s68, v168
  v_max_f32 v169, s68, v169
  v_max_f32 v170, s68, v170
  v_max_f32 v171, s68, v171
  v_pk_add_f32 v[168:169], v[168:169], v[40:41]
  v_pk_add_f32 v[170:171], v[170:171], v[42:43]
  v_cvt_pk_bf16_f32 v168, v168, v169
  v_cvt_pk_bf16_f32 v169, v170, v171
  v_pk_mul_f32 v[44:45], v[172:173], v[26:27] op_sel_hi:[1,0]
  v_pk_mul_f32 v[46:47], v[174:175], v[26:27] op_sel_hi:[1,0]
  v_exp_f32 v44, v44 clamp
  v_exp_f32 v45, v45 clamp
  v_exp_f32 v46, v46 clamp
  v_exp_f32 v47, v47 clamp
  v_pk_fma_f32 v[172:173], v[172:173], v[26:27], s[68:69] op_sel:[0,1,0] op_sel_hi:[1,1,1]
  v_pk_fma_f32 v[174:175], v[174:175], v[26:27], s[68:69] op_sel:[0,1,0] op_sel_hi:[1,1,1]
  v_max_f32 v172, s68, v172
  v_max_f32 v173, s68, v173
  v_max_f32 v174, s68, v174
  v_max_f32 v175, s68, v175
  v_pk_add_f32 v[172:173], v[172:173], v[44:45]
  v_pk_add_f32 v[174:175], v[174:175], v[46:47]
  v_cvt_pk_bf16_f32 v172, v172, v173
  v_cvt_pk_bf16_f32 v173, v174, v175
  v_pk_mul_f32 v[40:41], v[176:177], v[20:21] op_sel_hi:[1,0]
  v_pk_mul_f32 v[42:43], v[178:179], v[20:21] op_sel_hi:[1,0]
  v_exp_f32 v40, v40 clamp
  v_exp_f32 v41, v41 clamp
  v_exp_f32 v42, v42 clamp
  v_exp_f32 v43, v43 clamp
  v_pk_fma_f32 v[176:177], v[176:177], v[20:21], s[68:69] op_sel:[0,1,0] op_sel_hi:[1,1,1]
  v_pk_fma_f32 v[178:179], v[178:179], v[20:21], s[68:69] op_sel:[0,1,0] op_sel_hi:[1,1,1]
  v_max_f32 v176, s68, v176
  v_max_f32 v177, s68, v177
  v_max_f32 v178, s68, v178
  v_max_f32 v179, s68, v179
  v_pk_add_f32 v[176:177], v[176:177], v[40:41]
  v_pk_add_f32 v[178:179], v[178:179], v[42:43]
  v_cvt_pk_bf16_f32 v88, v176, v177
  v_cvt_pk_bf16_f32 v89, v178, v179
  v_pk_mul_f32 v[44:45], v[180:181], v[22:23] op_sel_hi:[1,0]
  v_pk_mul_f32 v[46:47], v[182:183], v[22:23] op_sel_hi:[1,0]
  v_exp_f32 v44, v44 clamp
  v_exp_f32 v45, v45 clamp
  v_exp_f32 v46, v46 clamp
  v_exp_f32 v47, v47 clamp
  v_pk_fma_f32 v[180:181], v[180:181], v[22:23], s[68:69] op_sel:[0,1,0] op_sel_hi:[1,1,1]
  v_pk_fma_f32 v[182:183], v[182:183], v[22:23], s[68:69] op_sel:[0,1,0] op_sel_hi:[1,1,1]
  v_max_f32 v180, s68, v180
  v_max_f32 v181, s68, v181
  v_max_f32 v182, s68, v182
  v_max_f32 v183, s68, v183
  v_pk_add_f32 v[180:181], v[180:181], v[44:45]
  v_pk_add_f32 v[182:183], v[182:183], v[46:47]
  v_cvt_pk_bf16_f32 v92, v180, v181
  v_cvt_pk_bf16_f32 v93, v182, v183
  v_pk_mul_f32 v[40:41], v[184:185], v[24:25] op_sel_hi:[1,0]
  v_pk_mul_f32 v[42:43], v[186:187], v[24:25] op_sel_hi:[1,0]
  v_exp_f32 v40, v40 clamp
  v_exp_f32 v41, v41 clamp
  v_exp_f32 v42, v42 clamp
  v_exp_f32 v43, v43 clamp
  v_pk_fma_f32 v[184:185], v[184:185], v[24:25], s[68:69] op_sel:[0,1,0] op_sel_hi:[1,1,1]
  v_pk_fma_f32 v[186:187], v[186:187], v[24:25], s[68:69] op_sel:[0,1,0] op_sel_hi:[1,1,1]
  v_max_f32 v184, s68, v184
  v_max_f32 v185, s68, v185
  v_max_f32 v186, s68, v186
  v_max_f32 v187, s68, v187
  v_pk_add_f32 v[184:185], v[184:185], v[40:41]
  v_pk_add_f32 v[186:187], v[186:187], v[42:43]
  v_cvt_pk_bf16_f32 v170, v184, v185
  v_cvt_pk_bf16_f32 v171, v186, v187
  buffer_store_dwordx4 v[168:171], v59, s[12:15], s64 offen offset:2048 sc1
  v_pk_mul_f32 v[44:45], v[188:189], v[26:27] op_sel_hi:[1,0]
  v_pk_mul_f32 v[46:47], v[190:191], v[26:27] op_sel_hi:[1,0]
  v_exp_f32 v44, v44 clamp
  v_exp_f32 v45, v45 clamp
  v_exp_f32 v46, v46 clamp
  v_exp_f32 v47, v47 clamp
  v_pk_fma_f32 v[188:189], v[188:189], v[26:27], s[68:69] op_sel:[0,1,0] op_sel_hi:[1,1,1]
  v_pk_fma_f32 v[190:191], v[190:191], v[26:27], s[68:69] op_sel:[0,1,0] op_sel_hi:[1,1,1]
  v_max_f32 v188, s68, v188
  v_max_f32 v189, s68, v189
  v_max_f32 v190, s68, v190
  v_max_f32 v191, s68, v191
  v_pk_add_f32 v[188:189], v[188:189], v[44:45]
  v_pk_add_f32 v[190:191], v[190:191], v[46:47]
  v_cvt_pk_bf16_f32 v174, v188, v189
  v_cvt_pk_bf16_f32 v175, v190, v191
  buffer_store_dwordx4 v[172:175], v59, s[12:15], s64 offen offset:3072 sc1
  s_add_u32 s64, s64, 16384
  v_pk_mul_f32 v[40:41], v[192:193], v[20:21] op_sel_hi:[1,0]
  v_pk_mul_f32 v[42:43], v[194:195], v[20:21] op_sel_hi:[1,0]
  v_exp_f32 v40, v40 clamp
  v_exp_f32 v41, v41 clamp
  v_exp_f32 v42, v42 clamp
  v_exp_f32 v43, v43 clamp
  v_pk_fma_f32 v[192:193], v[192:193], v[20:21], s[68:69] op_sel:[0,1,0] op_sel_hi:[1,1,1]
  v_pk_fma_f32 v[194:195], v[194:195], v[20:21], s[68:69] op_sel:[0,1,0] op_sel_hi:[1,1,1]
  v_max_f32 v192, s68, v192
  v_max_f32 v193, s68, v193
  v_max_f32 v194, s68, v194
  v_max_f32 v195, s68, v195
  v_pk_add_f32 v[192:193], v[192:193], v[40:41]
  v_pk_add_f32 v[194:195], v[194:195], v[42:43]
  v_cvt_pk_bf16_f32 v66, v192, v193
  v_cvt_pk_bf16_f32 v67, v194, v195
  v_cvt_pk_bf16_f32 v82, v192, v193
  v_cvt_pk_bf16_f32 v83, v194, v195
  v_cvt_pk_bf16_f32 v98, v192, v193
  v_cvt_pk_bf16_f32 v99, v194, v195
  v_cvt_pk_bf16_f32 v114, v192, v193
  v_cvt_pk_bf16_f32 v115, v194, v195
  v_pk_mul_f32 v[44:45], v[196:197], v[22:23] op_sel_hi:[1,0]
  v_pk_mul_f32 v[46:47], v[198:199], v[22:23] op_sel_hi:[1,0]
  v_exp_f32 v44, v44 clamp
  v_exp_f32 v45, v45 clamp
  v_exp_f32 v46, v46 clamp
  v_exp_f32 v47, v47 clamp
  v_pk_fma_f32 v[196:197], v[196:197], v[22:23], s[68:69] op_sel:[0,1,0] op_sel_hi:[1,1,1]
  v_pk_fma_f32 v[198:199], v[198:199], v[22:23], s[68:69] op_sel:[0,1,0] op_sel_hi:[1,1,1]
  v_max_f32 v196, s68, v196
  v_max_f32 v197, s68, v197
  v_max_f32 v198, s68, v198
  v_max_f32 v199, s68, v199
  v_pk_add_f32 v[196:197], v[196:197], v[44:45]
  v_pk_add_f32 v[198:199], v[198:199], v[46:47]
  v_cvt_pk_bf16_f32 v70, v196, v197
  v_cvt_pk_bf16_f32 v71, v198, v199
  v_cvt_pk_bf16_f32 v86, v196, v197
  v_cvt_pk_bf16_f32 v87, v198, v199
  v_cvt_pk_bf16_f32 v102, v196, v197
  v_cvt_pk_bf16_f32 v103, v198, v199
  v_cvt_pk_bf16_f32 v118, v196, v197
  v_cvt_pk_bf16_f32 v119, v198, v199
  v_pk_mul_f32 v[40:41], v[200:201], v[24:25] op_sel_hi:[1,0]
  v_pk_mul_f32 v[42:43], v[202:203], v[24:25] op_sel_hi:[1,0]
  v_exp_f32 v40, v40 clamp
  v_exp_f32 v41, v41 clamp
  v_exp_f32 v42, v42 clamp
  v_exp_f32 v43, v43 clamp
  v_pk_fma_f32 v[200:201], v[200:201], v[24:25], s[68:69] op_sel:[0,1,0] op_sel_hi:[1,1,1]
  v_pk_fma_f32 v[202:203], v[202:203], v[24:25], s[68:69] op_sel:[0,1,0] op_sel_hi:[1,1,1]
  v_max_f32 v200, s68, v200
  v_max_f32 v201, s68, v201
  v_max_f32 v202, s68, v202
  v_max_f32 v203, s68, v203
  v_pk_add_f32 v[200:201], v[200:201], v[40:41]
  v_pk_add_f32 v[202:203], v[202:203], v[42:43]
  v_cvt_pk_bf16_f32 v200, v200, v201
  v_cvt_pk_bf16_f32 v201, v202, v203
  v_pk_mul_f32 v[44:45], v[204:205], v[26:27] op_sel_hi:[1,0]
  v_pk_mul_f32 v[46:47], v[206:207], v[26:27] op_sel_hi:[1,0]
  v_exp_f32 v44, v44 clamp
  v_exp_f32 v45, v45 clamp
  v_exp_f32 v46, v46 clamp
  v_exp_f32 v47, v47 clamp
  v_pk_fma_f32 v[204:205], v[204:205], v[26:27], s[68:69] op_sel:[0,1,0] op_sel_hi:[1,1,1]
  v_pk_fma_f32 v[206:207], v[206:207], v[26:27], s[68:69] op_sel:[0,1,0] op_sel_hi:[1,1,1]
  v_max_f32 v204, s68, v204
L_hop_q4:
  s_cbranch_execz L_retq2
  v_max_f32 v205, s68, v205
  v_max_f32 v206, s68, v206
  v_max_f32 v207, s68, v207
  v_pk_add_f32 v[204:205], v[204:205], v[44:45]
  v_pk_add_f32 v[206:207], v[206:207], v[46:47]
  v_cvt_pk_bf16_f32 v204, v204, v205
  v_cvt_pk_bf16_f32 v205, v206, v207
  v_pk_mul_f32 v[40:41], v[208:209], v[20:21] op_sel_hi:[1,0]
  v_pk_mul_f32 v[42:43], v[210:211], v[20:21] op_sel_hi:[1,0]
  v_exp_f32 v40, v40 clamp
  v_exp_f32 v41, v41 clamp
  v_exp_f32 v42, v42 clamp
  v_exp_f32 v43, v43 clamp
  v_pk_fma_f32 v[208:209], v[208:209], v[20:21], s[68:69] op_sel:[0,1,0] op_sel_hi:[1,1,1]
  v_pk_fma_f32 v[210:211], v[210:211], v[20:21], s[68:69] op_sel:[0,1,0] op_sel_hi:[1,1,1]
  v_max_f32 v208, s68, v208
  v_max_f32 v209, s68, v209
  v_max_f32 v210, s68, v210
  v_max_f32 v211, s68, v211
  v_pk_add_f32 v[208:209], v[208:209], v[40:41]
  v_pk_add_f32 v[210:211], v[210:211], v[42:43]
  v_cvt_pk_bf16_f32 v130, v208, v209
  v_cvt_pk_bf16_f32 v131, v210, v211
  v_cvt_pk_bf16_f32 v146, v208, v209
  v_cvt_pk_bf16_f32 v147, v210, v211
  v_cvt_pk_bf16_f32 v162, v208, v209
  v_cvt_pk_bf16_f32 v163, v210, v211
  v_cvt_pk_bf16_f32 v90, v208, v209
  v_cvt_pk_bf16_f32 v91, v210, v211
  v_pk_mul_f32 v[44:45], v[212:213], v[22:23] op_sel_hi:[1,0]
  v_pk_mul_f32 v[46:47], v[214:215], v[22:23] op_sel_hi:[1,0]
  v_exp_f32 v44, v44 clamp
  v_exp_f32 v45, v45 clamp
  v_exp_f32 v46, v46 clamp
  v_exp_f32 v47, v47 clamp
  v_pk_fma_f32 v[212:213], v[212:213], v[22:23], s[68:69] op_sel:[0,1,0] op_sel_hi:[1,1,1]
  v_pk_fma_f32 v[214:215], v[214:215], v[22:23], s[68:69] op_sel:[0,1,0] op_sel_hi:[1,1,1]
  v_max_f32 v212, s68, v212
  v_max_f32 v213, s68, v213
  v_max_f32 v214, s68, v214
  v_max_f32 v215, s68, v215
  v_pk_add_f32 v[212:213], v[212:213], v[44:45]
  v_pk_add_f32 v[214:215], v[214:215], v[46:47]
  v_cvt_pk_bf16_f32 v134, v212, v213
  v_cvt_pk_bf16_f32 v135, v214, v215
  v_cvt_pk_bf16_f32 v150, v212, v213
  v_cvt_pk_bf16_f32 v151, v214, v215
  v_cvt_pk_bf16_f32 v166, v212, v213
  v_cvt_pk_bf16_f32 v167, v214, v215
  v_cvt_pk_bf16_f32 v94, v212, v213
  v_cvt_pk_bf16_f32 v95, v214, v215
  v_pk_mul_f32 v[40:41], v[216:217], v[24:25] op_sel_hi:[1,0]
  v_pk_mul_f32 v[42:43], v[218:219], v[24:25] op_sel_hi:[1,0]
  v_exp_f32 v40, v40 clamp
  v_exp_f32 v41, v41 clamp
  v_exp_f32 v42, v42 clamp
  v_exp_f32 v43, v43 clamp
  v_pk_fma_f32 v[216:217], v[216:217], v[24:25], s[68:69] op_sel:[0,1,0] op_sel_hi:[1,1,1]
  v_pk_fma_f32 v[218:219], v[218:219], v[24:25], s[68:69] op_sel:[0,1,0] op_sel_hi:[1,1,1]
  v_max_f32 v216, s68, v216
  v_max_f32 v217, s68, v217
  v_max_f32 v218, s68, v218
  v_max_f32 v219, s68, v219
  v_pk_add_f32 v[216:217], v[216:217], v[40:41]
  v_pk_add_f32 v[218:219], v[218:219], v[42:43]
  v_cvt_pk_bf16_f32 v202, v216, v217
  v_cvt_pk_bf16_f32 v203, v218, v219
  buffer_store_dwordx4 v[200:203], v59, s[12:15], s64 offen offset:2048 sc1
  v_pk_mul_f32 v[44:45], v[220:221], v[26:27] op_sel_hi:[1,0]
  v_pk_mul_f32 v[46:47], v[222:223], v[26:27] op_sel_hi:[1,0]
  v_exp_f32 v44, v44 clamp
  v_exp_f32 v45, v45 clamp
  v_exp_f32 v46, v46 clamp
  v_exp_f32 v47, v47 clamp
  v_pk_fma_f32 v[220:221], v[220:221], v[26:27], s[68:69] op_sel:[0,1,0] op_sel_hi:[1,1,1]
  v_pk_fma_f32 v[222:223], v[222:223], v[26:27], s[68:69] op_sel:[0,1,0] op_sel_hi:[1,1,1]
  v_max_f32 v220, s68, v220
  v_max_f32 v221, s68, v221
  v_max_f32 v222, s68, v222
  v_max_f32 v223, s68, v223
  v_pk_add_f32 v[220:221], v[220:221], v[44:45]
  v_pk_add_f32 v[222:223], v[222:223], v[46:47]
  v_cvt_pk_bf16_f32 v206, v220, v221
  v_cvt_pk_bf16_f32 v207, v222, v223
  buffer_store_dwordx4 v[204:207], v59, s[12:15], s64 offen offset:3072 sc1
  s_add_u32 s64, s64, 16384
  s_mov_b32 s62, 26214400
  buffer_load_dword v39, v38, s[12:15], s62 offen sc1
  s_add_u32 s23, s83, 1474560
  s_add_u32 m0, s48, 5120
  s_nop 0
  buffer_load_dwordx4 v59, s[12:15], s23 offen offset:0 sc1 lds
  s_add_u32 m0, s48, 5120
  s_nop 0
  buffer_load_dwordx4 v59, s[12:15], s23 offen offset:1024 sc1 lds
  s_add_u32 m0, s48, 5120
  s_nop 0
  buffer_load_dwordx4 v59, s[12:15], s23 offen offset:2048 sc1 lds
  s_add_u32 m0, s48, 29696
  s_nop 0
  buffer_load_dwordx4 v59, s[12:15], s23 offen offset:3072 sc1 lds
  s_add_u32 m0, s48, 33792
  s_nop 0
  buffer_load_dwordx4 v60, s[12:15], s23 offen offset:0 sc1 lds
  s_add_u32 s23, s83, 1638400
  s_add_u32 m0, s48, 34816
  s_nop 0
  buffer_load_dwordx4 v59, s[12:15], s23 offen offset:0 sc1 lds
  s_add_u32 m0, s48, 34816
  s_nop 0
  buffer_load_dwordx4 v59, s[12:15], s23 offen offset:1024 sc1 lds
  s_add_u32 m0, s48, 34816
  s_nop 0
  buffer_load_dwordx4 v59, s[12:15], s23 offen offset:2048 sc1 lds
  s_add_u32 m0, s48, 34816
  s_nop 0
  buffer_load_dwordx4 v59, s[12:15], s23 offen offset:3072 sc1 lds
  s_add_u32 m0, s48, 38912
  s_nop 0
  buffer_load_dwordx4 v60, s[12:15], s23 offen offset:0 sc1 lds
  s_waitcnt vmcnt(10)
  s_barrier
  v_cmp_ne_u32 vcc, s61, v39
  s_mov_b32 s62, 24117248
  v_mov_b32 v39, s61
  buffer_store_dword v39, v1, s[12:15], s62 offen sc1
  s_cbranch_vccnz L_slow_89
L_back_90:
  s_add_u32 s23, s83, 1802240
  buffer_load_dwordx4 a[0:3], v59, s[12:15], s23 offen offset:0 sc1
  buffer_load_dwordx4 a[4:7], v59, s[12:15], s23 offen offset:1024 sc1
  buffer_load_dwordx4 a[8:11], v59, s[12:15], s23 offen offset:2048 sc1
  buffer_load_dwordx4 a[12:15], v59, s[12:15], s23 offen offset:3072 sc1
  buffer_load_dwordx4 a[16:19], v60, s[12:15], s23 offen offset:0 sc1
  s_add_u32 s23, s83, 1966080
  buffer_load_dwordx4 a[20:23], v59, s[12:15], s23 offen offset:0 sc1
  buffer_load_dwordx4 a[24:27], v59, s[12:15], s23 offen offset:1024 sc1
  buffer_load_dwordx4 a[28:31], v59, s[12:15], s23 offen offset:2048 sc1
  buffer_load_dwordx4 a[32:35], v59, s[12:15], s23 offen offset:3072 sc1
  buffer_load_dwordx4 a[36:39], v60, s[12:15], s23 offen offset:0 sc1
  s_and_b32 s23, s3, 2
  s_mul_i32 s23, s23, 40960
  s_sub_u32 s23, s83, s23
  s_add_u32 s23, s23, 2129920
  buffer_load_dwordx4 a[40:43], v59, s[12:15], s23 offen offset:0 sc1
  buffer_load_dwordx4 a[44:47], v59, s[12:15], s23 offen offset:1024 sc1
  buffer_load_dwordx4 a[48:51], v59, s[12:15], s23 offen offset:2048 sc1
  buffer_load_dwordx4 a[52:55], v59, s[12:15], s23 offen offset:3072 sc1
  buffer_load_dwordx4 a[56:59], v60, s[12:15], s23 offen offset:0 sc1
  s_mov_b32 s62, 28311552
  buffer_load_dword v39, v38, s[12:15], s62 offen sc1
  s_add_u32 s23, s83, 2211840
  buffer_load_dwordx4 a[60:63], v59, s[12:15], s23 offen offset:0 sc1
  buffer_load_dwordx4 a[64:67], v59, s[12:15], s23 offen offset:1024 sc1
  buffer_load_dwordx4 a[68:71], v59, s[12:15], s23 offen offset:2048 sc1
  buffer_load_dwordx4 a[72:75], v59, s[12:15], s23 offen offset:3072 sc1
  buffer_load_dwordx4 a[76:79], v60, s[12:15], s23 offen offset:0 sc1
  s_add_u32 s23, s83, 2375680
  buffer_load_dwordx4 v[176:179], v59, s[12:15], s23 offen offset:0 sc1
  buffer_load_dwordx4 v[180:183], v59, s[12:15], s23 offen offset:1024 sc1
  buffer_load_dwordx4 v[184:187], v59, s[12:15], s23 offen offset:2048 sc1
  buffer_load_dwordx4 v[188:191], v59, s[12:15], s23 offen offset:3072 sc1
  buffer_load_dwordx4 v[192:195], v60, s[12:15], s23 offen offset:0 sc1
  s_waitcnt vmcnt(10)
  v_cmp_ne_u32 vcc, s61, v39
  s_nop 1
  s_cbranch_vccnz L_slow_91
L_back_92:
  s_add_u32 s23, s83, 2539520
  buffer_load_dwordx4 v[196:199], v59, s[12:15], s23 offen offset:0 sc1
  buffer_load_dwordx4 v[200:203], v59, s[12:15], s23 offen offset:1024 sc1
  buffer_load_dwordx4 v[204:207], v59, s[12:15], s23 offen offset:2048 sc1
  buffer_load_dwordx4 v[208:211], v59, s[12:15], s23 offen offset:3072 sc1
  buffer_load_dwordx4 v[212:215], v60, s[12:15], s23 offen offset:0 sc1
  s_add_u32 s23, s83, 2703360
  buffer_load_dwordx4 v[216:219], v59, s[12:15], s23 offen offset:0 sc1
  buffer_load_dwordx4 v[220:223], v59, s[12:15], s23 offen offset:1024 sc1
  buffer_load_dwordx4 v[224:227], v59, s[12:15], s23 offen offset:2048 sc1
  buffer_load_dwordx4 v[228:231], v59, s[12:15], s23 offen offset:3072 sc1
  buffer_load_dwordx4 v[232:235], v60, s[12:15], s23 offen offset:0 sc1
  s_add_u32 s23, s83, 2867200
  buffer_load_dwordx4 v[236:239], v59, s[12:15], s23 offen offset:0 sc1
  buffer_load_dwordx4 v[240:243], v59, s[12:15], s23 offen offset:1024 sc1
  buffer_load_dwordx4 v[244:247], v59, s[12:15], s23 offen offset:2048 sc1
  buffer_load_dwordx4 v[248:251], v59, s[12:15], s23 offen offset:3072 sc1
  buffer_load_dwordx4 v[252:255], v60, s[12:15], s23 offen offset:0 sc1
  v_lshlrev_b32 v2, 3, v0
  v_add_u32 v2, 98304, v2
  v_lshrrev_b32 v12, 4, v0
  v_and_b32 v13, 15, v0
  v_lshrrev_b32 v14, 2, v13
  v_and_b32 v13, 3, v13
  v_lshlrev_b32 v15, 7, v12
  v_add_u32 v15, 98304, v15
  v_lshl_add_u32 v14, v14, 3, v15
  v_add_u32 v16, 2560, v14
  v_add_u32 v17, 3072, v15
  v_cmp_eq_u32 vcc, 0, v13
  v_mov_b32 v18, 106496
  v_mov_b32 v56, 0
  v_cndmask_b32 v7, v17, v16, vcc
  v_mov_b32 v57, 0
  v_add_u32 v19, 2048, v2
  ds_write_b64 v18, v[56:57]
  ds_write_b64 v18, v[56:57] offset:4096
  v_add_u32 v16, 3584, v14
  v_add_u32 v17, 3616, v15
  v_cmp_eq_u32 s[68:69], 0, v12
  v_cndmask_b32 v16, v17, v16, vcc
  s_nop 0
  v_cndmask_b32 v3, v18, v19, s[68:69]
  v_cndmask_b32 v8, v18, v16, s[68:69]
  v_add_u32 v16, 3616, v14
  v_add_u32 v17, 3648, v15
  v_cmp_eq_u32 s[68:69], 1, v12
  v_cndmask_b32 v16, v17, v16, vcc
  s_nop 0
  v_cndmask_b32 v4, v18, v19, s[68:69]
  v_cndmask_b32 v9, v18, v16, s[68:69]
  v_add_u32 v16, 3648, v14
  v_add_u32 v17, 3680, v15
  v_cmp_eq_u32 s[68:69], 2, v12
  v_cndmask_b32 v16, v17, v16, vcc
  s_nop 0
  v_cndmask_b32 v5, v18, v19, s[68:69]
  v_cndmask_b32 v10, v18, v16, s[68:69]
  v_add_u32 v16, 3680, v14
  v_add_u32 v17, 3584, v15
  v_cmp_eq_u32 s[68:69], 3, v12
  v_cndmask_b32 v16, v17, v16, vcc
  s_nop 0
  v_cndmask_b32 v6, v18, v19, s[68:69]
  v_cndmask_b32 v11, v18, v16, s[68:69]
  s_branch L_touch4
L_qback:
  s_lshl_b32 s64, s5, 2
  s_add_u32 s64, s64, s3
  s_lshl_b32 s64, s64, 12
  s_add_u32 s64, s64, 458752
  s_mov_b32 s70, s5
  s_mov_b32 s72, 0
  s_lshl_b32 s65, s5, 1
  s_add_u32 s65, s65, 18
  v_lshrrev_b32 v38, 3, v0
  v_bfe_u32 v39, v0, 2, 1
  v_mad_u32_u24 v38, v38, 32, v39
  v_add_lshl_u32 v38, v38, s65, 7
  s_lshl_b32 s73, s4, 2
  s_add_u32 s73, s73, s3
  s_lshl_b32 s73, s73, 4
  s_add_u32 s73, s73, s70
  s_mul_i32 s73, s73, 19456
  s_add_u32 s73, s73, 5257216
  s_lshl_b32 s75, s72, 9
  s_add_u32 s75, s75, s73
  s_sub_u32 s75, s75, 94208
  s_add_u32 s76, s75, 77824
  s_lshl_b32 s74, s72, 11
  s_add_u32 s73, s73, s74
  s_mul_i32 s66, s3, 2048
  v_add_u32 v36, s66, v2
  s_mov_b32 s66, 0x07060302
  s_add_u32 s77, s82, 4096
  s_add_u32 s78, s82, 8192
  s_xor_b32 s65, s3, 3
  s_mul_i32 s65, s65, 77824
  v_add_u32 v30, s65, v59
  s_sub_u32 s73, s73, s65
  s_add_u32 s74, s73, 77824
  s_mov_b32 s65, 26214400
  s_lshr_b32 s71, s80, 2
  s_mul_i32 s71, s71, 32
  v_lshrrev_b32 v28, 1, v0
  v_min_u32 v28, 17, v28
  s_and_b32 s62, s80, 0
  s_lshl_b32 s62, s62, 9
  s_add_u32 s62, s62, s71
  v_add_lshl_u32 v28, v28, s62, 7
  buffer_load_dword v29, v28, s[12:15], s65 offen sc1
  buffer_load_dwordx4 v[40:43], v59, s[12:15], s64 offen offset:0 sc1
  buffer_load_dwordx4 v[44:47], v59, s[12:15], s64 offen offset:1024 sc1
  buffer_load_dwordx4 v[48:51], v59, s[12:15], s64 offen offset:2048 sc1
  buffer_load_dwordx4 v[52:55], v59, s[12:15], s64 offen offset:3072 sc1
  s_waitcnt vmcnt(0)
  v_xor_b32 v37, s61, v40
  v_bitop3_b32 v37, v41, s61, v37 bitop3:0xbe
  v_bitop3_b32 v37, v42, s61, v37 bitop3:0xbe
  v_bitop3_b32 v37, v43, s61, v37 bitop3:0xbe
  v_bitop3_b32 v37, v44, s61, v37 bitop3:0xbe
  v_bitop3_b32 v37, v45, s61, v37 bitop3:0xbe
  v_bitop3_b32 v37, v46, s61, v37 bitop3:0xbe
  v_bitop3_b32 v37, v47, s61, v37 bitop3:0xbe
  v_bitop3_b32 v37, v48, s61, v37 bitop3:0xbe
  v_bitop3_b32 v37, v49, s61, v37 bitop3:0xbe
  v_bitop3_b32 v37, v50, s61, v37 bitop3:0xbe
  v_bitop3_b32 v37, v51, s61, v37 bitop3:0xbe
  v_bitop3_b32 v37, v52, s61, v37 bitop3:0xbe
  v_bitop3_b32 v37, v53, s61, v37 bitop3:0xbe
  v_bitop3_b32 v37, v54, s61, v37 bitop3:0xbe
  v_bitop3_b32 v37, v55, s61, v37 bitop3:0xbe
  v_and_b32 v37, 0xffff, v37
  v_cmp_ne_u32 vcc, 0, v37
  s_nop 1
  s_cbranch_vccnz L_slow_93
L_back_94:
  v_cmp_ne_u32 vcc, s61, v29
  v_mov_b32 v38, v28
  v_perm_b32 v40, v41, v40, s66
  v_perm_b32 v41, v43, v42, s66
  v_perm_b32 v44, v45, v44, s66
  v_perm_b32 v45, v47, v46, s66
  v_perm_b32 v48, v49, v48, s66
  v_perm_b32 v49, v51, v50, s66
  v_perm_b32 v52, v53, v52, s66
  v_perm_b32 v53, v55, v54, s66
  ds_write_b64 v36, v[40:41] offset:0
  ds_write_b64 v36, v[44:45] offset:512
  ds_write_b64 v36, v[48:49] offset:1024
  ds_write_b64 v36, v[52:53] offset:1536
  s_cbranch_vccnz L_slow_95
L_back_96:
  v_mov_b32 v28, 0
  v_mov_b32 v29, 0x358637bd
  s_add_u32 s79, s82, 12288
  s_bitcmp1_b32 s3, 0
  s_cselect_b32 s65, 1, -1
  s_mul_i32 s65, s65, 77824
  s_add_u32 s65, s65, s82
  buffer_load_dwordx4 a[80:83], v30, s[12:15], s82 offen offset:0 sc1
  buffer_load_dwordx4 a[84:87], v30, s[12:15], s82 offen offset:1024 sc1
  buffer_load_dwordx4 a[88:91], v30, s[12:15], s82 offen offset:2048 sc1
  buffer_load_dwordx4 a[92:95], v30, s[12:15], s82 offen offset:3072 sc1
  buffer_load_dwordx4 v[32:35], v30, s[12:15], s77 offen offset:0 sc1
  s_waitcnt lgkmcnt(0)
  s_barrier
  ds_read_b64 v[76:77], v7 offset:0
  ds_read_b64 v[78:79], v8 offset:0
  ds_read_b64 v[72:73], v2 offset:0
  ds_read_b64 v[74:75], v3 offset:0
  ds_read_b64 v[124:125], v7 offset:32
  ds_read_b64 v[126:127], v9 offset:0
  ds_read_b64 v[120:121], v2 offset:512
  ds_read_b64 v[122:123], v4 offset:0
  ds_read_b64 v[140:141], v7 offset:64
  ds_read_b64 v[142:143], v10 offset:0
  ds_read_b64 v[136:137], v2 offset:1024
  ds_read_b64 v[138:139], v5 offset:0
  buffer_load_dwordx4 v[36:39], v30, s[12:15], s77 offen offset:1024 sc1
  buffer_load_dwordx4 v[40:43], v30, s[12:15], s77 offen offset:2048 sc1
  buffer_load_dwordx4 v[44:47], v30, s[12:15], s77 offen offset:3072 sc1
  buffer_load_dwordx4 v[48:51], v30, s[12:15], s78 offen offset:0 sc1
  buffer_load_dwordx4 v[52:55], v30, s[12:15], s78 offen offset:1024 sc1
  buffer_load_dwordx4 v[56:59], v30, s[12:15], s78 offen offset:2048 sc1
  buffer_load_dwordx4 v[60:63], v30, s[12:15], s78 offen offset:3072 sc1
  s_waitcnt lgkmcnt(8)
  v_mfma_f32_16x16x32_bf16 v[16:19], v[76:79], v[64:67], v[28:31]
  v_mfma_f32_16x16x32_bf16 v[12:15], v[72:75], v[64:67], 0
  v_mfma_f32_16x16x32_bf16 v[24:27], v[76:79], v[68:71], v[28:31]
  v_mfma_f32_16x16x32_bf16 v[20:23], v[72:75], v[68:71], 0
  s_nop 3
  s_waitcnt lgkmcnt(4)
  v_mfma_f32_16x16x32_bf16 v[156:159], v[124:127], v[80:83], v[28:31]
  v_rcp_f32 v17, v17
  v_mfma_f32_16x16x32_bf16 v[152:155], v[120:123], v[80:83], 0
  ds_read_b64 v[76:77], v7 offset:96
  ds_read_b64 v[78:79], v11 offset:0
  ds_read_b64 v[72:73], v2 offset:1536
  ds_read_b64 v[74:75], v6 offset:0
  v_mul_f32 v168, v16, v17
  v_mul_f32 v12, v12, v17
  v_mul_f32 v13, v13, v17
  v_mul_f32 v14, v14, v17
  v_mul_f32 v15, v15, v17
  v_cvt_pk_bf16_f32 v64, v12, v13
  v_cvt_pk_bf16_f32 v65, v14, v15
  v_mfma_f32_16x16x32_bf16 v[16:19], v[124:127], v[84:87], v[28:31]
  v_rcp_f32 v25, v25
  v_mfma_f32_16x16x32_bf16 v[12:15], v[120:123], v[84:87], 0
  v_mul_f32 v172, v24, v25
  v_mul_f32 v20, v20, v25
  v_mul_f32 v21, v21, v25
  v_mul_f32 v22, v22, v25
  v_mul_f32 v23, v23, v25
  v_cvt_pk_bf16_f32 v68, v20, v21
  v_cvt_pk_bf16_f32 v69, v22, v23
  s_waitcnt lgkmcnt(4)
  v_mfma_f32_16x16x32_bf16 v[24:27], v[140:143], v[96:99], v[28:31]
  v_rcp_f32 v157, v157
  v_mfma_f32_16x16x32_bf16 v[20:23], v[136:139], v[96:99], 0
  ds_read_b64 v[124:125], v7 offset:4096
  ds_read_b64 v[126:127], v8 offset:4096
  ds_read_b64 v[120:121], v2 offset:4096
  ds_read_b64 v[122:123], v3 offset:4096
  v_mul_f32 v156, v156, v157
  v_mul_f32 v152, v152, v157
  v_mul_f32 v153, v153, v157
  v_mul_f32 v154, v154, v157
  v_mul_f32 v155, v155, v157
  v_cvt_pk_bf16_f32 v168, v168, v156
  v_cvt_pk_bf16_f32 v66, v152, v153
  v_cvt_pk_bf16_f32 v67, v154, v155
  v_mfma_f32_16x16x32_bf16 v[156:159], v[140:143], v[100:103], v[28:31]
  buffer_store_dwordx4 v[64:67], v30, s[12:15], s73 offen offset:0 sc1
  v_rcp_f32 v17, v17
  v_mfma_f32_16x16x32_bf16 v[152:155], v[136:139], v[100:103], 0
  v_mul_f32 v16, v16, v17
  v_mul_f32 v12, v12, v17
  v_mul_f32 v13, v13, v17
  v_mul_f32 v14, v14, v17
  v_mul_f32 v15, v15, v17
  v_cvt_pk_bf16_f32 v172, v172, v16
  v_cvt_pk_bf16_f32 v70, v12, v13
  v_cvt_pk_bf16_f32 v71, v14, v15
  s_waitcnt lgkmcnt(4)
  v_mfma_f32_16x16x32_bf16 v[16:19], v[76:79], v[112:115], v[28:31]
  buffer_store_dwordx4 v[68:71], v30, s[12:15], s74 offen offset:0 sc1
  v_rcp_f32 v25, v25
  v_mfma_f32_16x16x32_bf16 v[12:15], v[72:75], v[112:115], 0
  ds_read_b64 v[140:141], v7 offset:4128
  ds_read_b64 v[142:143], v9 offset:4096
  ds_read_b64 v[136:137], v2 offset:4608
  ds_read_b64 v[138:139], v4 offset:4096
  v_mul_f32 v169, v24, v25
  v_mul_f32 v20, v20, v25
  v_mul_f32 v21, v21, v25
  v_mul_f32 v22, v22, v25
  v_mul_f32 v23, v23, v25
  v_cvt_pk_bf16_f32 v96, v20, v21
  v_cvt_pk_bf16_f32 v97, v22, v23
  v_mfma_f32_16x16x32_bf16 v[24:27], v[76:79], v[116:119], v[28:31]
  v_rcp_f32 v157, v157
  v_mfma_f32_16x16x32_bf16 v[20:23], v[72:75], v[116:119], 0
  v_mul_f32 v173, v156, v157
  v_mul_f32 v152, v152, v157
  v_mul_f32 v153, v153, v157
  v_mul_f32 v154, v154, v157
  v_mul_f32 v155, v155, v157
  v_cvt_pk_bf16_f32 v100, v152, v153
  v_cvt_pk_bf16_f32 v101, v154, v155
  s_waitcnt lgkmcnt(4)
  v_mfma_f32_16x16x32_bf16 v[156:159], v[124:127], v[128:131], v[28:31]
  v_rcp_f32 v17, v17
  v_mfma_f32_16x16x32_bf16 v[152:155], v[120:123], v[128:131], 0
  ds_read_b64 v[76:77], v7 offset:4160
  ds_read_b64 v[78:79], v10 offset:4096
  ds_read_b64 v[72:73], v2 offset:5120
  ds_read_b64 v[74:75], v5 offset:4096
  v_mul_f32 v16, v16, v17
  v_mul_f32 v12, v12, v17
  v_mul_f32 v13, v13, v17
  v_mul_f32 v14, v14, v17
  v_mul_f32 v15, v15, v17
  v_cvt_pk_bf16_f32 v169, v169, v16
  v_cvt_pk_bf16_f32 v98, v12, v13
  v_cvt_pk_bf16_f32 v99, v14, v15
  v_mfma_f32_16x16x32_bf16 v[16:19], v[124:127], v[132:135], v[28:31]
  buffer_store_dwordx4 v[96:99], v30, s[12:15], s73 offen offset:1024 sc1
  v_rcp_f32 v25, v25
  v_mfma_f32_16x16x32_bf16 v[12:15], v[120:123], v[132:135], 0
  v_mul_f32 v24, v24, v25
  v_mul_f32 v20, v20, v25
  v_mul_f32 v21, v21, v25
  v_mul_f32 v22, v22, v25
  v_mul_f32 v23, v23, v25
  v_cvt_pk_bf16_f32 v173, v173, v24
  v_cvt_pk_bf16_f32 v102, v20, v21
  v_cvt_pk_bf16_f32 v103, v22, v23
  s_waitcnt lgkmcnt(4)
  v_mfma_f32_16x16x32_bf16 v[24:27], v[140:143], v[144:147], v[28:31]
  buffer_store_dwordx4 v[100:103], v30, s[12:15], s74 offen offset:1024 sc1
  v_rcp_f32 v157, v157
  v_mfma_f32_16x16x32_bf16 v[20:23], v[136:139], v[144:147], 0
  ds_read_b64 v[124:125], v7 offset:4192
  ds_read_b64 v[126:127], v11 offset:4096
  ds_read_b64 v[120:121], v2 offset:5632
  ds_read_b64 v[122:123], v6 offset:4096
  v_mul_f32 v170, v156, v157
  v_mul_f32 v152, v152, v157
  v_mul_f32 v153, v153, v157
  v_mul_f32 v154, v154, v157
  v_mul_f32 v155, v155, v157
  v_cvt_pk_bf16_f32 v128, v152, v153
  v_cvt_pk_bf16_f32 v129, v154, v155
  v_mfma_f32_16x16x32_bf16 v[156:159], v[140:143], v[148:151], v[28:31]
  v_rcp_f32 v17, v17
  v_mfma_f32_16x16x32_bf16 v[152:155], v[136:139], v[148:151], 0
  v_mul_f32 v174, v16, v17
  v_mul_f32 v12, v12, v17
  v_mul_f32 v13, v13, v17
  v_mul_f32 v14, v14, v17
  v_mul_f32 v15, v15, v17
  v_cvt_pk_bf16_f32 v132, v12, v13
  v_cvt_pk_bf16_f32 v133, v14, v15
  s_waitcnt lgkmcnt(4)
  v_mfma_f32_16x16x32_bf16 v[16:19], v[76:79], v[160:163], v[28:31]
  v_rcp_f32 v25, v25
  v_mfma_f32_16x16x32_bf16 v[12:15], v[72:75], v[160:163], 0
  v_mul_f32 v24, v24, v25
  v_mul_f32 v20, v20, v25
  v_mul_f32 v21, v21, v25
  v_mul_f32 v22, v22, v25
  v_mul_f32 v23, v23, v25
  v_cvt_pk_bf16_f32 v170, v170, v24
  v_cvt_pk_bf16_f32 v130, v20, v21
  v_cvt_pk_bf16_f32 v131, v22, v23
  v_mfma_f32_16x16x32_bf16 v[24:27], v[76:79], v[164:167], v[28:31]
  buffer_store_dwordx4 v[128:131], v30, s[12:15], s73 offen offset:2048 sc1
  v_rcp_f32 v157, v157
  v_mfma_f32_16x16x32_bf16 v[20:23], v[72:75], v[164:167], 0
  v_mul_f32 v156, v156, v157
  v_mul_f32 v152, v152, v157
  v_mul_f32 v153, v153, v157
  v_mul_f32 v154, v154, v157
  v_mul_f32 v155, v155, v157
  v_cvt_pk_bf16_f32 v174, v174, v156
  v_cvt_pk_bf16_f32 v134, v152, v153
  v_cvt_pk_bf16_f32 v135, v154, v155
  s_waitcnt lgkmcnt(0)
  v_mfma_f32_16x16x32_bf16 v[156:159], v[124:127], v[88:91], v[28:31]
  buffer_store_dwordx4 v[132:135], v30, s[12:15], s74 offen offset:2048 sc1
  v_rcp_f32 v17, v17
  v_mfma_f32_16x16x32_bf16 v[152:155], v[120:123], v[88:91], 0
  v_mul_f32 v171, v16, v17
  v_mul_f32 v12, v12, v17
  v_mul_f32 v13, v13, v17
  v_mul_f32 v14, v14, v17
  v_mul_f32 v15, v15, v17
  v_cvt_pk_bf16_f32 v160, v12, v13
  v_cvt_pk_bf16_f32 v161, v14, v15
  v_mfma_f32_16x16x32_bf16 v[16:19], v[124:127], v[92:95], v[28:31]
  v_rcp_f32 v25, v25
  v_mfma_f32_16x16x32_bf16 v[12:15], v[120:123], v[92:95], 0
  v_mul_f32 v175, v24, v25
  v_mul_f32 v20, v20, v25
  v_mul_f32 v21, v21, v25
  v_mul_f32 v22, v22, v25
  v_mul_f32 v23, v23, v25
  v_cvt_pk_bf16_f32 v164, v20, v21
  v_cvt_pk_bf16_f32 v165, v22, v23
  s_nop 0
  v_rcp_f32 v157, v157
  s_nop 0
  v_mul_f32 v156, v156, v157
  v_mul_f32 v152, v152, v157
  v_mul_f32 v153, v153, v157
  v_mul_f32 v154, v154, v157
  v_mul_f32 v155, v155, v157
  v_cvt_pk_bf16_f32 v171, v171, v156
  v_cvt_pk_bf16_f32 v162, v152, v153
  v_cvt_pk_bf16_f32 v163, v154, v155
  s_nop 0
  buffer_store_dwordx4 v[160:163], v30, s[12:15], s73 offen offset:3072 sc1
  v_rcp_f32 v17, v17
  s_nop 0
  v_mul_f32 v16, v16, v17
  v_mul_f32 v12, v12, v17
  v_mul_f32 v13, v13, v17
  v_mul_f32 v14, v14, v17
  v_mul_f32 v15, v15, v17
  v_cvt_pk_bf16_f32 v175, v175, v16
  v_cvt_pk_bf16_f32 v166, v12, v13
  v_cvt_pk_bf16_f32 v167, v14, v15
  buffer_store_dwordx4 v[164:167], v30, s[12:15], s74 offen offset:3072 sc1
  buffer_store_dwordx2 v[168:169], v2, s[12:15], s75 offen offset:0 sc1
  buffer_store_dwordx2 v[170:171], v2, s[12:15], s75 offen offset:512 sc1
  buffer_store_dwordx2 v[172:173], v2, s[12:15], s76 offen offset:0 sc1
  buffer_store_dwordx2 v[174:175], v2, s[12:15], s76 offen offset:512 sc1
  s_waitcnt vmcnt(12)
  s_branch L_p2c
L_slow_83:
  s_mov_b32 s59, 131072
  s_branch L_first_98
L_spin_97:
  s_sleep 2
L_first_98:
  buffer_load_dwordx4 v[40:43], v38, s[12:15], s64 offen sc1
  buffer_load_dwordx4 v[44:47], v38, s[12:15], s65 offen sc1
  buffer_load_dwordx2 v[48:49], v62, s[12:15], s66 offen sc1
  s_waitcnt vmcnt(0)
  v_xor_b32 v39, s61, v43
  v_bitop3_b32 v39, v47, s61, v39 bitop3:0xbe
  v_bitop3_b32 v39, v49, s61, v39 bitop3:0xbe
  v_cmp_ne_u32 vcc, 0, v39
  s_sub_u32 s59, s59, 1
  s_cbranch_scc1 L_back_84
  s_cbranch_vccnz L_spin_97
  s_branch L_back_84
L_slow_85:
  s_mov_b32 s59, 131072
  s_branch L_first_100
L_spin_99:
  s_sleep 2
L_first_100:
  s_mov_b32 s62, 22020096
  buffer_load_dword v39, v38, s[12:15], s62 offen sc1
  s_waitcnt vmcnt(0)
  v_cmp_ne_u32 vcc, s61, v39
  s_sub_u32 s59, s59, 1
  s_cbranch_scc1 L_back_86
  s_cbranch_vccnz L_spin_99
  s_branch L_back_86
L_slow_87:
  s_mov_b32 s59, 131072
  s_branch L_first_102
L_spin_101:
  s_sleep 2
L_first_102:
  s_mov_b32 s62, 24117248
  buffer_load_dword v39, v38, s[12:15], s62 offen sc1
  s_waitcnt vmcnt(0)
  v_cmp_ne_u32 vcc, s61, v39
  s_sub_u32 s59, s59, 1
  s_cbranch_scc1 L_back_88
  s_cbranch_vccnz L_spin_101
  s_branch L_back_88
L_slow_89:
  s_mov_b32 s59, 131072
  s_branch L_first_104
L_spin_103:
  s_sleep 2
L_first_104:
  s_mov_b32 s62, 26214400
  buffer_load_dword v39, v38, s[12:15], s62 offen sc1
  s_waitcnt vmcnt(0)
  v_cmp_ne_u32 vcc, s61, v39
  s_sub_u32 s59, s59, 1
  s_cbranch_scc1 L_back_90
  s_cbranch_vccnz L_spin_103
  s_branch L_back_90
L_slow_91:
  s_mov_b32 s59, 131072
  s_branch L_first_106
L_spin_105:
  s_sleep 2
L_first_106:
  s_mov_b32 s62, 28311552
  buffer_load_dword v39, v38, s[12:15], s62 offen sc1
  s_waitcnt vmcnt(0)
  v_cmp_ne_u32 vcc, s61, v39
  s_sub_u32 s59, s59, 1
  s_cbranch_scc1 L_back_92
  s_cbranch_vccnz L_spin_105
  s_branch L_back_92
L_slow_93:
  s_mov_b32 s79, 64
  s_branch L_first_108
L_spin_107:
  s_sleep 2
L_first_108:
  s_mov_b32 s59, 131072
  s_branch L_first_111
L_spin_109:
  s_sleep 2
L_first_111:
  s_mov_b32 s62, 22020096
  buffer_load_dword v39, v38, s[12:15], s62 offen sc1
  s_waitcnt vmcnt(0)
  v_cmp_ne_u32 vcc, s61, v39
  s_sub_u32 s59, s59, 1
  s_cbranch_scc1 L_spun_110
  s_cbranch_vccnz L_spin_109
L_spun_110:
  buffer_load_dword v29, v28, s[12:15], s65 offen sc1
  buffer_load_dwordx4 v[40:43], v59, s[12:15], s64 offen offset:0 sc1
  buffer_load_dwordx4 v[44:47], v59, s[12:15], s64 offen offset:1024 sc1
  buffer_load_dwordx4 v[48:51], v59, s[12:15], s64 offen offset:2048 sc1
  buffer_load_dwordx4 v[52:55], v59, s[12:15], s64 offen offset:3072 sc1
  s_waitcnt vmcnt(0)
  v_xor_b32 v37, s61, v40
  v_bitop3_b32 v37, v41, s61, v37 bitop3:0xbe
  v_bitop3_b32 v37, v42, s61, v37 bitop3:0xbe
  v_bitop3_b32 v37, v43, s61, v37 bitop3:0xbe
  v_bitop3_b32 v37, v44, s61, v37 bitop3:0xbe
  v_bitop3_b32 v37, v45, s61, v37 bitop3:0xbe
  v_bitop3_b32 v37, v46, s61, v37 bitop3:0xbe
  v_bitop3_b32 v37, v47, s61, v37 bitop3:0xbe
  v_bitop3_b32 v37, v48, s61, v37 bitop3:0xbe
  v_bitop3_b32 v37, v49, s61, v37 bitop3:0xbe
  v_bitop3_b32 v37, v50, s61, v37 bitop3:0xbe
  v_bitop3_b32 v37, v51, s61, v37 bitop3:0xbe
  v_bitop3_b32 v37, v52, s61, v37 bitop3:0xbe
  v_bitop3_b32 v37, v53, s61, v37 bitop3:0xbe
  v_bitop3_b32 v37, v54, s61, v37 bitop3:0xbe
  v_bitop3_b32 v37, v55, s61, v37 bitop3:0xbe
  v_and_b32 v37, 0xffff, v37
  v_cmp_ne_u32 vcc, 0, v37
  s_sub_u32 s79, s79, 1
  s_cbranch_scc1 L_back_94
  s_cbranch_vccnz L_spin_107
  s_branch L_back_94
L_slow_95:
  s_mov_b32 s59, 131072
  s_branch L_first_113
L_spin_112:
  s_sleep 2
L_first_113:
  s_mov_b32 s62, 26214400
  buffer_load_dword v39, v38, s[12:15], s62 offen sc1
  s_waitcnt vmcnt(0)
  v_cmp_ne_u32 vcc, s61, v39
  s_sub_u32 s59, s59, 1
  s_cbranch_scc1 L_back_96
  s_cbranch_vccnz L_spin_112
  s_branch L_back_96
L_end:
  s_endpgm
.section .rodata,"a"
.p2align 6
.amdhsa_kernel recurrent_scan__linear_attn_block__swiglu_ffn__prompt_kernel
  .amdhsa_next_free_vgpr 512
  .amdhsa_next_free_sgpr 102
  .amdhsa_accum_offset 256
  .amdhsa_group_segment_fixed_size 0
  .amdhsa_kernarg_size 80
  .amdhsa_user_sgpr_count 2
  .amdhsa_user_sgpr_kernarg_segment_ptr 1
  .amdhsa_system_sgpr_workgroup_id_x 1
.end_amdhsa_kernel
```
